```python
import torch

def _softmax(x, axis=-1):
    return torch.softmax(x, dim=axis)

def _gelu(x):
    return torch.nn.functional.gelu(x, approximate='tanh')

def _silu(x):
    return torch.nn.functional.silu(x)

def _sigmoid(x):
    return torch.sigmoid(x)

def _layernorm(x, axis=-1, eps=1e-05):
    m = x.mean(dim=axis, keepdim=True)
    v = x.var(dim=axis, keepdim=True, unbiased=False)
    return (x - m) / torch.sqrt(v + eps)

def _scatter_add(tgt, idx, src, axis=0):
    return tgt.clone().index_add_(axis, idx, src)

def _segment_sum(src, seg, n):
    out = torch.zeros((n,) + src.shape[1:], dtype=src.dtype)
    return out.index_add_(0, seg, src)

def _pad(x, pw):
    flat = tuple((v for pair in reversed(pw) for v in pair))
    return torch.nn.functional.pad(x, flat)
kernel_name = 'sequential_preLN__spectral_gfnet__mixer_gmlp__prompt'

def setup_inputs():

    _w = lambda a: (lambda t: t.to(torch.bfloat16) if t.is_floating_point() else t)(torch.as_tensor(a))

    def _A_setup():
        B, S, D = (1, 2048, 1024)
        Df = D // 2 + 1
        return {'x': _w((lambda *s: torch.randn(*s, dtype=torch.bfloat16) * 0.05)(B, S, D)), 'w_r': _w((lambda *s: torch.randn(*s, dtype=torch.bfloat16) * 0.4)(S, Df) * 0.02), 'w_i': _w((lambda *s: torch.randn(*s, dtype=torch.bfloat16) * 0.4)(S, Df) * 0.02)}
    _A_in = _A_setup()

    def _B_setup():
        B, S, D, F = (1, 2048, 1024, 3584)
        Fh = F // 2
        return {'x': _w((lambda *s: torch.randn(*s, dtype=torch.bfloat16) * 0.05)(B, S, D)), 'w_in': _w((lambda *s: torch.randn(*s, dtype=torch.bfloat16) * 0.4)(D, 2 * Fh)), 'w_sp': _w(0.01 * (lambda *s: torch.randn(*s, dtype=torch.bfloat16) * 0.4)(S, S)), 'b_sp': _w(1.0 + 0.01 * (lambda *s: torch.randn(*s, dtype=torch.bfloat16) * 0.05)(S)), 'w_out': _w((lambda *s: torch.randn(*s, dtype=torch.bfloat16) * 0.05)(Fh, D))}
    _B_in = _B_setup()
    return {'A_x': _A_in['x'], 'A_w_r': _A_in['w_r'], 'A_w_i': _A_in['w_i'], 'B_x': _B_in['x'], 'B_w_in': _B_in['w_in'], 'B_w_sp': _B_in['w_sp'], 'B_b_sp': _B_in['b_sp'], 'B_w_out': _B_in['w_out']}

def reference(A_x, A_w_r, A_w_i, B_x, B_w_in, B_w_sp, B_b_sp, B_w_out):

    def _A_ref(x, w_r, w_i):
        B, S, D = x.shape
        X = (lambda x, axes=(-2, -1): torch.fft.rfft2(x.float(), dim=axes))(x, axes=(-2, -1))
        W = w_r + 1j * w_i
        X = X * W
        y = (lambda x, s, axes=(-2, -1): torch.fft.irfft2(x, s=s, dim=axes).to(torch.bfloat16))(X, (S, D), axes=(-2, -1))
        return y

    def _B_ref(x, w_in, w_sp, b_sp, w_out):
        B, S, D = x.shape
        F = w_in.shape[-1]
        Fh = F // 2
        z = _gelu(torch.einsum('bsd,df->bsf', x, w_in))
        z1 = z[..., :Fh].clone()
        z2 = _layernorm(z[..., Fh:], axis=-1)
        g = torch.einsum('ts,bsf->btf', w_sp, z2) + b_sp[None, :, None]
        return torch.einsum('bsf,fd->bsd', z1 * g, w_out)
    x = A_x
    h = x + _A_ref(_layernorm(x, axis=-1), A_w_r, A_w_i)
    h2 = h + _B_ref(_layernorm(h, axis=-1), B_w_in, B_w_sp, B_b_sp, B_w_out)
    return h2
```

```asm
; @launch kernel=k1_kernel grid=(512,1,1) block=(256,1,1) lds=33280
; @launch kernel=k2_kernel grid=(512,1,1) block=(256,1,1) lds=32768
; @launch kernel=k3_kernel grid=(512,1,1) block=(256,1,1) lds=16384
; @launch kernel=kg_kernel grid=(256,1,1) block=(512,1,1) lds=155648
.amdgcn_target "amdgcn-amd-amdhsa--gfx950"
.text
.globl k1_kernel
.p2align 8
.type k1_kernel,@function
k1_kernel:
  s_cmp_lt_u32 s2, 256
  s_cbranch_scc1 L_k1_p1
  s_cmp_lt_u32 s2, 512
  s_cbranch_scc1 L_k1_wp
  s_endpgm
L_k1_wp:
  s_load_dwordx4 s[4:7], s[0:1], 8
  s_load_dwordx2 s[22:23], s[0:1], 80
  v_and_b32 v1, 63, v0
  v_lshrrev_b32 v2, 6, v0
  s_nop 0
  v_readfirstlane_b32 s20, v2
  s_sub_u32 s21, s2, 256
  s_and_b32 s28, s21, 3
  s_lshr_b32 s21, s21, 2
  s_lshl_b32 s24, s21, 5
  s_lshl_b32 s25, s28, 8
  s_movk_i32 s26, 3641
  s_movk_i32 s27, 1026
  s_add_u32 s29, s20, 0
  s_lshl_b32 s30, s29, 6
  v_add_u32 v3, s30, v1
  v_mul_lo_u32 v4, v3, s26
  v_lshrrev_b32 v4, 16, v4
  v_mul_u32_u24 v5, 18, v4
  v_sub_u32 v5, v3, v5
  v_add_u32 v4, s24, v4
  v_mul_lo_u32 v4, v4, s27
  v_add_u32 v4, s25, v4
  v_and_b32 v4, 0xfffffff0, v4
  v_lshlrev_b32 v5, 4, v5
  v_add_u32 v10, v4, v5
  s_add_u32 s29, s20, 4
  s_lshl_b32 s30, s29, 6
  v_add_u32 v3, s30, v1
  v_mul_lo_u32 v4, v3, s26
  v_lshrrev_b32 v4, 16, v4
  v_mul_u32_u24 v5, 18, v4
  v_sub_u32 v5, v3, v5
  v_add_u32 v4, s24, v4
  v_mul_lo_u32 v4, v4, s27
  v_add_u32 v4, s25, v4
  v_and_b32 v4, 0xfffffff0, v4
  v_lshlrev_b32 v5, 4, v5
  v_add_u32 v11, v4, v5
  s_add_u32 s29, s20, 8
  s_lshl_b32 s30, s29, 6
  v_add_u32 v3, s30, v1
  v_mul_lo_u32 v4, v3, s26
  v_lshrrev_b32 v4, 16, v4
  v_mul_u32_u24 v5, 18, v4
  v_sub_u32 v5, v3, v5
  v_add_u32 v4, s24, v4
  v_mul_lo_u32 v4, v4, s27
  v_add_u32 v4, s25, v4
  v_and_b32 v4, 0xfffffff0, v4
  v_lshlrev_b32 v5, 4, v5
  v_add_u32 v12, v4, v5
  s_waitcnt lgkmcnt(0)
  s_mov_b32 s8, s4
  s_and_b32 s9, s5, 0xffff
  s_mov_b32 s10, 2101248
  s_mov_b32 s11, 0x20000
  s_mov_b32 s12, s6
  s_and_b32 s13, s7, 0xffff
  s_mov_b32 s14, 2101248
  s_mov_b32 s15, 0x20000
  s_add_u32 s16, s22, 8388608
  s_addc_u32 s17, s23, 0
  s_and_b32 s17, s17, 0xffff
  s_mov_b32 s18, 4194304
  s_mov_b32 s19, 0x20000
  s_add_u32 s29, s20, 0
  s_lshl_b32 s29, s29, 10
  s_add_u32 m0, s29, 0
  s_nop 0
  buffer_load_dwordx4 v10, s[8:11], 0 offen lds
  s_add_u32 s29, s20, 4
  s_lshl_b32 s29, s29, 10
  s_add_u32 m0, s29, 0
  s_nop 0
  buffer_load_dwordx4 v11, s[8:11], 0 offen lds
  s_cmp_lg_u32 s20, 0
  s_cbranch_scc1 L_wp_skip0_2
  s_add_u32 s29, s20, 8
  s_lshl_b32 s29, s29, 10
  s_add_u32 m0, s29, 0
  s_nop 0
  buffer_load_dwordx4 v12, s[8:11], 0 offen lds
L_wp_skip0_2:
  s_add_u32 s29, s20, 0
  s_lshl_b32 s29, s29, 10
  s_add_u32 m0, s29, 9216
  s_nop 0
  buffer_load_dwordx4 v10, s[12:15], 0 offen lds
  s_add_u32 s29, s20, 4
  s_lshl_b32 s29, s29, 10
  s_add_u32 m0, s29, 9216
  s_nop 0
  buffer_load_dwordx4 v11, s[12:15], 0 offen lds
  s_cmp_lg_u32 s20, 0
  s_cbranch_scc1 L_wp_skip1_2
  s_add_u32 s29, s20, 8
  s_lshl_b32 s29, s29, 10
  s_add_u32 m0, s29, 9216
  s_nop 0
  buffer_load_dwordx4 v12, s[12:15], 0 offen lds
L_wp_skip1_2:
  v_and_b32 v3, 7, v1
  v_lshlrev_b32 v3, 2, v3
  v_lshrrev_b32 v5, 4, v1
  v_lshlrev_b32 v5, 1, v5
  v_bfe_u32 v6, v1, 3, 1
  v_lshlrev_b32 v7, 6, v6
  v_add_u32 v5, v5, v7
  s_and_b32 s29, s20, 1
  s_lshl_b32 s29, s29, 5
  s_lshr_b32 s30, s20, 1
  s_lshl_b32 s30, s30, 7
  s_add_u32 s29, s29, s30
  v_add_u32 v5, s29, v5
  v_add_u32 v4, 0, v3
  v_add_u32 v7, s24, v4
  v_mul_lo_u32 v7, v7, s27
  v_and_b32 v7, 15, v7
  v_mul_u32_u24 v4, 288, v4
  v_add_u32 v4, v4, v7
  v_add_u32 v40, v4, v5
  v_add_u32 v4, 1, v3
  v_add_u32 v7, s24, v4
  v_mul_lo_u32 v7, v7, s27
  v_and_b32 v7, 15, v7
  v_mul_u32_u24 v4, 288, v4
  v_add_u32 v4, v4, v7
  v_add_u32 v41, v4, v5
  v_add_u32 v4, 2, v3
  v_add_u32 v7, s24, v4
  v_mul_lo_u32 v7, v7, s27
  v_and_b32 v7, 15, v7
  v_mul_u32_u24 v4, 288, v4
  v_add_u32 v4, v4, v7
  v_add_u32 v42, v4, v5
  v_add_u32 v4, 3, v3
  v_add_u32 v7, s24, v4
  v_mul_lo_u32 v7, v7, s27
  v_and_b32 v7, 15, v7
  v_mul_u32_u24 v4, 288, v4
  v_add_u32 v4, v4, v7
  v_add_u32 v43, v4, v5
  v_lshrrev_b32 v4, 4, v1
  v_lshlrev_b32 v4, 14, v4
  v_lshlrev_b32 v6, 13, v6
  v_add_u32 v6, v6, v4
  v_lshlrev_b32 v4, 2, v3
  v_add_u32 v6, v6, v4
  s_and_b32 s25, s21, 1
  s_lshl_b32 s25, s25, 12
  s_lshr_b32 s26, s21, 4
  s_lshl_b32 s26, s26, 10
  s_add_u32 s25, s25, s26
  s_bfe_u32 s26, s21, 0x20001
  s_lshl_b32 s26, s26, 8
  s_add_u32 s25, s25, s26
  s_bfe_u32 s26, s21, 0x10003
  s_lshl_b32 s26, s26, 7
  s_add_u32 s25, s25, s26
  s_lshl_b32 s26, s28, 20
  s_add_u32 s25, s25, s26
  s_lshl_b32 s26, s20, 18
  s_add_u32 s25, s25, s26
  s_lshl_b32 s29, s28, 2
  s_add_u32 s29, s29, s20
  s_cmp_lg_u32 s29, 0
  s_cbranch_scc1 L_wp_nonyq
  v_add_u32 v7, 0, v3
  v_add_u32 v7, s24, v7
  v_mul_lo_u32 v7, v7, s27
  v_add_u32 v7, 1024, v7
  buffer_load_ushort v44, v7, s[8:11], 0 offen
  buffer_load_ushort v48, v7, s[12:15], 0 offen
  v_add_u32 v7, 1, v3
  v_add_u32 v7, s24, v7
  v_mul_lo_u32 v7, v7, s27
  v_add_u32 v7, 1024, v7
  buffer_load_ushort v45, v7, s[8:11], 0 offen
  buffer_load_ushort v49, v7, s[12:15], 0 offen
  v_add_u32 v7, 2, v3
  v_add_u32 v7, s24, v7
  v_mul_lo_u32 v7, v7, s27
  v_add_u32 v7, 1024, v7
  buffer_load_ushort v46, v7, s[8:11], 0 offen
  buffer_load_ushort v50, v7, s[12:15], 0 offen
  v_add_u32 v7, 3, v3
  v_add_u32 v7, s24, v7
  v_mul_lo_u32 v7, v7, s27
  v_add_u32 v7, 1024, v7
  buffer_load_ushort v47, v7, s[8:11], 0 offen
  buffer_load_ushort v51, v7, s[12:15], 0 offen
  s_waitcnt vmcnt(0)
  v_lshl_or_b32 v44, v48, 16, v44
  v_lshl_or_b32 v45, v49, 16, v45
  v_lshl_or_b32 v46, v50, 16, v46
  v_lshl_or_b32 v47, v51, 16, v47
L_wp_nonyq:
  v_cmp_gt_u32 vcc, 8, v1
  s_nop 1
  s_cmp_eq_u32 s29, 0
  s_cselect_b64 s[30:31], vcc, 0
  s_waitcnt vmcnt(0)
  s_barrier
  ds_read_u16 v10, v40 offset:0
  ds_read_u16_d16_hi v14, v40 offset:9216
  ds_read_u16 v11, v41 offset:0
  ds_read_u16_d16_hi v15, v41 offset:9216
  ds_read_u16 v12, v42 offset:0
  ds_read_u16_d16_hi v16, v42 offset:9216
  ds_read_u16 v13, v43 offset:0
  ds_read_u16_d16_hi v17, v43 offset:9216
  s_waitcnt lgkmcnt(0)
  v_or_b32 v18, v10, v14
  v_or_b32 v19, v11, v15
  v_or_b32 v20, v12, v16
  v_or_b32 v21, v13, v17
  v_cndmask_b32 v18, v18, v44, s[30:31]
  v_cndmask_b32 v19, v19, v45, s[30:31]
  v_cndmask_b32 v20, v20, v46, s[30:31]
  v_cndmask_b32 v21, v21, v47, s[30:31]
  s_add_u32 s26, s25, 0
  buffer_store_dwordx4 v[18:21], v6, s[16:19], s26 offen sc1
  ds_read_u16 v22, v40 offset:8
  ds_read_u16_d16_hi v26, v40 offset:9224
  ds_read_u16 v23, v41 offset:8
  ds_read_u16_d16_hi v27, v41 offset:9224
  ds_read_u16 v24, v42 offset:8
  ds_read_u16_d16_hi v28, v42 offset:9224
  ds_read_u16 v25, v43 offset:8
  ds_read_u16_d16_hi v29, v43 offset:9224
  s_waitcnt lgkmcnt(0)
  v_or_b32 v30, v22, v26
  v_or_b32 v31, v23, v27
  v_or_b32 v32, v24, v28
  v_or_b32 v33, v25, v29
  s_add_u32 s26, s25, 65536
  buffer_store_dwordx4 v[30:33], v6, s[16:19], s26 offen sc1
  ds_read_u16 v10, v40 offset:16
  ds_read_u16_d16_hi v14, v40 offset:9232
  ds_read_u16 v11, v41 offset:16
  ds_read_u16_d16_hi v15, v41 offset:9232
  ds_read_u16 v12, v42 offset:16
  ds_read_u16_d16_hi v16, v42 offset:9232
  ds_read_u16 v13, v43 offset:16
  ds_read_u16_d16_hi v17, v43 offset:9232
  s_waitcnt lgkmcnt(0)
  v_or_b32 v18, v10, v14
  v_or_b32 v19, v11, v15
  v_or_b32 v20, v12, v16
  v_or_b32 v21, v13, v17
  s_add_u32 s26, s25, 131072
  buffer_store_dwordx4 v[18:21], v6, s[16:19], s26 offen sc1
  ds_read_u16 v22, v40 offset:24
  ds_read_u16_d16_hi v26, v40 offset:9240
  ds_read_u16 v23, v41 offset:24
  ds_read_u16_d16_hi v27, v41 offset:9240
  ds_read_u16 v24, v42 offset:24
  ds_read_u16_d16_hi v28, v42 offset:9240
  ds_read_u16 v25, v43 offset:24
  ds_read_u16_d16_hi v29, v43 offset:9240
  s_waitcnt lgkmcnt(0)
  v_or_b32 v30, v22, v26
  v_or_b32 v31, v23, v27
  v_or_b32 v32, v24, v28
  v_or_b32 v33, v25, v29
  s_add_u32 s26, s25, 196608
  buffer_store_dwordx4 v[30:33], v6, s[16:19], s26 offen sc1
  s_endpgm
L_k1_p1:
  s_load_dwordx2 s[4:5], s[0:1], 0
  s_load_dwordx2 s[6:7], s[0:1], 80
  v_and_b32 v1, 63, v0
  v_lshrrev_b32 v2, 6, v0
  s_nop 0
  v_readfirstlane_b32 s16, v2
  s_lshr_b32 s17, s2, 6
  s_lshl_b32 s17, s17, 4
  s_bfe_u32 s18, s2, 0x10005
  s_lshl_b32 s18, s18, 2
  s_add_u32 s17, s17, s18
  s_lshr_b32 s18, s16, 1
  s_lshl_b32 s18, s18, 3
  s_add_u32 s17, s17, s18
  s_and_b32 s18, s16, 1
  s_lshl_b32 s18, s18, 1
  s_add_u32 s17, s17, s18
  s_lshl_b32 s17, s17, 5
  s_and_b32 s18, s2, 31
  s_add_u32 s17, s17, s18
  s_lshl_b32 s20, s17, 11
  s_add_u32 s21, s20, 65536
  v_lshlrev_b32 v2, 4, v1
  s_waitcnt lgkmcnt(0)
  s_mov_b32 s8, s4
  s_and_b32 s9, s5, 0xffff
  s_mov_b32 s10, 4194304
  s_mov_b32 s11, 0x20000
  s_add_u32 s12, s6, 0
  s_addc_u32 s13, s7, 0
  s_and_b32 s13, s13, 0xffff
  s_mov_b32 s14, 4194304
  s_mov_b32 s15, 0x20000
  buffer_load_dwordx4 v[80:83], v2, s[8:11], s20 offen
  buffer_load_dwordx4 v[84:87], v2, s[8:11], s20 offen offset:1024
  buffer_load_dwordx4 v[160:163], v2, s[8:11], s21 offen
  buffer_load_dwordx4 v[164:167], v2, s[8:11], s21 offen offset:1024
  s_getpc_b64 s[40:41]
L_pf1:
  s_add_u32 s40, s40, (L_k1_p1)-L_pf1
  s_addc_u32 s41, s41, -1
  v_lshlrev_b32 v250, 7, v1
  v_min_u32 v250, L_k1_end-(L_k1_p1)-4, v250
  v_mov_b32 v251, s41
  v_add_co_u32 v250, s[42:43], s40, v250
  s_nop 1
  v_addc_co_u32 v251, s[42:43], 0, v251, s[42:43]
  global_load_dword v252, v[250:251], off
  s_getpc_b64 s[40:41]
L_pf2:
  s_add_u32 s40, s40, (k2_kernel)-L_pf2
  s_addc_u32 s41, s41, 0
  v_lshlrev_b32 v250, 7, v1
  v_min_u32 v250, L_k2_end-(k2_kernel)-4, v250
  v_mov_b32 v251, s41
  v_add_co_u32 v250, s[42:43], s40, v250
  s_nop 1
  v_addc_co_u32 v251, s[42:43], 0, v251, s[42:43]
  global_load_dword v253, v[250:251], off
  v_and_b32 v3, 31, v1
  v_cvt_f32_u32 v6, v3
  v_lshrrev_b32 v3, 5, v1
  v_cvt_f32_u32 v7, v3
  v_mul_f32 v4, 0x3d000000, v6
  v_mul_f32 v8, 0x41000000, v7
  v_mul_f32 v8, v8, v4
  v_fmamk_f32 v240, v4, 0x00000000, v8
  v_fmamk_f32 v241, v4, 0x3f800000, v8
  v_cos_f32 v242, v240
  v_cos_f32 v243, v241
  v_sin_f32 v244, v240
  v_sin_f32 v245, v241
  v_cvt_pk_bf16_f32 v10, v242, v243
  v_cvt_pk_bf16_f32 v18, -v244, -v245
  v_fmamk_f32 v240, v4, 0x40000000, v8
  v_fmamk_f32 v241, v4, 0x40400000, v8
  v_cos_f32 v242, v240
  v_cos_f32 v243, v241
  v_sin_f32 v244, v240
  v_sin_f32 v245, v241
  v_cvt_pk_bf16_f32 v11, v242, v243
  v_cvt_pk_bf16_f32 v19, -v244, -v245
  v_fmamk_f32 v240, v4, 0x40800000, v8
  v_fmamk_f32 v241, v4, 0x40a00000, v8
  v_cos_f32 v242, v240
  v_cos_f32 v243, v241
  v_sin_f32 v244, v240
  v_sin_f32 v245, v241
  v_cvt_pk_bf16_f32 v12, v242, v243
  v_cvt_pk_bf16_f32 v20, -v244, -v245
  v_fmamk_f32 v240, v4, 0x40c00000, v8
  v_fmamk_f32 v241, v4, 0x40e00000, v8
  v_cos_f32 v242, v240
  v_cos_f32 v243, v241
  v_sin_f32 v244, v240
  v_sin_f32 v245, v241
  v_cvt_pk_bf16_f32 v13, v242, v243
  v_cvt_pk_bf16_f32 v21, -v244, -v245
  v_bfe_u32 v9, v1, 0, 1
  v_sub_u32 v9, 0, v9
  v_and_b32 v9, 0x80008000, v9
  v_xor_b32 v14, v9, v10
  v_xor_b32 v22, v9, v18
  v_xor_b32 v15, v9, v11
  v_xor_b32 v23, v9, v19
  v_xor_b32 v16, v9, v12
  v_xor_b32 v24, v9, v20
  v_xor_b32 v17, v9, v13
  v_xor_b32 v25, v9, v21
  v_bfe_u32 v2, v1, 1, 4
  v_cvt_f32_u32 v2, v2
  v_mul_f32 v4, 0x3d000000, v2
  v_and_b32 v2, 1, v1
  v_cvt_f32_u32 v2, v2
  v_mul_f32 v2, 0x3e800000, v2
  v_mul_f32 v8, 4.0, v7
  v_fma_f32 v8, v8, v4, v2
  v_fmamk_f32 v240, v4, 0x00000000, v8
  v_fmamk_f32 v241, v4, 0x3f800000, v8
  v_cos_f32 v242, v240
  v_cos_f32 v243, v241
  v_sin_f32 v244, v240
  v_sin_f32 v245, v241
  v_cvt_pk_bf16_f32 v26, v242, v243
  v_cvt_pk_bf16_f32 v34, v244, v245
  v_fmamk_f32 v240, v4, 0x40000000, v8
  v_fmamk_f32 v241, v4, 0x40400000, v8
  v_cos_f32 v242, v240
  v_cos_f32 v243, v241
  v_sin_f32 v244, v240
  v_sin_f32 v245, v241
  v_cvt_pk_bf16_f32 v27, v242, v243
  v_cvt_pk_bf16_f32 v35, v244, v245
  v_fmamk_f32 v240, v4, 0x41000000, v8
  v_fmamk_f32 v241, v4, 0x41100000, v8
  v_cos_f32 v242, v240
  v_cos_f32 v243, v241
  v_sin_f32 v244, v240
  v_sin_f32 v245, v241
  v_cvt_pk_bf16_f32 v28, v242, v243
  v_cvt_pk_bf16_f32 v36, v244, v245
  v_fmamk_f32 v240, v4, 0x41200000, v8
  v_fmamk_f32 v241, v4, 0x41300000, v8
  v_cos_f32 v242, v240
  v_cos_f32 v243, v241
  v_sin_f32 v244, v240
  v_sin_f32 v245, v241
  v_cvt_pk_bf16_f32 v29, v242, v243
  v_cvt_pk_bf16_f32 v37, v244, v245
  v_bfe_u32 v9, v1, 1, 1
  v_sub_u32 v9, 0, v9
  v_and_b32 v9, 0x80008000, v9
  v_xor_b32 v30, v9, v26
  v_xor_b32 v38, v9, v34
  v_xor_b32 v31, v9, v27
  v_xor_b32 v39, v9, v35
  v_xor_b32 v32, v9, v28
  v_xor_b32 v40, v9, v36
  v_xor_b32 v33, v9, v29
  v_xor_b32 v41, v9, v37
  v_mul_f32 v4, 0xba800000, v6
  v_mul_f32 v8, 4.0, v7
  v_mul_f32 v8, v8, v4
  v_fmamk_f32 v240, v4, 0x00000000, v8
  v_fmamk_f32 v241, v4, 0x3f800000, v8
  v_cos_f32 v42, v240
  v_cos_f32 v43, v241
  v_sin_f32 v58, v240
  v_sin_f32 v59, v241
  v_fmamk_f32 v240, v4, 0x40000000, v8
  v_fmamk_f32 v241, v4, 0x40400000, v8
  v_cos_f32 v44, v240
  v_cos_f32 v45, v241
  v_sin_f32 v60, v240
  v_sin_f32 v61, v241
  v_fmamk_f32 v240, v4, 0x41000000, v8
  v_fmamk_f32 v241, v4, 0x41100000, v8
  v_cos_f32 v46, v240
  v_cos_f32 v47, v241
  v_sin_f32 v62, v240
  v_sin_f32 v63, v241
  v_fmamk_f32 v240, v4, 0x41200000, v8
  v_fmamk_f32 v241, v4, 0x41300000, v8
  v_cos_f32 v48, v240
  v_cos_f32 v49, v241
  v_sin_f32 v64, v240
  v_sin_f32 v65, v241
  v_fmamk_f32 v240, v4, 0x41800000, v8
  v_fmamk_f32 v241, v4, 0x41880000, v8
  v_cos_f32 v50, v240
  v_cos_f32 v51, v241
  v_sin_f32 v66, v240
  v_sin_f32 v67, v241
  v_fmamk_f32 v240, v4, 0x41900000, v8
  v_fmamk_f32 v241, v4, 0x41980000, v8
  v_cos_f32 v52, v240
  v_cos_f32 v53, v241
  v_sin_f32 v68, v240
  v_sin_f32 v69, v241
  v_fmamk_f32 v240, v4, 0x41c00000, v8
  v_fmamk_f32 v241, v4, 0x41c80000, v8
  v_cos_f32 v54, v240
  v_cos_f32 v55, v241
  v_sin_f32 v70, v240
  v_sin_f32 v71, v241
  v_fmamk_f32 v240, v4, 0x41d00000, v8
  v_fmamk_f32 v241, v4, 0x41d80000, v8
  v_cos_f32 v56, v240
  v_cos_f32 v57, v241
  v_sin_f32 v72, v240
  v_sin_f32 v73, v241
  s_waitcnt vmcnt(2)
  v_lshlrev_b32 v88, 16, v80
  v_and_b32 v89, 0xffff0000, v80
  v_lshlrev_b32 v90, 16, v81
  v_and_b32 v91, 0xffff0000, v81
  v_lshlrev_b32 v92, 16, v82
  v_and_b32 v93, 0xffff0000, v82
  v_lshlrev_b32 v94, 16, v83
  v_and_b32 v95, 0xffff0000, v83
  v_lshlrev_b32 v96, 16, v84
  v_and_b32 v97, 0xffff0000, v84
  v_lshlrev_b32 v98, 16, v85
  v_and_b32 v99, 0xffff0000, v85
  v_lshlrev_b32 v100, 16, v86
  v_and_b32 v101, 0xffff0000, v86
  v_lshlrev_b32 v102, 16, v87
  v_and_b32 v103, 0xffff0000, v87
  v_lshlrev_b32 v168, 16, v160
  v_and_b32 v169, 0xffff0000, v160
  v_lshlrev_b32 v170, 16, v161
  v_and_b32 v171, 0xffff0000, v161
  v_lshlrev_b32 v172, 16, v162
  v_and_b32 v173, 0xffff0000, v162
  v_lshlrev_b32 v174, 16, v163
  v_and_b32 v175, 0xffff0000, v163
  v_lshlrev_b32 v176, 16, v164
  v_and_b32 v177, 0xffff0000, v164
  v_lshlrev_b32 v178, 16, v165
  v_and_b32 v179, 0xffff0000, v165
  v_lshlrev_b32 v180, 16, v166
  v_and_b32 v181, 0xffff0000, v166
  v_lshlrev_b32 v182, 16, v167
  v_and_b32 v183, 0xffff0000, v167
  v_pk_add_f32 v[104:105], v[88:89], v[90:91]
  v_pk_add_f32 v[106:107], v[92:93], v[94:95]
  v_pk_add_f32 v[104:105], v[104:105], v[96:97]
  v_pk_add_f32 v[106:107], v[106:107], v[98:99]
  v_pk_add_f32 v[104:105], v[104:105], v[100:101]
  v_pk_add_f32 v[106:107], v[106:107], v[102:103]
  v_pk_add_f32 v[104:105], v[104:105], v[106:107]
  v_sub_f32 v106, v104, v105
  v_add_f32 v104, v104, v105
  v_pk_add_f32 v[184:185], v[168:169], v[170:171]
  v_pk_add_f32 v[186:187], v[172:173], v[174:175]
  v_pk_add_f32 v[184:185], v[184:185], v[176:177]
  v_pk_add_f32 v[186:187], v[186:187], v[178:179]
  v_pk_add_f32 v[184:185], v[184:185], v[180:181]
  v_pk_add_f32 v[186:187], v[186:187], v[182:183]
  v_pk_add_f32 v[184:185], v[184:185], v[186:187]
  v_sub_f32 v186, v184, v185
  v_add_f32 v184, v184, v185
  s_nop 1
  v_add_f32_dpp v104, v104, v104 row_ror:8 row_mask:0xf bank_mask:0xf
  v_add_f32_dpp v184, v184, v184 row_ror:8 row_mask:0xf bank_mask:0xf
  v_add_f32_dpp v106, v106, v106 row_ror:8 row_mask:0xf bank_mask:0xf
  v_add_f32_dpp v186, v186, v186 row_ror:8 row_mask:0xf bank_mask:0xf
  v_add_f32_dpp v104, v104, v104 row_ror:4 row_mask:0xf bank_mask:0xf
  v_add_f32_dpp v184, v184, v184 row_ror:4 row_mask:0xf bank_mask:0xf
  v_add_f32_dpp v106, v106, v106 row_ror:4 row_mask:0xf bank_mask:0xf
  v_add_f32_dpp v186, v186, v186 row_ror:4 row_mask:0xf bank_mask:0xf
  v_add_f32_dpp v104, v104, v104 row_ror:2 row_mask:0xf bank_mask:0xf
  v_add_f32_dpp v184, v184, v184 row_ror:2 row_mask:0xf bank_mask:0xf
  v_add_f32_dpp v106, v106, v106 row_ror:2 row_mask:0xf bank_mask:0xf
  v_add_f32_dpp v186, v186, v186 row_ror:2 row_mask:0xf bank_mask:0xf
  v_add_f32_dpp v104, v104, v104 row_ror:1 row_mask:0xf bank_mask:0xf
  v_add_f32_dpp v184, v184, v184 row_ror:1 row_mask:0xf bank_mask:0xf
  v_add_f32_dpp v106, v106, v106 row_ror:1 row_mask:0xf bank_mask:0xf
  v_add_f32_dpp v186, v186, v186 row_ror:1 row_mask:0xf bank_mask:0xf
  v_add_f32_dpp v104, v104, v104 row_bcast:15 row_mask:0xa bank_mask:0xf
  v_add_f32_dpp v184, v184, v184 row_bcast:15 row_mask:0xa bank_mask:0xf
  v_add_f32_dpp v106, v106, v106 row_bcast:15 row_mask:0xa bank_mask:0xf
  v_add_f32_dpp v186, v186, v186 row_bcast:15 row_mask:0xa bank_mask:0xf
  v_add_f32_dpp v104, v104, v104 row_bcast:31 row_mask:0xc bank_mask:0xf
  v_add_f32_dpp v184, v184, v184 row_bcast:31 row_mask:0xc bank_mask:0xf
  v_add_f32_dpp v106, v106, v106 row_bcast:31 row_mask:0xc bank_mask:0xf
  v_add_f32_dpp v186, v186, v186 row_bcast:31 row_mask:0xc bank_mask:0xf
  s_nop 1
  v_readlane_b32 s26, v104, 63
  v_readlane_b32 s30, v106, 63
  v_readlane_b32 s27, v184, 63
  v_readlane_b32 s31, v186, 63
  s_nop 1
  v_mov_b32 v110, s26
  v_mul_f32 v110, 0xba800000, v110
  v_mov_b32 v111, v110
  v_mov_b32 v190, s27
  v_mul_f32 v190, 0xba800000, v190
  v_mov_b32 v191, v190
  v_pk_add_f32 v[88:89], v[88:89], v[110:111]
  v_pk_add_f32 v[90:91], v[90:91], v[110:111]
  v_pk_add_f32 v[92:93], v[92:93], v[110:111]
  v_pk_add_f32 v[94:95], v[94:95], v[110:111]
  v_pk_add_f32 v[96:97], v[96:97], v[110:111]
  v_pk_add_f32 v[98:99], v[98:99], v[110:111]
  v_pk_add_f32 v[100:101], v[100:101], v[110:111]
  v_pk_add_f32 v[102:103], v[102:103], v[110:111]
  v_pk_add_f32 v[168:169], v[168:169], v[190:191]
  v_pk_add_f32 v[170:171], v[170:171], v[190:191]
  v_pk_add_f32 v[172:173], v[172:173], v[190:191]
  v_pk_add_f32 v[174:175], v[174:175], v[190:191]
  v_pk_add_f32 v[176:177], v[176:177], v[190:191]
  v_pk_add_f32 v[178:179], v[178:179], v[190:191]
  v_pk_add_f32 v[180:181], v[180:181], v[190:191]
  v_pk_add_f32 v[182:183], v[182:183], v[190:191]
  v_pk_mul_f32 v[104:105], v[88:89], v[88:89]
  v_pk_mul_f32 v[106:107], v[90:91], v[90:91]
  v_pk_fma_f32 v[104:105], v[92:93], v[92:93], v[104:105]
  v_pk_fma_f32 v[106:107], v[94:95], v[94:95], v[106:107]
  v_pk_fma_f32 v[104:105], v[96:97], v[96:97], v[104:105]
  v_pk_fma_f32 v[106:107], v[98:99], v[98:99], v[106:107]
  v_pk_fma_f32 v[104:105], v[100:101], v[100:101], v[104:105]
  v_pk_fma_f32 v[106:107], v[102:103], v[102:103], v[106:107]
  v_pk_add_f32 v[104:105], v[104:105], v[106:107]
  v_add_f32 v104, v104, v105
  v_pk_mul_f32 v[184:185], v[168:169], v[168:169]
  v_pk_mul_f32 v[186:187], v[170:171], v[170:171]
  v_pk_fma_f32 v[184:185], v[172:173], v[172:173], v[184:185]
  v_pk_fma_f32 v[186:187], v[174:175], v[174:175], v[186:187]
  v_pk_fma_f32 v[184:185], v[176:177], v[176:177], v[184:185]
  v_pk_fma_f32 v[186:187], v[178:179], v[178:179], v[186:187]
  v_pk_fma_f32 v[184:185], v[180:181], v[180:181], v[184:185]
  v_pk_fma_f32 v[186:187], v[182:183], v[182:183], v[186:187]
  v_pk_add_f32 v[184:185], v[184:185], v[186:187]
  v_add_f32 v184, v184, v185
  s_nop 1
  v_add_f32_dpp v104, v104, v104 row_ror:8 row_mask:0xf bank_mask:0xf
  v_add_f32_dpp v184, v184, v184 row_ror:8 row_mask:0xf bank_mask:0xf
  s_nop 0
  v_add_f32_dpp v104, v104, v104 row_ror:4 row_mask:0xf bank_mask:0xf
  v_add_f32_dpp v184, v184, v184 row_ror:4 row_mask:0xf bank_mask:0xf
  s_nop 0
  v_add_f32_dpp v104, v104, v104 row_ror:2 row_mask:0xf bank_mask:0xf
  v_add_f32_dpp v184, v184, v184 row_ror:2 row_mask:0xf bank_mask:0xf
  s_nop 0
  v_add_f32_dpp v104, v104, v104 row_ror:1 row_mask:0xf bank_mask:0xf
  v_add_f32_dpp v184, v184, v184 row_ror:1 row_mask:0xf bank_mask:0xf
  s_nop 0
  v_add_f32_dpp v104, v104, v104 row_bcast:15 row_mask:0xa bank_mask:0xf
  v_add_f32_dpp v184, v184, v184 row_bcast:15 row_mask:0xa bank_mask:0xf
  s_nop 0
  v_add_f32_dpp v104, v104, v104 row_bcast:31 row_mask:0xc bank_mask:0xf
  v_add_f32_dpp v184, v184, v184 row_bcast:31 row_mask:0xc bank_mask:0xf
  s_nop 1
  v_readlane_b32 s28, v104, 63
  v_readlane_b32 s29, v184, 63
  s_nop 1
  v_mov_b32 v108, s28
  v_mov_b32 v188, s29
  v_mul_f32 v108, 0x3a800000, v108
  v_mul_f32 v188, 0x3a800000, v188
  v_add_f32 v108, 0x3727c5ac, v108
  v_add_f32 v188, 0x3727c5ac, v188
  v_rsq_f32 v108, v108
  v_rsq_f32 v188, v188
  s_nop 0
  s_nop 0
  v_mov_b32 v109, v108
  v_mov_b32 v189, v188
  v_pk_mul_f32 v[88:89], v[88:89], v[108:109]
  v_pk_mul_f32 v[90:91], v[90:91], v[108:109]
  v_pk_mul_f32 v[92:93], v[92:93], v[108:109]
  v_pk_mul_f32 v[94:95], v[94:95], v[108:109]
  v_pk_mul_f32 v[96:97], v[96:97], v[108:109]
  v_pk_mul_f32 v[98:99], v[98:99], v[108:109]
  v_pk_mul_f32 v[100:101], v[100:101], v[108:109]
  v_pk_mul_f32 v[102:103], v[102:103], v[108:109]
  v_cvt_pk_bf16_f32 v80, v88, v89
  v_cvt_pk_bf16_f32 v81, v90, v91
  v_cvt_pk_bf16_f32 v82, v92, v93
  v_cvt_pk_bf16_f32 v83, v94, v95
  v_cvt_pk_bf16_f32 v84, v96, v97
  v_cvt_pk_bf16_f32 v85, v98, v99
  v_cvt_pk_bf16_f32 v86, v100, v101
  v_cvt_pk_bf16_f32 v87, v102, v103
  v_mul_f32 v74, s30, v108
  v_pk_mul_f32 v[168:169], v[168:169], v[188:189]
  v_pk_mul_f32 v[170:171], v[170:171], v[188:189]
  v_pk_mul_f32 v[172:173], v[172:173], v[188:189]
  v_pk_mul_f32 v[174:175], v[174:175], v[188:189]
  v_pk_mul_f32 v[176:177], v[176:177], v[188:189]
  v_pk_mul_f32 v[178:179], v[178:179], v[188:189]
  v_pk_mul_f32 v[180:181], v[180:181], v[188:189]
  v_pk_mul_f32 v[182:183], v[182:183], v[188:189]
  v_cvt_pk_bf16_f32 v160, v168, v169
  v_cvt_pk_bf16_f32 v161, v170, v171
  v_cvt_pk_bf16_f32 v162, v172, v173
  v_cvt_pk_bf16_f32 v163, v174, v175
  v_cvt_pk_bf16_f32 v164, v176, v177
  v_cvt_pk_bf16_f32 v165, v178, v179
  v_cvt_pk_bf16_f32 v166, v180, v181
  v_cvt_pk_bf16_f32 v167, v182, v183
  v_mul_f32 v75, s31, v188
  v_cvt_pk_bf16_f32 v74, 0, v74
  v_cvt_pk_bf16_f32 v75, 0, v75
  s_lshl_b32 s22, s16, 12
  v_lshlrev_b32 v2, 4, v1
  v_add_u32 v2, s22, v2
  ds_write_b128 v2, v[80:83] offset:0
  ds_write_b128 v2, v[84:87] offset:1024
  ds_write_b128 v2, v[160:163] offset:2048
  ds_write_b128 v2, v[164:167] offset:3072
  v_lshrrev_b32 v3, 5, v1
  v_lshlrev_b32 v3, 9, v3
  v_bfe_u32 v4, v1, 2, 2
  v_lshlrev_b32 v4, 6, v4
  v_add_u32 v3, v3, v4
  v_bfe_u32 v4, v1, 4, 1
  v_lshlrev_b32 v4, 5, v4
  v_add_u32 v3, v3, v4
  v_and_b32 v4, 3, v1
  v_lshlrev_b32 v4, 3, v4
  v_add_u32 v3, v3, v4
  v_add_u32 v3, s22, v3
  s_waitcnt lgkmcnt(0)
  ds_read_b64_tr_b16 v[88:89], v3 offset:0
  ds_read_b64_tr_b16 v[90:91], v3 offset:256
  ds_read_b64_tr_b16 v[92:93], v3 offset:1024
  ds_read_b64_tr_b16 v[94:95], v3 offset:1280
  ds_read_b64_tr_b16 v[168:169], v3 offset:2048
  ds_read_b64_tr_b16 v[170:171], v3 offset:2304
  ds_read_b64_tr_b16 v[172:173], v3 offset:3072
  ds_read_b64_tr_b16 v[174:175], v3 offset:3328
  s_waitcnt lgkmcnt(0)
  v_mfma_f32_32x32x16_bf16 v[96:111], v[88:91], v[10:13], 0
  v_mfma_f32_32x32x16_bf16 v[112:127], v[88:91], v[18:21], 0
  v_mfma_f32_32x32x16_bf16 v[176:191], v[168:171], v[10:13], 0
  v_mfma_f32_32x32x16_bf16 v[192:207], v[168:171], v[18:21], 0
  v_mfma_f32_32x32x16_bf16 v[96:111], v[92:95], v[14:17], v[96:111]
  v_mfma_f32_32x32x16_bf16 v[112:127], v[92:95], v[22:25], v[112:127]
  v_mfma_f32_32x32x16_bf16 v[176:191], v[172:175], v[14:17], v[176:191]
  v_mfma_f32_32x32x16_bf16 v[192:207], v[172:175], v[22:25], v[192:207]
  s_nop 7
  s_nop 7
  v_pk_mul_f32 v[128:129], v[96:97], v[42:43]
  v_pk_mul_f32 v[144:145], v[112:113], v[42:43]
  v_pk_fma_f32 v[128:129], v[112:113], v[58:59], v[128:129] neg_lo:[1,0,0] neg_hi:[1,0,0]
  v_pk_fma_f32 v[144:145], v[96:97], v[58:59], v[144:145]
  v_pk_mul_f32 v[130:131], v[98:99], v[44:45]
  v_pk_mul_f32 v[146:147], v[114:115], v[44:45]
  v_pk_fma_f32 v[130:131], v[114:115], v[60:61], v[130:131] neg_lo:[1,0,0] neg_hi:[1,0,0]
  v_pk_fma_f32 v[146:147], v[98:99], v[60:61], v[146:147]
  v_pk_mul_f32 v[132:133], v[100:101], v[46:47]
  v_pk_mul_f32 v[148:149], v[116:117], v[46:47]
  v_pk_fma_f32 v[132:133], v[116:117], v[62:63], v[132:133] neg_lo:[1,0,0] neg_hi:[1,0,0]
  v_pk_fma_f32 v[148:149], v[100:101], v[62:63], v[148:149]
  v_pk_mul_f32 v[134:135], v[102:103], v[48:49]
  v_pk_mul_f32 v[150:151], v[118:119], v[48:49]
  v_pk_fma_f32 v[134:135], v[118:119], v[64:65], v[134:135] neg_lo:[1,0,0] neg_hi:[1,0,0]
  v_pk_fma_f32 v[150:151], v[102:103], v[64:65], v[150:151]
  v_pk_mul_f32 v[136:137], v[104:105], v[50:51]
  v_pk_mul_f32 v[152:153], v[120:121], v[50:51]
  v_pk_fma_f32 v[136:137], v[120:121], v[66:67], v[136:137] neg_lo:[1,0,0] neg_hi:[1,0,0]
  v_pk_fma_f32 v[152:153], v[104:105], v[66:67], v[152:153]
  v_pk_mul_f32 v[138:139], v[106:107], v[52:53]
  v_pk_mul_f32 v[154:155], v[122:123], v[52:53]
  v_pk_fma_f32 v[138:139], v[122:123], v[68:69], v[138:139] neg_lo:[1,0,0] neg_hi:[1,0,0]
  v_pk_fma_f32 v[154:155], v[106:107], v[68:69], v[154:155]
  v_pk_mul_f32 v[140:141], v[108:109], v[54:55]
  v_pk_mul_f32 v[156:157], v[124:125], v[54:55]
  v_pk_fma_f32 v[140:141], v[124:125], v[70:71], v[140:141] neg_lo:[1,0,0] neg_hi:[1,0,0]
  v_pk_fma_f32 v[156:157], v[108:109], v[70:71], v[156:157]
  v_pk_mul_f32 v[142:143], v[110:111], v[56:57]
  v_pk_mul_f32 v[158:159], v[126:127], v[56:57]
  v_pk_fma_f32 v[142:143], v[126:127], v[72:73], v[142:143] neg_lo:[1,0,0] neg_hi:[1,0,0]
  v_pk_fma_f32 v[158:159], v[110:111], v[72:73], v[158:159]
  v_cvt_pk_bf16_f32 v80, v128, v129
  v_cvt_pk_bf16_f32 v88, v144, v145
  v_cvt_pk_bf16_f32 v81, v130, v131
  v_cvt_pk_bf16_f32 v89, v146, v147
  v_cvt_pk_bf16_f32 v82, v132, v133
  v_cvt_pk_bf16_f32 v90, v148, v149
  v_cvt_pk_bf16_f32 v83, v134, v135
  v_cvt_pk_bf16_f32 v91, v150, v151
  v_cvt_pk_bf16_f32 v84, v136, v137
  v_cvt_pk_bf16_f32 v92, v152, v153
  v_cvt_pk_bf16_f32 v85, v138, v139
  v_cvt_pk_bf16_f32 v93, v154, v155
  v_cvt_pk_bf16_f32 v86, v140, v141
  v_cvt_pk_bf16_f32 v94, v156, v157
  v_cvt_pk_bf16_f32 v87, v142, v143
  v_cvt_pk_bf16_f32 v95, v158, v159
  v_pk_mul_f32 v[208:209], v[176:177], v[42:43]
  v_pk_mul_f32 v[224:225], v[192:193], v[42:43]
  v_pk_fma_f32 v[208:209], v[192:193], v[58:59], v[208:209] neg_lo:[1,0,0] neg_hi:[1,0,0]
  v_pk_fma_f32 v[224:225], v[176:177], v[58:59], v[224:225]
  v_pk_mul_f32 v[210:211], v[178:179], v[44:45]
  v_pk_mul_f32 v[226:227], v[194:195], v[44:45]
  v_pk_fma_f32 v[210:211], v[194:195], v[60:61], v[210:211] neg_lo:[1,0,0] neg_hi:[1,0,0]
  v_pk_fma_f32 v[226:227], v[178:179], v[60:61], v[226:227]
  v_pk_mul_f32 v[212:213], v[180:181], v[46:47]
  v_pk_mul_f32 v[228:229], v[196:197], v[46:47]
  v_pk_fma_f32 v[212:213], v[196:197], v[62:63], v[212:213] neg_lo:[1,0,0] neg_hi:[1,0,0]
  v_pk_fma_f32 v[228:229], v[180:181], v[62:63], v[228:229]
  v_pk_mul_f32 v[214:215], v[182:183], v[48:49]
  v_pk_mul_f32 v[230:231], v[198:199], v[48:49]
  v_pk_fma_f32 v[214:215], v[198:199], v[64:65], v[214:215] neg_lo:[1,0,0] neg_hi:[1,0,0]
  v_pk_fma_f32 v[230:231], v[182:183], v[64:65], v[230:231]
  v_pk_mul_f32 v[216:217], v[184:185], v[50:51]
  v_pk_mul_f32 v[232:233], v[200:201], v[50:51]
  v_pk_fma_f32 v[216:217], v[200:201], v[66:67], v[216:217] neg_lo:[1,0,0] neg_hi:[1,0,0]
  v_pk_fma_f32 v[232:233], v[184:185], v[66:67], v[232:233]
  v_pk_mul_f32 v[218:219], v[186:187], v[52:53]
  v_pk_mul_f32 v[234:235], v[202:203], v[52:53]
  v_pk_fma_f32 v[218:219], v[202:203], v[68:69], v[218:219] neg_lo:[1,0,0] neg_hi:[1,0,0]
  v_pk_fma_f32 v[234:235], v[186:187], v[68:69], v[234:235]
  v_pk_mul_f32 v[220:221], v[188:189], v[54:55]
  v_pk_mul_f32 v[236:237], v[204:205], v[54:55]
  v_pk_fma_f32 v[220:221], v[204:205], v[70:71], v[220:221] neg_lo:[1,0,0] neg_hi:[1,0,0]
  v_pk_fma_f32 v[236:237], v[188:189], v[70:71], v[236:237]
  v_pk_mul_f32 v[222:223], v[190:191], v[56:57]
  v_pk_mul_f32 v[238:239], v[206:207], v[56:57]
  v_pk_fma_f32 v[222:223], v[206:207], v[72:73], v[222:223] neg_lo:[1,0,0] neg_hi:[1,0,0]
  v_pk_fma_f32 v[238:239], v[190:191], v[72:73], v[238:239]
  v_cvt_pk_bf16_f32 v160, v208, v209
  v_cvt_pk_bf16_f32 v168, v224, v225
  v_cvt_pk_bf16_f32 v161, v210, v211
  v_cvt_pk_bf16_f32 v169, v226, v227
  v_cvt_pk_bf16_f32 v162, v212, v213
  v_cvt_pk_bf16_f32 v170, v228, v229
  v_cvt_pk_bf16_f32 v163, v214, v215
  v_cvt_pk_bf16_f32 v171, v230, v231
  v_cvt_pk_bf16_f32 v164, v216, v217
  v_cvt_pk_bf16_f32 v172, v232, v233
  v_cvt_pk_bf16_f32 v165, v218, v219
  v_cvt_pk_bf16_f32 v173, v234, v235
  v_cvt_pk_bf16_f32 v166, v220, v221
  v_cvt_pk_bf16_f32 v174, v236, v237
  v_cvt_pk_bf16_f32 v167, v222, v223
  v_cvt_pk_bf16_f32 v175, v238, v239
  s_nop 1
  v_mfma_f32_32x32x16_bf16 v[96:111], v[26:29], v[80:83], 0
  v_mfma_f32_32x32x16_bf16 v[176:191], v[26:29], v[160:163], 0
  v_mfma_f32_32x32x16_bf16 v[96:111], v[34:37], v[88:91], v[96:111]
  v_mfma_f32_32x32x16_bf16 v[176:191], v[34:37], v[168:171], v[176:191]
  v_mfma_f32_32x32x16_bf16 v[96:111], v[30:33], v[84:87], v[96:111]
  v_mfma_f32_32x32x16_bf16 v[176:191], v[30:33], v[164:167], v[176:191]
  v_mfma_f32_32x32x16_bf16 v[96:111], v[38:41], v[92:95], v[96:111]
  v_mfma_f32_32x32x16_bf16 v[176:191], v[38:41], v[172:175], v[176:191]
  v_and_b32 v2, 31, v1
  v_lshlrev_b32 v2, 3, v2
  v_lshrrev_b32 v3, 5, v1
  v_lshlrev_b32 v3, 8, v3
  v_add_u32 v2, v2, v3
  s_mul_i32 s22, s16, 4224
  v_add_u32 v2, s22, v2
  v_cmp_eq_u32 vcc, 0, v1
  s_nop 7
  s_nop 7
  v_cvt_pk_bf16_f32 v112, v96, v97
  v_cvt_pk_bf16_f32 v113, v98, v99
  v_cvt_pk_bf16_f32 v114, v100, v101
  v_cvt_pk_bf16_f32 v115, v102, v103
  v_cvt_pk_bf16_f32 v116, v104, v105
  v_cvt_pk_bf16_f32 v117, v106, v107
  v_cvt_pk_bf16_f32 v118, v108, v109
  v_cvt_pk_bf16_f32 v119, v110, v111
  v_cndmask_b32 v112, v112, v74, vcc
  ds_write_b64 v2, v[112:113] offset:16384
  ds_write_b64 v2, v[114:115] offset:16896
  ds_write_b64 v2, v[116:117] offset:17408
  ds_write_b64 v2, v[118:119] offset:17920
  v_cvt_pk_bf16_f32 v192, v176, v177
  v_cvt_pk_bf16_f32 v193, v178, v179
  v_cvt_pk_bf16_f32 v194, v180, v181
  v_cvt_pk_bf16_f32 v195, v182, v183
  v_cvt_pk_bf16_f32 v196, v184, v185
  v_cvt_pk_bf16_f32 v197, v186, v187
  v_cvt_pk_bf16_f32 v198, v188, v189
  v_cvt_pk_bf16_f32 v199, v190, v191
  v_cndmask_b32 v192, v192, v75, vcc
  ds_write_b64 v2, v[192:193] offset:18496
  ds_write_b64 v2, v[194:195] offset:19008
  ds_write_b64 v2, v[196:197] offset:19520
  ds_write_b64 v2, v[198:199] offset:20032
  v_bfe_u32 v3, v1, 2, 2
  s_mov_b32 s22, 2112
  v_mul_lo_u32 v3, v3, s22
  v_lshrrev_b32 v4, 4, v1
  v_lshlrev_b32 v4, 4, v4
  v_add_u32 v3, v3, v4
  v_bfe_u32 v4, v1, 1, 1
  v_lshlrev_b32 v4, 3, v4
  v_add_u32 v3, v3, v4
  v_and_b32 v4, 1, v1
  v_lshlrev_b32 v4, 6, v4
  v_add_u32 v3, v3, v4
  s_lshl_b32 s22, s16, 9
  v_add_u32 v3, s22, v3
  v_lshrrev_b32 v4, 3, v1
  v_lshlrev_b32 v4, 15, v4
  v_bfe_u32 v2, v1, 2, 1
  v_lshlrev_b32 v2, 6, v2
  v_add_u32 v4, v4, v2
  s_bfe_u32 s22, s2, 0x20002
  v_and_b32 v2, 3, v1
  v_xor_b32 v2, s22, v2
  v_lshlrev_b32 v2, 4, v2
  v_add_u32 v4, v4, v2
  s_lshl_b32 s22, s2, 7
  s_lshl_b32 s23, s16, 20
  s_add_u32 s22, s22, s23
  s_waitcnt lgkmcnt(0)
  s_barrier
  ds_read_b64_tr_b16 v[80:81], v3 offset:16384
  ds_read_b64_tr_b16 v[82:83], v3 offset:24832
  ds_read_b64_tr_b16 v[84:85], v3 offset:16512
  ds_read_b64_tr_b16 v[86:87], v3 offset:24960
  ds_read_b64_tr_b16 v[88:89], v3 offset:16640
  ds_read_b64_tr_b16 v[90:91], v3 offset:25088
  ds_read_b64_tr_b16 v[92:93], v3 offset:16768
  ds_read_b64_tr_b16 v[94:95], v3 offset:25216
  s_waitcnt lgkmcnt(6)
  s_add_u32 s23, s22, 0
  buffer_store_dwordx4 v[80:83], v4, s[12:15], s23 offen sc1
  s_waitcnt lgkmcnt(4)
  s_add_u32 s23, s22, 262144
  buffer_store_dwordx4 v[84:87], v4, s[12:15], s23 offen sc1
  s_waitcnt lgkmcnt(2)
  s_add_u32 s23, s22, 524288
  buffer_store_dwordx4 v[88:91], v4, s[12:15], s23 offen sc1
  s_waitcnt lgkmcnt(0)
  s_add_u32 s23, s22, 786432
  buffer_store_dwordx4 v[92:95], v4, s[12:15], s23 offen sc1
  s_endpgm
L_k1_end:
.globl k2_kernel
.p2align 8
.type k2_kernel,@function
k2_kernel:
  s_cmp_lt_u32 s2, 256
  s_cbranch_scc1 L_k2_p2
  s_cmp_lt_u32 s2, 512
  s_cbranch_scc1 L_k2_side
  s_endpgm
L_k2_side:
  s_load_dwordx2 s[4:5], s[0:1], 32
  s_load_dwordx2 s[6:7], s[0:1], 80
  v_and_b32 v1, 63, v0
  v_lshrrev_b32 v2, 6, v0
  s_nop 0
  v_readfirstlane_b32 s20, v2
  s_sub_u32 s21, s2, 256
  s_lshl_b32 s22, s20, 2
  s_cmp_eq_u32 s20, 3
  s_cselect_b32 s22, 11, s22
  s_lshl_b32 s25, s22, 10
  s_lshl_b32 s22, s22, 6
  v_add_u32 v2, s22, v1
  s_movk_i32 s23, 2341
  s_movk_i32 s24, 7168
  v_add_u32 v3, 0, v2
  v_mul_lo_u32 v4, v3, s23
  v_lshrrev_b32 v4, 16, v4
  v_mul_u32_u24 v5, 28, v4
  v_sub_u32 v5, v3, v5
  v_mul_lo_u32 v4, v4, s24
  v_lshlrev_b32 v5, 4, v5
  v_add_u32 v10, v4, v5
  v_add_u32 v3, 64, v2
  v_mul_lo_u32 v4, v3, s23
  v_lshrrev_b32 v4, 16, v4
  v_mul_u32_u24 v5, 28, v4
  v_sub_u32 v5, v3, v5
  v_mul_lo_u32 v4, v4, s24
  v_lshlrev_b32 v5, 4, v5
  v_add_u32 v11, v4, v5
  v_add_u32 v3, 128, v2
  v_mul_lo_u32 v4, v3, s23
  v_lshrrev_b32 v4, 16, v4
  v_mul_u32_u24 v5, 28, v4
  v_sub_u32 v5, v3, v5
  v_mul_lo_u32 v4, v4, s24
  v_lshlrev_b32 v5, 4, v5
  v_add_u32 v12, v4, v5
  v_add_u32 v3, 192, v2
  v_mul_lo_u32 v4, v3, s23
  v_lshrrev_b32 v4, 16, v4
  v_mul_u32_u24 v5, 28, v4
  v_sub_u32 v5, v3, v5
  v_mul_lo_u32 v4, v4, s24
  v_lshlrev_b32 v5, 4, v5
  v_add_u32 v13, v4, v5
  s_lshr_b32 s22, s21, 3
  s_mul_i32 s22, s22, 229376
  s_and_b32 s23, s21, 7
  s_mul_i32 s23, s23, 448
  s_add_u32 s22, s22, s23
  s_add_u32 s22, s22, 3584
  s_waitcnt lgkmcnt(0)
  s_mov_b32 s8, s4
  s_and_b32 s9, s5, 0xffff
  s_mov_b32 s10, 7340032
  s_mov_b32 s11, 0x20000
  s_add_u32 s12, s6, 54525952
  s_addc_u32 s13, s7, 0
  s_and_b32 s13, s13, 0xffff
  s_mov_b32 s14, 7340032
  s_mov_b32 s15, 0x20000
  s_add_u32 m0, s25, 0
  s_nop 0
  buffer_load_dwordx4 v10, s[8:11], s22 offen lds
  s_add_u32 m0, s25, 1024
  s_nop 0
  buffer_load_dwordx4 v11, s[8:11], s22 offen lds
  s_add_u32 m0, s25, 2048
  s_nop 0
  buffer_load_dwordx4 v12, s[8:11], s22 offen lds
  s_cmp_ge_u32 s20, 2
  s_cbranch_scc1 L_pk_skip16
  s_add_u32 m0, s25, 3072
  s_nop 0
  buffer_load_dwordx4 v13, s[8:11], s22 offen lds
L_pk_skip16:
  v_lshrrev_b32 v2, 4, v1
  v_lshlrev_b32 v2, 3, v2
  v_bfe_u32 v3, v1, 2, 2
  v_add_u32 v2, v2, v3
  s_movk_i32 s24, 448
  v_mul_lo_u32 v2, v2, s24
  v_and_b32 v3, 3, v1
  v_lshlrev_b32 v3, 3, v3
  v_add_u32 v2, v2, v3
  s_lshr_b32 s24, s20, 1
  s_mul_i32 s24, s24, 224
  s_and_b32 s26, s20, 1
  s_lshl_b32 s26, s26, 7
  s_add_u32 s24, s24, s26
  v_add_u32 v2, s24, v2
  s_and_b32 s23, s21, 7
  s_lshl_b32 s23, s23, 1
  s_lshr_b32 s24, s20, 1
  s_add_u32 s23, s23, s24
  s_add_u32 s23, s23, 16
  s_lshl_b32 s23, s23, 5
  s_lshr_b32 s24, s21, 3
  s_add_u32 s23, s23, s24
  s_mul_i32 s23, s23, 7168
  s_lshl_b32 s26, s26, 5
  s_add_u32 s23, s23, s26
  v_lshlrev_b32 v3, 4, v1
  s_waitcnt vmcnt(0)
  s_barrier
  ds_read_b64_tr_b16 v[20:21], v2 offset:0
  ds_read_b64_tr_b16 v[22:23], v2 offset:1792
  ds_read_b64_tr_b16 v[24:25], v2 offset:32
  ds_read_b64_tr_b16 v[26:27], v2 offset:1824
  ds_read_b64_tr_b16 v[28:29], v2 offset:64
  ds_read_b64_tr_b16 v[30:31], v2 offset:1856
  ds_read_b64_tr_b16 v[32:33], v2 offset:96
  ds_read_b64_tr_b16 v[34:35], v2 offset:1888
  s_waitcnt lgkmcnt(6)
  s_add_u32 s24, s23, 0
  buffer_store_dwordx4 v[20:23], v3, s[12:15], s24 offen sc1
  s_waitcnt lgkmcnt(4)
  s_add_u32 s24, s23, 1024
  buffer_store_dwordx4 v[24:27], v3, s[12:15], s24 offen sc1
  s_waitcnt lgkmcnt(2)
  s_add_u32 s24, s23, 2048
  buffer_store_dwordx4 v[28:31], v3, s[12:15], s24 offen sc1
  s_bitcmp1_b32 s20, 0
  s_cbranch_scc1 L_pk_done16
  s_waitcnt lgkmcnt(0)
  s_add_u32 s24, s23, 3072
  buffer_store_dwordx4 v[32:35], v3, s[12:15], s24 offen sc1
L_pk_done16:
  s_endpgm
L_k2_p2:
  s_load_dwordx2 s[6:7], s[0:1], 80
  s_load_dwordx2 s[4:5], s[0:1], 40
  v_and_b32 v1, 63, v0
  v_lshrrev_b32 v2, 6, v0
  s_nop 0
  v_readfirstlane_b32 s20, v2
  v_lshlrev_b32 v2, 4, v1
  v_lshlrev_b32 v3, 2, v1
  s_and_b32 s21, s20, 1
  s_lshr_b32 s22, s20, 1
  s_waitcnt lgkmcnt(0)
  s_add_u32 s8, s6, 0
  s_addc_u32 s9, s7, 0
  s_and_b32 s9, s9, 0xffff
  s_mov_b32 s10, 4194304
  s_mov_b32 s11, 0x20000
  s_add_u32 s12, s6, 8388608
  s_addc_u32 s13, s7, 0
  s_and_b32 s13, s13, 0xffff
  s_mov_b32 s14, 4194304
  s_mov_b32 s15, 0x20000
  s_add_u32 s16, s6, 4194304
  s_addc_u32 s17, s7, 0
  s_and_b32 s17, s17, 0xffff
  s_mov_b32 s18, 4194304
  s_mov_b32 s19, 0x20000
  s_mov_b32 s56, s4
  s_and_b32 s57, s5, 0xffff
  s_mov_b32 s58, 8388608
  s_mov_b32 s59, 0x20000
  s_lshl_b32 s23, s20, 12
  s_mov_b32 m0, s23
  s_lshl_b32 s24, s2, 14
  s_add_u32 s24, s24, s23
  v_lshrrev_b32 v4, 2, v1
  v_lshlrev_b32 v4, 7, v4
  v_and_b32 v5, 3, v1
  v_lshlrev_b32 v5, 4, v5
  v_add_u32 v4, v4, v5
  s_lshr_b32 s25, s2, 4
  s_lshl_b32 s25, s25, 3
  s_and_b32 s26, s2, 7
  s_add_u32 s25, s25, s26
  s_lshl_b32 s25, s25, 15
  s_bfe_u32 s26, s2, 0x10003
  s_lshl_b32 s26, s26, 6
  s_add_u32 s25, s25, s26
  s_lshl_b32 s26, s20, 13
  s_add_u32 s25, s25, s26
  s_add_u32 s26, s25, 0
  buffer_load_dwordx4 v4, s[8:11], s26 offen offset:0 lds
  s_add_u32 s26, s25, 1024
  buffer_load_dwordx4 v4, s[8:11], s26 offen offset:1024 lds
  s_add_u32 s26, s25, 2048
  buffer_load_dwordx4 v4, s[8:11], s26 offen offset:2048 lds
  s_add_u32 s26, s25, 3072
  buffer_load_dwordx4 v4, s[8:11], s26 offen offset:3072 lds
  v_mov_b32 v255, v3
  s_getpc_b64 s[40:41]
L_pf3:
  s_add_u32 s40, s40, (k3_kernel)-L_pf3
  s_addc_u32 s41, s41, 0
  v_lshlrev_b32 v250, 7, v1
  v_min_u32 v250, L_k3_end-(k3_kernel)-4, v250
  v_mov_b32 v251, s41
  v_add_co_u32 v250, s[42:43], s40, v250
  s_nop 1
  v_addc_co_u32 v251, s[42:43], 0, v251, s[42:43]
  global_load_dword v253, v[250:251], off
  v_bfe_u32 v7, v1, 2, 2
  s_lshl_b32 s25, s22, 1
  v_xor_b32 v7, s25, v7
  v_lshlrev_b32 v8, 6, v1
  v_xor_b32 v9, 0, v7
  v_lshlrev_b32 v9, 4, v9
  v_add_u32 v9, v9, v8
  s_lshl_b32 s25, s21, 13
  v_add_u32 v244, s25, v9
  s_xor_b32 s25, s25, 8192
  v_add_u32 v245, s25, v9
  v_xor_b32 v9, 1, v7
  v_lshlrev_b32 v9, 4, v9
  v_add_u32 v9, v9, v8
  s_lshl_b32 s25, s21, 13
  v_add_u32 v246, s25, v9
  s_xor_b32 s25, s25, 8192
  v_add_u32 v247, s25, v9
  v_and_b32 v4, 31, v1
  v_cvt_f32_u32 v5, v4
  v_lshrrev_b32 v4, 5, v1
  v_cvt_f32_u32 v6, v4
  s_lshl_b32 s25, s21, 5
  v_cvt_f32_u32 v2, s25
  v_add_f32 v9, v5, v2
  v_mul_f32 v3, 4.0, v6
  v_add_f32 v2, v3, v2
  v_mul_f32 v232, 0x3d000000, v5
  v_mul_f32 v233, v3, v232
  v_mul_f32 v234, 0xba000000, v9
  v_mul_f32 v235, v3, v234
  v_mul_f32 v248, 0x3a000000, v5
  v_mul_f32 v249, v2, v248
  v_mul_f32 v4, 0x3c800000, v9
  v_mul_f32 v7, v2, v4
  v_bfe_u32 v8, v1, 0, 1
  v_sub_u32 v8, 0, v8
  v_and_b32 v8, 0x80008000, v8
  v_fmamk_f32 v226, v4, 0x00000000, v7
  v_fmamk_f32 v227, v4, 0x3f800000, v7
  v_cos_f32 v228, v226
  v_cos_f32 v229, v227
  v_sin_f32 v230, v226
  v_sin_f32 v231, v227
  v_cvt_pk_bf16_f32 v10, v228, v229
  v_cvt_pk_bf16_f32 v26, v230, v231
  v_fmamk_f32 v226, v4, 0x40000000, v7
  v_fmamk_f32 v227, v4, 0x40400000, v7
  v_cos_f32 v228, v226
  v_cos_f32 v229, v227
  v_sin_f32 v230, v226
  v_sin_f32 v231, v227
  v_cvt_pk_bf16_f32 v11, v228, v229
  v_cvt_pk_bf16_f32 v27, v230, v231
  v_fmamk_f32 v226, v4, 0x41000000, v7
  v_fmamk_f32 v227, v4, 0x41100000, v7
  v_cos_f32 v228, v226
  v_cos_f32 v229, v227
  v_sin_f32 v230, v226
  v_sin_f32 v231, v227
  v_cvt_pk_bf16_f32 v12, v228, v229
  v_cvt_pk_bf16_f32 v28, v230, v231
  v_fmamk_f32 v226, v4, 0x41200000, v7
  v_fmamk_f32 v227, v4, 0x41300000, v7
  v_cos_f32 v228, v226
  v_cos_f32 v229, v227
  v_sin_f32 v230, v226
  v_sin_f32 v231, v227
  v_cvt_pk_bf16_f32 v13, v228, v229
  v_cvt_pk_bf16_f32 v29, v230, v231
  v_xor_b32 v18, v8, v10
  v_xor_b32 v34, v8, v26
  v_xor_b32 v19, v8, v11
  v_xor_b32 v35, v8, v27
  v_xor_b32 v20, v8, v12
  v_xor_b32 v36, v8, v28
  v_xor_b32 v21, v8, v13
  v_xor_b32 v37, v8, v29
  v_fmamk_f32 v226, v4, 0x41800000, v7
  v_fmamk_f32 v227, v4, 0x41880000, v7
  v_cos_f32 v228, v226
  v_cos_f32 v229, v227
  v_sin_f32 v230, v226
  v_sin_f32 v231, v227
  v_cvt_pk_bf16_f32 v14, v228, v229
  v_cvt_pk_bf16_f32 v30, v230, v231
  v_fmamk_f32 v226, v4, 0x41900000, v7
  v_fmamk_f32 v227, v4, 0x41980000, v7
  v_cos_f32 v228, v226
  v_cos_f32 v229, v227
  v_sin_f32 v230, v226
  v_sin_f32 v231, v227
  v_cvt_pk_bf16_f32 v15, v228, v229
  v_cvt_pk_bf16_f32 v31, v230, v231
  v_fmamk_f32 v226, v4, 0x41c00000, v7
  v_fmamk_f32 v227, v4, 0x41c80000, v7
  v_cos_f32 v228, v226
  v_cos_f32 v229, v227
  v_sin_f32 v230, v226
  v_sin_f32 v231, v227
  v_cvt_pk_bf16_f32 v16, v228, v229
  v_cvt_pk_bf16_f32 v32, v230, v231
  v_fmamk_f32 v226, v4, 0x41d00000, v7
  v_fmamk_f32 v227, v4, 0x41d80000, v7
  v_cos_f32 v228, v226
  v_cos_f32 v229, v227
  v_sin_f32 v230, v226
  v_sin_f32 v231, v227
  v_cvt_pk_bf16_f32 v17, v228, v229
  v_cvt_pk_bf16_f32 v33, v230, v231
  v_xor_b32 v22, v8, v14
  v_xor_b32 v38, v8, v30
  v_xor_b32 v23, v8, v15
  v_xor_b32 v39, v8, v31
  v_xor_b32 v24, v8, v16
  v_xor_b32 v40, v8, v32
  v_xor_b32 v25, v8, v17
  v_xor_b32 v41, v8, v33
  v_xor_b32 v42, 0x80008000, v26
  v_xor_b32 v43, 0x80008000, v27
  v_xor_b32 v44, 0x80008000, v28
  v_xor_b32 v45, 0x80008000, v29
  v_xor_b32 v46, 0x80008000, v30
  v_xor_b32 v47, 0x80008000, v31
  v_xor_b32 v48, 0x80008000, v32
  v_xor_b32 v49, 0x80008000, v33
  v_xor_b32 v50, 0x80008000, v34
  v_xor_b32 v51, 0x80008000, v35
  v_xor_b32 v52, 0x80008000, v36
  v_xor_b32 v53, 0x80008000, v37
  v_xor_b32 v54, 0x80008000, v38
  v_xor_b32 v55, 0x80008000, v39
  v_xor_b32 v56, 0x80008000, v40
  v_xor_b32 v57, 0x80008000, v41
  s_waitcnt vmcnt(1)
  s_barrier
  ds_read_b128 v[162:165], v244 offset:0
  ds_read_b128 v[178:181], v246 offset:0
  ds_read_b128 v[166:169], v244 offset:4096
  ds_read_b128 v[182:185], v246 offset:4096
  ds_read_b128 v[170:173], v245 offset:0
  ds_read_b128 v[186:189], v247 offset:0
  ds_read_b128 v[174:177], v245 offset:4096
  ds_read_b128 v[190:193], v247 offset:4096
  buffer_load_dword v146, v255, s[12:15], s24 offen offset:0
  buffer_load_dword v147, v255, s[12:15], s24 offen offset:256
  buffer_load_dword v148, v255, s[12:15], s24 offen offset:512
  buffer_load_dword v149, v255, s[12:15], s24 offen offset:768
  buffer_load_dword v150, v255, s[12:15], s24 offen offset:1024
  buffer_load_dword v151, v255, s[12:15], s24 offen offset:1280
  buffer_load_dword v152, v255, s[12:15], s24 offen offset:1536
  buffer_load_dword v153, v255, s[12:15], s24 offen offset:1792
  buffer_load_dword v154, v255, s[12:15], s24 offen offset:2048
  buffer_load_dword v155, v255, s[12:15], s24 offen offset:2304
  buffer_load_dword v156, v255, s[12:15], s24 offen offset:2560
  buffer_load_dword v157, v255, s[12:15], s24 offen offset:2816
  buffer_load_dword v158, v255, s[12:15], s24 offen offset:3072
  buffer_load_dword v159, v255, s[12:15], s24 offen offset:3328
  buffer_load_dword v160, v255, s[12:15], s24 offen offset:3584
  buffer_load_dword v161, v255, s[12:15], s24 offen offset:3840
  v_and_b32 v252, 31, v1
  v_lshlrev_b32 v252, 7, v252
  s_lshl_b32 s60, s2, 14
  s_lshl_b32 s61, s20, 12
  s_add_u32 s60, s60, s61
  s_add_u32 s60, s60, 0
  s_mov_b32 exec_hi, 0
  buffer_load_dword v254, v252, s[56:59], s60 offen
  s_mov_b64 exec, -1
  s_waitcnt lgkmcnt(6)
  v_mfma_f32_32x32x16_bf16 v[194:209], v[162:165], v[10:13], 0
  v_fmamk_f32 v226, v234, 0x00000000, v235
  v_fmamk_f32 v227, v234, 0x3f800000, v235
  v_cos_f32 v82, v226
  v_cos_f32 v83, v227
  v_mfma_f32_32x32x16_bf16 v[210:225], v[178:181], v[10:13], 0
  v_sin_f32 v98, v226
  v_sin_f32 v99, v227
  v_fmamk_f32 v226, v234, 0x40000000, v235
  v_fmamk_f32 v227, v234, 0x40400000, v235
  v_mfma_f32_32x32x16_bf16 v[194:209], v[178:181], v[26:29], v[194:209]
  v_cos_f32 v84, v226
  v_cos_f32 v85, v227
  v_sin_f32 v100, v226
  v_mfma_f32_32x32x16_bf16 v[210:225], v[162:165], v[42:45], v[210:225]
  v_sin_f32 v101, v227
  v_fmamk_f32 v226, v234, 0x41000000, v235
  v_fmamk_f32 v227, v234, 0x41100000, v235
  v_cos_f32 v86, v226
  s_waitcnt lgkmcnt(4)
  v_mfma_f32_32x32x16_bf16 v[194:209], v[166:169], v[14:17], v[194:209]
  v_cos_f32 v87, v227
  v_sin_f32 v102, v226
  v_sin_f32 v103, v227
  v_mfma_f32_32x32x16_bf16 v[210:225], v[182:185], v[14:17], v[210:225]
  v_fmamk_f32 v226, v234, 0x41200000, v235
  v_fmamk_f32 v227, v234, 0x41300000, v235
  v_cos_f32 v88, v226
  v_cos_f32 v89, v227
  v_mfma_f32_32x32x16_bf16 v[194:209], v[182:185], v[30:33], v[194:209]
  v_sin_f32 v104, v226
  v_sin_f32 v105, v227
  v_fmamk_f32 v226, v234, 0x41800000, v235
  v_fmamk_f32 v227, v234, 0x41880000, v235
  v_mfma_f32_32x32x16_bf16 v[210:225], v[166:169], v[46:49], v[210:225]
  v_cos_f32 v90, v226
  v_cos_f32 v91, v227
  v_sin_f32 v106, v226
  s_waitcnt lgkmcnt(2)
  v_mfma_f32_32x32x16_bf16 v[194:209], v[170:173], v[18:21], v[194:209]
  v_sin_f32 v107, v227
  v_fmamk_f32 v226, v234, 0x41900000, v235
  v_fmamk_f32 v227, v234, 0x41980000, v235
  v_cos_f32 v92, v226
  v_mfma_f32_32x32x16_bf16 v[210:225], v[186:189], v[18:21], v[210:225]
  v_cos_f32 v93, v227
  v_sin_f32 v108, v226
  v_sin_f32 v109, v227
  v_mfma_f32_32x32x16_bf16 v[194:209], v[186:189], v[34:37], v[194:209]
  v_fmamk_f32 v226, v234, 0x41c00000, v235
  v_fmamk_f32 v227, v234, 0x41c80000, v235
  v_cos_f32 v94, v226
  v_cos_f32 v95, v227
  v_mfma_f32_32x32x16_bf16 v[210:225], v[170:173], v[50:53], v[210:225]
  v_sin_f32 v110, v226
  v_sin_f32 v111, v227
  v_fmamk_f32 v226, v234, 0x41d00000, v235
  v_fmamk_f32 v227, v234, 0x41d80000, v235
  s_waitcnt lgkmcnt(0)
  v_mfma_f32_32x32x16_bf16 v[194:209], v[174:177], v[22:25], v[194:209]
  v_cos_f32 v96, v226
  v_cos_f32 v97, v227
  v_sin_f32 v112, v226
  v_mfma_f32_32x32x16_bf16 v[210:225], v[190:193], v[22:25], v[210:225]
  v_sin_f32 v113, v227
  v_fmamk_f32 v226, v232, 0x00000000, v233
  v_fmamk_f32 v227, v232, 0x3f800000, v233
  v_cos_f32 v228, v226
  v_mfma_f32_32x32x16_bf16 v[194:209], v[190:193], v[38:41], v[194:209]
  v_cos_f32 v229, v227
  v_sin_f32 v230, v226
  v_sin_f32 v231, v227
  v_mfma_f32_32x32x16_bf16 v[210:225], v[174:177], v[54:57], v[210:225]
  v_cvt_pk_bf16_f32 v58, v228, v229
  v_cvt_pk_bf16_f32 v66, v230, v231
  v_fmamk_f32 v226, v232, 0x40000000, v233
  v_fmamk_f32 v227, v232, 0x40400000, v233
  v_cos_f32 v228, v226
  v_cos_f32 v229, v227
  v_sin_f32 v230, v226
  v_sin_f32 v231, v227
  v_cvt_pk_bf16_f32 v59, v228, v229
  v_cvt_pk_bf16_f32 v67, v230, v231
  v_fmamk_f32 v226, v232, 0x41000000, v233
  v_fmamk_f32 v227, v232, 0x41100000, v233
  v_cos_f32 v228, v226
  v_cos_f32 v229, v227
  v_sin_f32 v230, v226
  v_sin_f32 v231, v227
  v_cvt_pk_bf16_f32 v60, v228, v229
  v_cvt_pk_bf16_f32 v68, v230, v231
  v_fmamk_f32 v226, v232, 0x41200000, v233
  v_fmamk_f32 v227, v232, 0x41300000, v233
  v_cos_f32 v228, v226
  v_cos_f32 v229, v227
  v_sin_f32 v230, v226
  v_sin_f32 v231, v227
  v_cvt_pk_bf16_f32 v61, v228, v229
  v_cvt_pk_bf16_f32 v69, v230, v231
  v_xor_b32 v62, v8, v58
  v_xor_b32 v70, v8, v66
  v_xor_b32 v63, v8, v59
  v_xor_b32 v71, v8, v67
  v_xor_b32 v64, v8, v60
  v_xor_b32 v72, v8, v68
  v_xor_b32 v65, v8, v61
  v_xor_b32 v73, v8, v69
  v_xor_b32 v74, 0x80008000, v66
  v_xor_b32 v75, 0x80008000, v67
  v_xor_b32 v76, 0x80008000, v68
  v_xor_b32 v77, 0x80008000, v69
  v_xor_b32 v78, 0x80008000, v70
  v_xor_b32 v79, 0x80008000, v71
  v_xor_b32 v80, 0x80008000, v72
  v_xor_b32 v81, 0x80008000, v73
  s_nop 7
  s_nop 4
  v_pk_mul_f32 v[162:163], v[194:195], v[82:83]
  v_pk_mul_f32 v[178:179], v[210:211], v[82:83]
  v_pk_fma_f32 v[162:163], v[210:211], v[98:99], v[162:163] neg_lo:[1,0,0] neg_hi:[1,0,0]
  v_pk_fma_f32 v[178:179], v[194:195], v[98:99], v[178:179]
  v_pk_mul_f32 v[164:165], v[196:197], v[84:85]
  v_pk_mul_f32 v[180:181], v[212:213], v[84:85]
  v_pk_fma_f32 v[164:165], v[212:213], v[100:101], v[164:165] neg_lo:[1,0,0] neg_hi:[1,0,0]
  v_pk_fma_f32 v[180:181], v[196:197], v[100:101], v[180:181]
  v_pk_mul_f32 v[166:167], v[198:199], v[86:87]
  v_pk_mul_f32 v[182:183], v[214:215], v[86:87]
  v_pk_fma_f32 v[166:167], v[214:215], v[102:103], v[166:167] neg_lo:[1,0,0] neg_hi:[1,0,0]
  v_pk_fma_f32 v[182:183], v[198:199], v[102:103], v[182:183]
  v_pk_mul_f32 v[168:169], v[200:201], v[88:89]
  v_pk_mul_f32 v[184:185], v[216:217], v[88:89]
  v_pk_fma_f32 v[168:169], v[216:217], v[104:105], v[168:169] neg_lo:[1,0,0] neg_hi:[1,0,0]
  v_pk_fma_f32 v[184:185], v[200:201], v[104:105], v[184:185]
  v_pk_mul_f32 v[170:171], v[202:203], v[90:91]
  v_pk_mul_f32 v[186:187], v[218:219], v[90:91]
  v_pk_fma_f32 v[170:171], v[218:219], v[106:107], v[170:171] neg_lo:[1,0,0] neg_hi:[1,0,0]
  v_pk_fma_f32 v[186:187], v[202:203], v[106:107], v[186:187]
  v_pk_mul_f32 v[172:173], v[204:205], v[92:93]
  v_pk_mul_f32 v[188:189], v[220:221], v[92:93]
  v_pk_fma_f32 v[172:173], v[220:221], v[108:109], v[172:173] neg_lo:[1,0,0] neg_hi:[1,0,0]
  v_pk_fma_f32 v[188:189], v[204:205], v[108:109], v[188:189]
  v_pk_mul_f32 v[174:175], v[206:207], v[94:95]
  v_pk_mul_f32 v[190:191], v[222:223], v[94:95]
  v_pk_fma_f32 v[174:175], v[222:223], v[110:111], v[174:175] neg_lo:[1,0,0] neg_hi:[1,0,0]
  v_pk_fma_f32 v[190:191], v[206:207], v[110:111], v[190:191]
  v_pk_mul_f32 v[176:177], v[208:209], v[96:97]
  v_pk_mul_f32 v[192:193], v[224:225], v[96:97]
  v_pk_fma_f32 v[176:177], v[224:225], v[112:113], v[176:177] neg_lo:[1,0,0] neg_hi:[1,0,0]
  v_pk_fma_f32 v[192:193], v[208:209], v[112:113], v[192:193]
  v_cvt_pk_bf16_f32 v226, v162, v163
  v_cvt_pk_bf16_f32 v234, v178, v179
  v_cvt_pk_bf16_f32 v227, v164, v165
  v_cvt_pk_bf16_f32 v235, v180, v181
  v_cvt_pk_bf16_f32 v228, v166, v167
  v_cvt_pk_bf16_f32 v236, v182, v183
  v_cvt_pk_bf16_f32 v229, v168, v169
  v_cvt_pk_bf16_f32 v237, v184, v185
  v_cvt_pk_bf16_f32 v230, v170, v171
  v_cvt_pk_bf16_f32 v238, v186, v187
  v_cvt_pk_bf16_f32 v231, v172, v173
  v_cvt_pk_bf16_f32 v239, v188, v189
  v_cvt_pk_bf16_f32 v232, v174, v175
  v_cvt_pk_bf16_f32 v240, v190, v191
  v_cvt_pk_bf16_f32 v233, v176, v177
  v_cvt_pk_bf16_f32 v241, v192, v193
  s_nop 1
  v_mfma_f32_32x32x16_bf16 v[194:209], v[58:61], v[226:229], 0
  v_fmamk_f32 v242, v248, 0x00000000, v249
  v_fmamk_f32 v243, v248, 0x3f800000, v249
  v_cos_f32 v114, v242
  v_cos_f32 v115, v243
  v_mfma_f32_32x32x16_bf16 v[210:225], v[58:61], v[234:237], 0
  v_sin_f32 v130, v242
  v_sin_f32 v131, v243
  v_fmamk_f32 v242, v248, 0x40000000, v249
  v_fmamk_f32 v243, v248, 0x40400000, v249
  v_mfma_f32_32x32x16_bf16 v[194:209], v[66:69], v[234:237], v[194:209]
  v_cos_f32 v116, v242
  v_cos_f32 v117, v243
  v_sin_f32 v132, v242
  v_mfma_f32_32x32x16_bf16 v[210:225], v[74:77], v[226:229], v[210:225]
  v_sin_f32 v133, v243
  v_fmamk_f32 v242, v248, 0x41000000, v249
  v_fmamk_f32 v243, v248, 0x41100000, v249
  v_cos_f32 v118, v242
  v_mfma_f32_32x32x16_bf16 v[194:209], v[62:65], v[230:233], v[194:209]
  v_cos_f32 v119, v243
  v_sin_f32 v134, v242
  v_sin_f32 v135, v243
  v_mfma_f32_32x32x16_bf16 v[210:225], v[62:65], v[238:241], v[210:225]
  v_fmamk_f32 v242, v248, 0x41200000, v249
  v_fmamk_f32 v243, v248, 0x41300000, v249
  v_cos_f32 v120, v242
  v_cos_f32 v121, v243
  v_mfma_f32_32x32x16_bf16 v[194:209], v[70:73], v[238:241], v[194:209]
  v_sin_f32 v136, v242
  v_sin_f32 v137, v243
  v_fmamk_f32 v242, v248, 0x41800000, v249
  v_fmamk_f32 v243, v248, 0x41880000, v249
  v_mfma_f32_32x32x16_bf16 v[210:225], v[78:81], v[230:233], v[210:225]
  v_cos_f32 v122, v242
  v_cos_f32 v123, v243
  v_sin_f32 v138, v242
  v_sin_f32 v139, v243
  v_fmamk_f32 v242, v248, 0x41900000, v249
  v_fmamk_f32 v243, v248, 0x41980000, v249
  v_cos_f32 v124, v242
  v_cos_f32 v125, v243
  v_sin_f32 v140, v242
  v_sin_f32 v141, v243
  v_fmamk_f32 v242, v248, 0x41c00000, v249
  v_fmamk_f32 v243, v248, 0x41c80000, v249
  v_cos_f32 v126, v242
  v_cos_f32 v127, v243
  v_sin_f32 v142, v242
  v_sin_f32 v143, v243
  v_fmamk_f32 v242, v248, 0x41d00000, v249
  v_fmamk_f32 v243, v248, 0x41d80000, v249
  v_cos_f32 v128, v242
  v_cos_f32 v129, v243
  v_sin_f32 v144, v242
  v_sin_f32 v145, v243
  s_waitcnt vmcnt(1)
  v_lshlrev_b32 v162, 16, v146
  v_and_b32 v178, 0xffff0000, v146
  v_lshlrev_b32 v163, 16, v147
  v_and_b32 v179, 0xffff0000, v147
  v_lshlrev_b32 v164, 16, v148
  v_and_b32 v180, 0xffff0000, v148
  v_lshlrev_b32 v165, 16, v149
  v_and_b32 v181, 0xffff0000, v149
  v_lshlrev_b32 v166, 16, v150
  v_and_b32 v182, 0xffff0000, v150
  v_lshlrev_b32 v167, 16, v151
  v_and_b32 v183, 0xffff0000, v151
  v_lshlrev_b32 v168, 16, v152
  v_and_b32 v184, 0xffff0000, v152
  v_lshlrev_b32 v169, 16, v153
  v_and_b32 v185, 0xffff0000, v153
  v_lshlrev_b32 v170, 16, v154
  v_and_b32 v186, 0xffff0000, v154
  v_lshlrev_b32 v171, 16, v155
  v_and_b32 v187, 0xffff0000, v155
  v_lshlrev_b32 v172, 16, v156
  v_and_b32 v188, 0xffff0000, v156
  v_lshlrev_b32 v173, 16, v157
  v_and_b32 v189, 0xffff0000, v157
  v_lshlrev_b32 v174, 16, v158
  v_and_b32 v190, 0xffff0000, v158
  v_lshlrev_b32 v175, 16, v159
  v_and_b32 v191, 0xffff0000, v159
  v_lshlrev_b32 v176, 16, v160
  v_and_b32 v192, 0xffff0000, v160
  v_lshlrev_b32 v177, 16, v161
  v_and_b32 v193, 0xffff0000, v161
  v_pk_mul_f32 v[82:83], v[194:195], v[162:163]
  v_pk_mul_f32 v[98:99], v[210:211], v[162:163]
  v_pk_fma_f32 v[82:83], v[210:211], v[178:179], v[82:83] neg_lo:[1,0,0] neg_hi:[1,0,0]
  v_pk_fma_f32 v[98:99], v[194:195], v[178:179], v[98:99]
  v_pk_mul_f32 v[84:85], v[196:197], v[164:165]
  v_pk_mul_f32 v[100:101], v[212:213], v[164:165]
  v_pk_fma_f32 v[84:85], v[212:213], v[180:181], v[84:85] neg_lo:[1,0,0] neg_hi:[1,0,0]
  v_pk_fma_f32 v[100:101], v[196:197], v[180:181], v[100:101]
  v_pk_mul_f32 v[86:87], v[198:199], v[166:167]
  v_pk_mul_f32 v[102:103], v[214:215], v[166:167]
  v_pk_fma_f32 v[86:87], v[214:215], v[182:183], v[86:87] neg_lo:[1,0,0] neg_hi:[1,0,0]
  v_pk_fma_f32 v[102:103], v[198:199], v[182:183], v[102:103]
  v_pk_mul_f32 v[88:89], v[200:201], v[168:169]
  v_pk_mul_f32 v[104:105], v[216:217], v[168:169]
  v_pk_fma_f32 v[88:89], v[216:217], v[184:185], v[88:89] neg_lo:[1,0,0] neg_hi:[1,0,0]
  v_pk_fma_f32 v[104:105], v[200:201], v[184:185], v[104:105]
  v_pk_mul_f32 v[90:91], v[202:203], v[170:171]
  v_pk_mul_f32 v[106:107], v[218:219], v[170:171]
  v_pk_fma_f32 v[90:91], v[218:219], v[186:187], v[90:91] neg_lo:[1,0,0] neg_hi:[1,0,0]
  v_pk_fma_f32 v[106:107], v[202:203], v[186:187], v[106:107]
  v_pk_mul_f32 v[92:93], v[204:205], v[172:173]
  v_pk_mul_f32 v[108:109], v[220:221], v[172:173]
  v_pk_fma_f32 v[92:93], v[220:221], v[188:189], v[92:93] neg_lo:[1,0,0] neg_hi:[1,0,0]
  v_pk_fma_f32 v[108:109], v[204:205], v[188:189], v[108:109]
  v_pk_mul_f32 v[94:95], v[206:207], v[174:175]
  v_pk_mul_f32 v[110:111], v[222:223], v[174:175]
  v_pk_fma_f32 v[94:95], v[222:223], v[190:191], v[94:95] neg_lo:[1,0,0] neg_hi:[1,0,0]
  v_pk_fma_f32 v[110:111], v[206:207], v[190:191], v[110:111]
  v_pk_mul_f32 v[96:97], v[208:209], v[176:177]
  v_pk_mul_f32 v[112:113], v[224:225], v[176:177]
  v_pk_fma_f32 v[96:97], v[224:225], v[192:193], v[96:97] neg_lo:[1,0,0] neg_hi:[1,0,0]
  v_pk_fma_f32 v[112:113], v[208:209], v[192:193], v[112:113]
  v_cvt_pk_bf16_f32 v226, v82, v83
  v_cvt_pk_bf16_f32 v234, v98, v99
  v_cvt_pk_bf16_f32 v227, v84, v85
  v_cvt_pk_bf16_f32 v235, v100, v101
  v_cvt_pk_bf16_f32 v228, v86, v87
  v_cvt_pk_bf16_f32 v236, v102, v103
  v_cvt_pk_bf16_f32 v229, v88, v89
  v_cvt_pk_bf16_f32 v237, v104, v105
  v_cvt_pk_bf16_f32 v230, v90, v91
  v_cvt_pk_bf16_f32 v238, v106, v107
  v_cvt_pk_bf16_f32 v231, v92, v93
  v_cvt_pk_bf16_f32 v239, v108, v109
  v_cvt_pk_bf16_f32 v232, v94, v95
  v_cvt_pk_bf16_f32 v240, v110, v111
  v_cvt_pk_bf16_f32 v233, v96, v97
  v_cvt_pk_bf16_f32 v241, v112, v113
  s_nop 1
  v_mfma_f32_32x32x16_bf16 v[194:209], v[226:229], v[58:61], 0
  v_mfma_f32_32x32x16_bf16 v[210:225], v[234:237], v[58:61], 0
  v_mfma_f32_32x32x16_bf16 v[194:209], v[234:237], v[74:77], v[194:209]
  v_mfma_f32_32x32x16_bf16 v[210:225], v[226:229], v[66:69], v[210:225]
  v_mfma_f32_32x32x16_bf16 v[194:209], v[230:233], v[62:65], v[194:209]
  v_mfma_f32_32x32x16_bf16 v[210:225], v[238:241], v[62:65], v[210:225]
  v_mfma_f32_32x32x16_bf16 v[194:209], v[238:241], v[78:81], v[194:209]
  v_mfma_f32_32x32x16_bf16 v[210:225], v[230:233], v[70:73], v[210:225]
  v_lshlrev_b32 v2, 4, v1
  s_lshl_b32 s25, s20, 12
  v_add_u32 v3, s25, v2
  s_xor_b32 s25, s25, 4096
  v_add_u32 v4, s25, v2
  s_nop 7
  s_nop 5
  v_pk_mul_f32 v[162:163], v[194:195], v[114:115]
  v_pk_mul_f32 v[178:179], v[210:211], v[114:115]
  v_pk_fma_f32 v[162:163], v[210:211], v[130:131], v[162:163] neg_lo:[1,0,0] neg_hi:[1,0,0]
  v_pk_fma_f32 v[178:179], v[194:195], v[130:131], v[178:179]
  v_pk_mul_f32 v[164:165], v[196:197], v[116:117]
  v_pk_mul_f32 v[180:181], v[212:213], v[116:117]
  v_pk_fma_f32 v[164:165], v[212:213], v[132:133], v[164:165] neg_lo:[1,0,0] neg_hi:[1,0,0]
  v_pk_fma_f32 v[180:181], v[196:197], v[132:133], v[180:181]
  v_pk_mul_f32 v[166:167], v[198:199], v[118:119]
  v_pk_mul_f32 v[182:183], v[214:215], v[118:119]
  v_pk_fma_f32 v[166:167], v[214:215], v[134:135], v[166:167] neg_lo:[1,0,0] neg_hi:[1,0,0]
  v_pk_fma_f32 v[182:183], v[198:199], v[134:135], v[182:183]
  v_pk_mul_f32 v[168:169], v[200:201], v[120:121]
  v_pk_mul_f32 v[184:185], v[216:217], v[120:121]
  v_pk_fma_f32 v[168:169], v[216:217], v[136:137], v[168:169] neg_lo:[1,0,0] neg_hi:[1,0,0]
  v_pk_fma_f32 v[184:185], v[200:201], v[136:137], v[184:185]
  v_pk_mul_f32 v[170:171], v[202:203], v[122:123]
  v_pk_mul_f32 v[186:187], v[218:219], v[122:123]
  v_pk_fma_f32 v[170:171], v[218:219], v[138:139], v[170:171] neg_lo:[1,0,0] neg_hi:[1,0,0]
  v_pk_fma_f32 v[186:187], v[202:203], v[138:139], v[186:187]
  v_pk_mul_f32 v[172:173], v[204:205], v[124:125]
  v_pk_mul_f32 v[188:189], v[220:221], v[124:125]
  v_pk_fma_f32 v[172:173], v[220:221], v[140:141], v[172:173] neg_lo:[1,0,0] neg_hi:[1,0,0]
  v_pk_fma_f32 v[188:189], v[204:205], v[140:141], v[188:189]
  v_pk_mul_f32 v[174:175], v[206:207], v[126:127]
  v_pk_mul_f32 v[190:191], v[222:223], v[126:127]
  v_pk_fma_f32 v[174:175], v[222:223], v[142:143], v[174:175] neg_lo:[1,0,0] neg_hi:[1,0,0]
  v_pk_fma_f32 v[190:191], v[206:207], v[142:143], v[190:191]
  v_pk_mul_f32 v[176:177], v[208:209], v[128:129]
  v_pk_mul_f32 v[192:193], v[224:225], v[128:129]
  v_pk_fma_f32 v[176:177], v[224:225], v[144:145], v[176:177] neg_lo:[1,0,0] neg_hi:[1,0,0]
  v_pk_fma_f32 v[192:193], v[208:209], v[144:145], v[192:193]
  v_cvt_pk_bf16_f32 v226, v162, v163
  v_cvt_pk_bf16_f32 v234, v178, v179
  v_cvt_pk_bf16_f32 v227, v164, v165
  v_cvt_pk_bf16_f32 v235, v180, v181
  v_cvt_pk_bf16_f32 v228, v166, v167
  v_cvt_pk_bf16_f32 v236, v182, v183
  v_cvt_pk_bf16_f32 v229, v168, v169
  v_cvt_pk_bf16_f32 v237, v184, v185
  v_cvt_pk_bf16_f32 v230, v170, v171
  v_cvt_pk_bf16_f32 v238, v186, v187
  v_cvt_pk_bf16_f32 v231, v172, v173
  v_cvt_pk_bf16_f32 v239, v188, v189
  v_cvt_pk_bf16_f32 v232, v174, v175
  v_cvt_pk_bf16_f32 v240, v190, v191
  v_cvt_pk_bf16_f32 v233, v176, v177
  v_cvt_pk_bf16_f32 v241, v192, v193
  ds_write_b128 v3, v[226:229] offset:16384
  ds_write_b128 v3, v[234:237] offset:18432
  ds_write_b128 v3, v[230:233] offset:17408
  ds_write_b128 v3, v[238:241] offset:19456
  s_waitcnt lgkmcnt(0)
  s_barrier
  ds_read_b128 v[242:245], v4 offset:16384
  ds_read_b128 v[162:165], v4 offset:18432
  ds_read_b128 v[246:249], v4 offset:17408
  ds_read_b128 v[166:169], v4 offset:19456
  v_mfma_f32_32x32x16_bf16 v[194:209], v[10:13], v[226:229], 0
  v_mfma_f32_32x32x16_bf16 v[210:225], v[26:29], v[226:229], 0
  v_mfma_f32_32x32x16_bf16 v[194:209], v[42:45], v[234:237], v[194:209]
  v_mfma_f32_32x32x16_bf16 v[210:225], v[10:13], v[234:237], v[210:225]
  v_mfma_f32_32x32x16_bf16 v[194:209], v[14:17], v[230:233], v[194:209]
  v_mfma_f32_32x32x16_bf16 v[210:225], v[30:33], v[230:233], v[210:225]
  v_mfma_f32_32x32x16_bf16 v[194:209], v[46:49], v[238:241], v[194:209]
  v_mfma_f32_32x32x16_bf16 v[210:225], v[14:17], v[238:241], v[210:225]
  s_waitcnt lgkmcnt(0)
  v_mfma_f32_32x32x16_bf16 v[194:209], v[18:21], v[242:245], v[194:209]
  v_mfma_f32_32x32x16_bf16 v[210:225], v[34:37], v[242:245], v[210:225]
  v_mfma_f32_32x32x16_bf16 v[194:209], v[50:53], v[162:165], v[194:209]
  v_mfma_f32_32x32x16_bf16 v[210:225], v[18:21], v[162:165], v[210:225]
  v_mfma_f32_32x32x16_bf16 v[194:209], v[22:25], v[246:249], v[194:209]
  v_mfma_f32_32x32x16_bf16 v[210:225], v[38:41], v[246:249], v[210:225]
  v_mfma_f32_32x32x16_bf16 v[194:209], v[54:57], v[166:169], v[194:209]
  v_mfma_f32_32x32x16_bf16 v[210:225], v[22:25], v[166:169], v[210:225]
  s_bfe_u32 s25, s2, 0x30002
  v_and_b32 v2, 31, v1
  v_xor_b32 v2, s25, v2
  v_lshlrev_b32 v2, 3, v2
  v_lshrrev_b32 v3, 5, v1
  v_lshlrev_b32 v3, 10, v3
  v_add_u32 v2, v2, v3
  s_lshl_b32 s25, s21, 13
  s_lshl_b32 s26, s22, 2
  s_add_u32 s25, s25, s26
  v_add_u32 v2, s25, v2
  v_lshrrev_b32 v3, 3, v1
  v_lshlrev_b32 v3, 6, v3
  v_bfe_u32 v4, v1, 2, 1
  v_lshlrev_b32 v4, 9, v4
  v_add_u32 v3, v3, v4
  v_and_b32 v4, 3, v1
  v_lshlrev_b32 v4, 4, v4
  v_add_u32 v3, v3, v4
  s_lshl_b32 s25, s20, 12
  v_add_u32 v3, s25, v3
  v_lshrrev_b32 v4, 3, v1
  v_lshlrev_b32 v4, 15, v4
  v_bfe_u32 v7, v1, 2, 1
  v_lshlrev_b32 v7, 6, v7
  v_add_u32 v4, v4, v7
  v_and_b32 v7, 3, v1
  v_lshlrev_b32 v7, 4, v7
  v_add_u32 v4, v4, v7
  s_lshl_b32 s25, s2, 7
  s_lshl_b32 s26, s20, 20
  s_add_u32 s25, s25, s26
  s_nop 7
  s_nop 3
  v_cvt_pk_bf16_f32 v162, v194, v210
  v_cvt_pk_bf16_f32 v163, v195, v211
  v_cvt_pk_bf16_f32 v164, v196, v212
  v_cvt_pk_bf16_f32 v165, v197, v213
  v_cvt_pk_bf16_f32 v166, v198, v214
  v_cvt_pk_bf16_f32 v167, v199, v215
  v_cvt_pk_bf16_f32 v168, v200, v216
  v_cvt_pk_bf16_f32 v169, v201, v217
  v_cvt_pk_bf16_f32 v170, v202, v218
  v_cvt_pk_bf16_f32 v171, v203, v219
  v_cvt_pk_bf16_f32 v172, v204, v220
  v_cvt_pk_bf16_f32 v173, v205, v221
  v_cvt_pk_bf16_f32 v174, v206, v222
  v_cvt_pk_bf16_f32 v175, v207, v223
  v_cvt_pk_bf16_f32 v176, v208, v224
  v_cvt_pk_bf16_f32 v177, v209, v225
  ds_write_b32 v2, v162 offset:0
  ds_write_b32 v2, v163 offset:256
  ds_write_b32 v2, v164 offset:512
  ds_write_b32 v2, v165 offset:768
  ds_write_b32 v2, v166 offset:2048
  ds_write_b32 v2, v167 offset:2304
  ds_write_b32 v2, v168 offset:2560
  ds_write_b32 v2, v169 offset:2816
  ds_write_b32 v2, v170 offset:4096
  ds_write_b32 v2, v171 offset:4352
  ds_write_b32 v2, v172 offset:4608
  ds_write_b32 v2, v173 offset:4864
  ds_write_b32 v2, v174 offset:6144
  ds_write_b32 v2, v175 offset:6400
  ds_write_b32 v2, v176 offset:6656
  ds_write_b32 v2, v177 offset:6912
  s_waitcnt lgkmcnt(0)
  s_barrier
  ds_read_b128 v[194:197], v3 offset:0
  ds_read_b128 v[198:201], v3 offset:1024
  ds_read_b128 v[202:205], v3 offset:2048
  ds_read_b128 v[206:209], v3 offset:3072
  s_waitcnt lgkmcnt(3)
  s_add_u32 s26, s25, 0
  buffer_store_dwordx4 v[194:197], v4, s[16:19], s26 offen sc1
  s_waitcnt lgkmcnt(2)
  s_add_u32 s26, s25, 262144
  buffer_store_dwordx4 v[198:201], v4, s[16:19], s26 offen sc1
  s_waitcnt lgkmcnt(1)
  s_add_u32 s26, s25, 524288
  buffer_store_dwordx4 v[202:205], v4, s[16:19], s26 offen sc1
  s_waitcnt lgkmcnt(0)
  s_add_u32 s26, s25, 786432
  buffer_store_dwordx4 v[206:209], v4, s[16:19], s26 offen sc1
  s_endpgm
L_k2_end:
.globl k3_kernel
.p2align 8
.type k3_kernel,@function
k3_kernel:
  s_cmp_lt_u32 s2, 256
  s_cbranch_scc1 L_k3_p3
  s_cmp_lt_u32 s2, 512
  s_cbranch_scc1 L_k3_side
  s_endpgm
L_k3_side:
  s_load_dwordx2 s[4:5], s[0:1], 32
  s_load_dwordx2 s[6:7], s[0:1], 80
  v_and_b32 v1, 63, v0
  v_lshrrev_b32 v2, 6, v0
  s_nop 0
  v_readfirstlane_b32 s20, v2
  s_sub_u32 s21, s2, 256
  s_lshl_b32 s22, s20, 2
  s_cmp_eq_u32 s20, 3
  s_cselect_b32 s22, 11, s22
  s_lshl_b32 s25, s22, 10
  s_lshl_b32 s22, s22, 6
  v_add_u32 v2, s22, v1
  s_movk_i32 s23, 2341
  s_movk_i32 s24, 7168
  v_add_u32 v3, 0, v2
  v_mul_lo_u32 v4, v3, s23
  v_lshrrev_b32 v4, 16, v4
  v_mul_u32_u24 v5, 28, v4
  v_sub_u32 v5, v3, v5
  v_mul_lo_u32 v4, v4, s24
  v_lshlrev_b32 v5, 4, v5
  v_add_u32 v10, v4, v5
  v_add_u32 v3, 64, v2
  v_mul_lo_u32 v4, v3, s23
  v_lshrrev_b32 v4, 16, v4
  v_mul_u32_u24 v5, 28, v4
  v_sub_u32 v5, v3, v5
  v_mul_lo_u32 v4, v4, s24
  v_lshlrev_b32 v5, 4, v5
  v_add_u32 v11, v4, v5
  v_add_u32 v3, 128, v2
  v_mul_lo_u32 v4, v3, s23
  v_lshrrev_b32 v4, 16, v4
  v_mul_u32_u24 v5, 28, v4
  v_sub_u32 v5, v3, v5
  v_mul_lo_u32 v4, v4, s24
  v_lshlrev_b32 v5, 4, v5
  v_add_u32 v12, v4, v5
  v_add_u32 v3, 192, v2
  v_mul_lo_u32 v4, v3, s23
  v_lshrrev_b32 v4, 16, v4
  v_mul_u32_u24 v5, 28, v4
  v_sub_u32 v5, v3, v5
  v_mul_lo_u32 v4, v4, s24
  v_lshlrev_b32 v5, 4, v5
  v_add_u32 v13, v4, v5
  s_lshr_b32 s22, s21, 3
  s_mul_i32 s22, s22, 229376
  s_and_b32 s23, s21, 7
  s_mul_i32 s23, s23, 448
  s_add_u32 s22, s22, s23
  s_add_u32 s22, s22, 0
  s_waitcnt lgkmcnt(0)
  s_mov_b32 s8, s4
  s_and_b32 s9, s5, 0xffff
  s_mov_b32 s10, 7340032
  s_mov_b32 s11, 0x20000
  s_add_u32 s12, s6, 54525952
  s_addc_u32 s13, s7, 0
  s_and_b32 s13, s13, 0xffff
  s_mov_b32 s14, 7340032
  s_mov_b32 s15, 0x20000
  s_add_u32 m0, s25, 0
  s_nop 0
  buffer_load_dwordx4 v10, s[8:11], s22 offen lds
  s_add_u32 m0, s25, 1024
  s_nop 0
  buffer_load_dwordx4 v11, s[8:11], s22 offen lds
  s_add_u32 m0, s25, 2048
  s_nop 0
  buffer_load_dwordx4 v12, s[8:11], s22 offen lds
  s_cmp_ge_u32 s20, 2
  s_cbranch_scc1 L_pk_skip0
  s_add_u32 m0, s25, 3072
  s_nop 0
  buffer_load_dwordx4 v13, s[8:11], s22 offen lds
L_pk_skip0:
  v_lshrrev_b32 v2, 4, v1
  v_lshlrev_b32 v2, 3, v2
  v_bfe_u32 v3, v1, 2, 2
  v_add_u32 v2, v2, v3
  s_movk_i32 s24, 448
  v_mul_lo_u32 v2, v2, s24
  v_and_b32 v3, 3, v1
  v_lshlrev_b32 v3, 3, v3
  v_add_u32 v2, v2, v3
  s_lshr_b32 s24, s20, 1
  s_mul_i32 s24, s24, 224
  s_and_b32 s26, s20, 1
  s_lshl_b32 s26, s26, 7
  s_add_u32 s24, s24, s26
  v_add_u32 v2, s24, v2
  s_and_b32 s23, s21, 7
  s_lshl_b32 s23, s23, 1
  s_lshr_b32 s24, s20, 1
  s_add_u32 s23, s23, s24
  s_add_u32 s23, s23, 0
  s_lshl_b32 s23, s23, 5
  s_lshr_b32 s24, s21, 3
  s_add_u32 s23, s23, s24
  s_mul_i32 s23, s23, 7168
  s_lshl_b32 s26, s26, 5
  s_add_u32 s23, s23, s26
  v_lshlrev_b32 v3, 4, v1
  s_waitcnt vmcnt(0)
  s_barrier
  ds_read_b64_tr_b16 v[20:21], v2 offset:0
  ds_read_b64_tr_b16 v[22:23], v2 offset:1792
  ds_read_b64_tr_b16 v[24:25], v2 offset:32
  ds_read_b64_tr_b16 v[26:27], v2 offset:1824
  ds_read_b64_tr_b16 v[28:29], v2 offset:64
  ds_read_b64_tr_b16 v[30:31], v2 offset:1856
  ds_read_b64_tr_b16 v[32:33], v2 offset:96
  ds_read_b64_tr_b16 v[34:35], v2 offset:1888
  s_waitcnt lgkmcnt(6)
  s_add_u32 s24, s23, 0
  buffer_store_dwordx4 v[20:23], v3, s[12:15], s24 offen sc1
  s_waitcnt lgkmcnt(4)
  s_add_u32 s24, s23, 1024
  buffer_store_dwordx4 v[24:27], v3, s[12:15], s24 offen sc1
  s_waitcnt lgkmcnt(2)
  s_add_u32 s24, s23, 2048
  buffer_store_dwordx4 v[28:31], v3, s[12:15], s24 offen sc1
  s_bitcmp1_b32 s20, 0
  s_cbranch_scc1 L_pk_done0
  s_waitcnt lgkmcnt(0)
  s_add_u32 s24, s23, 3072
  buffer_store_dwordx4 v[32:35], v3, s[12:15], s24 offen sc1
L_pk_done0:
  s_endpgm
L_k3_p3:
  s_load_dwordx2 s[4:5], s[0:1], 0
  s_load_dwordx2 s[6:7], s[0:1], 80
  s_load_dwordx2 s[62:63], s[0:1], 40
  v_and_b32 v1, 63, v0
  v_lshrrev_b32 v2, 6, v0
  s_nop 0
  v_readfirstlane_b32 s24, v2
  v_lshlrev_b32 v2, 4, v1
  v_and_b32 v75, 31, v1
  v_lshlrev_b32 v75, 6, v75
  v_lshrrev_b32 v3, 5, v1
  v_lshlrev_b32 v3, 5, v3
  v_add_u32 v75, v75, v3
  s_lshl_b32 s25, s2, 3
  s_lshl_b32 s26, s24, 1
  s_add_u32 s25, s25, s26
  s_lshl_b32 s28, s25, 11
  s_add_u32 s29, s28, 2048
  s_waitcnt lgkmcnt(0)
  s_mov_b32 s8, s4
  s_and_b32 s9, s5, 0xffff
  s_mov_b32 s10, 4194304
  s_mov_b32 s11, 0x20000
  s_add_u32 s12, s6, 4194304
  s_addc_u32 s13, s7, 0
  s_and_b32 s13, s13, 0xffff
  s_mov_b32 s14, 4194304
  s_mov_b32 s15, 0x20000
  s_add_u32 s16, s6, 12582912
  s_addc_u32 s17, s7, 0
  s_and_b32 s17, s17, 0xffff
  s_mov_b32 s18, 4194304
  s_mov_b32 s19, 0x20000
  s_add_u32 s20, s6, 16777216
  s_addc_u32 s21, s7, 0
  s_and_b32 s21, s21, 0xffff
  s_mov_b32 s22, 4194304
  s_mov_b32 s23, 0x20000
  s_mov_b32 s56, s62
  s_and_b32 s57, s63, 0xffff
  s_mov_b32 s58, 8388608
  s_mov_b32 s59, 0x20000
  s_lshl_b32 s26, s24, 12
  s_mov_b32 m0, s26
  v_lshrrev_b32 v3, 2, v1
  v_lshlrev_b32 v3, 7, v3
  v_and_b32 v4, 3, v1
  v_lshlrev_b32 v4, 4, v4
  v_add_u32 v3, v3, v4
  s_lshr_b32 s27, s2, 4
  s_lshl_b32 s27, s27, 3
  s_and_b32 s37, s2, 7
  s_add_u32 s27, s27, s37
  s_lshl_b32 s27, s27, 15
  s_bfe_u32 s37, s2, 0x10003
  s_lshl_b32 s37, s37, 6
  s_add_u32 s27, s27, s37
  s_lshl_b32 s37, s24, 13
  s_add_u32 s27, s27, s37
  s_add_u32 s37, s27, 0
  buffer_load_dwordx4 v3, s[12:15], s37 offen offset:0 lds
  s_add_u32 s37, s27, 1024
  buffer_load_dwordx4 v3, s[12:15], s37 offen offset:1024 lds
  s_add_u32 s37, s27, 2048
  buffer_load_dwordx4 v3, s[12:15], s37 offen offset:2048 lds
  s_add_u32 s37, s27, 3072
  buffer_load_dwordx4 v3, s[12:15], s37 offen offset:3072 lds
  s_add_u32 s44, s6, 46137344
  s_addc_u32 s45, s7, 0
  s_and_b32 s45, s45, 0xffff
  s_mov_b32 s46, 262144
  s_mov_b32 s47, 0x20000
  s_add_u32 s48, s6, 46661632
  s_addc_u32 s49, s7, 0
  s_and_b32 s49, s49, 0xffff
  s_mov_b32 s50, 262144
  s_mov_b32 s51, 0x20000
  v_lshlrev_b32 v240, 4, v1
  s_lshl_b32 s36, s2, 10
  v_mov_b32 v244, 0xbf800000
  v_mov_b32 v245, 0xbf800000
  v_mov_b32 v246, 0xbf800000
  v_mov_b32 v247, 0xbf800000
  s_cmp_lg_u32 s24, 0
  s_cbranch_scc1 L_p3_nost
  buffer_store_dwordx4 v[244:247], v240, s[44:47], s36 offen sc1
L_p3_nost:
  s_cmp_lg_u32 s24, 1
  s_cbranch_scc1 L_p3_nofl
  v_mov_b32 v244, 0
  v_mov_b32 v245, 0
  v_mov_b32 v246, 0
  v_mov_b32 v247, 0
  buffer_store_dwordx4 v[244:247], v240, s[48:51], s36 offen sc1
L_p3_nofl:
  s_getpc_b64 s[40:41]
L_pf4:
  s_add_u32 s40, s40, (kg_kernel)-L_pf4
  s_addc_u32 s41, s41, 0
  v_lshlrev_b32 v250, 7, v1
  s_lshl_b32 s42, s24, 13
  v_add_u32 v250, s42, v250
  v_min_u32 v250, L_kg_end-(kg_kernel)-4, v250
  v_mov_b32 v251, s41
  v_add_co_u32 v250, s[42:43], s40, v250
  s_nop 1
  v_addc_co_u32 v251, s[42:43], 0, v251, s[42:43]
  global_load_dword v253, v[250:251], off
  s_getpc_b64 s[40:41]
L_pf5:
  s_add_u32 s40, s40, (kg_kernel)-L_pf5
  s_addc_u32 s41, s41, 0
  v_lshlrev_b32 v250, 7, v1
  v_add_u32 v250, 32768, v250
  s_lshl_b32 s42, s24, 13
  v_add_u32 v250, s42, v250
  v_min_u32 v250, L_kg_end-(kg_kernel)-4, v250
  v_mov_b32 v251, s41
  v_add_co_u32 v250, s[42:43], s40, v250
  s_nop 1
  v_addc_co_u32 v251, s[42:43], 0, v251, s[42:43]
  global_load_dword v254, v[250:251], off
  v_and_b32 v4, 31, v1
  v_cvt_f32_u32 v5, v4
  v_lshrrev_b32 v4, 5, v1
  v_cvt_f32_u32 v6, v4
  v_bfe_u32 v2, v1, 2, 1
  v_lshlrev_b32 v2, 4, v2
  v_bfe_u32 v3, v1, 3, 2
  v_lshlrev_b32 v3, 2, v3
  v_add_u32 v2, v2, v3
  v_and_b32 v3, 3, v1
  v_add_u32 v2, v2, v3
  v_cvt_f32_u32 v9, v2
  v_mul_f32 v4, 0x3d000000, v9
  v_mul_f32 v7, 4.0, v6
  v_mul_f32 v7, v7, v4
  v_fmamk_f32 v232, v4, 0x00000000, v7
  v_cos_f32 v233, v232
  v_sin_f32 v234, v232
  s_nop 0
  v_cvt_pk_bf16_f32 v10, v233, -v234
  v_cvt_pk_bf16_f32 v18, v234, v233
  v_fmamk_f32 v232, v4, 0x3f800000, v7
  v_cos_f32 v233, v232
  v_sin_f32 v234, v232
  s_nop 0
  v_cvt_pk_bf16_f32 v11, v233, -v234
  v_cvt_pk_bf16_f32 v19, v234, v233
  v_fmamk_f32 v232, v4, 0x40000000, v7
  v_cos_f32 v233, v232
  v_sin_f32 v234, v232
  s_nop 0
  v_cvt_pk_bf16_f32 v12, v233, -v234
  v_cvt_pk_bf16_f32 v20, v234, v233
  v_fmamk_f32 v232, v4, 0x40400000, v7
  v_cos_f32 v233, v232
  v_sin_f32 v234, v232
  s_nop 0
  v_cvt_pk_bf16_f32 v13, v233, -v234
  v_cvt_pk_bf16_f32 v21, v234, v233
  v_fmamk_f32 v232, v4, 0x41000000, v7
  v_cos_f32 v233, v232
  v_sin_f32 v234, v232
  s_nop 0
  v_cvt_pk_bf16_f32 v14, v233, -v234
  v_cvt_pk_bf16_f32 v22, v234, v233
  v_fmamk_f32 v232, v4, 0x41100000, v7
  v_cos_f32 v233, v232
  v_sin_f32 v234, v232
  s_nop 0
  v_cvt_pk_bf16_f32 v15, v233, -v234
  v_cvt_pk_bf16_f32 v23, v234, v233
  v_fmamk_f32 v232, v4, 0x41200000, v7
  v_cos_f32 v233, v232
  v_sin_f32 v234, v232
  s_nop 0
  v_cvt_pk_bf16_f32 v16, v233, -v234
  v_cvt_pk_bf16_f32 v24, v234, v233
  v_fmamk_f32 v232, v4, 0x41300000, v7
  v_cos_f32 v233, v232
  v_sin_f32 v234, v232
  s_nop 0
  v_cvt_pk_bf16_f32 v17, v233, -v234
  v_cvt_pk_bf16_f32 v25, v234, v233
  v_mul_f32 v4, 0x3d000000, v5
  v_mul_f32 v7, 4.0, v6
  v_mul_f32 v7, v7, v4
  v_fmamk_f32 v232, v4, 0x00000000, v7
  v_fmamk_f32 v233, v4, 0x3f800000, v7
  v_cos_f32 v234, v232
  v_cos_f32 v235, v233
  v_sin_f32 v236, v232
  v_sin_f32 v237, v233
  v_cvt_pk_bf16_f32 v26, v234, v235
  v_cvt_pk_bf16_f32 v34, -v236, -v237
  v_fmamk_f32 v232, v4, 0x40000000, v7
  v_fmamk_f32 v233, v4, 0x40400000, v7
  v_cos_f32 v234, v232
  v_cos_f32 v235, v233
  v_sin_f32 v236, v232
  v_sin_f32 v237, v233
  v_cvt_pk_bf16_f32 v27, v234, v235
  v_cvt_pk_bf16_f32 v35, -v236, -v237
  v_fmamk_f32 v232, v4, 0x41000000, v7
  v_fmamk_f32 v233, v4, 0x41100000, v7
  v_cos_f32 v234, v232
  v_cos_f32 v235, v233
  v_sin_f32 v236, v232
  v_sin_f32 v237, v233
  v_cvt_pk_bf16_f32 v28, v234, v235
  v_cvt_pk_bf16_f32 v36, -v236, -v237
  v_fmamk_f32 v232, v4, 0x41200000, v7
  v_fmamk_f32 v233, v4, 0x41300000, v7
  v_cos_f32 v234, v232
  v_cos_f32 v235, v233
  v_sin_f32 v236, v232
  v_sin_f32 v237, v233
  v_cvt_pk_bf16_f32 v29, v234, v235
  v_cvt_pk_bf16_f32 v37, -v236, -v237
  v_bfe_u32 v8, v1, 0, 1
  v_sub_u32 v8, 0, v8
  v_and_b32 v8, 0x80008000, v8
  v_xor_b32 v30, v8, v26
  v_xor_b32 v38, v8, v34
  v_xor_b32 v31, v8, v27
  v_xor_b32 v39, v8, v35
  v_xor_b32 v32, v8, v28
  v_xor_b32 v40, v8, v36
  v_xor_b32 v33, v8, v29
  v_xor_b32 v41, v8, v37
  v_mul_f32 v4, 0x3a800000, v9
  v_mul_f32 v7, 4.0, v6
  v_mul_f32 v7, v7, v4
  v_fmamk_f32 v232, v4, 0x00000000, v7
  v_fmamk_f32 v233, v4, 0x3f800000, v7
  v_cos_f32 v42, v232
  v_cos_f32 v43, v233
  v_sin_f32 v58, v232
  v_sin_f32 v59, v233
  v_fmamk_f32 v232, v4, 0x40000000, v7
  v_fmamk_f32 v233, v4, 0x40400000, v7
  v_cos_f32 v44, v232
  v_cos_f32 v45, v233
  v_sin_f32 v60, v232
  v_sin_f32 v61, v233
  v_fmamk_f32 v232, v4, 0x41000000, v7
  v_fmamk_f32 v233, v4, 0x41100000, v7
  v_cos_f32 v46, v232
  v_cos_f32 v47, v233
  v_sin_f32 v62, v232
  v_sin_f32 v63, v233
  v_fmamk_f32 v232, v4, 0x41200000, v7
  v_fmamk_f32 v233, v4, 0x41300000, v7
  v_cos_f32 v48, v232
  v_cos_f32 v49, v233
  v_sin_f32 v64, v232
  v_sin_f32 v65, v233
  v_fmamk_f32 v232, v4, 0x41800000, v7
  v_fmamk_f32 v233, v4, 0x41880000, v7
  v_cos_f32 v50, v232
  v_cos_f32 v51, v233
  v_sin_f32 v66, v232
  v_sin_f32 v67, v233
  v_fmamk_f32 v232, v4, 0x41900000, v7
  v_fmamk_f32 v233, v4, 0x41980000, v7
  v_cos_f32 v52, v232
  v_cos_f32 v53, v233
  v_sin_f32 v68, v232
  v_sin_f32 v69, v233
  v_fmamk_f32 v232, v4, 0x41c00000, v7
  v_fmamk_f32 v233, v4, 0x41c80000, v7
  v_cos_f32 v54, v232
  v_cos_f32 v55, v233
  v_sin_f32 v70, v232
  v_sin_f32 v71, v233
  v_fmamk_f32 v232, v4, 0x41d00000, v7
  v_fmamk_f32 v233, v4, 0x41d80000, v7
  v_cos_f32 v56, v232
  v_cos_f32 v57, v233
  v_sin_f32 v72, v232
  v_sin_f32 v73, v233
  v_and_b32 v2, 1, v1
  v_cvt_f32_u32 v2, v2
  v_sub_f32 v2, 0.5, v2
  v_cmp_gt_u32 vcc, 32, v1
  s_nop 1
  v_cndmask_b32 v74, 0, v2, vcc
  v_bfe_u32 v2, v1, 2, 3
  s_lshl_b32 s26, s24, 1
  v_and_b32 v3, 31, v1
  v_lshlrev_b32 v3, 6, v3
  v_lshrrev_b32 v4, 5, v1
  v_lshlrev_b32 v4, 12, v4
  v_add_u32 v3, v3, v4
  v_xor_b32 v7, s26, v2
  v_xor_b32 v8, 1, v7
  v_lshlrev_b32 v7, 3, v7
  v_lshlrev_b32 v8, 3, v8
  v_add_u32 v2, v3, v7
  v_add_u32 v3, v3, v8
  s_waitcnt vmcnt(2)
  s_barrier
  buffer_load_dwordx4 v[80:83], v75, s[8:11], s28 offen
  buffer_load_dwordx4 v[84:87], v75, s[8:11], s28 offen offset:16
  buffer_load_dwordx4 v[160:163], v75, s[8:11], s29 offen
  buffer_load_dwordx4 v[164:167], v75, s[8:11], s29 offen offset:16
  v_and_b32 v241, 31, v1
  v_lshlrev_b32 v241, 7, v241
  s_lshl_b32 s60, s2, 14
  s_lshl_b32 s61, s24, 12
  s_add_u32 s60, s60, s61
  s_add_u32 s60, s60, 4194304
  s_mov_b32 exec_hi, 0
  buffer_load_dword v242, v241, s[56:59], s60 offen
  s_mov_b64 exec, -1
  ds_read_b64 v[88:89], v2 offset:0
  ds_read_b64 v[90:91], v2 offset:2048
  ds_read_b64 v[92:93], v2 offset:8192
  ds_read_b64 v[94:95], v2 offset:10240
  ds_read_b64 v[168:169], v3 offset:0
  ds_read_b64 v[170:171], v3 offset:2048
  ds_read_b64 v[172:173], v3 offset:8192
  ds_read_b64 v[174:175], v3 offset:10240
  s_waitcnt lgkmcnt(0)
  s_barrier
  v_readlane_b32 s30, v88, 0
  v_readlane_b32 s31, v168, 0
  s_nop 0
  s_and_b32 s30, s30, 0xffff0000
  v_writelane_b32 v88, 0, 0
  s_and_b32 s31, s31, 0xffff0000
  v_writelane_b32 v168, 0, 0
  s_nop 1
  v_mfma_f32_32x32x16_bf16 v[96:111], v[88:91], v[10:13], 0
  v_mfma_f32_32x32x16_bf16 v[112:127], v[88:91], v[18:21], 0
  v_mfma_f32_32x32x16_bf16 v[176:191], v[168:171], v[10:13], 0
  v_mfma_f32_32x32x16_bf16 v[192:207], v[168:171], v[18:21], 0
  v_mfma_f32_32x32x16_bf16 v[96:111], v[92:95], v[14:17], v[96:111]
  v_mfma_f32_32x32x16_bf16 v[112:127], v[92:95], v[22:25], v[112:127]
  v_mfma_f32_32x32x16_bf16 v[176:191], v[172:175], v[14:17], v[176:191]
  v_mfma_f32_32x32x16_bf16 v[192:207], v[172:175], v[22:25], v[192:207]
  s_nop 7
  s_nop 7
  v_fmac_f32 v96, s30, v74
  v_fmac_f32 v176, s31, v74
  v_pk_mul_f32 v[128:129], v[96:97], v[42:43]
  v_pk_mul_f32 v[144:145], v[112:113], v[42:43]
  v_pk_fma_f32 v[128:129], v[112:113], v[58:59], v[128:129] neg_lo:[1,0,0] neg_hi:[1,0,0]
  v_pk_fma_f32 v[144:145], v[96:97], v[58:59], v[144:145]
  v_pk_mul_f32 v[130:131], v[98:99], v[44:45]
  v_pk_mul_f32 v[146:147], v[114:115], v[44:45]
  v_pk_fma_f32 v[130:131], v[114:115], v[60:61], v[130:131] neg_lo:[1,0,0] neg_hi:[1,0,0]
  v_pk_fma_f32 v[146:147], v[98:99], v[60:61], v[146:147]
  v_pk_mul_f32 v[132:133], v[100:101], v[46:47]
  v_pk_mul_f32 v[148:149], v[116:117], v[46:47]
  v_pk_fma_f32 v[132:133], v[116:117], v[62:63], v[132:133] neg_lo:[1,0,0] neg_hi:[1,0,0]
  v_pk_fma_f32 v[148:149], v[100:101], v[62:63], v[148:149]
  v_pk_mul_f32 v[134:135], v[102:103], v[48:49]
  v_pk_mul_f32 v[150:151], v[118:119], v[48:49]
  v_pk_fma_f32 v[134:135], v[118:119], v[64:65], v[134:135] neg_lo:[1,0,0] neg_hi:[1,0,0]
  v_pk_fma_f32 v[150:151], v[102:103], v[64:65], v[150:151]
  v_pk_mul_f32 v[136:137], v[104:105], v[50:51]
  v_pk_mul_f32 v[152:153], v[120:121], v[50:51]
  v_pk_fma_f32 v[136:137], v[120:121], v[66:67], v[136:137] neg_lo:[1,0,0] neg_hi:[1,0,0]
  v_pk_fma_f32 v[152:153], v[104:105], v[66:67], v[152:153]
  v_pk_mul_f32 v[138:139], v[106:107], v[52:53]
  v_pk_mul_f32 v[154:155], v[122:123], v[52:53]
  v_pk_fma_f32 v[138:139], v[122:123], v[68:69], v[138:139] neg_lo:[1,0,0] neg_hi:[1,0,0]
  v_pk_fma_f32 v[154:155], v[106:107], v[68:69], v[154:155]
  v_pk_mul_f32 v[140:141], v[108:109], v[54:55]
  v_pk_mul_f32 v[156:157], v[124:125], v[54:55]
  v_pk_fma_f32 v[140:141], v[124:125], v[70:71], v[140:141] neg_lo:[1,0,0] neg_hi:[1,0,0]
  v_pk_fma_f32 v[156:157], v[108:109], v[70:71], v[156:157]
  v_pk_mul_f32 v[142:143], v[110:111], v[56:57]
  v_pk_mul_f32 v[158:159], v[126:127], v[56:57]
  v_pk_fma_f32 v[142:143], v[126:127], v[72:73], v[142:143] neg_lo:[1,0,0] neg_hi:[1,0,0]
  v_pk_fma_f32 v[158:159], v[110:111], v[72:73], v[158:159]
  v_cvt_pk_bf16_f32 v88, v128, v129
  v_cvt_pk_bf16_f32 v120, v144, v145
  v_cvt_pk_bf16_f32 v89, v130, v131
  v_cvt_pk_bf16_f32 v121, v146, v147
  v_cvt_pk_bf16_f32 v90, v132, v133
  v_cvt_pk_bf16_f32 v122, v148, v149
  v_cvt_pk_bf16_f32 v91, v134, v135
  v_cvt_pk_bf16_f32 v123, v150, v151
  v_cvt_pk_bf16_f32 v92, v136, v137
  v_cvt_pk_bf16_f32 v124, v152, v153
  v_cvt_pk_bf16_f32 v93, v138, v139
  v_cvt_pk_bf16_f32 v125, v154, v155
  v_cvt_pk_bf16_f32 v94, v140, v141
  v_cvt_pk_bf16_f32 v126, v156, v157
  v_cvt_pk_bf16_f32 v95, v142, v143
  v_cvt_pk_bf16_f32 v127, v158, v159
  v_pk_mul_f32 v[208:209], v[176:177], v[42:43]
  v_pk_mul_f32 v[224:225], v[192:193], v[42:43]
  v_pk_fma_f32 v[208:209], v[192:193], v[58:59], v[208:209] neg_lo:[1,0,0] neg_hi:[1,0,0]
  v_pk_fma_f32 v[224:225], v[176:177], v[58:59], v[224:225]
  v_pk_mul_f32 v[210:211], v[178:179], v[44:45]
  v_pk_mul_f32 v[226:227], v[194:195], v[44:45]
  v_pk_fma_f32 v[210:211], v[194:195], v[60:61], v[210:211] neg_lo:[1,0,0] neg_hi:[1,0,0]
  v_pk_fma_f32 v[226:227], v[178:179], v[60:61], v[226:227]
  v_pk_mul_f32 v[212:213], v[180:181], v[46:47]
  v_pk_mul_f32 v[228:229], v[196:197], v[46:47]
  v_pk_fma_f32 v[212:213], v[196:197], v[62:63], v[212:213] neg_lo:[1,0,0] neg_hi:[1,0,0]
  v_pk_fma_f32 v[228:229], v[180:181], v[62:63], v[228:229]
  v_pk_mul_f32 v[214:215], v[182:183], v[48:49]
  v_pk_mul_f32 v[230:231], v[198:199], v[48:49]
  v_pk_fma_f32 v[214:215], v[198:199], v[64:65], v[214:215] neg_lo:[1,0,0] neg_hi:[1,0,0]
  v_pk_fma_f32 v[230:231], v[182:183], v[64:65], v[230:231]
  v_pk_mul_f32 v[216:217], v[184:185], v[50:51]
  v_pk_mul_f32 v[232:233], v[200:201], v[50:51]
  v_pk_fma_f32 v[216:217], v[200:201], v[66:67], v[216:217] neg_lo:[1,0,0] neg_hi:[1,0,0]
  v_pk_fma_f32 v[232:233], v[184:185], v[66:67], v[232:233]
  v_pk_mul_f32 v[218:219], v[186:187], v[52:53]
  v_pk_mul_f32 v[234:235], v[202:203], v[52:53]
  v_pk_fma_f32 v[218:219], v[202:203], v[68:69], v[218:219] neg_lo:[1,0,0] neg_hi:[1,0,0]
  v_pk_fma_f32 v[234:235], v[186:187], v[68:69], v[234:235]
  v_pk_mul_f32 v[220:221], v[188:189], v[54:55]
  v_pk_mul_f32 v[236:237], v[204:205], v[54:55]
  v_pk_fma_f32 v[220:221], v[204:205], v[70:71], v[220:221] neg_lo:[1,0,0] neg_hi:[1,0,0]
  v_pk_fma_f32 v[236:237], v[188:189], v[70:71], v[236:237]
  v_pk_mul_f32 v[222:223], v[190:191], v[56:57]
  v_pk_mul_f32 v[238:239], v[206:207], v[56:57]
  v_pk_fma_f32 v[222:223], v[206:207], v[72:73], v[222:223] neg_lo:[1,0,0] neg_hi:[1,0,0]
  v_pk_fma_f32 v[238:239], v[190:191], v[72:73], v[238:239]
  v_cvt_pk_bf16_f32 v168, v208, v209
  v_cvt_pk_bf16_f32 v200, v224, v225
  v_cvt_pk_bf16_f32 v169, v210, v211
  v_cvt_pk_bf16_f32 v201, v226, v227
  v_cvt_pk_bf16_f32 v170, v212, v213
  v_cvt_pk_bf16_f32 v202, v228, v229
  v_cvt_pk_bf16_f32 v171, v214, v215
  v_cvt_pk_bf16_f32 v203, v230, v231
  v_cvt_pk_bf16_f32 v172, v216, v217
  v_cvt_pk_bf16_f32 v204, v232, v233
  v_cvt_pk_bf16_f32 v173, v218, v219
  v_cvt_pk_bf16_f32 v205, v234, v235
  v_cvt_pk_bf16_f32 v174, v220, v221
  v_cvt_pk_bf16_f32 v206, v236, v237
  v_cvt_pk_bf16_f32 v175, v222, v223
  v_cvt_pk_bf16_f32 v207, v238, v239
  s_nop 1
  v_mfma_f32_32x32x16_bf16 v[96:111], v[88:91], v[26:29], 0
  v_mfma_f32_32x32x16_bf16 v[176:191], v[168:171], v[26:29], 0
  v_mfma_f32_32x32x16_bf16 v[96:111], v[120:123], v[34:37], v[96:111]
  v_mfma_f32_32x32x16_bf16 v[176:191], v[200:203], v[34:37], v[176:191]
  v_mfma_f32_32x32x16_bf16 v[96:111], v[92:95], v[30:33], v[96:111]
  v_mfma_f32_32x32x16_bf16 v[176:191], v[172:175], v[30:33], v[176:191]
  v_mfma_f32_32x32x16_bf16 v[96:111], v[124:127], v[38:41], v[96:111]
  v_mfma_f32_32x32x16_bf16 v[176:191], v[204:207], v[38:41], v[176:191]
  s_waitcnt vmcnt(1)
  v_lshlrev_b32 v128, 16, v80
  v_and_b32 v129, 0xffff0000, v80
  v_lshlrev_b32 v130, 16, v81
  v_and_b32 v131, 0xffff0000, v81
  v_lshlrev_b32 v132, 16, v82
  v_and_b32 v133, 0xffff0000, v82
  v_lshlrev_b32 v134, 16, v83
  v_and_b32 v135, 0xffff0000, v83
  v_lshlrev_b32 v136, 16, v84
  v_and_b32 v137, 0xffff0000, v84
  v_lshlrev_b32 v138, 16, v85
  v_and_b32 v139, 0xffff0000, v85
  v_lshlrev_b32 v140, 16, v86
  v_and_b32 v141, 0xffff0000, v86
  v_lshlrev_b32 v142, 16, v87
  v_and_b32 v143, 0xffff0000, v87
  v_lshlrev_b32 v208, 16, v160
  v_and_b32 v209, 0xffff0000, v160
  v_lshlrev_b32 v210, 16, v161
  v_and_b32 v211, 0xffff0000, v161
  v_lshlrev_b32 v212, 16, v162
  v_and_b32 v213, 0xffff0000, v162
  v_lshlrev_b32 v214, 16, v163
  v_and_b32 v215, 0xffff0000, v163
  v_lshlrev_b32 v216, 16, v164
  v_and_b32 v217, 0xffff0000, v164
  v_lshlrev_b32 v218, 16, v165
  v_and_b32 v219, 0xffff0000, v165
  v_lshlrev_b32 v220, 16, v166
  v_and_b32 v221, 0xffff0000, v166
  v_lshlrev_b32 v222, 16, v167
  v_and_b32 v223, 0xffff0000, v167
  s_nop 7
  s_nop 3
  v_mov_b32 v238, 0x35800000
  v_mov_b32 v239, v238
  v_pk_fma_f32 v[96:97], v[96:97], v[238:239], v[128:129]
  v_pk_fma_f32 v[98:99], v[98:99], v[238:239], v[130:131]
  v_pk_fma_f32 v[100:101], v[100:101], v[238:239], v[132:133]
  v_pk_fma_f32 v[102:103], v[102:103], v[238:239], v[134:135]
  v_pk_fma_f32 v[104:105], v[104:105], v[238:239], v[136:137]
  v_pk_fma_f32 v[106:107], v[106:107], v[238:239], v[138:139]
  v_pk_fma_f32 v[108:109], v[108:109], v[238:239], v[140:141]
  v_pk_fma_f32 v[110:111], v[110:111], v[238:239], v[142:143]
  v_cvt_pk_bf16_f32 v80, v96, v97
  v_cvt_pk_bf16_f32 v81, v98, v99
  v_cvt_pk_bf16_f32 v82, v100, v101
  v_cvt_pk_bf16_f32 v83, v102, v103
  v_cvt_pk_bf16_f32 v84, v104, v105
  v_cvt_pk_bf16_f32 v85, v106, v107
  v_cvt_pk_bf16_f32 v86, v108, v109
  v_cvt_pk_bf16_f32 v87, v110, v111
  v_lshlrev_b32 v96, 16, v80
  v_and_b32 v97, 0xffff0000, v80
  v_lshlrev_b32 v98, 16, v81
  v_and_b32 v99, 0xffff0000, v81
  v_lshlrev_b32 v100, 16, v82
  v_and_b32 v101, 0xffff0000, v82
  v_lshlrev_b32 v102, 16, v83
  v_and_b32 v103, 0xffff0000, v83
  v_lshlrev_b32 v104, 16, v84
  v_and_b32 v105, 0xffff0000, v84
  v_lshlrev_b32 v106, 16, v85
  v_and_b32 v107, 0xffff0000, v85
  v_lshlrev_b32 v108, 16, v86
  v_and_b32 v109, 0xffff0000, v86
  v_lshlrev_b32 v110, 16, v87
  v_and_b32 v111, 0xffff0000, v87
  v_pk_fma_f32 v[176:177], v[176:177], v[238:239], v[208:209]
  v_pk_fma_f32 v[178:179], v[178:179], v[238:239], v[210:211]
  v_pk_fma_f32 v[180:181], v[180:181], v[238:239], v[212:213]
  v_pk_fma_f32 v[182:183], v[182:183], v[238:239], v[214:215]
  v_pk_fma_f32 v[184:185], v[184:185], v[238:239], v[216:217]
  v_pk_fma_f32 v[186:187], v[186:187], v[238:239], v[218:219]
  v_pk_fma_f32 v[188:189], v[188:189], v[238:239], v[220:221]
  v_pk_fma_f32 v[190:191], v[190:191], v[238:239], v[222:223]
  v_cvt_pk_bf16_f32 v160, v176, v177
  v_cvt_pk_bf16_f32 v161, v178, v179
  v_cvt_pk_bf16_f32 v162, v180, v181
  v_cvt_pk_bf16_f32 v163, v182, v183
  v_cvt_pk_bf16_f32 v164, v184, v185
  v_cvt_pk_bf16_f32 v165, v186, v187
  v_cvt_pk_bf16_f32 v166, v188, v189
  v_cvt_pk_bf16_f32 v167, v190, v191
  v_lshlrev_b32 v176, 16, v160
  v_and_b32 v177, 0xffff0000, v160
  v_lshlrev_b32 v178, 16, v161
  v_and_b32 v179, 0xffff0000, v161
  v_lshlrev_b32 v180, 16, v162
  v_and_b32 v181, 0xffff0000, v162
  v_lshlrev_b32 v182, 16, v163
  v_and_b32 v183, 0xffff0000, v163
  v_lshlrev_b32 v184, 16, v164
  v_and_b32 v185, 0xffff0000, v164
  v_lshlrev_b32 v186, 16, v165
  v_and_b32 v187, 0xffff0000, v165
  v_lshlrev_b32 v188, 16, v166
  v_and_b32 v189, 0xffff0000, v166
  v_lshlrev_b32 v190, 16, v167
  v_and_b32 v191, 0xffff0000, v167
  v_pk_add_f32 v[128:129], v[96:97], v[98:99]
  v_pk_add_f32 v[130:131], v[100:101], v[102:103]
  v_pk_add_f32 v[128:129], v[128:129], v[104:105]
  v_pk_add_f32 v[130:131], v[130:131], v[106:107]
  v_pk_add_f32 v[128:129], v[128:129], v[108:109]
  v_pk_add_f32 v[130:131], v[130:131], v[110:111]
  v_pk_add_f32 v[128:129], v[128:129], v[130:131]
  v_add_f32 v128, v128, v129
  v_pk_add_f32 v[208:209], v[176:177], v[178:179]
  v_pk_add_f32 v[210:211], v[180:181], v[182:183]
  v_pk_add_f32 v[208:209], v[208:209], v[184:185]
  v_pk_add_f32 v[210:211], v[210:211], v[186:187]
  v_pk_add_f32 v[208:209], v[208:209], v[188:189]
  v_pk_add_f32 v[210:211], v[210:211], v[190:191]
  v_pk_add_f32 v[208:209], v[208:209], v[210:211]
  v_add_f32 v208, v208, v209
  s_nop 1
  v_add_f32_dpp v128, v128, v128 row_ror:8 row_mask:0xf bank_mask:0xf
  v_add_f32_dpp v208, v208, v208 row_ror:8 row_mask:0xf bank_mask:0xf
  s_nop 0
  v_add_f32_dpp v128, v128, v128 row_ror:4 row_mask:0xf bank_mask:0xf
  v_add_f32_dpp v208, v208, v208 row_ror:4 row_mask:0xf bank_mask:0xf
  s_nop 0
  v_add_f32_dpp v128, v128, v128 row_ror:2 row_mask:0xf bank_mask:0xf
  v_add_f32_dpp v208, v208, v208 row_ror:2 row_mask:0xf bank_mask:0xf
  s_nop 0
  v_add_f32_dpp v128, v128, v128 row_ror:1 row_mask:0xf bank_mask:0xf
  v_add_f32_dpp v208, v208, v208 row_ror:1 row_mask:0xf bank_mask:0xf
  s_nop 0
  v_add_f32_dpp v128, v128, v128 row_bcast:15 row_mask:0xa bank_mask:0xf
  v_add_f32_dpp v208, v208, v208 row_bcast:15 row_mask:0xa bank_mask:0xf
  s_nop 0
  v_add_f32_dpp v128, v128, v128 row_bcast:31 row_mask:0xc bank_mask:0xf
  v_add_f32_dpp v208, v208, v208 row_bcast:31 row_mask:0xc bank_mask:0xf
  s_nop 1
  v_readlane_b32 s32, v128, 63
  v_readlane_b32 s33, v208, 63
  s_nop 1
  v_mov_b32 v134, s32
  v_mul_f32 v134, 0xba800000, v134
  v_mov_b32 v135, v134
  v_mov_b32 v214, s33
  v_mul_f32 v214, 0xba800000, v214
  v_mov_b32 v215, v214
  v_pk_add_f32 v[96:97], v[96:97], v[134:135]
  v_pk_add_f32 v[98:99], v[98:99], v[134:135]
  v_pk_add_f32 v[100:101], v[100:101], v[134:135]
  v_pk_add_f32 v[102:103], v[102:103], v[134:135]
  v_pk_add_f32 v[104:105], v[104:105], v[134:135]
  v_pk_add_f32 v[106:107], v[106:107], v[134:135]
  v_pk_add_f32 v[108:109], v[108:109], v[134:135]
  v_pk_add_f32 v[110:111], v[110:111], v[134:135]
  v_pk_add_f32 v[176:177], v[176:177], v[214:215]
  v_pk_add_f32 v[178:179], v[178:179], v[214:215]
  v_pk_add_f32 v[180:181], v[180:181], v[214:215]
  v_pk_add_f32 v[182:183], v[182:183], v[214:215]
  v_pk_add_f32 v[184:185], v[184:185], v[214:215]
  v_pk_add_f32 v[186:187], v[186:187], v[214:215]
  v_pk_add_f32 v[188:189], v[188:189], v[214:215]
  v_pk_add_f32 v[190:191], v[190:191], v[214:215]
  v_pk_mul_f32 v[128:129], v[96:97], v[96:97]
  v_pk_mul_f32 v[130:131], v[98:99], v[98:99]
  v_pk_fma_f32 v[128:129], v[100:101], v[100:101], v[128:129]
  v_pk_fma_f32 v[130:131], v[102:103], v[102:103], v[130:131]
  v_pk_fma_f32 v[128:129], v[104:105], v[104:105], v[128:129]
  v_pk_fma_f32 v[130:131], v[106:107], v[106:107], v[130:131]
  v_pk_fma_f32 v[128:129], v[108:109], v[108:109], v[128:129]
  v_pk_fma_f32 v[130:131], v[110:111], v[110:111], v[130:131]
  v_pk_add_f32 v[128:129], v[128:129], v[130:131]
  v_add_f32 v128, v128, v129
  v_pk_mul_f32 v[208:209], v[176:177], v[176:177]
  v_pk_mul_f32 v[210:211], v[178:179], v[178:179]
  v_pk_fma_f32 v[208:209], v[180:181], v[180:181], v[208:209]
  v_pk_fma_f32 v[210:211], v[182:183], v[182:183], v[210:211]
  v_pk_fma_f32 v[208:209], v[184:185], v[184:185], v[208:209]
  v_pk_fma_f32 v[210:211], v[186:187], v[186:187], v[210:211]
  v_pk_fma_f32 v[208:209], v[188:189], v[188:189], v[208:209]
  v_pk_fma_f32 v[210:211], v[190:191], v[190:191], v[210:211]
  v_pk_add_f32 v[208:209], v[208:209], v[210:211]
  v_add_f32 v208, v208, v209
  s_nop 1
  v_add_f32_dpp v128, v128, v128 row_ror:8 row_mask:0xf bank_mask:0xf
  v_add_f32_dpp v208, v208, v208 row_ror:8 row_mask:0xf bank_mask:0xf
  s_nop 0
  v_add_f32_dpp v128, v128, v128 row_ror:4 row_mask:0xf bank_mask:0xf
  v_add_f32_dpp v208, v208, v208 row_ror:4 row_mask:0xf bank_mask:0xf
  s_nop 0
  v_add_f32_dpp v128, v128, v128 row_ror:2 row_mask:0xf bank_mask:0xf
  v_add_f32_dpp v208, v208, v208 row_ror:2 row_mask:0xf bank_mask:0xf
  s_nop 0
  v_add_f32_dpp v128, v128, v128 row_ror:1 row_mask:0xf bank_mask:0xf
  v_add_f32_dpp v208, v208, v208 row_ror:1 row_mask:0xf bank_mask:0xf
  s_nop 0
  v_add_f32_dpp v128, v128, v128 row_bcast:15 row_mask:0xa bank_mask:0xf
  v_add_f32_dpp v208, v208, v208 row_bcast:15 row_mask:0xa bank_mask:0xf
  s_nop 0
  v_add_f32_dpp v128, v128, v128 row_bcast:31 row_mask:0xc bank_mask:0xf
  v_add_f32_dpp v208, v208, v208 row_bcast:31 row_mask:0xc bank_mask:0xf
  s_nop 1
  v_readlane_b32 s34, v128, 63
  v_readlane_b32 s35, v208, 63
  s_nop 1
  v_mov_b32 v132, s34
  v_mov_b32 v212, s35
  v_mul_f32 v132, 0x3a800000, v132
  v_mul_f32 v212, 0x3a800000, v212
  v_add_f32 v132, 0x3727c5ac, v132
  v_add_f32 v212, 0x3727c5ac, v212
  v_rsq_f32 v132, v132
  v_rsq_f32 v212, v212
  s_nop 0
  s_nop 0
  v_mov_b32 v133, v132
  v_mov_b32 v213, v212
  v_pk_mul_f32 v[96:97], v[96:97], v[132:133]
  v_pk_mul_f32 v[98:99], v[98:99], v[132:133]
  v_pk_mul_f32 v[100:101], v[100:101], v[132:133]
  v_pk_mul_f32 v[102:103], v[102:103], v[132:133]
  v_pk_mul_f32 v[104:105], v[104:105], v[132:133]
  v_pk_mul_f32 v[106:107], v[106:107], v[132:133]
  v_pk_mul_f32 v[108:109], v[108:109], v[132:133]
  v_pk_mul_f32 v[110:111], v[110:111], v[132:133]
  v_cvt_pk_bf16_f32 v144, v96, v97
  v_cvt_pk_bf16_f32 v145, v98, v99
  v_cvt_pk_bf16_f32 v146, v100, v101
  v_cvt_pk_bf16_f32 v147, v102, v103
  v_cvt_pk_bf16_f32 v148, v104, v105
  v_cvt_pk_bf16_f32 v149, v106, v107
  v_cvt_pk_bf16_f32 v150, v108, v109
  v_cvt_pk_bf16_f32 v151, v110, v111
  v_pk_mul_f32 v[176:177], v[176:177], v[212:213]
  v_pk_mul_f32 v[178:179], v[178:179], v[212:213]
  v_pk_mul_f32 v[180:181], v[180:181], v[212:213]
  v_pk_mul_f32 v[182:183], v[182:183], v[212:213]
  v_pk_mul_f32 v[184:185], v[184:185], v[212:213]
  v_pk_mul_f32 v[186:187], v[186:187], v[212:213]
  v_pk_mul_f32 v[188:189], v[188:189], v[212:213]
  v_pk_mul_f32 v[190:191], v[190:191], v[212:213]
  v_cvt_pk_bf16_f32 v224, v176, v177
  v_cvt_pk_bf16_f32 v225, v178, v179
  v_cvt_pk_bf16_f32 v226, v180, v181
  v_cvt_pk_bf16_f32 v227, v182, v183
  v_cvt_pk_bf16_f32 v228, v184, v185
  v_cvt_pk_bf16_f32 v229, v186, v187
  v_cvt_pk_bf16_f32 v230, v188, v189
  v_cvt_pk_bf16_f32 v231, v190, v191
  s_lshl_b32 s26, s24, 12
  v_add_u32 v2, s26, v75
  v_lshlrev_b32 v3, 4, v1
  v_add_u32 v4, s26, v3
  ds_write_b128 v2, v[144:147] offset:0
  ds_write_b128 v2, v[148:151] offset:16
  ds_write_b128 v2, v[224:227] offset:2048
  ds_write_b128 v2, v[228:231] offset:2064
  v_rcp_f32 v245, v132
  v_sub_f32 v244, 0, v134
  v_rcp_f32 v247, v212
  v_sub_f32 v246, 0, v214
  s_waitcnt lgkmcnt(0)
  ds_read_b128 v[80:83], v4 offset:0
  ds_read_b128 v[84:87], v4 offset:1024
  ds_read_b128 v[160:163], v4 offset:2048
  ds_read_b128 v[164:167], v4 offset:3072
  s_lshl_b32 s26, s25, 3
  v_mov_b32 v248, 0
  s_mov_b64 exec, 1
  buffer_store_dwordx4 v[244:247], v248, s[16:19], s26 offen sc1
  s_mov_b64 exec, -1
  s_waitcnt lgkmcnt(3)
  buffer_store_dwordx4 v[80:83], v3, s[20:23], s28 offen offset:0 sc1
  s_waitcnt lgkmcnt(2)
  buffer_store_dwordx4 v[84:87], v3, s[20:23], s28 offen offset:1024 sc1
  s_waitcnt lgkmcnt(1)
  buffer_store_dwordx4 v[160:163], v3, s[20:23], s29 offen offset:0 sc1
  s_waitcnt lgkmcnt(0)
  buffer_store_dwordx4 v[164:167], v3, s[20:23], s29 offen offset:1024 sc1
  s_endpgm
L_k3_end:
.globl kg_kernel
.p2align 8
.type kg_kernel,@function
kg_kernel:
  s_cmp_ge_u32 s2, 256
  s_cbranch_scc1 L_kg_end
  s_load_dwordx2 s[4:5], s[0:1], 80
  s_load_dwordx4 s[92:95], s[0:1], 40
  s_load_dwordx4 s[96:99], s[0:1], 56
  v_lshrrev_b32 v1, 6, v0
  v_and_b32 v14, 63, v0
  v_readfirstlane_b32 s62, v1
  s_and_b32 s3, s2, 7
  s_lshr_b32 s58, s2, 3
  s_and_b32 s59, s58, 3
  s_lshr_b32 s60, s58, 2
  s_lshr_b32 s53, s3, 1
  s_lshl_b32 s53, s53, 2
  s_add_u32 s53, s53, s59
  s_and_b32 s54, s3, 1
  s_lshl_b32 s54, s54, 3
  s_add_u32 s54, s54, s60
  s_and_b32 s52, s62, 3
  s_add_u32 s55, s52, s60
  s_and_b32 s55, s55, 3
  s_lshl_b32 s56, s59, 1
  s_and_b32 s57, s56, 2
  s_cmp_ge_u32 s62, 4
  s_cbranch_scc0 L_kg_compute
  v_lshrrev_b32 v1, 3, v14
  s_lshl_b32 s58, s53, 7
  s_lshl_b32 s59, s55, 5
  s_add_u32 s58, s58, s59
  v_add_u32 v30, s58, v1
  v_and_b32 v7, 7, v14
  v_bfe_u32 v15, v14, 4, 1
  v_xor_b32 v31, v7, v15
  v_lshlrev_b32 v25, 11, v30
  v_xor_b32 v15, 0, v31
  v_lshlrev_b32 v15, 4, v15
  v_add_u32 v15, v25, v15
  v_add_u32 v2, 0, v15
  v_xor_b32 v15, 2, v31
  v_lshlrev_b32 v15, 4, v15
  v_add_u32 v15, v25, v15
  v_add_u32 v3, 15360, v15
  v_xor_b32 v15, 4, v31
  v_lshlrev_b32 v15, 4, v15
  v_add_u32 v15, v25, v15
  v_add_u32 v4, 30720, v15
  v_xor_b32 v15, 6, v31
  v_lshlrev_b32 v15, 4, v15
  v_add_u32 v15, v25, v15
  v_add_u32 v5, 46080, v15
  v_lshlrev_b32 v32, 4, v14
  s_lshl_b32 s58, s52, 2
  s_lshr_b32 s59, 17952, s58
  s_and_b32 s59, s59, 15
  s_add_u32 s59, s59, s56
  s_sub_u32 s60, s59, 7
  s_cmp_ge_u32 s59, 7
  s_cselect_b32 s59, s60, s59
  s_lshr_b32 s60, 28672, s58
  s_and_b32 s60, s60, 15
  s_add_u32 s59, s59, s60
  s_lshl_b32 s59, s59, 10
  s_add_u32 s59, s59, 3072
  v_add_u32 v16, s59, v32
  s_lshr_b32 s59, 21041, s58
  s_and_b32 s59, s59, 15
  s_add_u32 s59, s59, s56
  s_sub_u32 s60, s59, 7
  s_cmp_ge_u32 s59, 7
  s_cselect_b32 s59, s60, s59
  s_lshr_b32 s60, 30464, s58
  s_and_b32 s60, s60, 15
  s_add_u32 s59, s59, s60
  s_lshl_b32 s59, s59, 10
  s_add_u32 s59, s59, 2048
  v_add_u32 v17, s59, v32
  s_lshr_b32 s59, 25408, s58
  s_and_b32 s59, s59, 15
  s_add_u32 s59, s59, s56
  s_sub_u32 s60, s59, 7
  s_cmp_ge_u32 s59, 7
  s_cselect_b32 s59, s60, s59
  s_lshr_b32 s60, 30471, s58
  s_and_b32 s60, s60, 15
  s_add_u32 s59, s59, s60
  s_lshl_b32 s59, s59, 10
  s_add_u32 s59, s59, 1024
  v_add_u32 v18, s59, v32
  s_lshr_b32 s59, 81, s58
  s_and_b32 s59, s59, 15
  s_add_u32 s59, s59, s56
  s_sub_u32 s60, s59, 7
  s_cmp_ge_u32 s59, 7
  s_cselect_b32 s59, s60, s59
  s_lshr_b32 s60, 7, s58
  s_and_b32 s60, s60, 15
  s_add_u32 s59, s59, s60
  s_lshl_b32 s59, s59, 10
  s_add_u32 s59, s59, 0
  v_add_u32 v19, s59, v32
  s_add_u32 s59, s54, 16
  s_mul_i32 s64, s59, 229376
  s_lshr_b32 s47, s53, 2
  s_mul_i32 s48, s47, 4
  s_mul_i32 s47, s47, 8
  s_sub_u32 s59, s52, 1
  s_lshl_b32 s69, s59, 12
  s_lshl_b32 s71, s59, 11
  s_lshr_b32 s59, 29696, s58
  s_and_b32 s59, s59, 15
  s_lshl_b32 s70, s59, 10
  s_cmp_eq_u32 s52, 1
  s_cselect_b64 vcc, -1, 0
  s_waitcnt lgkmcnt(0)
  s_add_u32 s8, s4, 16777216
  s_addc_u32 s9, s5, 0
  s_and_b32 s9, s9, 0xffff
  s_mov_b32 s10, 4194304
  s_mov_b32 s11, 0x20000
  s_add_u32 s12, s4, 54522880
  s_addc_u32 s13, s5, 0
  s_and_b32 s13, s13, 0xffff
  s_mov_b32 s14, 7343104
  s_mov_b32 s15, 0x20000
  s_cmp_eq_u32 s52, 0
  s_cbranch_scc0 L_kg_norm
  s_mov_b32 m0, 49152
  s_movk_i32 s62, 0
  buffer_load_dwordx4 v2, s[8:11], s62 offen offset:0 lds
  buffer_load_dwordx4 v3, s[8:11], s62 offen offset:1024 lds
  buffer_load_dwordx4 v4, s[8:11], s62 offen offset:2048 lds
  buffer_load_dwordx4 v5, s[8:11], s62 offen offset:3072 lds
  s_mov_b32 m0, 122880
  s_add_u32 s63, s64, 0
  buffer_load_dwordx4 v16, s[12:15], s63 offen offset:0 lds
  buffer_load_dwordx4 v17, s[12:15], s63 offen offset:1024 lds
  buffer_load_dwordx4 v18, s[12:15], s63 offen offset:2048 lds
  buffer_load_dwordx4 v19, s[12:15], s63 offen offset:3072 lds
  s_mov_b32 m0, 53248
  s_movk_i32 s62, 128
  buffer_load_dwordx4 v2, s[8:11], s62 offen offset:0 lds
  buffer_load_dwordx4 v3, s[8:11], s62 offen offset:1024 lds
  buffer_load_dwordx4 v4, s[8:11], s62 offen offset:2048 lds
  buffer_load_dwordx4 v5, s[8:11], s62 offen offset:3072 lds
  s_mov_b32 m0, 126976
  s_add_u32 s63, s64, 14336
  buffer_load_dwordx4 v16, s[12:15], s63 offen offset:0 lds
  buffer_load_dwordx4 v17, s[12:15], s63 offen offset:1024 lds
  buffer_load_dwordx4 v18, s[12:15], s63 offen offset:2048 lds
  buffer_load_dwordx4 v19, s[12:15], s63 offen offset:3072 lds
  v_lshlrev_b32 v25, 12, v30
  v_xor_b32 v15, 0, v31
  v_lshlrev_b32 v15, 4, v15
  v_add_u32 v15, v25, v15
  v_add_u32 v8, 0, v15
  v_xor_b32 v15, 2, v31
  v_lshlrev_b32 v15, 4, v15
  v_add_u32 v15, v25, v15
  v_add_u32 v9, 31744, v15
  v_xor_b32 v15, 4, v31
  v_lshlrev_b32 v15, 4, v15
  v_add_u32 v15, v25, v15
  v_add_u32 v10, 63488, v15
  v_xor_b32 v15, 6, v31
  v_lshlrev_b32 v15, 4, v15
  v_add_u32 v15, v25, v15
  v_add_u32 v11, 95232, v15
  v_mov_b32 v12, v32
  v_add_u32 v13, 55296, v32
  v_lshlrev_b32 v24, 7, v14
  s_mul_i32 s65, s54, 229376
  s_mul_i32 s66, s54, 458752
  v_lshrrev_b32 v1, 3, v14
  v_bfe_u32 v7, v14, 4, 2
  v_bfe_u32 v15, v14, 1, 2
  v_xor_b32 v7, v7, v15
  v_lshlrev_b32 v7, 5, v7
  v_and_b32 v15, 1, v14
  v_lshlrev_b32 v15, 4, v15
  v_add_u32 v7, v7, v15
  v_lshlrev_b32 v1, 11, v1
  v_add_u32 v7, v7, v1
  s_lshl_b32 s58, s54, 7
  v_add_u32 v20, s58, v7
  v_add_u32 v21, 15360, v20
  s_add_u32 s58, s56, 0
  s_sub_u32 s59, s58, 7
  s_cmp_ge_u32 s58, 7
  s_cselect_b32 s58, s59, s58
  s_lshl_b32 s40, s58, 15
  s_add_u32 s58, s56, 1
  s_sub_u32 s59, s58, 7
  s_cmp_ge_u32 s58, 7
  s_cselect_b32 s58, s59, s58
  s_lshl_b32 s41, s58, 15
  s_add_u32 s58, s56, 2
  s_sub_u32 s59, s58, 7
  s_cmp_ge_u32 s58, 7
  s_cselect_b32 s58, s59, s58
  s_lshl_b32 s42, s58, 15
  s_add_u32 s58, s56, 3
  s_sub_u32 s59, s58, 7
  s_cmp_ge_u32 s58, 7
  s_cselect_b32 s58, s59, s58
  s_lshl_b32 s43, s58, 15
  s_add_u32 s58, s56, 4
  s_sub_u32 s59, s58, 7
  s_cmp_ge_u32 s58, 7
  s_cselect_b32 s58, s59, s58
  s_lshl_b32 s44, s58, 15
  s_add_u32 s58, s56, 5
  s_sub_u32 s59, s58, 7
  s_cmp_ge_u32 s58, 7
  s_cselect_b32 s58, s59, s58
  s_lshl_b32 s45, s58, 15
  s_add_u32 s58, s56, 6
  s_sub_u32 s59, s58, 7
  s_cmp_ge_u32 s58, 7
  s_cselect_b32 s58, s59, s58
  s_lshl_b32 s46, s58, 15
  s_lshr_b32 s58, s2, 4
  s_mul_i32 s58, s58, 112
  v_add_u32 v23, s58, v14
  v_lshlrev_b32 v23, 11, v23
  s_and_b32 s58, s2, 15
  s_lshl_b32 s58, s58, 7
  v_add_u32 v23, s58, v23
  s_lshl_b32 s58, s53, 2
  s_add_u32 s58, s58, s55
  s_mul_i32 s67, s58, 114688
  s_mov_b32 s16, s92
  s_and_b32 s17, s93, 0xffff
  s_mov_b32 s18, 8388608
  s_mov_b32 s19, 0x20000
  s_add_u32 s20, s4, 29357056
  s_addc_u32 s21, s5, 0
  s_and_b32 s21, s21, 0xffff
  s_mov_b32 s22, 7343104
  s_mov_b32 s23, 0x20000
  s_add_u32 s24, s4, 37748736
  s_addc_u32 s25, s5, 0
  s_and_b32 s25, s25, 0xffff
  s_mov_b32 s26, 7340032
  s_mov_b32 s27, 0x20000
  s_mov_b32 s28, s96
  s_and_b32 s29, s97, 0xffff
  s_mov_b32 s30, 3670016
  s_mov_b32 s31, 0x20000
  s_add_u32 s36, s4, 46661632
  s_addc_u32 s37, s5, 0
  s_and_b32 s37, s37, 0xffff
  s_mov_b32 s38, 262144
  s_mov_b32 s39, 0x20000
  s_waitcnt vmcnt(8)
  s_barrier
  s_mov_b32 m0, 57344
  s_movk_i32 s62, 256
  buffer_load_dwordx4 v2, s[8:11], s62 offen offset:0 lds
  buffer_load_dwordx4 v3, s[8:11], s62 offen offset:1024 lds
  buffer_load_dwordx4 v4, s[8:11], s62 offen offset:2048 lds
  buffer_load_dwordx4 v5, s[8:11], s62 offen offset:3072 lds
  s_mov_b32 m0, 131072
  s_add_u32 s63, s64, 28672
  buffer_load_dwordx4 v16, s[12:15], s63 offen offset:0 lds
  buffer_load_dwordx4 v17, s[12:15], s63 offen offset:1024 lds
  buffer_load_dwordx4 v18, s[12:15], s63 offen offset:2048 lds
  buffer_load_dwordx4 v19, s[12:15], s63 offen offset:3072 lds
  s_mov_b32 m0, 61440
  s_movk_i32 s62, 384
  buffer_load_dwordx4 v2, s[8:11], s62 offen offset:0 lds
  buffer_load_dwordx4 v3, s[8:11], s62 offen offset:1024 lds
  buffer_load_dwordx4 v4, s[8:11], s62 offen offset:2048 lds
  buffer_load_dwordx4 v5, s[8:11], s62 offen offset:3072 lds
  s_mov_b32 m0, 135168
  s_add_u32 s63, s64, 43008
  buffer_load_dwordx4 v16, s[12:15], s63 offen offset:0 lds
  buffer_load_dwordx4 v17, s[12:15], s63 offen offset:1024 lds
  buffer_load_dwordx4 v18, s[12:15], s63 offen offset:2048 lds
  buffer_load_dwordx4 v19, s[12:15], s63 offen offset:3072 lds
  s_mov_b32 m0, 65536
  s_movk_i32 s62, 512
  buffer_load_dwordx4 v2, s[8:11], s62 offen offset:0 lds
  buffer_load_dwordx4 v3, s[8:11], s62 offen offset:1024 lds
  buffer_load_dwordx4 v4, s[8:11], s62 offen offset:2048 lds
  buffer_load_dwordx4 v5, s[8:11], s62 offen offset:3072 lds
  s_mov_b32 m0, 139264
  s_add_u32 s63, s64, 57344
  buffer_load_dwordx4 v16, s[12:15], s63 offen offset:0 lds
  buffer_load_dwordx4 v17, s[12:15], s63 offen offset:1024 lds
  buffer_load_dwordx4 v18, s[12:15], s63 offen offset:2048 lds
  buffer_load_dwordx4 v19, s[12:15], s63 offen offset:3072 lds
  s_mov_b32 m0, 69632
  s_movk_i32 s62, 640
  buffer_load_dwordx4 v2, s[8:11], s62 offen offset:0 lds
  buffer_load_dwordx4 v3, s[8:11], s62 offen offset:1024 lds
  buffer_load_dwordx4 v4, s[8:11], s62 offen offset:2048 lds
  buffer_load_dwordx4 v5, s[8:11], s62 offen offset:3072 lds
  s_mov_b32 m0, 143360
  s_add_u32 s63, s64, 71680
  buffer_load_dwordx4 v16, s[12:15], s63 offen offset:0 lds
  buffer_load_dwordx4 v17, s[12:15], s63 offen offset:1024 lds
  buffer_load_dwordx4 v18, s[12:15], s63 offen offset:2048 lds
  buffer_load_dwordx4 v19, s[12:15], s63 offen offset:3072 lds
  s_mov_b32 m0, 73728
  s_movk_i32 s62, 768
  buffer_load_dwordx4 v2, s[8:11], s62 offen offset:0 lds
  buffer_load_dwordx4 v3, s[8:11], s62 offen offset:1024 lds
  buffer_load_dwordx4 v4, s[8:11], s62 offen offset:2048 lds
  buffer_load_dwordx4 v5, s[8:11], s62 offen offset:3072 lds
  s_mov_b32 m0, 147456
  s_add_u32 s63, s64, 86016
  buffer_load_dwordx4 v16, s[12:15], s63 offen offset:0 lds
  buffer_load_dwordx4 v17, s[12:15], s63 offen offset:1024 lds
  buffer_load_dwordx4 v18, s[12:15], s63 offen offset:2048 lds
  buffer_load_dwordx4 v19, s[12:15], s63 offen offset:3072 lds
  s_waitcnt vmcnt(40)
  s_barrier
  s_mov_b32 m0, 77824
  s_movk_i32 s62, 896
  buffer_load_dwordx4 v2, s[8:11], s62 offen offset:0 lds
  buffer_load_dwordx4 v3, s[8:11], s62 offen offset:1024 lds
  buffer_load_dwordx4 v4, s[8:11], s62 offen offset:2048 lds
  buffer_load_dwordx4 v5, s[8:11], s62 offen offset:3072 lds
  s_mov_b32 m0, 151552
  s_add_u32 s63, s64, 100352
  buffer_load_dwordx4 v16, s[12:15], s63 offen offset:0 lds
  buffer_load_dwordx4 v17, s[12:15], s63 offen offset:1024 lds
  buffer_load_dwordx4 v18, s[12:15], s63 offen offset:2048 lds
  buffer_load_dwordx4 v19, s[12:15], s63 offen offset:3072 lds
  s_waitcnt vmcnt(40)
  s_barrier
  s_mov_b32 m0, 49152
  s_movk_i32 s62, 1024
  buffer_load_dwordx4 v2, s[8:11], s62 offen offset:0 lds
  buffer_load_dwordx4 v3, s[8:11], s62 offen offset:1024 lds
  buffer_load_dwordx4 v4, s[8:11], s62 offen offset:2048 lds
  buffer_load_dwordx4 v5, s[8:11], s62 offen offset:3072 lds
  s_mov_b32 m0, 122880
  s_add_u32 s63, s64, 114688
  buffer_load_dwordx4 v16, s[12:15], s63 offen offset:0 lds
  buffer_load_dwordx4 v17, s[12:15], s63 offen offset:1024 lds
  buffer_load_dwordx4 v18, s[12:15], s63 offen offset:2048 lds
  buffer_load_dwordx4 v19, s[12:15], s63 offen offset:3072 lds
  s_waitcnt vmcnt(40)
  s_barrier
  s_mov_b32 m0, 53248
  s_movk_i32 s62, 1152
  buffer_load_dwordx4 v2, s[8:11], s62 offen offset:0 lds
  buffer_load_dwordx4 v3, s[8:11], s62 offen offset:1024 lds
  buffer_load_dwordx4 v4, s[8:11], s62 offen offset:2048 lds
  buffer_load_dwordx4 v5, s[8:11], s62 offen offset:3072 lds
  s_mov_b32 m0, 126976
  s_add_u32 s63, s64, 129024
  buffer_load_dwordx4 v16, s[12:15], s63 offen offset:0 lds
  buffer_load_dwordx4 v17, s[12:15], s63 offen offset:1024 lds
  buffer_load_dwordx4 v18, s[12:15], s63 offen offset:2048 lds
  buffer_load_dwordx4 v19, s[12:15], s63 offen offset:3072 lds
  s_waitcnt vmcnt(40)
  s_barrier
  s_mov_b32 m0, 57344
  s_movk_i32 s62, 1280
  buffer_load_dwordx4 v2, s[8:11], s62 offen offset:0 lds
  buffer_load_dwordx4 v3, s[8:11], s62 offen offset:1024 lds
  buffer_load_dwordx4 v4, s[8:11], s62 offen offset:2048 lds
  buffer_load_dwordx4 v5, s[8:11], s62 offen offset:3072 lds
  s_mov_b32 m0, 131072
  s_add_u32 s63, s64, 143360
  buffer_load_dwordx4 v16, s[12:15], s63 offen offset:0 lds
  buffer_load_dwordx4 v17, s[12:15], s63 offen offset:1024 lds
  buffer_load_dwordx4 v18, s[12:15], s63 offen offset:2048 lds
  buffer_load_dwordx4 v19, s[12:15], s63 offen offset:3072 lds
  s_waitcnt vmcnt(40)
  s_barrier
  s_mov_b32 m0, 61440
  s_movk_i32 s62, 1408
  buffer_load_dwordx4 v2, s[8:11], s62 offen offset:0 lds
  buffer_load_dwordx4 v3, s[8:11], s62 offen offset:1024 lds
  buffer_load_dwordx4 v4, s[8:11], s62 offen offset:2048 lds
  buffer_load_dwordx4 v5, s[8:11], s62 offen offset:3072 lds
  s_mov_b32 m0, 135168
  s_add_u32 s63, s64, 157696
  buffer_load_dwordx4 v16, s[12:15], s63 offen offset:0 lds
  buffer_load_dwordx4 v17, s[12:15], s63 offen offset:1024 lds
  buffer_load_dwordx4 v18, s[12:15], s63 offen offset:2048 lds
  buffer_load_dwordx4 v19, s[12:15], s63 offen offset:3072 lds
  s_waitcnt vmcnt(40)
  s_barrier
  s_mov_b32 m0, 65536
  s_movk_i32 s62, 1536
  buffer_load_dwordx4 v2, s[8:11], s62 offen offset:0 lds
  buffer_load_dwordx4 v3, s[8:11], s62 offen offset:1024 lds
  buffer_load_dwordx4 v4, s[8:11], s62 offen offset:2048 lds
  buffer_load_dwordx4 v5, s[8:11], s62 offen offset:3072 lds
  s_mov_b32 m0, 139264
  s_add_u32 s63, s64, 172032
  buffer_load_dwordx4 v16, s[12:15], s63 offen offset:0 lds
  buffer_load_dwordx4 v17, s[12:15], s63 offen offset:1024 lds
  buffer_load_dwordx4 v18, s[12:15], s63 offen offset:2048 lds
  buffer_load_dwordx4 v19, s[12:15], s63 offen offset:3072 lds
  s_waitcnt vmcnt(40)
  s_barrier
  s_mov_b32 m0, 69632
  s_movk_i32 s62, 1664
  buffer_load_dwordx4 v2, s[8:11], s62 offen offset:0 lds
  buffer_load_dwordx4 v3, s[8:11], s62 offen offset:1024 lds
  buffer_load_dwordx4 v4, s[8:11], s62 offen offset:2048 lds
  buffer_load_dwordx4 v5, s[8:11], s62 offen offset:3072 lds
  s_mov_b32 m0, 143360
  s_add_u32 s63, s64, 186368
  buffer_load_dwordx4 v16, s[12:15], s63 offen offset:0 lds
  buffer_load_dwordx4 v17, s[12:15], s63 offen offset:1024 lds
  buffer_load_dwordx4 v18, s[12:15], s63 offen offset:2048 lds
  buffer_load_dwordx4 v19, s[12:15], s63 offen offset:3072 lds
  s_waitcnt vmcnt(40)
  s_barrier
  s_mov_b32 m0, 73728
  s_movk_i32 s62, 1792
  buffer_load_dwordx4 v2, s[8:11], s62 offen offset:0 lds
  buffer_load_dwordx4 v3, s[8:11], s62 offen offset:1024 lds
  buffer_load_dwordx4 v4, s[8:11], s62 offen offset:2048 lds
  buffer_load_dwordx4 v5, s[8:11], s62 offen offset:3072 lds
  s_mov_b32 m0, 147456
  s_add_u32 s63, s64, 200704
  buffer_load_dwordx4 v16, s[12:15], s63 offen offset:0 lds
  buffer_load_dwordx4 v17, s[12:15], s63 offen offset:1024 lds
  buffer_load_dwordx4 v18, s[12:15], s63 offen offset:2048 lds
  buffer_load_dwordx4 v19, s[12:15], s63 offen offset:3072 lds
  s_waitcnt vmcnt(40)
  s_barrier
  s_mov_b32 m0, 77824
  s_movk_i32 s62, 1920
  buffer_load_dwordx4 v2, s[8:11], s62 offen offset:0 lds
  buffer_load_dwordx4 v3, s[8:11], s62 offen offset:1024 lds
  buffer_load_dwordx4 v4, s[8:11], s62 offen offset:2048 lds
  buffer_load_dwordx4 v5, s[8:11], s62 offen offset:3072 lds
  s_mov_b32 m0, 151552
  s_add_u32 s63, s64, 215040
  buffer_load_dwordx4 v16, s[12:15], s63 offen offset:0 lds
  buffer_load_dwordx4 v17, s[12:15], s63 offen offset:1024 lds
  buffer_load_dwordx4 v18, s[12:15], s63 offen offset:2048 lds
  buffer_load_dwordx4 v19, s[12:15], s63 offen offset:3072 lds
  s_waitcnt vmcnt(40)
  s_barrier
  s_mov_b32 m0, 49152
  s_movk_i32 s62, 0
  buffer_load_dwordx4 v2, s[8:11], s62 offen offset:0 lds
  buffer_load_dwordx4 v3, s[8:11], s62 offen offset:1024 lds
  buffer_load_dwordx4 v4, s[8:11], s62 offen offset:2048 lds
  buffer_load_dwordx4 v5, s[8:11], s62 offen offset:3072 lds
  s_mov_b32 m0, 122880
  s_add_u32 s63, s65, 0
  buffer_load_dwordx4 v16, s[12:15], s63 offen offset:0 lds
  buffer_load_dwordx4 v17, s[12:15], s63 offen offset:1024 lds
  buffer_load_dwordx4 v18, s[12:15], s63 offen offset:2048 lds
  buffer_load_dwordx4 v19, s[12:15], s63 offen offset:3072 lds
  s_waitcnt vmcnt(40)
  s_barrier
  s_mov_b32 m0, 53248
  s_movk_i32 s62, 128
  buffer_load_dwordx4 v2, s[8:11], s62 offen offset:0 lds
  buffer_load_dwordx4 v3, s[8:11], s62 offen offset:1024 lds
  buffer_load_dwordx4 v4, s[8:11], s62 offen offset:2048 lds
  buffer_load_dwordx4 v5, s[8:11], s62 offen offset:3072 lds
  s_mov_b32 m0, 126976
  s_add_u32 s63, s65, 14336
  buffer_load_dwordx4 v16, s[12:15], s63 offen offset:0 lds
  buffer_load_dwordx4 v17, s[12:15], s63 offen offset:1024 lds
  buffer_load_dwordx4 v18, s[12:15], s63 offen offset:2048 lds
  buffer_load_dwordx4 v19, s[12:15], s63 offen offset:3072 lds
  s_waitcnt vmcnt(40)
  s_barrier
  s_mov_b32 m0, 57344
  s_movk_i32 s62, 256
  buffer_load_dwordx4 v2, s[8:11], s62 offen offset:0 lds
  buffer_load_dwordx4 v3, s[8:11], s62 offen offset:1024 lds
  buffer_load_dwordx4 v4, s[8:11], s62 offen offset:2048 lds
  buffer_load_dwordx4 v5, s[8:11], s62 offen offset:3072 lds
  s_mov_b32 m0, 131072
  s_add_u32 s63, s65, 28672
  buffer_load_dwordx4 v16, s[12:15], s63 offen offset:0 lds
  buffer_load_dwordx4 v17, s[12:15], s63 offen offset:1024 lds
  buffer_load_dwordx4 v18, s[12:15], s63 offen offset:2048 lds
  buffer_load_dwordx4 v19, s[12:15], s63 offen offset:3072 lds
  s_waitcnt vmcnt(40)
  s_barrier
  s_mov_b32 m0, 61440
  s_movk_i32 s62, 384
  buffer_load_dwordx4 v2, s[8:11], s62 offen offset:0 lds
  buffer_load_dwordx4 v3, s[8:11], s62 offen offset:1024 lds
  buffer_load_dwordx4 v4, s[8:11], s62 offen offset:2048 lds
  buffer_load_dwordx4 v5, s[8:11], s62 offen offset:3072 lds
  s_mov_b32 m0, 135168
  s_add_u32 s63, s65, 43008
  buffer_load_dwordx4 v16, s[12:15], s63 offen offset:0 lds
  buffer_load_dwordx4 v17, s[12:15], s63 offen offset:1024 lds
  buffer_load_dwordx4 v18, s[12:15], s63 offen offset:2048 lds
  buffer_load_dwordx4 v19, s[12:15], s63 offen offset:3072 lds
  s_waitcnt vmcnt(40)
  s_barrier
  s_mov_b32 m0, 65536
  s_movk_i32 s62, 512
  buffer_load_dwordx4 v2, s[8:11], s62 offen offset:0 lds
  buffer_load_dwordx4 v3, s[8:11], s62 offen offset:1024 lds
  buffer_load_dwordx4 v4, s[8:11], s62 offen offset:2048 lds
  buffer_load_dwordx4 v5, s[8:11], s62 offen offset:3072 lds
  s_mov_b32 m0, 139264
  s_add_u32 s63, s65, 57344
  buffer_load_dwordx4 v16, s[12:15], s63 offen offset:0 lds
  buffer_load_dwordx4 v17, s[12:15], s63 offen offset:1024 lds
  buffer_load_dwordx4 v18, s[12:15], s63 offen offset:2048 lds
  buffer_load_dwordx4 v19, s[12:15], s63 offen offset:3072 lds
  s_waitcnt vmcnt(40)
  s_barrier
  s_mov_b32 m0, 69632
  s_movk_i32 s62, 640
  buffer_load_dwordx4 v2, s[8:11], s62 offen offset:0 lds
  buffer_load_dwordx4 v3, s[8:11], s62 offen offset:1024 lds
  buffer_load_dwordx4 v4, s[8:11], s62 offen offset:2048 lds
  buffer_load_dwordx4 v5, s[8:11], s62 offen offset:3072 lds
  s_mov_b32 m0, 143360
  s_add_u32 s63, s65, 71680
  buffer_load_dwordx4 v16, s[12:15], s63 offen offset:0 lds
  buffer_load_dwordx4 v17, s[12:15], s63 offen offset:1024 lds
  buffer_load_dwordx4 v18, s[12:15], s63 offen offset:2048 lds
  buffer_load_dwordx4 v19, s[12:15], s63 offen offset:3072 lds
  s_waitcnt vmcnt(40)
  s_barrier
  s_mov_b32 m0, 73728
  s_movk_i32 s62, 768
  buffer_load_dwordx4 v2, s[8:11], s62 offen offset:0 lds
  buffer_load_dwordx4 v3, s[8:11], s62 offen offset:1024 lds
  buffer_load_dwordx4 v4, s[8:11], s62 offen offset:2048 lds
  buffer_load_dwordx4 v5, s[8:11], s62 offen offset:3072 lds
  s_mov_b32 m0, 147456
  s_add_u32 s63, s65, 86016
  buffer_load_dwordx4 v16, s[12:15], s63 offen offset:0 lds
  buffer_load_dwordx4 v17, s[12:15], s63 offen offset:1024 lds
  buffer_load_dwordx4 v18, s[12:15], s63 offen offset:2048 lds
  buffer_load_dwordx4 v19, s[12:15], s63 offen offset:3072 lds
  v_add_u32 v25, 131072, v23
  buffer_load_dword v27, v23, s[28:31], 0 offen
  s_mov_b32 exec_hi, 0xffff
  buffer_load_dword v28, v25, s[28:31], 0 offen
  s_mov_b64 exec, -1
  s_waitcnt vmcnt(42)
  s_barrier
  s_mov_b32 m0, 77824
  s_movk_i32 s62, 896
  buffer_load_dwordx4 v2, s[8:11], s62 offen offset:0 lds
  buffer_load_dwordx4 v3, s[8:11], s62 offen offset:1024 lds
  buffer_load_dwordx4 v4, s[8:11], s62 offen offset:2048 lds
  buffer_load_dwordx4 v5, s[8:11], s62 offen offset:3072 lds
  s_mov_b32 m0, 151552
  s_add_u32 s63, s65, 100352
  buffer_load_dwordx4 v16, s[12:15], s63 offen offset:0 lds
  buffer_load_dwordx4 v17, s[12:15], s63 offen offset:1024 lds
  buffer_load_dwordx4 v18, s[12:15], s63 offen offset:2048 lds
  buffer_load_dwordx4 v19, s[12:15], s63 offen offset:3072 lds
  s_waitcnt vmcnt(42)
  s_barrier
  s_mov_b32 m0, 49152
  s_movk_i32 s62, 1024
  buffer_load_dwordx4 v2, s[8:11], s62 offen offset:0 lds
  buffer_load_dwordx4 v3, s[8:11], s62 offen offset:1024 lds
  buffer_load_dwordx4 v4, s[8:11], s62 offen offset:2048 lds
  buffer_load_dwordx4 v5, s[8:11], s62 offen offset:3072 lds
  s_mov_b32 m0, 122880
  s_add_u32 s63, s65, 114688
  buffer_load_dwordx4 v16, s[12:15], s63 offen offset:0 lds
  buffer_load_dwordx4 v17, s[12:15], s63 offen offset:1024 lds
  buffer_load_dwordx4 v18, s[12:15], s63 offen offset:2048 lds
  buffer_load_dwordx4 v19, s[12:15], s63 offen offset:3072 lds
  s_waitcnt vmcnt(42)
  s_barrier
  s_mov_b32 m0, 53248
  s_movk_i32 s62, 1152
  buffer_load_dwordx4 v2, s[8:11], s62 offen offset:0 lds
  buffer_load_dwordx4 v3, s[8:11], s62 offen offset:1024 lds
  buffer_load_dwordx4 v4, s[8:11], s62 offen offset:2048 lds
  buffer_load_dwordx4 v5, s[8:11], s62 offen offset:3072 lds
  s_mov_b32 m0, 126976
  s_add_u32 s63, s65, 129024
  buffer_load_dwordx4 v16, s[12:15], s63 offen offset:0 lds
  buffer_load_dwordx4 v17, s[12:15], s63 offen offset:1024 lds
  buffer_load_dwordx4 v18, s[12:15], s63 offen offset:2048 lds
  buffer_load_dwordx4 v19, s[12:15], s63 offen offset:3072 lds
  s_waitcnt vmcnt(42)
  s_barrier
  s_mov_b32 m0, 57344
  s_movk_i32 s62, 1280
  buffer_load_dwordx4 v2, s[8:11], s62 offen offset:0 lds
  buffer_load_dwordx4 v3, s[8:11], s62 offen offset:1024 lds
  buffer_load_dwordx4 v4, s[8:11], s62 offen offset:2048 lds
  buffer_load_dwordx4 v5, s[8:11], s62 offen offset:3072 lds
  s_mov_b32 m0, 131072
  s_add_u32 s63, s65, 143360
  buffer_load_dwordx4 v16, s[12:15], s63 offen offset:0 lds
  buffer_load_dwordx4 v17, s[12:15], s63 offen offset:1024 lds
  buffer_load_dwordx4 v18, s[12:15], s63 offen offset:2048 lds
  buffer_load_dwordx4 v19, s[12:15], s63 offen offset:3072 lds
  s_waitcnt vmcnt(42)
  s_barrier
  s_mov_b32 m0, 61440
  s_movk_i32 s62, 1408
  buffer_load_dwordx4 v2, s[8:11], s62 offen offset:0 lds
  buffer_load_dwordx4 v3, s[8:11], s62 offen offset:1024 lds
  buffer_load_dwordx4 v4, s[8:11], s62 offen offset:2048 lds
  buffer_load_dwordx4 v5, s[8:11], s62 offen offset:3072 lds
  s_mov_b32 m0, 135168
  s_add_u32 s63, s65, 157696
  buffer_load_dwordx4 v16, s[12:15], s63 offen offset:0 lds
  buffer_load_dwordx4 v17, s[12:15], s63 offen offset:1024 lds
  buffer_load_dwordx4 v18, s[12:15], s63 offen offset:2048 lds
  buffer_load_dwordx4 v19, s[12:15], s63 offen offset:3072 lds
  s_waitcnt vmcnt(42)
  s_barrier
  s_mov_b32 m0, 65536
  s_movk_i32 s62, 1536
  buffer_load_dwordx4 v2, s[8:11], s62 offen offset:0 lds
  buffer_load_dwordx4 v3, s[8:11], s62 offen offset:1024 lds
  buffer_load_dwordx4 v4, s[8:11], s62 offen offset:2048 lds
  buffer_load_dwordx4 v5, s[8:11], s62 offen offset:3072 lds
  s_mov_b32 m0, 139264
  s_add_u32 s63, s65, 172032
  buffer_load_dwordx4 v16, s[12:15], s63 offen offset:0 lds
  buffer_load_dwordx4 v17, s[12:15], s63 offen offset:1024 lds
  buffer_load_dwordx4 v18, s[12:15], s63 offen offset:2048 lds
  buffer_load_dwordx4 v19, s[12:15], s63 offen offset:3072 lds
  s_waitcnt vmcnt(40)
  s_barrier
  s_mov_b32 m0, 69632
  s_movk_i32 s62, 1664
  buffer_load_dwordx4 v2, s[8:11], s62 offen offset:0 lds
  buffer_load_dwordx4 v3, s[8:11], s62 offen offset:1024 lds
  buffer_load_dwordx4 v4, s[8:11], s62 offen offset:2048 lds
  buffer_load_dwordx4 v5, s[8:11], s62 offen offset:3072 lds
  s_mov_b32 m0, 143360
  s_add_u32 s63, s65, 186368
  buffer_load_dwordx4 v16, s[12:15], s63 offen offset:0 lds
  buffer_load_dwordx4 v17, s[12:15], s63 offen offset:1024 lds
  buffer_load_dwordx4 v18, s[12:15], s63 offen offset:2048 lds
  buffer_load_dwordx4 v19, s[12:15], s63 offen offset:3072 lds
  s_waitcnt vmcnt(40)
  s_barrier
  s_mov_b32 m0, 73728
  s_movk_i32 s62, 1792
  buffer_load_dwordx4 v2, s[8:11], s62 offen offset:0 lds
  buffer_load_dwordx4 v3, s[8:11], s62 offen offset:1024 lds
  buffer_load_dwordx4 v4, s[8:11], s62 offen offset:2048 lds
  buffer_load_dwordx4 v5, s[8:11], s62 offen offset:3072 lds
  s_mov_b32 m0, 147456
  s_add_u32 s63, s65, 200704
  buffer_load_dwordx4 v16, s[12:15], s63 offen offset:0 lds
  buffer_load_dwordx4 v17, s[12:15], s63 offen offset:1024 lds
  buffer_load_dwordx4 v18, s[12:15], s63 offen offset:2048 lds
  buffer_load_dwordx4 v19, s[12:15], s63 offen offset:3072 lds
  s_waitcnt vmcnt(40)
  s_barrier
  s_mov_b32 m0, 77824
  s_movk_i32 s62, 1920
  buffer_load_dwordx4 v2, s[8:11], s62 offen offset:0 lds
  buffer_load_dwordx4 v3, s[8:11], s62 offen offset:1024 lds
  buffer_load_dwordx4 v4, s[8:11], s62 offen offset:2048 lds
  buffer_load_dwordx4 v5, s[8:11], s62 offen offset:3072 lds
  s_mov_b32 m0, 151552
  s_add_u32 s63, s65, 215040
  buffer_load_dwordx4 v16, s[12:15], s63 offen offset:0 lds
  buffer_load_dwordx4 v17, s[12:15], s63 offen offset:1024 lds
  buffer_load_dwordx4 v18, s[12:15], s63 offen offset:2048 lds
  buffer_load_dwordx4 v19, s[12:15], s63 offen offset:3072 lds
  s_waitcnt vmcnt(40)
  s_barrier
  s_mov_b32 m0, 49152
  s_movk_i32 s62, 0
  buffer_load_dwordx4 v8, s[16:19], s62 offen offset:0 lds
  buffer_load_dwordx4 v9, s[16:19], s62 offen offset:1024 lds
  buffer_load_dwordx4 v10, s[16:19], s62 offen offset:2048 lds
  buffer_load_dwordx4 v11, s[16:19], s62 offen offset:3072 lds
  s_waitcnt vmcnt(36)
  s_barrier
  s_mov_b32 m0, 53248
  s_movk_i32 s62, 128
  buffer_load_dwordx4 v8, s[16:19], s62 offen offset:0 lds
  buffer_load_dwordx4 v9, s[16:19], s62 offen offset:1024 lds
  buffer_load_dwordx4 v10, s[16:19], s62 offen offset:2048 lds
  buffer_load_dwordx4 v11, s[16:19], s62 offen offset:3072 lds
  s_waitcnt vmcnt(32)
  s_barrier
  s_lshl_b32 s59, s54, 13
  buffer_load_dword v25, v24, s[36:39], s59 offen sc1
  s_mov_b32 m0, 57344
  s_movk_i32 s62, 256
  buffer_load_dwordx4 v8, s[16:19], s62 offen offset:0 lds
  buffer_load_dwordx4 v9, s[16:19], s62 offen offset:1024 lds
  buffer_load_dwordx4 v10, s[16:19], s62 offen offset:2048 lds
  buffer_load_dwordx4 v11, s[16:19], s62 offen offset:3072 lds
  s_waitcnt vmcnt(29)
  s_barrier
  s_lshl_b32 s59, s54, 13
  s_movk_i32 s61, 20000
  s_waitcnt vmcnt(4)
  v_cmp_eq_u32 s[90:91], 0, v25
  s_nop 0
  s_cmp_eq_u64 s[90:91], 0
  s_cbranch_scc1 L_kg_pollZ0_fast
L_kg_pollZ0:
  buffer_load_dword v25, v24, s[36:39], s59 offen sc1
  s_waitcnt vmcnt(0)
  v_cmp_eq_u32 s[90:91], 0, v25
  s_nop 0
  s_cmp_eq_u64 s[90:91], 0
  s_cbranch_scc1 L_kg_pollZ0_ok
  s_sub_u32 s61, s61, 1
  s_cmp_lg_u32 s61, 0
  s_cbranch_scc1 L_kg_pollZ0
L_kg_pollZ0_ok:
L_kg_pollZ0_fast:
  s_mov_b32 m0, 61440
  s_movk_i32 s62, 384
  buffer_load_dwordx4 v8, s[16:19], s62 offen offset:0 lds
  buffer_load_dwordx4 v9, s[16:19], s62 offen offset:1024 lds
  buffer_load_dwordx4 v10, s[16:19], s62 offen offset:2048 lds
  buffer_load_dwordx4 v11, s[16:19], s62 offen offset:3072 lds
  s_mov_b32 m0, 122880
  s_add_u32 s63, s66, 0
  buffer_load_dwordx4 v16, s[20:23], s63 offen offset:0 sc1 lds
  buffer_load_dwordx4 v17, s[20:23], s63 offen offset:1024 sc1 lds
  buffer_load_dwordx4 v18, s[20:23], s63 offen offset:2048 sc1 lds
  buffer_load_dwordx4 v19, s[20:23], s63 offen offset:3072 sc1 lds
  s_mov_b32 m0, 126976
  s_add_u32 s63, s66, 14336
  buffer_load_dwordx4 v16, s[20:23], s63 offen offset:0 sc1 lds
  buffer_load_dwordx4 v17, s[20:23], s63 offen offset:1024 sc1 lds
  buffer_load_dwordx4 v18, s[20:23], s63 offen offset:2048 sc1 lds
  buffer_load_dwordx4 v19, s[20:23], s63 offen offset:3072 sc1 lds
  s_mov_b32 m0, 131072
  s_add_u32 s63, s66, 28672
  buffer_load_dwordx4 v16, s[20:23], s63 offen offset:0 sc1 lds
  buffer_load_dwordx4 v17, s[20:23], s63 offen offset:1024 sc1 lds
  buffer_load_dwordx4 v18, s[20:23], s63 offen offset:2048 sc1 lds
  buffer_load_dwordx4 v19, s[20:23], s63 offen offset:3072 sc1 lds
  s_mov_b32 m0, 135168
  s_add_u32 s63, s66, 43008
  buffer_load_dwordx4 v16, s[20:23], s63 offen offset:0 sc1 lds
  buffer_load_dwordx4 v17, s[20:23], s63 offen offset:1024 sc1 lds
  buffer_load_dwordx4 v18, s[20:23], s63 offen offset:2048 sc1 lds
  buffer_load_dwordx4 v19, s[20:23], s63 offen offset:3072 sc1 lds
  s_barrier
  s_mov_b32 m0, 65536
  s_movk_i32 s62, 512
  buffer_load_dwordx4 v8, s[16:19], s62 offen offset:0 lds
  buffer_load_dwordx4 v9, s[16:19], s62 offen offset:1024 lds
  buffer_load_dwordx4 v10, s[16:19], s62 offen offset:2048 lds
  buffer_load_dwordx4 v11, s[16:19], s62 offen offset:3072 lds
  s_mov_b32 m0, 139264
  s_add_u32 s63, s66, 57344
  buffer_load_dwordx4 v16, s[20:23], s63 offen offset:0 sc1 lds
  buffer_load_dwordx4 v17, s[20:23], s63 offen offset:1024 sc1 lds
  buffer_load_dwordx4 v18, s[20:23], s63 offen offset:2048 sc1 lds
  buffer_load_dwordx4 v19, s[20:23], s63 offen offset:3072 sc1 lds
  s_barrier
  s_mov_b32 m0, 69632
  s_movk_i32 s62, 640
  buffer_load_dwordx4 v8, s[16:19], s62 offen offset:0 lds
  buffer_load_dwordx4 v9, s[16:19], s62 offen offset:1024 lds
  buffer_load_dwordx4 v10, s[16:19], s62 offen offset:2048 lds
  buffer_load_dwordx4 v11, s[16:19], s62 offen offset:3072 lds
  s_mov_b32 m0, 143360
  s_add_u32 s63, s66, 71680
  buffer_load_dwordx4 v16, s[20:23], s63 offen offset:0 sc1 lds
  buffer_load_dwordx4 v17, s[20:23], s63 offen offset:1024 sc1 lds
  buffer_load_dwordx4 v18, s[20:23], s63 offen offset:2048 sc1 lds
  buffer_load_dwordx4 v19, s[20:23], s63 offen offset:3072 sc1 lds
  s_waitcnt vmcnt(28)
  s_barrier
  s_mov_b32 m0, 73728
  s_movk_i32 s62, 768
  buffer_load_dwordx4 v8, s[16:19], s62 offen offset:0 lds
  buffer_load_dwordx4 v9, s[16:19], s62 offen offset:1024 lds
  buffer_load_dwordx4 v10, s[16:19], s62 offen offset:2048 lds
  buffer_load_dwordx4 v11, s[16:19], s62 offen offset:3072 lds
  s_mov_b32 m0, 147456
  s_add_u32 s63, s66, 86016
  buffer_load_dwordx4 v16, s[20:23], s63 offen offset:0 sc1 lds
  buffer_load_dwordx4 v17, s[20:23], s63 offen offset:1024 sc1 lds
  buffer_load_dwordx4 v18, s[20:23], s63 offen offset:2048 sc1 lds
  buffer_load_dwordx4 v19, s[20:23], s63 offen offset:3072 sc1 lds
  s_waitcnt vmcnt(32)
  s_barrier
  s_mov_b32 m0, 77824
  s_movk_i32 s62, 896
  buffer_load_dwordx4 v8, s[16:19], s62 offen offset:0 lds
  buffer_load_dwordx4 v9, s[16:19], s62 offen offset:1024 lds
  buffer_load_dwordx4 v10, s[16:19], s62 offen offset:2048 lds
  buffer_load_dwordx4 v11, s[16:19], s62 offen offset:3072 lds
  s_mov_b32 m0, 151552
  s_add_u32 s63, s66, 100352
  buffer_load_dwordx4 v16, s[20:23], s63 offen offset:0 sc1 lds
  buffer_load_dwordx4 v17, s[20:23], s63 offen offset:1024 sc1 lds
  buffer_load_dwordx4 v18, s[20:23], s63 offen offset:2048 sc1 lds
  buffer_load_dwordx4 v19, s[20:23], s63 offen offset:3072 sc1 lds
  s_waitcnt vmcnt(36)
  s_barrier
  s_mov_b32 m0, 49152
  s_movk_i32 s62, 1024
  buffer_load_dwordx4 v8, s[16:19], s62 offen offset:0 lds
  buffer_load_dwordx4 v9, s[16:19], s62 offen offset:1024 lds
  buffer_load_dwordx4 v10, s[16:19], s62 offen offset:2048 lds
  buffer_load_dwordx4 v11, s[16:19], s62 offen offset:3072 lds
  s_mov_b32 m0, 122880
  s_add_u32 s63, s66, 114688
  buffer_load_dwordx4 v16, s[20:23], s63 offen offset:0 sc1 lds
  buffer_load_dwordx4 v17, s[20:23], s63 offen offset:1024 sc1 lds
  buffer_load_dwordx4 v18, s[20:23], s63 offen offset:2048 sc1 lds
  buffer_load_dwordx4 v19, s[20:23], s63 offen offset:3072 sc1 lds
  s_waitcnt vmcnt(40)
  s_barrier
  s_mov_b32 m0, 53248
  s_movk_i32 s62, 1152
  buffer_load_dwordx4 v8, s[16:19], s62 offen offset:0 lds
  buffer_load_dwordx4 v9, s[16:19], s62 offen offset:1024 lds
  buffer_load_dwordx4 v10, s[16:19], s62 offen offset:2048 lds
  buffer_load_dwordx4 v11, s[16:19], s62 offen offset:3072 lds
  s_mov_b32 m0, 126976
  s_add_u32 s63, s66, 129024
  buffer_load_dwordx4 v16, s[20:23], s63 offen offset:0 sc1 lds
  buffer_load_dwordx4 v17, s[20:23], s63 offen offset:1024 sc1 lds
  buffer_load_dwordx4 v18, s[20:23], s63 offen offset:2048 sc1 lds
  buffer_load_dwordx4 v19, s[20:23], s63 offen offset:3072 sc1 lds
  s_waitcnt vmcnt(40)
  s_barrier
  s_mov_b32 m0, 57344
  s_movk_i32 s62, 1280
  buffer_load_dwordx4 v8, s[16:19], s62 offen offset:0 lds
  buffer_load_dwordx4 v9, s[16:19], s62 offen offset:1024 lds
  buffer_load_dwordx4 v10, s[16:19], s62 offen offset:2048 lds
  buffer_load_dwordx4 v11, s[16:19], s62 offen offset:3072 lds
  s_mov_b32 m0, 131072
  s_add_u32 s63, s66, 143360
  buffer_load_dwordx4 v16, s[20:23], s63 offen offset:0 sc1 lds
  buffer_load_dwordx4 v17, s[20:23], s63 offen offset:1024 sc1 lds
  buffer_load_dwordx4 v18, s[20:23], s63 offen offset:2048 sc1 lds
  buffer_load_dwordx4 v19, s[20:23], s63 offen offset:3072 sc1 lds
  s_waitcnt vmcnt(40)
  s_barrier
  s_mov_b32 m0, 61440
  s_movk_i32 s62, 1408
  buffer_load_dwordx4 v8, s[16:19], s62 offen offset:0 lds
  buffer_load_dwordx4 v9, s[16:19], s62 offen offset:1024 lds
  buffer_load_dwordx4 v10, s[16:19], s62 offen offset:2048 lds
  buffer_load_dwordx4 v11, s[16:19], s62 offen offset:3072 lds
  s_mov_b32 m0, 135168
  s_add_u32 s63, s66, 157696
  buffer_load_dwordx4 v16, s[20:23], s63 offen offset:0 sc1 lds
  buffer_load_dwordx4 v17, s[20:23], s63 offen offset:1024 sc1 lds
  buffer_load_dwordx4 v18, s[20:23], s63 offen offset:2048 sc1 lds
  buffer_load_dwordx4 v19, s[20:23], s63 offen offset:3072 sc1 lds
  s_waitcnt vmcnt(40)
  s_barrier
  s_mov_b32 m0, 65536
  s_movk_i32 s62, 1536
  buffer_load_dwordx4 v8, s[16:19], s62 offen offset:0 lds
  buffer_load_dwordx4 v9, s[16:19], s62 offen offset:1024 lds
  buffer_load_dwordx4 v10, s[16:19], s62 offen offset:2048 lds
  buffer_load_dwordx4 v11, s[16:19], s62 offen offset:3072 lds
  s_mov_b32 m0, 139264
  s_add_u32 s63, s66, 172032
  buffer_load_dwordx4 v16, s[20:23], s63 offen offset:0 sc1 lds
  buffer_load_dwordx4 v17, s[20:23], s63 offen offset:1024 sc1 lds
  buffer_load_dwordx4 v18, s[20:23], s63 offen offset:2048 sc1 lds
  buffer_load_dwordx4 v19, s[20:23], s63 offen offset:3072 sc1 lds
  s_waitcnt vmcnt(40)
  s_barrier
  s_mov_b32 m0, 69632
  s_movk_i32 s62, 1664
  buffer_load_dwordx4 v8, s[16:19], s62 offen offset:0 lds
  buffer_load_dwordx4 v9, s[16:19], s62 offen offset:1024 lds
  buffer_load_dwordx4 v10, s[16:19], s62 offen offset:2048 lds
  buffer_load_dwordx4 v11, s[16:19], s62 offen offset:3072 lds
  s_mov_b32 m0, 143360
  s_add_u32 s63, s66, 186368
  buffer_load_dwordx4 v16, s[20:23], s63 offen offset:0 sc1 lds
  buffer_load_dwordx4 v17, s[20:23], s63 offen offset:1024 sc1 lds
  buffer_load_dwordx4 v18, s[20:23], s63 offen offset:2048 sc1 lds
  buffer_load_dwordx4 v19, s[20:23], s63 offen offset:3072 sc1 lds
  s_waitcnt vmcnt(40)
  s_barrier
  s_mov_b32 m0, 73728
  s_movk_i32 s62, 1792
  buffer_load_dwordx4 v8, s[16:19], s62 offen offset:0 lds
  buffer_load_dwordx4 v9, s[16:19], s62 offen offset:1024 lds
  buffer_load_dwordx4 v10, s[16:19], s62 offen offset:2048 lds
  buffer_load_dwordx4 v11, s[16:19], s62 offen offset:3072 lds
  s_mov_b32 m0, 147456
  s_add_u32 s63, s66, 200704
  buffer_load_dwordx4 v16, s[20:23], s63 offen offset:0 sc1 lds
  buffer_load_dwordx4 v17, s[20:23], s63 offen offset:1024 sc1 lds
  buffer_load_dwordx4 v18, s[20:23], s63 offen offset:2048 sc1 lds
  buffer_load_dwordx4 v19, s[20:23], s63 offen offset:3072 sc1 lds
  s_waitcnt vmcnt(40)
  s_barrier
  s_mov_b32 m0, 77824
  s_movk_i32 s62, 1920
  buffer_load_dwordx4 v8, s[16:19], s62 offen offset:0 lds
  buffer_load_dwordx4 v9, s[16:19], s62 offen offset:1024 lds
  buffer_load_dwordx4 v10, s[16:19], s62 offen offset:2048 lds
  buffer_load_dwordx4 v11, s[16:19], s62 offen offset:3072 lds
  s_mov_b32 m0, 151552
  s_add_u32 s63, s66, 215040
  buffer_load_dwordx4 v16, s[20:23], s63 offen offset:0 sc1 lds
  buffer_load_dwordx4 v17, s[20:23], s63 offen offset:1024 sc1 lds
  buffer_load_dwordx4 v18, s[20:23], s63 offen offset:2048 sc1 lds
  buffer_load_dwordx4 v19, s[20:23], s63 offen offset:3072 sc1 lds
  s_waitcnt vmcnt(40)
  s_barrier
  s_mov_b32 m0, 49152
  s_movk_i32 s62, 2048
  buffer_load_dwordx4 v8, s[16:19], s62 offen offset:0 lds
  buffer_load_dwordx4 v9, s[16:19], s62 offen offset:1024 lds
  buffer_load_dwordx4 v10, s[16:19], s62 offen offset:2048 lds
  buffer_load_dwordx4 v11, s[16:19], s62 offen offset:3072 lds
  s_mov_b32 m0, 122880
  s_add_u32 s63, s66, 229376
  buffer_load_dwordx4 v16, s[20:23], s63 offen offset:0 sc1 lds
  buffer_load_dwordx4 v17, s[20:23], s63 offen offset:1024 sc1 lds
  buffer_load_dwordx4 v18, s[20:23], s63 offen offset:2048 sc1 lds
  buffer_load_dwordx4 v19, s[20:23], s63 offen offset:3072 sc1 lds
  s_waitcnt vmcnt(40)
  s_barrier
  s_mov_b32 m0, 53248
  s_movk_i32 s62, 2176
  buffer_load_dwordx4 v8, s[16:19], s62 offen offset:0 lds
  buffer_load_dwordx4 v9, s[16:19], s62 offen offset:1024 lds
  buffer_load_dwordx4 v10, s[16:19], s62 offen offset:2048 lds
  buffer_load_dwordx4 v11, s[16:19], s62 offen offset:3072 lds
  s_mov_b32 m0, 126976
  s_add_u32 s63, s66, 243712
  buffer_load_dwordx4 v16, s[20:23], s63 offen offset:0 sc1 lds
  buffer_load_dwordx4 v17, s[20:23], s63 offen offset:1024 sc1 lds
  buffer_load_dwordx4 v18, s[20:23], s63 offen offset:2048 sc1 lds
  buffer_load_dwordx4 v19, s[20:23], s63 offen offset:3072 sc1 lds
  s_waitcnt vmcnt(40)
  s_barrier
  s_mov_b32 m0, 57344
  s_movk_i32 s62, 2304
  buffer_load_dwordx4 v8, s[16:19], s62 offen offset:0 lds
  buffer_load_dwordx4 v9, s[16:19], s62 offen offset:1024 lds
  buffer_load_dwordx4 v10, s[16:19], s62 offen offset:2048 lds
  buffer_load_dwordx4 v11, s[16:19], s62 offen offset:3072 lds
  s_mov_b32 m0, 131072
  s_add_u32 s63, s66, 258048
  buffer_load_dwordx4 v16, s[20:23], s63 offen offset:0 sc1 lds
  buffer_load_dwordx4 v17, s[20:23], s63 offen offset:1024 sc1 lds
  buffer_load_dwordx4 v18, s[20:23], s63 offen offset:2048 sc1 lds
  buffer_load_dwordx4 v19, s[20:23], s63 offen offset:3072 sc1 lds
  s_waitcnt vmcnt(40)
  s_barrier
  s_mov_b32 m0, 61440
  s_movk_i32 s62, 2432
  buffer_load_dwordx4 v8, s[16:19], s62 offen offset:0 lds
  buffer_load_dwordx4 v9, s[16:19], s62 offen offset:1024 lds
  buffer_load_dwordx4 v10, s[16:19], s62 offen offset:2048 lds
  buffer_load_dwordx4 v11, s[16:19], s62 offen offset:3072 lds
  s_mov_b32 m0, 135168
  s_add_u32 s63, s66, 272384
  buffer_load_dwordx4 v16, s[20:23], s63 offen offset:0 sc1 lds
  buffer_load_dwordx4 v17, s[20:23], s63 offen offset:1024 sc1 lds
  buffer_load_dwordx4 v18, s[20:23], s63 offen offset:2048 sc1 lds
  buffer_load_dwordx4 v19, s[20:23], s63 offen offset:3072 sc1 lds
  s_waitcnt vmcnt(40)
  s_barrier
  s_mov_b32 m0, 65536
  s_movk_i32 s62, 2560
  buffer_load_dwordx4 v8, s[16:19], s62 offen offset:0 lds
  buffer_load_dwordx4 v9, s[16:19], s62 offen offset:1024 lds
  buffer_load_dwordx4 v10, s[16:19], s62 offen offset:2048 lds
  buffer_load_dwordx4 v11, s[16:19], s62 offen offset:3072 lds
  s_mov_b32 m0, 139264
  s_add_u32 s63, s66, 286720
  buffer_load_dwordx4 v16, s[20:23], s63 offen offset:0 sc1 lds
  buffer_load_dwordx4 v17, s[20:23], s63 offen offset:1024 sc1 lds
  buffer_load_dwordx4 v18, s[20:23], s63 offen offset:2048 sc1 lds
  buffer_load_dwordx4 v19, s[20:23], s63 offen offset:3072 sc1 lds
  s_waitcnt vmcnt(40)
  s_barrier
  s_mov_b32 m0, 69632
  s_movk_i32 s62, 2688
  buffer_load_dwordx4 v8, s[16:19], s62 offen offset:0 lds
  buffer_load_dwordx4 v9, s[16:19], s62 offen offset:1024 lds
  buffer_load_dwordx4 v10, s[16:19], s62 offen offset:2048 lds
  buffer_load_dwordx4 v11, s[16:19], s62 offen offset:3072 lds
  s_mov_b32 m0, 143360
  s_add_u32 s63, s66, 301056
  buffer_load_dwordx4 v16, s[20:23], s63 offen offset:0 sc1 lds
  buffer_load_dwordx4 v17, s[20:23], s63 offen offset:1024 sc1 lds
  buffer_load_dwordx4 v18, s[20:23], s63 offen offset:2048 sc1 lds
  buffer_load_dwordx4 v19, s[20:23], s63 offen offset:3072 sc1 lds
  s_waitcnt vmcnt(40)
  s_barrier
  s_mov_b32 m0, 73728
  s_movk_i32 s62, 2816
  buffer_load_dwordx4 v8, s[16:19], s62 offen offset:0 lds
  buffer_load_dwordx4 v9, s[16:19], s62 offen offset:1024 lds
  buffer_load_dwordx4 v10, s[16:19], s62 offen offset:2048 lds
  buffer_load_dwordx4 v11, s[16:19], s62 offen offset:3072 lds
  s_mov_b32 m0, 147456
  s_add_u32 s63, s66, 315392
  buffer_load_dwordx4 v16, s[20:23], s63 offen offset:0 sc1 lds
  buffer_load_dwordx4 v17, s[20:23], s63 offen offset:1024 sc1 lds
  buffer_load_dwordx4 v18, s[20:23], s63 offen offset:2048 sc1 lds
  buffer_load_dwordx4 v19, s[20:23], s63 offen offset:3072 sc1 lds
  s_waitcnt vmcnt(40)
  s_barrier
  s_mov_b32 m0, 77824
  s_movk_i32 s62, 2944
  buffer_load_dwordx4 v8, s[16:19], s62 offen offset:0 lds
  buffer_load_dwordx4 v9, s[16:19], s62 offen offset:1024 lds
  buffer_load_dwordx4 v10, s[16:19], s62 offen offset:2048 lds
  buffer_load_dwordx4 v11, s[16:19], s62 offen offset:3072 lds
  s_mov_b32 m0, 151552
  s_add_u32 s63, s66, 329728
  buffer_load_dwordx4 v16, s[20:23], s63 offen offset:0 sc1 lds
  buffer_load_dwordx4 v17, s[20:23], s63 offen offset:1024 sc1 lds
  buffer_load_dwordx4 v18, s[20:23], s63 offen offset:2048 sc1 lds
  buffer_load_dwordx4 v19, s[20:23], s63 offen offset:3072 sc1 lds
  s_waitcnt vmcnt(40)
  s_barrier
  s_mov_b32 m0, 49152
  s_movk_i32 s62, 3072
  buffer_load_dwordx4 v8, s[16:19], s62 offen offset:0 lds
  buffer_load_dwordx4 v9, s[16:19], s62 offen offset:1024 lds
  buffer_load_dwordx4 v10, s[16:19], s62 offen offset:2048 lds
  buffer_load_dwordx4 v11, s[16:19], s62 offen offset:3072 lds
  s_mov_b32 m0, 122880
  s_add_u32 s63, s66, 344064
  buffer_load_dwordx4 v16, s[20:23], s63 offen offset:0 sc1 lds
  buffer_load_dwordx4 v17, s[20:23], s63 offen offset:1024 sc1 lds
  buffer_load_dwordx4 v18, s[20:23], s63 offen offset:2048 sc1 lds
  buffer_load_dwordx4 v19, s[20:23], s63 offen offset:3072 sc1 lds
  s_waitcnt vmcnt(40)
  s_barrier
  s_mov_b32 m0, 53248
  s_movk_i32 s62, 3200
  buffer_load_dwordx4 v8, s[16:19], s62 offen offset:0 lds
  buffer_load_dwordx4 v9, s[16:19], s62 offen offset:1024 lds
  buffer_load_dwordx4 v10, s[16:19], s62 offen offset:2048 lds
  buffer_load_dwordx4 v11, s[16:19], s62 offen offset:3072 lds
  s_mov_b32 m0, 126976
  s_add_u32 s63, s66, 358400
  buffer_load_dwordx4 v16, s[20:23], s63 offen offset:0 sc1 lds
  buffer_load_dwordx4 v17, s[20:23], s63 offen offset:1024 sc1 lds
  buffer_load_dwordx4 v18, s[20:23], s63 offen offset:2048 sc1 lds
  buffer_load_dwordx4 v19, s[20:23], s63 offen offset:3072 sc1 lds
  s_waitcnt vmcnt(40)
  s_barrier
  s_mov_b32 m0, 57344
  s_movk_i32 s62, 3328
  buffer_load_dwordx4 v8, s[16:19], s62 offen offset:0 lds
  buffer_load_dwordx4 v9, s[16:19], s62 offen offset:1024 lds
  buffer_load_dwordx4 v10, s[16:19], s62 offen offset:2048 lds
  buffer_load_dwordx4 v11, s[16:19], s62 offen offset:3072 lds
  s_mov_b32 m0, 131072
  s_add_u32 s63, s66, 372736
  buffer_load_dwordx4 v16, s[20:23], s63 offen offset:0 sc1 lds
  buffer_load_dwordx4 v17, s[20:23], s63 offen offset:1024 sc1 lds
  buffer_load_dwordx4 v18, s[20:23], s63 offen offset:2048 sc1 lds
  buffer_load_dwordx4 v19, s[20:23], s63 offen offset:3072 sc1 lds
  s_waitcnt vmcnt(40)
  s_barrier
  s_mov_b32 m0, 61440
  s_movk_i32 s62, 3456
  buffer_load_dwordx4 v8, s[16:19], s62 offen offset:0 lds
  buffer_load_dwordx4 v9, s[16:19], s62 offen offset:1024 lds
  buffer_load_dwordx4 v10, s[16:19], s62 offen offset:2048 lds
  buffer_load_dwordx4 v11, s[16:19], s62 offen offset:3072 lds
  s_mov_b32 m0, 135168
  s_add_u32 s63, s66, 387072
  buffer_load_dwordx4 v16, s[20:23], s63 offen offset:0 sc1 lds
  buffer_load_dwordx4 v17, s[20:23], s63 offen offset:1024 sc1 lds
  buffer_load_dwordx4 v18, s[20:23], s63 offen offset:2048 sc1 lds
  buffer_load_dwordx4 v19, s[20:23], s63 offen offset:3072 sc1 lds
  s_waitcnt vmcnt(40)
  s_barrier
  s_mov_b32 m0, 65536
  s_movk_i32 s62, 3584
  buffer_load_dwordx4 v8, s[16:19], s62 offen offset:0 lds
  buffer_load_dwordx4 v9, s[16:19], s62 offen offset:1024 lds
  buffer_load_dwordx4 v10, s[16:19], s62 offen offset:2048 lds
  buffer_load_dwordx4 v11, s[16:19], s62 offen offset:3072 lds
  s_mov_b32 m0, 139264
  s_add_u32 s63, s66, 401408
  buffer_load_dwordx4 v16, s[20:23], s63 offen offset:0 sc1 lds
  buffer_load_dwordx4 v17, s[20:23], s63 offen offset:1024 sc1 lds
  buffer_load_dwordx4 v18, s[20:23], s63 offen offset:2048 sc1 lds
  buffer_load_dwordx4 v19, s[20:23], s63 offen offset:3072 sc1 lds
  s_waitcnt vmcnt(40)
  s_barrier
  s_mov_b32 m0, 69632
  s_movk_i32 s62, 3712
  buffer_load_dwordx4 v8, s[16:19], s62 offen offset:0 lds
  buffer_load_dwordx4 v9, s[16:19], s62 offen offset:1024 lds
  buffer_load_dwordx4 v10, s[16:19], s62 offen offset:2048 lds
  buffer_load_dwordx4 v11, s[16:19], s62 offen offset:3072 lds
  s_mov_b32 m0, 143360
  s_add_u32 s63, s66, 415744
  buffer_load_dwordx4 v16, s[20:23], s63 offen offset:0 sc1 lds
  buffer_load_dwordx4 v17, s[20:23], s63 offen offset:1024 sc1 lds
  buffer_load_dwordx4 v18, s[20:23], s63 offen offset:2048 sc1 lds
  buffer_load_dwordx4 v19, s[20:23], s63 offen offset:3072 sc1 lds
  s_waitcnt vmcnt(40)
  s_barrier
  s_mov_b32 m0, 73728
  s_movk_i32 s62, 3840
  buffer_load_dwordx4 v8, s[16:19], s62 offen offset:0 lds
  buffer_load_dwordx4 v9, s[16:19], s62 offen offset:1024 lds
  buffer_load_dwordx4 v10, s[16:19], s62 offen offset:2048 lds
  buffer_load_dwordx4 v11, s[16:19], s62 offen offset:3072 lds
  s_mov_b32 m0, 147456
  s_add_u32 s63, s66, 430080
  buffer_load_dwordx4 v16, s[20:23], s63 offen offset:0 sc1 lds
  buffer_load_dwordx4 v17, s[20:23], s63 offen offset:1024 sc1 lds
  buffer_load_dwordx4 v18, s[20:23], s63 offen offset:2048 sc1 lds
  buffer_load_dwordx4 v19, s[20:23], s63 offen offset:3072 sc1 lds
  s_waitcnt vmcnt(40)
  s_barrier
  s_mov_b32 m0, 77824
  s_movk_i32 s62, 3968
  buffer_load_dwordx4 v8, s[16:19], s62 offen offset:0 lds
  buffer_load_dwordx4 v9, s[16:19], s62 offen offset:1024 lds
  buffer_load_dwordx4 v10, s[16:19], s62 offen offset:2048 lds
  buffer_load_dwordx4 v11, s[16:19], s62 offen offset:3072 lds
  s_mov_b32 m0, 151552
  s_add_u32 s63, s66, 444416
  buffer_load_dwordx4 v16, s[20:23], s63 offen offset:0 sc1 lds
  buffer_load_dwordx4 v17, s[20:23], s63 offen offset:1024 sc1 lds
  buffer_load_dwordx4 v18, s[20:23], s63 offen offset:2048 sc1 lds
  buffer_load_dwordx4 v19, s[20:23], s63 offen offset:3072 sc1 lds
  s_waitcnt vmcnt(40)
  s_barrier
  s_mov_b32 m0, 122880
  s_add_u32 s63, s40, 0
  buffer_load_dwordx4 v20, s[28:31], s63 offen offset:0 lds
  buffer_load_dwordx4 v21, s[28:31], s63 offen offset:1024 lds
  s_waitcnt vmcnt(34)
  s_barrier
  s_mov_b32 m0, 126976
  s_add_u32 s63, s44, 0
  buffer_load_dwordx4 v20, s[28:31], s63 offen offset:0 lds
  buffer_load_dwordx4 v21, s[28:31], s63 offen offset:1024 lds
  s_waitcnt vmcnt(28)
  s_barrier
  s_mov_b32 m0, 131072
  s_add_u32 s63, s42, 229376
  buffer_load_dwordx4 v20, s[28:31], s63 offen offset:0 lds
  buffer_load_dwordx4 v21, s[28:31], s63 offen offset:1024 lds
  s_waitcnt vmcnt(22)
  s_barrier
  s_mov_b32 m0, 135168
  s_add_u32 s63, s46, 0
  buffer_load_dwordx4 v20, s[28:31], s63 offen offset:0 lds
  buffer_load_dwordx4 v21, s[28:31], s63 offen offset:1024 lds
  s_waitcnt vmcnt(16)
  s_barrier
  s_mov_b32 m0, 139264
  s_add_u32 s63, s42, 458752
  buffer_load_dwordx4 v20, s[28:31], s63 offen offset:0 lds
  buffer_load_dwordx4 v21, s[28:31], s63 offen offset:1024 lds
  s_waitcnt vmcnt(10)
  s_barrier
  s_mov_b32 m0, 143360
  s_add_u32 s63, s40, 688128
  buffer_load_dwordx4 v20, s[28:31], s63 offen offset:0 lds
  buffer_load_dwordx4 v21, s[28:31], s63 offen offset:1024 lds
  s_waitcnt vmcnt(10)
  s_barrier
  s_mov_b32 m0, 147456
  s_add_u32 s63, s44, 688128
  buffer_load_dwordx4 v20, s[28:31], s63 offen offset:0 lds
  buffer_load_dwordx4 v21, s[28:31], s63 offen offset:1024 lds
  s_barrier
  s_lshl_b32 s59, s53, 13
  s_add_u32 s59, s59, 131072
  s_movk_i32 s61, 20000
L_kg_pollP0:
  buffer_load_dword v25, v24, s[36:39], s59 offen sc1
  s_waitcnt vmcnt(0)
  v_cmp_eq_u32 s[90:91], 0, v25
  s_nop 0
  s_cmp_eq_u64 s[90:91], 0
  s_cbranch_scc1 L_kg_pollP0_ok
  s_sub_u32 s61, s61, 1
  s_cmp_lg_u32 s61, 0
  s_cbranch_scc1 L_kg_pollP0
L_kg_pollP0_ok:
  s_barrier
  s_mov_b32 m0, 49152
  s_add_u32 s62, s67, 0
  buffer_load_dwordx4 v12, s[24:27], s62 offen offset:0 sc1 lds
  buffer_load_dwordx4 v12, s[24:27], s62 offen offset:1024 sc1 lds
  buffer_load_dwordx4 v13, s[24:27], s62 offen offset:2048 sc1 lds
  buffer_load_dwordx4 v13, s[24:27], s62 offen offset:3072 sc1 lds
  s_mov_b32 m0, 53248
  s_add_u32 s62, s67, 2048
  buffer_load_dwordx4 v12, s[24:27], s62 offen offset:0 sc1 lds
  buffer_load_dwordx4 v12, s[24:27], s62 offen offset:1024 sc1 lds
  buffer_load_dwordx4 v13, s[24:27], s62 offen offset:2048 sc1 lds
  buffer_load_dwordx4 v13, s[24:27], s62 offen offset:3072 sc1 lds
  s_mov_b32 m0, 57344
  s_add_u32 s62, s67, 4096
  buffer_load_dwordx4 v12, s[24:27], s62 offen offset:0 sc1 lds
  buffer_load_dwordx4 v12, s[24:27], s62 offen offset:1024 sc1 lds
  buffer_load_dwordx4 v13, s[24:27], s62 offen offset:2048 sc1 lds
  buffer_load_dwordx4 v13, s[24:27], s62 offen offset:3072 sc1 lds
  s_mov_b32 m0, 61440
  s_add_u32 s62, s67, 6144
  buffer_load_dwordx4 v12, s[24:27], s62 offen offset:0 sc1 lds
  buffer_load_dwordx4 v12, s[24:27], s62 offen offset:1024 sc1 lds
  buffer_load_dwordx4 v13, s[24:27], s62 offen offset:2048 sc1 lds
  buffer_load_dwordx4 v13, s[24:27], s62 offen offset:3072 sc1 lds
  s_mov_b32 m0, 65536
  s_add_u32 s62, s67, 8192
  buffer_load_dwordx4 v12, s[24:27], s62 offen offset:0 sc1 lds
  buffer_load_dwordx4 v12, s[24:27], s62 offen offset:1024 sc1 lds
  buffer_load_dwordx4 v13, s[24:27], s62 offen offset:2048 sc1 lds
  buffer_load_dwordx4 v13, s[24:27], s62 offen offset:3072 sc1 lds
  s_mov_b32 m0, 69632
  s_add_u32 s62, s67, 10240
  buffer_load_dwordx4 v12, s[24:27], s62 offen offset:0 sc1 lds
  buffer_load_dwordx4 v12, s[24:27], s62 offen offset:1024 sc1 lds
  buffer_load_dwordx4 v13, s[24:27], s62 offen offset:2048 sc1 lds
  buffer_load_dwordx4 v13, s[24:27], s62 offen offset:3072 sc1 lds
  s_mov_b32 m0, 73728
  s_add_u32 s62, s67, 12288
  buffer_load_dwordx4 v12, s[24:27], s62 offen offset:0 sc1 lds
  buffer_load_dwordx4 v12, s[24:27], s62 offen offset:1024 sc1 lds
  buffer_load_dwordx4 v13, s[24:27], s62 offen offset:2048 sc1 lds
  buffer_load_dwordx4 v13, s[24:27], s62 offen offset:3072 sc1 lds
  s_waitcnt vmcnt(24)
  s_barrier
  s_waitcnt vmcnt(20)
  s_barrier
  s_mov_b32 m0, 77824
  s_add_u32 s62, s67, 14336
  buffer_load_dwordx4 v12, s[24:27], s62 offen offset:0 sc1 lds
  buffer_load_dwordx4 v12, s[24:27], s62 offen offset:1024 sc1 lds
  buffer_load_dwordx4 v13, s[24:27], s62 offen offset:2048 sc1 lds
  buffer_load_dwordx4 v13, s[24:27], s62 offen offset:3072 sc1 lds
  s_mov_b32 m0, 151552
  s_add_u32 s63, s40, 917504
  buffer_load_dwordx4 v20, s[28:31], s63 offen offset:0 lds
  buffer_load_dwordx4 v21, s[28:31], s63 offen offset:1024 lds
  s_waitcnt vmcnt(22)
  s_barrier
  s_mov_b32 m0, 49152
  s_add_u32 s62, s67, 16384
  buffer_load_dwordx4 v12, s[24:27], s62 offen offset:0 sc1 lds
  buffer_load_dwordx4 v12, s[24:27], s62 offen offset:1024 sc1 lds
  buffer_load_dwordx4 v13, s[24:27], s62 offen offset:2048 sc1 lds
  buffer_load_dwordx4 v13, s[24:27], s62 offen offset:3072 sc1 lds
  s_mov_b32 m0, 122880
  s_add_u32 s63, s44, 917504
  buffer_load_dwordx4 v20, s[28:31], s63 offen offset:0 lds
  buffer_load_dwordx4 v21, s[28:31], s63 offen offset:1024 lds
  s_waitcnt vmcnt(24)
  s_barrier
  s_mov_b32 m0, 53248
  s_add_u32 s62, s67, 18432
  buffer_load_dwordx4 v12, s[24:27], s62 offen offset:0 sc1 lds
  buffer_load_dwordx4 v12, s[24:27], s62 offen offset:1024 sc1 lds
  buffer_load_dwordx4 v13, s[24:27], s62 offen offset:2048 sc1 lds
  buffer_load_dwordx4 v13, s[24:27], s62 offen offset:3072 sc1 lds
  s_mov_b32 m0, 126976
  s_add_u32 s63, s42, 1146880
  buffer_load_dwordx4 v20, s[28:31], s63 offen offset:0 lds
  buffer_load_dwordx4 v21, s[28:31], s63 offen offset:1024 lds
  s_waitcnt vmcnt(26)
  s_barrier
  s_mov_b32 m0, 57344
  s_add_u32 s62, s67, 20480
  buffer_load_dwordx4 v12, s[24:27], s62 offen offset:0 sc1 lds
  buffer_load_dwordx4 v12, s[24:27], s62 offen offset:1024 sc1 lds
  buffer_load_dwordx4 v13, s[24:27], s62 offen offset:2048 sc1 lds
  buffer_load_dwordx4 v13, s[24:27], s62 offen offset:3072 sc1 lds
  s_mov_b32 m0, 131072
  s_add_u32 s63, s46, 917504
  buffer_load_dwordx4 v20, s[28:31], s63 offen offset:0 lds
  buffer_load_dwordx4 v21, s[28:31], s63 offen offset:1024 lds
  s_waitcnt vmcnt(28)
  s_barrier
  s_mov_b32 m0, 61440
  s_add_u32 s62, s67, 22528
  buffer_load_dwordx4 v12, s[24:27], s62 offen offset:0 sc1 lds
  buffer_load_dwordx4 v12, s[24:27], s62 offen offset:1024 sc1 lds
  buffer_load_dwordx4 v13, s[24:27], s62 offen offset:2048 sc1 lds
  buffer_load_dwordx4 v13, s[24:27], s62 offen offset:3072 sc1 lds
  s_mov_b32 m0, 135168
  s_add_u32 s63, s42, 1376256
  buffer_load_dwordx4 v20, s[28:31], s63 offen offset:0 lds
  buffer_load_dwordx4 v21, s[28:31], s63 offen offset:1024 lds
  s_waitcnt vmcnt(30)
  s_barrier
  s_mov_b32 m0, 65536
  s_add_u32 s62, s67, 24576
  buffer_load_dwordx4 v12, s[24:27], s62 offen offset:0 sc1 lds
  buffer_load_dwordx4 v12, s[24:27], s62 offen offset:1024 sc1 lds
  buffer_load_dwordx4 v13, s[24:27], s62 offen offset:2048 sc1 lds
  buffer_load_dwordx4 v13, s[24:27], s62 offen offset:3072 sc1 lds
  s_mov_b32 m0, 139264
  s_add_u32 s63, s40, 1605632
  buffer_load_dwordx4 v20, s[28:31], s63 offen offset:0 lds
  buffer_load_dwordx4 v21, s[28:31], s63 offen offset:1024 lds
  s_waitcnt vmcnt(30)
  s_barrier
  s_mov_b32 m0, 69632
  s_add_u32 s62, s67, 26624
  buffer_load_dwordx4 v12, s[24:27], s62 offen offset:0 sc1 lds
  buffer_load_dwordx4 v12, s[24:27], s62 offen offset:1024 sc1 lds
  buffer_load_dwordx4 v13, s[24:27], s62 offen offset:2048 sc1 lds
  buffer_load_dwordx4 v13, s[24:27], s62 offen offset:3072 sc1 lds
  s_mov_b32 m0, 143360
  s_add_u32 s63, s44, 1605632
  buffer_load_dwordx4 v20, s[28:31], s63 offen offset:0 lds
  buffer_load_dwordx4 v21, s[28:31], s63 offen offset:1024 lds
  s_waitcnt vmcnt(30)
  s_barrier
  s_mov_b32 m0, 73728
  s_add_u32 s62, s67, 28672
  buffer_load_dwordx4 v12, s[24:27], s62 offen offset:0 sc1 lds
  buffer_load_dwordx4 v12, s[24:27], s62 offen offset:1024 sc1 lds
  buffer_load_dwordx4 v13, s[24:27], s62 offen offset:2048 sc1 lds
  buffer_load_dwordx4 v13, s[24:27], s62 offen offset:3072 sc1 lds
  s_mov_b32 m0, 147456
  s_add_u32 s63, s40, 1835008
  buffer_load_dwordx4 v20, s[28:31], s63 offen offset:0 lds
  buffer_load_dwordx4 v21, s[28:31], s63 offen offset:1024 lds
  s_waitcnt vmcnt(30)
  s_barrier
  s_mov_b32 m0, 77824
  s_add_u32 s62, s67, 30720
  buffer_load_dwordx4 v12, s[24:27], s62 offen offset:0 sc1 lds
  buffer_load_dwordx4 v12, s[24:27], s62 offen offset:1024 sc1 lds
  buffer_load_dwordx4 v13, s[24:27], s62 offen offset:2048 sc1 lds
  buffer_load_dwordx4 v13, s[24:27], s62 offen offset:3072 sc1 lds
  s_mov_b32 m0, 151552
  s_add_u32 s63, s44, 1835008
  buffer_load_dwordx4 v20, s[28:31], s63 offen offset:0 lds
  buffer_load_dwordx4 v21, s[28:31], s63 offen offset:1024 lds
  s_waitcnt vmcnt(30)
  s_barrier
  s_mov_b32 m0, 49152
  s_add_u32 s62, s67, 32768
  buffer_load_dwordx4 v12, s[24:27], s62 offen offset:0 sc1 lds
  buffer_load_dwordx4 v12, s[24:27], s62 offen offset:1024 sc1 lds
  buffer_load_dwordx4 v13, s[24:27], s62 offen offset:2048 sc1 lds
  buffer_load_dwordx4 v13, s[24:27], s62 offen offset:3072 sc1 lds
  s_mov_b32 m0, 122880
  s_add_u32 s63, s42, 2064384
  buffer_load_dwordx4 v20, s[28:31], s63 offen offset:0 lds
  buffer_load_dwordx4 v21, s[28:31], s63 offen offset:1024 lds
  s_waitcnt vmcnt(30)
  s_barrier
  s_mov_b32 m0, 53248
  s_add_u32 s62, s67, 34816
  buffer_load_dwordx4 v12, s[24:27], s62 offen offset:0 sc1 lds
  buffer_load_dwordx4 v12, s[24:27], s62 offen offset:1024 sc1 lds
  buffer_load_dwordx4 v13, s[24:27], s62 offen offset:2048 sc1 lds
  buffer_load_dwordx4 v13, s[24:27], s62 offen offset:3072 sc1 lds
  s_mov_b32 m0, 126976
  s_add_u32 s63, s46, 1835008
  buffer_load_dwordx4 v20, s[28:31], s63 offen offset:0 lds
  buffer_load_dwordx4 v21, s[28:31], s63 offen offset:1024 lds
  s_waitcnt vmcnt(30)
  s_barrier
  s_mov_b32 m0, 57344
  s_add_u32 s62, s67, 36864
  buffer_load_dwordx4 v12, s[24:27], s62 offen offset:0 sc1 lds
  buffer_load_dwordx4 v12, s[24:27], s62 offen offset:1024 sc1 lds
  buffer_load_dwordx4 v13, s[24:27], s62 offen offset:2048 sc1 lds
  buffer_load_dwordx4 v13, s[24:27], s62 offen offset:3072 sc1 lds
  s_mov_b32 m0, 131072
  s_add_u32 s63, s42, 2293760
  buffer_load_dwordx4 v20, s[28:31], s63 offen offset:0 lds
  buffer_load_dwordx4 v21, s[28:31], s63 offen offset:1024 lds
  s_waitcnt vmcnt(30)
  s_barrier
  s_mov_b32 m0, 61440
  s_add_u32 s62, s67, 38912
  buffer_load_dwordx4 v12, s[24:27], s62 offen offset:0 sc1 lds
  buffer_load_dwordx4 v12, s[24:27], s62 offen offset:1024 sc1 lds
  buffer_load_dwordx4 v13, s[24:27], s62 offen offset:2048 sc1 lds
  buffer_load_dwordx4 v13, s[24:27], s62 offen offset:3072 sc1 lds
  s_mov_b32 m0, 135168
  s_add_u32 s63, s40, 2523136
  buffer_load_dwordx4 v20, s[28:31], s63 offen offset:0 lds
  buffer_load_dwordx4 v21, s[28:31], s63 offen offset:1024 lds
  s_waitcnt vmcnt(30)
  s_barrier
  s_mov_b32 m0, 65536
  s_add_u32 s62, s67, 40960
  buffer_load_dwordx4 v12, s[24:27], s62 offen offset:0 sc1 lds
  buffer_load_dwordx4 v12, s[24:27], s62 offen offset:1024 sc1 lds
  buffer_load_dwordx4 v13, s[24:27], s62 offen offset:2048 sc1 lds
  buffer_load_dwordx4 v13, s[24:27], s62 offen offset:3072 sc1 lds
  s_mov_b32 m0, 139264
  s_add_u32 s63, s44, 2523136
  buffer_load_dwordx4 v20, s[28:31], s63 offen offset:0 lds
  buffer_load_dwordx4 v21, s[28:31], s63 offen offset:1024 lds
  s_waitcnt vmcnt(30)
  s_barrier
  s_mov_b32 m0, 69632
  s_add_u32 s62, s67, 43008
  buffer_load_dwordx4 v12, s[24:27], s62 offen offset:0 sc1 lds
  buffer_load_dwordx4 v12, s[24:27], s62 offen offset:1024 sc1 lds
  buffer_load_dwordx4 v13, s[24:27], s62 offen offset:2048 sc1 lds
  buffer_load_dwordx4 v13, s[24:27], s62 offen offset:3072 sc1 lds
  s_mov_b32 m0, 143360
  s_add_u32 s63, s40, 2752512
  buffer_load_dwordx4 v20, s[28:31], s63 offen offset:0 lds
  buffer_load_dwordx4 v21, s[28:31], s63 offen offset:1024 lds
  s_waitcnt vmcnt(30)
  s_barrier
  s_mov_b32 m0, 73728
  s_add_u32 s62, s67, 45056
  buffer_load_dwordx4 v12, s[24:27], s62 offen offset:0 sc1 lds
  buffer_load_dwordx4 v12, s[24:27], s62 offen offset:1024 sc1 lds
  buffer_load_dwordx4 v13, s[24:27], s62 offen offset:2048 sc1 lds
  buffer_load_dwordx4 v13, s[24:27], s62 offen offset:3072 sc1 lds
  s_mov_b32 m0, 147456
  s_add_u32 s63, s44, 2752512
  buffer_load_dwordx4 v20, s[28:31], s63 offen offset:0 lds
  buffer_load_dwordx4 v21, s[28:31], s63 offen offset:1024 lds
  s_waitcnt vmcnt(30)
  s_barrier
  s_mov_b32 m0, 77824
  s_add_u32 s62, s67, 47104
  buffer_load_dwordx4 v12, s[24:27], s62 offen offset:0 sc1 lds
  buffer_load_dwordx4 v12, s[24:27], s62 offen offset:1024 sc1 lds
  buffer_load_dwordx4 v13, s[24:27], s62 offen offset:2048 sc1 lds
  buffer_load_dwordx4 v13, s[24:27], s62 offen offset:3072 sc1 lds
  s_mov_b32 m0, 151552
  s_add_u32 s63, s42, 2981888
  buffer_load_dwordx4 v20, s[28:31], s63 offen offset:0 lds
  buffer_load_dwordx4 v21, s[28:31], s63 offen offset:1024 lds
  s_waitcnt vmcnt(30)
  s_barrier
  s_mov_b32 m0, 49152
  s_add_u32 s62, s67, 49152
  buffer_load_dwordx4 v12, s[24:27], s62 offen offset:0 sc1 lds
  buffer_load_dwordx4 v12, s[24:27], s62 offen offset:1024 sc1 lds
  buffer_load_dwordx4 v13, s[24:27], s62 offen offset:2048 sc1 lds
  buffer_load_dwordx4 v13, s[24:27], s62 offen offset:3072 sc1 lds
  s_mov_b32 m0, 122880
  s_add_u32 s63, s46, 2752512
  buffer_load_dwordx4 v20, s[28:31], s63 offen offset:0 lds
  buffer_load_dwordx4 v21, s[28:31], s63 offen offset:1024 lds
  s_waitcnt vmcnt(30)
  s_barrier
  s_mov_b32 m0, 53248
  s_add_u32 s62, s67, 51200
  buffer_load_dwordx4 v12, s[24:27], s62 offen offset:0 sc1 lds
  buffer_load_dwordx4 v12, s[24:27], s62 offen offset:1024 sc1 lds
  buffer_load_dwordx4 v13, s[24:27], s62 offen offset:2048 sc1 lds
  buffer_load_dwordx4 v13, s[24:27], s62 offen offset:3072 sc1 lds
  s_mov_b32 m0, 126976
  s_add_u32 s63, s42, 3211264
  buffer_load_dwordx4 v20, s[28:31], s63 offen offset:0 lds
  buffer_load_dwordx4 v21, s[28:31], s63 offen offset:1024 lds
  s_waitcnt vmcnt(30)
  s_barrier
  s_mov_b32 m0, 57344
  s_add_u32 s62, s67, 53248
  buffer_load_dwordx4 v12, s[24:27], s62 offen offset:0 sc1 lds
  buffer_load_dwordx4 v12, s[24:27], s62 offen offset:1024 sc1 lds
  buffer_load_dwordx4 v13, s[24:27], s62 offen offset:2048 sc1 lds
  buffer_load_dwordx4 v13, s[24:27], s62 offen offset:3072 sc1 lds
  s_mov_b32 m0, 131072
  s_add_u32 s63, s40, 3440640
  buffer_load_dwordx4 v20, s[28:31], s63 offen offset:0 lds
  buffer_load_dwordx4 v21, s[28:31], s63 offen offset:1024 lds
  s_waitcnt vmcnt(30)
  s_barrier
  s_mov_b32 m0, 61440
  s_add_u32 s62, s67, 55296
  buffer_load_dwordx4 v12, s[24:27], s62 offen offset:0 sc1 lds
  buffer_load_dwordx4 v12, s[24:27], s62 offen offset:1024 sc1 lds
  buffer_load_dwordx4 v13, s[24:27], s62 offen offset:2048 sc1 lds
  buffer_load_dwordx4 v13, s[24:27], s62 offen offset:3072 sc1 lds
  s_mov_b32 m0, 135168
  s_add_u32 s63, s44, 3440640
  buffer_load_dwordx4 v20, s[28:31], s63 offen offset:0 lds
  buffer_load_dwordx4 v21, s[28:31], s63 offen offset:1024 lds
  s_waitcnt vmcnt(30)
  s_barrier
  s_waitcnt vmcnt(24)
  s_barrier
  s_waitcnt vmcnt(18)
  s_barrier
  s_waitcnt vmcnt(12)
  s_barrier
  s_waitcnt vmcnt(6)
  s_barrier
  s_waitcnt vmcnt(0)
  s_barrier
  s_endpgm
L_kg_norm:
  s_add_u32 m0, s69, 0
  s_movk_i32 s62, 0
  buffer_load_dwordx4 v2, s[8:11], s62 offen offset:0 lds
  buffer_load_dwordx4 v3, s[8:11], s62 offen offset:1024 lds
  buffer_load_dwordx4 v4, s[8:11], s62 offen offset:2048 lds
  buffer_load_dwordx4 v5, s[8:11], s62 offen offset:3072 lds
  s_add_u32 m0, s70, 81920
  s_add_u32 s63, s64, 0
  buffer_load_dwordx4 v16, s[12:15], s63 offen offset:0 lds
  buffer_load_dwordx4 v17, s[12:15], s63 offen offset:1024 lds
  buffer_load_dwordx4 v18, s[12:15], s63 offen offset:2048 lds
  s_cbranch_vccz L_kg_skip1
  buffer_load_dwordx4 v19, s[12:15], s63 offen offset:3072 lds
L_kg_skip1:
  s_add_u32 m0, s69, 12288
  s_movk_i32 s62, 128
  buffer_load_dwordx4 v2, s[8:11], s62 offen offset:0 lds
  buffer_load_dwordx4 v3, s[8:11], s62 offen offset:1024 lds
  buffer_load_dwordx4 v4, s[8:11], s62 offen offset:2048 lds
  buffer_load_dwordx4 v5, s[8:11], s62 offen offset:3072 lds
  s_add_u32 m0, s70, 92160
  s_add_u32 s63, s64, 14336
  buffer_load_dwordx4 v16, s[12:15], s63 offen offset:0 lds
  buffer_load_dwordx4 v17, s[12:15], s63 offen offset:1024 lds
  buffer_load_dwordx4 v18, s[12:15], s63 offen offset:2048 lds
  s_cbranch_vccz L_kg_skip2
  buffer_load_dwordx4 v19, s[12:15], s63 offen offset:3072 lds
L_kg_skip2:
  v_lshlrev_b32 v25, 12, v30
  v_xor_b32 v15, 0, v31
  v_lshlrev_b32 v15, 4, v15
  v_add_u32 v15, v25, v15
  v_add_u32 v8, 0, v15
  v_xor_b32 v15, 2, v31
  v_lshlrev_b32 v15, 4, v15
  v_add_u32 v15, v25, v15
  v_add_u32 v9, 31744, v15
  v_xor_b32 v15, 4, v31
  v_lshlrev_b32 v15, 4, v15
  v_add_u32 v15, v25, v15
  v_add_u32 v10, 63488, v15
  v_xor_b32 v15, 6, v31
  v_lshlrev_b32 v15, 4, v15
  v_add_u32 v15, v25, v15
  v_add_u32 v11, 95232, v15
  v_mov_b32 v12, v32
  v_add_u32 v13, 55296, v32
  v_lshlrev_b32 v24, 7, v14
  s_mul_i32 s65, s54, 229376
  s_mul_i32 s66, s54, 458752
  v_lshrrev_b32 v1, 3, v14
  v_bfe_u32 v7, v14, 4, 2
  v_bfe_u32 v15, v14, 1, 2
  v_xor_b32 v7, v7, v15
  v_lshlrev_b32 v7, 5, v7
  v_and_b32 v15, 1, v14
  v_lshlrev_b32 v15, 4, v15
  v_add_u32 v7, v7, v15
  v_lshlrev_b32 v1, 11, v1
  v_add_u32 v7, v7, v1
  s_lshl_b32 s58, s54, 7
  v_add_u32 v20, s58, v7
  v_add_u32 v21, 15360, v20
  s_add_u32 s58, s56, 0
  s_sub_u32 s59, s58, 7
  s_cmp_ge_u32 s58, 7
  s_cselect_b32 s58, s59, s58
  s_lshl_b32 s40, s58, 15
  s_add_u32 s58, s56, 1
  s_sub_u32 s59, s58, 7
  s_cmp_ge_u32 s58, 7
  s_cselect_b32 s58, s59, s58
  s_lshl_b32 s41, s58, 15
  s_add_u32 s58, s56, 2
  s_sub_u32 s59, s58, 7
  s_cmp_ge_u32 s58, 7
  s_cselect_b32 s58, s59, s58
  s_lshl_b32 s42, s58, 15
  s_add_u32 s58, s56, 3
  s_sub_u32 s59, s58, 7
  s_cmp_ge_u32 s58, 7
  s_cselect_b32 s58, s59, s58
  s_lshl_b32 s43, s58, 15
  s_add_u32 s58, s56, 4
  s_sub_u32 s59, s58, 7
  s_cmp_ge_u32 s58, 7
  s_cselect_b32 s58, s59, s58
  s_lshl_b32 s44, s58, 15
  s_add_u32 s58, s56, 5
  s_sub_u32 s59, s58, 7
  s_cmp_ge_u32 s58, 7
  s_cselect_b32 s58, s59, s58
  s_lshl_b32 s45, s58, 15
  s_add_u32 s58, s56, 6
  s_sub_u32 s59, s58, 7
  s_cmp_ge_u32 s58, 7
  s_cselect_b32 s58, s59, s58
  s_lshl_b32 s46, s58, 15
  s_lshr_b32 s58, s2, 4
  s_mul_i32 s58, s58, 112
  v_add_u32 v23, s58, v14
  v_lshlrev_b32 v23, 11, v23
  s_and_b32 s58, s2, 15
  s_lshl_b32 s58, s58, 7
  v_add_u32 v23, s58, v23
  s_lshl_b32 s58, s53, 2
  s_add_u32 s58, s58, s55
  s_mul_i32 s67, s58, 114688
  s_mov_b32 s16, s92
  s_and_b32 s17, s93, 0xffff
  s_mov_b32 s18, 8388608
  s_mov_b32 s19, 0x20000
  s_add_u32 s20, s4, 29357056
  s_addc_u32 s21, s5, 0
  s_and_b32 s21, s21, 0xffff
  s_mov_b32 s22, 7343104
  s_mov_b32 s23, 0x20000
  s_add_u32 s24, s4, 37748736
  s_addc_u32 s25, s5, 0
  s_and_b32 s25, s25, 0xffff
  s_mov_b32 s26, 7340032
  s_mov_b32 s27, 0x20000
  s_mov_b32 s28, s96
  s_and_b32 s29, s97, 0xffff
  s_mov_b32 s30, 3670016
  s_mov_b32 s31, 0x20000
  s_add_u32 s36, s4, 46661632
  s_addc_u32 s37, s5, 0
  s_and_b32 s37, s37, 0xffff
  s_mov_b32 s38, 262144
  s_mov_b32 s39, 0x20000
  s_waitcnt vmcnt(7)
  s_barrier
  s_add_u32 m0, s69, 24576
  s_movk_i32 s62, 256
  buffer_load_dwordx4 v2, s[8:11], s62 offen offset:0 lds
  buffer_load_dwordx4 v3, s[8:11], s62 offen offset:1024 lds
  buffer_load_dwordx4 v4, s[8:11], s62 offen offset:2048 lds
  buffer_load_dwordx4 v5, s[8:11], s62 offen offset:3072 lds
  s_add_u32 m0, s70, 102400
  s_add_u32 s63, s64, 28672
  buffer_load_dwordx4 v16, s[12:15], s63 offen offset:0 lds
  buffer_load_dwordx4 v17, s[12:15], s63 offen offset:1024 lds
  buffer_load_dwordx4 v18, s[12:15], s63 offen offset:2048 lds
  s_cbranch_vccz L_kg_skip3
  buffer_load_dwordx4 v19, s[12:15], s63 offen offset:3072 lds
L_kg_skip3:
  s_add_u32 m0, s69, 36864
  s_movk_i32 s62, 384
  buffer_load_dwordx4 v2, s[8:11], s62 offen offset:0 lds
  buffer_load_dwordx4 v3, s[8:11], s62 offen offset:1024 lds
  buffer_load_dwordx4 v4, s[8:11], s62 offen offset:2048 lds
  buffer_load_dwordx4 v5, s[8:11], s62 offen offset:3072 lds
  s_add_u32 m0, s70, 112640
  s_add_u32 s63, s64, 43008
  buffer_load_dwordx4 v16, s[12:15], s63 offen offset:0 lds
  buffer_load_dwordx4 v17, s[12:15], s63 offen offset:1024 lds
  buffer_load_dwordx4 v18, s[12:15], s63 offen offset:2048 lds
  s_cbranch_vccz L_kg_skip4
  buffer_load_dwordx4 v19, s[12:15], s63 offen offset:3072 lds
L_kg_skip4:
  s_waitcnt vmcnt(14)
  s_barrier
  s_add_u32 m0, s69, 0
  s_movk_i32 s62, 512
  buffer_load_dwordx4 v2, s[8:11], s62 offen offset:0 lds
  buffer_load_dwordx4 v3, s[8:11], s62 offen offset:1024 lds
  buffer_load_dwordx4 v4, s[8:11], s62 offen offset:2048 lds
  buffer_load_dwordx4 v5, s[8:11], s62 offen offset:3072 lds
  s_add_u32 m0, s70, 81920
  s_add_u32 s63, s64, 57344
  buffer_load_dwordx4 v16, s[12:15], s63 offen offset:0 lds
  buffer_load_dwordx4 v17, s[12:15], s63 offen offset:1024 lds
  buffer_load_dwordx4 v18, s[12:15], s63 offen offset:2048 lds
  s_cbranch_vccz L_kg_skip5
  buffer_load_dwordx4 v19, s[12:15], s63 offen offset:3072 lds
L_kg_skip5:
  s_waitcnt vmcnt(14)
  s_barrier
  s_add_u32 m0, s69, 12288
  s_movk_i32 s62, 640
  buffer_load_dwordx4 v2, s[8:11], s62 offen offset:0 lds
  buffer_load_dwordx4 v3, s[8:11], s62 offen offset:1024 lds
  buffer_load_dwordx4 v4, s[8:11], s62 offen offset:2048 lds
  buffer_load_dwordx4 v5, s[8:11], s62 offen offset:3072 lds
  s_add_u32 m0, s70, 92160
  s_add_u32 s63, s64, 71680
  buffer_load_dwordx4 v16, s[12:15], s63 offen offset:0 lds
  buffer_load_dwordx4 v17, s[12:15], s63 offen offset:1024 lds
  buffer_load_dwordx4 v18, s[12:15], s63 offen offset:2048 lds
  s_cbranch_vccz L_kg_skip6
  buffer_load_dwordx4 v19, s[12:15], s63 offen offset:3072 lds
L_kg_skip6:
  s_waitcnt vmcnt(14)
  s_barrier
  s_add_u32 m0, s69, 24576
  s_movk_i32 s62, 768
  buffer_load_dwordx4 v2, s[8:11], s62 offen offset:0 lds
  buffer_load_dwordx4 v3, s[8:11], s62 offen offset:1024 lds
  buffer_load_dwordx4 v4, s[8:11], s62 offen offset:2048 lds
  buffer_load_dwordx4 v5, s[8:11], s62 offen offset:3072 lds
  s_add_u32 m0, s70, 102400
  s_add_u32 s63, s64, 86016
  buffer_load_dwordx4 v16, s[12:15], s63 offen offset:0 lds
  buffer_load_dwordx4 v17, s[12:15], s63 offen offset:1024 lds
  buffer_load_dwordx4 v18, s[12:15], s63 offen offset:2048 lds
  s_cbranch_vccz L_kg_skip7
  buffer_load_dwordx4 v19, s[12:15], s63 offen offset:3072 lds
L_kg_skip7:
  s_waitcnt vmcnt(14)
  s_barrier
  s_add_u32 m0, s69, 36864
  s_movk_i32 s62, 896
  buffer_load_dwordx4 v2, s[8:11], s62 offen offset:0 lds
  buffer_load_dwordx4 v3, s[8:11], s62 offen offset:1024 lds
  buffer_load_dwordx4 v4, s[8:11], s62 offen offset:2048 lds
  buffer_load_dwordx4 v5, s[8:11], s62 offen offset:3072 lds
  s_add_u32 m0, s70, 112640
  s_add_u32 s63, s64, 100352
  buffer_load_dwordx4 v16, s[12:15], s63 offen offset:0 lds
  buffer_load_dwordx4 v17, s[12:15], s63 offen offset:1024 lds
  buffer_load_dwordx4 v18, s[12:15], s63 offen offset:2048 lds
  s_cbranch_vccz L_kg_skip8
  buffer_load_dwordx4 v19, s[12:15], s63 offen offset:3072 lds
L_kg_skip8:
  s_waitcnt vmcnt(14)
  s_barrier
  s_add_u32 m0, s69, 0
  s_movk_i32 s62, 1024
  buffer_load_dwordx4 v2, s[8:11], s62 offen offset:0 lds
  buffer_load_dwordx4 v3, s[8:11], s62 offen offset:1024 lds
  buffer_load_dwordx4 v4, s[8:11], s62 offen offset:2048 lds
  buffer_load_dwordx4 v5, s[8:11], s62 offen offset:3072 lds
  s_add_u32 m0, s70, 81920
  s_add_u32 s63, s64, 114688
  buffer_load_dwordx4 v16, s[12:15], s63 offen offset:0 lds
  buffer_load_dwordx4 v17, s[12:15], s63 offen offset:1024 lds
  buffer_load_dwordx4 v18, s[12:15], s63 offen offset:2048 lds
  s_cbranch_vccz L_kg_skip9
  buffer_load_dwordx4 v19, s[12:15], s63 offen offset:3072 lds
L_kg_skip9:
  s_waitcnt vmcnt(14)
  s_barrier
  s_add_u32 m0, s69, 12288
  s_movk_i32 s62, 1152
  buffer_load_dwordx4 v2, s[8:11], s62 offen offset:0 lds
  buffer_load_dwordx4 v3, s[8:11], s62 offen offset:1024 lds
  buffer_load_dwordx4 v4, s[8:11], s62 offen offset:2048 lds
  buffer_load_dwordx4 v5, s[8:11], s62 offen offset:3072 lds
  s_add_u32 m0, s70, 92160
  s_add_u32 s63, s64, 129024
  buffer_load_dwordx4 v16, s[12:15], s63 offen offset:0 lds
  buffer_load_dwordx4 v17, s[12:15], s63 offen offset:1024 lds
  buffer_load_dwordx4 v18, s[12:15], s63 offen offset:2048 lds
  s_cbranch_vccz L_kg_skip10
  buffer_load_dwordx4 v19, s[12:15], s63 offen offset:3072 lds
L_kg_skip10:
  s_waitcnt vmcnt(14)
  s_barrier
  s_add_u32 m0, s69, 24576
  s_movk_i32 s62, 1280
  buffer_load_dwordx4 v2, s[8:11], s62 offen offset:0 lds
  buffer_load_dwordx4 v3, s[8:11], s62 offen offset:1024 lds
  buffer_load_dwordx4 v4, s[8:11], s62 offen offset:2048 lds
  buffer_load_dwordx4 v5, s[8:11], s62 offen offset:3072 lds
  s_add_u32 m0, s70, 102400
  s_add_u32 s63, s64, 143360
  buffer_load_dwordx4 v16, s[12:15], s63 offen offset:0 lds
  buffer_load_dwordx4 v17, s[12:15], s63 offen offset:1024 lds
  buffer_load_dwordx4 v18, s[12:15], s63 offen offset:2048 lds
  s_cbranch_vccz L_kg_skip11
  buffer_load_dwordx4 v19, s[12:15], s63 offen offset:3072 lds
L_kg_skip11:
  s_waitcnt vmcnt(14)
  s_barrier
  s_add_u32 m0, s69, 36864
  s_movk_i32 s62, 1408
  buffer_load_dwordx4 v2, s[8:11], s62 offen offset:0 lds
  buffer_load_dwordx4 v3, s[8:11], s62 offen offset:1024 lds
  buffer_load_dwordx4 v4, s[8:11], s62 offen offset:2048 lds
  buffer_load_dwordx4 v5, s[8:11], s62 offen offset:3072 lds
  s_add_u32 m0, s70, 112640
  s_add_u32 s63, s64, 157696
  buffer_load_dwordx4 v16, s[12:15], s63 offen offset:0 lds
  buffer_load_dwordx4 v17, s[12:15], s63 offen offset:1024 lds
  buffer_load_dwordx4 v18, s[12:15], s63 offen offset:2048 lds
  s_cbranch_vccz L_kg_skip12
  buffer_load_dwordx4 v19, s[12:15], s63 offen offset:3072 lds
L_kg_skip12:
  s_waitcnt vmcnt(14)
  s_barrier
  s_add_u32 m0, s69, 0
  s_movk_i32 s62, 1536
  buffer_load_dwordx4 v2, s[8:11], s62 offen offset:0 lds
  buffer_load_dwordx4 v3, s[8:11], s62 offen offset:1024 lds
  buffer_load_dwordx4 v4, s[8:11], s62 offen offset:2048 lds
  buffer_load_dwordx4 v5, s[8:11], s62 offen offset:3072 lds
  s_add_u32 m0, s70, 81920
  s_add_u32 s63, s64, 172032
  buffer_load_dwordx4 v16, s[12:15], s63 offen offset:0 lds
  buffer_load_dwordx4 v17, s[12:15], s63 offen offset:1024 lds
  buffer_load_dwordx4 v18, s[12:15], s63 offen offset:2048 lds
  s_cbranch_vccz L_kg_skip13
  buffer_load_dwordx4 v19, s[12:15], s63 offen offset:3072 lds
L_kg_skip13:
  s_waitcnt vmcnt(14)
  s_barrier
  s_add_u32 m0, s69, 12288
  s_movk_i32 s62, 1664
  buffer_load_dwordx4 v2, s[8:11], s62 offen offset:0 lds
  buffer_load_dwordx4 v3, s[8:11], s62 offen offset:1024 lds
  buffer_load_dwordx4 v4, s[8:11], s62 offen offset:2048 lds
  buffer_load_dwordx4 v5, s[8:11], s62 offen offset:3072 lds
  s_add_u32 m0, s70, 92160
  s_add_u32 s63, s64, 186368
  buffer_load_dwordx4 v16, s[12:15], s63 offen offset:0 lds
  buffer_load_dwordx4 v17, s[12:15], s63 offen offset:1024 lds
  buffer_load_dwordx4 v18, s[12:15], s63 offen offset:2048 lds
  s_cbranch_vccz L_kg_skip14
  buffer_load_dwordx4 v19, s[12:15], s63 offen offset:3072 lds
L_kg_skip14:
  s_waitcnt vmcnt(14)
  s_barrier
  s_add_u32 m0, s69, 24576
  s_movk_i32 s62, 1792
  buffer_load_dwordx4 v2, s[8:11], s62 offen offset:0 lds
  buffer_load_dwordx4 v3, s[8:11], s62 offen offset:1024 lds
  buffer_load_dwordx4 v4, s[8:11], s62 offen offset:2048 lds
  buffer_load_dwordx4 v5, s[8:11], s62 offen offset:3072 lds
  s_add_u32 m0, s70, 102400
  s_add_u32 s63, s64, 200704
  buffer_load_dwordx4 v16, s[12:15], s63 offen offset:0 lds
  buffer_load_dwordx4 v17, s[12:15], s63 offen offset:1024 lds
  buffer_load_dwordx4 v18, s[12:15], s63 offen offset:2048 lds
  s_cbranch_vccz L_kg_skip15
  buffer_load_dwordx4 v19, s[12:15], s63 offen offset:3072 lds
L_kg_skip15:
  s_waitcnt vmcnt(14)
  s_barrier
  s_add_u32 m0, s69, 36864
  s_movk_i32 s62, 1920
  buffer_load_dwordx4 v2, s[8:11], s62 offen offset:0 lds
  buffer_load_dwordx4 v3, s[8:11], s62 offen offset:1024 lds
  buffer_load_dwordx4 v4, s[8:11], s62 offen offset:2048 lds
  buffer_load_dwordx4 v5, s[8:11], s62 offen offset:3072 lds
  s_add_u32 m0, s70, 112640
  s_add_u32 s63, s64, 215040
  buffer_load_dwordx4 v16, s[12:15], s63 offen offset:0 lds
  buffer_load_dwordx4 v17, s[12:15], s63 offen offset:1024 lds
  buffer_load_dwordx4 v18, s[12:15], s63 offen offset:2048 lds
  s_cbranch_vccz L_kg_skip16
  buffer_load_dwordx4 v19, s[12:15], s63 offen offset:3072 lds
L_kg_skip16:
  s_waitcnt vmcnt(14)
  s_barrier
  s_add_u32 m0, s69, 0
  s_movk_i32 s62, 0
  buffer_load_dwordx4 v2, s[8:11], s62 offen offset:0 lds
  buffer_load_dwordx4 v3, s[8:11], s62 offen offset:1024 lds
  buffer_load_dwordx4 v4, s[8:11], s62 offen offset:2048 lds
  buffer_load_dwordx4 v5, s[8:11], s62 offen offset:3072 lds
  s_add_u32 m0, s70, 81920
  s_add_u32 s63, s65, 0
  buffer_load_dwordx4 v16, s[12:15], s63 offen offset:0 lds
  buffer_load_dwordx4 v17, s[12:15], s63 offen offset:1024 lds
  buffer_load_dwordx4 v18, s[12:15], s63 offen offset:2048 lds
  s_cbranch_vccz L_kg_skip17
  buffer_load_dwordx4 v19, s[12:15], s63 offen offset:3072 lds
L_kg_skip17:
  s_waitcnt vmcnt(14)
  s_barrier
  s_add_u32 m0, s69, 12288
  s_movk_i32 s62, 128
  buffer_load_dwordx4 v2, s[8:11], s62 offen offset:0 lds
  buffer_load_dwordx4 v3, s[8:11], s62 offen offset:1024 lds
  buffer_load_dwordx4 v4, s[8:11], s62 offen offset:2048 lds
  buffer_load_dwordx4 v5, s[8:11], s62 offen offset:3072 lds
  s_add_u32 m0, s70, 92160
  s_add_u32 s63, s65, 14336
  buffer_load_dwordx4 v16, s[12:15], s63 offen offset:0 lds
  buffer_load_dwordx4 v17, s[12:15], s63 offen offset:1024 lds
  buffer_load_dwordx4 v18, s[12:15], s63 offen offset:2048 lds
  s_cbranch_vccz L_kg_skip18
  buffer_load_dwordx4 v19, s[12:15], s63 offen offset:3072 lds
L_kg_skip18:
  s_waitcnt vmcnt(14)
  s_barrier
  s_add_u32 m0, s69, 24576
  s_movk_i32 s62, 256
  buffer_load_dwordx4 v2, s[8:11], s62 offen offset:0 lds
  buffer_load_dwordx4 v3, s[8:11], s62 offen offset:1024 lds
  buffer_load_dwordx4 v4, s[8:11], s62 offen offset:2048 lds
  buffer_load_dwordx4 v5, s[8:11], s62 offen offset:3072 lds
  s_add_u32 m0, s70, 102400
  s_add_u32 s63, s65, 28672
  buffer_load_dwordx4 v16, s[12:15], s63 offen offset:0 lds
  buffer_load_dwordx4 v17, s[12:15], s63 offen offset:1024 lds
  buffer_load_dwordx4 v18, s[12:15], s63 offen offset:2048 lds
  s_cbranch_vccz L_kg_skip19
  buffer_load_dwordx4 v19, s[12:15], s63 offen offset:3072 lds
L_kg_skip19:
  s_waitcnt vmcnt(14)
  s_barrier
  s_add_u32 m0, s69, 36864
  s_movk_i32 s62, 384
  buffer_load_dwordx4 v2, s[8:11], s62 offen offset:0 lds
  buffer_load_dwordx4 v3, s[8:11], s62 offen offset:1024 lds
  buffer_load_dwordx4 v4, s[8:11], s62 offen offset:2048 lds
  buffer_load_dwordx4 v5, s[8:11], s62 offen offset:3072 lds
  s_add_u32 m0, s70, 112640
  s_add_u32 s63, s65, 43008
  buffer_load_dwordx4 v16, s[12:15], s63 offen offset:0 lds
  buffer_load_dwordx4 v17, s[12:15], s63 offen offset:1024 lds
  buffer_load_dwordx4 v18, s[12:15], s63 offen offset:2048 lds
  s_cbranch_vccz L_kg_skip20
  buffer_load_dwordx4 v19, s[12:15], s63 offen offset:3072 lds
L_kg_skip20:
  s_waitcnt vmcnt(14)
  s_barrier
  s_add_u32 m0, s69, 0
  s_movk_i32 s62, 512
  buffer_load_dwordx4 v2, s[8:11], s62 offen offset:0 lds
  buffer_load_dwordx4 v3, s[8:11], s62 offen offset:1024 lds
  buffer_load_dwordx4 v4, s[8:11], s62 offen offset:2048 lds
  buffer_load_dwordx4 v5, s[8:11], s62 offen offset:3072 lds
  s_add_u32 m0, s70, 81920
  s_add_u32 s63, s65, 57344
  buffer_load_dwordx4 v16, s[12:15], s63 offen offset:0 lds
  buffer_load_dwordx4 v17, s[12:15], s63 offen offset:1024 lds
  buffer_load_dwordx4 v18, s[12:15], s63 offen offset:2048 lds
  s_cbranch_vccz L_kg_skip21
  buffer_load_dwordx4 v19, s[12:15], s63 offen offset:3072 lds
L_kg_skip21:
  s_waitcnt vmcnt(14)
  s_barrier
  s_add_u32 m0, s69, 12288
  s_movk_i32 s62, 640
  buffer_load_dwordx4 v2, s[8:11], s62 offen offset:0 lds
  buffer_load_dwordx4 v3, s[8:11], s62 offen offset:1024 lds
  buffer_load_dwordx4 v4, s[8:11], s62 offen offset:2048 lds
  buffer_load_dwordx4 v5, s[8:11], s62 offen offset:3072 lds
  s_add_u32 m0, s70, 92160
  s_add_u32 s63, s65, 71680
  buffer_load_dwordx4 v16, s[12:15], s63 offen offset:0 lds
  buffer_load_dwordx4 v17, s[12:15], s63 offen offset:1024 lds
  buffer_load_dwordx4 v18, s[12:15], s63 offen offset:2048 lds
  s_cbranch_vccz L_kg_skip22
  buffer_load_dwordx4 v19, s[12:15], s63 offen offset:3072 lds
L_kg_skip22:
  s_waitcnt vmcnt(14)
  s_barrier
  s_add_u32 m0, s69, 24576
  s_movk_i32 s62, 768
  buffer_load_dwordx4 v2, s[8:11], s62 offen offset:0 lds
  buffer_load_dwordx4 v3, s[8:11], s62 offen offset:1024 lds
  buffer_load_dwordx4 v4, s[8:11], s62 offen offset:2048 lds
  buffer_load_dwordx4 v5, s[8:11], s62 offen offset:3072 lds
  s_add_u32 m0, s70, 102400
  s_add_u32 s63, s65, 86016
  buffer_load_dwordx4 v16, s[12:15], s63 offen offset:0 lds
  buffer_load_dwordx4 v17, s[12:15], s63 offen offset:1024 lds
  buffer_load_dwordx4 v18, s[12:15], s63 offen offset:2048 lds
  s_cbranch_vccz L_kg_skip23
  buffer_load_dwordx4 v19, s[12:15], s63 offen offset:3072 lds
L_kg_skip23:
  s_waitcnt vmcnt(14)
  s_barrier
  s_add_u32 m0, s69, 36864
  s_movk_i32 s62, 896
  buffer_load_dwordx4 v2, s[8:11], s62 offen offset:0 lds
  buffer_load_dwordx4 v3, s[8:11], s62 offen offset:1024 lds
  buffer_load_dwordx4 v4, s[8:11], s62 offen offset:2048 lds
  buffer_load_dwordx4 v5, s[8:11], s62 offen offset:3072 lds
  s_add_u32 m0, s70, 112640
  s_add_u32 s63, s65, 100352
  buffer_load_dwordx4 v16, s[12:15], s63 offen offset:0 lds
  buffer_load_dwordx4 v17, s[12:15], s63 offen offset:1024 lds
  buffer_load_dwordx4 v18, s[12:15], s63 offen offset:2048 lds
  s_cbranch_vccz L_kg_skip24
  buffer_load_dwordx4 v19, s[12:15], s63 offen offset:3072 lds
L_kg_skip24:
  s_waitcnt vmcnt(14)
  s_barrier
  s_add_u32 m0, s69, 0
  s_movk_i32 s62, 1024
  buffer_load_dwordx4 v2, s[8:11], s62 offen offset:0 lds
  buffer_load_dwordx4 v3, s[8:11], s62 offen offset:1024 lds
  buffer_load_dwordx4 v4, s[8:11], s62 offen offset:2048 lds
  buffer_load_dwordx4 v5, s[8:11], s62 offen offset:3072 lds
  s_add_u32 m0, s70, 81920
  s_add_u32 s63, s65, 114688
  buffer_load_dwordx4 v16, s[12:15], s63 offen offset:0 lds
  buffer_load_dwordx4 v17, s[12:15], s63 offen offset:1024 lds
  buffer_load_dwordx4 v18, s[12:15], s63 offen offset:2048 lds
  s_cbranch_vccz L_kg_skip25
  buffer_load_dwordx4 v19, s[12:15], s63 offen offset:3072 lds
L_kg_skip25:
  s_waitcnt vmcnt(14)
  s_barrier
  s_add_u32 m0, s69, 12288
  s_movk_i32 s62, 1152
  buffer_load_dwordx4 v2, s[8:11], s62 offen offset:0 lds
  buffer_load_dwordx4 v3, s[8:11], s62 offen offset:1024 lds
  buffer_load_dwordx4 v4, s[8:11], s62 offen offset:2048 lds
  buffer_load_dwordx4 v5, s[8:11], s62 offen offset:3072 lds
  s_add_u32 m0, s70, 92160
  s_add_u32 s63, s65, 129024
  buffer_load_dwordx4 v16, s[12:15], s63 offen offset:0 lds
  buffer_load_dwordx4 v17, s[12:15], s63 offen offset:1024 lds
  buffer_load_dwordx4 v18, s[12:15], s63 offen offset:2048 lds
  s_cbranch_vccz L_kg_skip26
  buffer_load_dwordx4 v19, s[12:15], s63 offen offset:3072 lds
L_kg_skip26:
  s_waitcnt vmcnt(14)
  s_barrier
  s_add_u32 m0, s69, 24576
  s_movk_i32 s62, 1280
  buffer_load_dwordx4 v2, s[8:11], s62 offen offset:0 lds
  buffer_load_dwordx4 v3, s[8:11], s62 offen offset:1024 lds
  buffer_load_dwordx4 v4, s[8:11], s62 offen offset:2048 lds
  buffer_load_dwordx4 v5, s[8:11], s62 offen offset:3072 lds
  s_add_u32 m0, s70, 102400
  s_add_u32 s63, s65, 143360
  buffer_load_dwordx4 v16, s[12:15], s63 offen offset:0 lds
  buffer_load_dwordx4 v17, s[12:15], s63 offen offset:1024 lds
  buffer_load_dwordx4 v18, s[12:15], s63 offen offset:2048 lds
  s_cbranch_vccz L_kg_skip27
  buffer_load_dwordx4 v19, s[12:15], s63 offen offset:3072 lds
L_kg_skip27:
  s_waitcnt vmcnt(14)
  s_barrier
  s_add_u32 m0, s69, 36864
  s_movk_i32 s62, 1408
  buffer_load_dwordx4 v2, s[8:11], s62 offen offset:0 lds
  buffer_load_dwordx4 v3, s[8:11], s62 offen offset:1024 lds
  buffer_load_dwordx4 v4, s[8:11], s62 offen offset:2048 lds
  buffer_load_dwordx4 v5, s[8:11], s62 offen offset:3072 lds
  s_add_u32 m0, s70, 112640
  s_add_u32 s63, s65, 157696
  buffer_load_dwordx4 v16, s[12:15], s63 offen offset:0 lds
  buffer_load_dwordx4 v17, s[12:15], s63 offen offset:1024 lds
  buffer_load_dwordx4 v18, s[12:15], s63 offen offset:2048 lds
  s_cbranch_vccz L_kg_skip28
  buffer_load_dwordx4 v19, s[12:15], s63 offen offset:3072 lds
L_kg_skip28:
  s_waitcnt vmcnt(14)
  s_barrier
  s_add_u32 m0, s69, 0
  s_movk_i32 s62, 1536
  buffer_load_dwordx4 v2, s[8:11], s62 offen offset:0 lds
  buffer_load_dwordx4 v3, s[8:11], s62 offen offset:1024 lds
  buffer_load_dwordx4 v4, s[8:11], s62 offen offset:2048 lds
  buffer_load_dwordx4 v5, s[8:11], s62 offen offset:3072 lds
  s_add_u32 m0, s70, 81920
  s_add_u32 s63, s65, 172032
  buffer_load_dwordx4 v16, s[12:15], s63 offen offset:0 lds
  buffer_load_dwordx4 v17, s[12:15], s63 offen offset:1024 lds
  buffer_load_dwordx4 v18, s[12:15], s63 offen offset:2048 lds
  s_cbranch_vccz L_kg_skip29
  buffer_load_dwordx4 v19, s[12:15], s63 offen offset:3072 lds
L_kg_skip29:
  s_waitcnt vmcnt(14)
  s_barrier
  s_add_u32 m0, s69, 12288
  s_movk_i32 s62, 1664
  buffer_load_dwordx4 v2, s[8:11], s62 offen offset:0 lds
  buffer_load_dwordx4 v3, s[8:11], s62 offen offset:1024 lds
  buffer_load_dwordx4 v4, s[8:11], s62 offen offset:2048 lds
  buffer_load_dwordx4 v5, s[8:11], s62 offen offset:3072 lds
  s_add_u32 m0, s70, 92160
  s_add_u32 s63, s65, 186368
  buffer_load_dwordx4 v16, s[12:15], s63 offen offset:0 lds
  buffer_load_dwordx4 v17, s[12:15], s63 offen offset:1024 lds
  buffer_load_dwordx4 v18, s[12:15], s63 offen offset:2048 lds
  s_cbranch_vccz L_kg_skip30
  buffer_load_dwordx4 v19, s[12:15], s63 offen offset:3072 lds
L_kg_skip30:
  s_waitcnt vmcnt(14)
  s_barrier
  s_add_u32 m0, s69, 24576
  s_movk_i32 s62, 1792
  buffer_load_dwordx4 v2, s[8:11], s62 offen offset:0 lds
  buffer_load_dwordx4 v3, s[8:11], s62 offen offset:1024 lds
  buffer_load_dwordx4 v4, s[8:11], s62 offen offset:2048 lds
  buffer_load_dwordx4 v5, s[8:11], s62 offen offset:3072 lds
  s_add_u32 m0, s70, 102400
  s_add_u32 s63, s65, 200704
  buffer_load_dwordx4 v16, s[12:15], s63 offen offset:0 lds
  buffer_load_dwordx4 v17, s[12:15], s63 offen offset:1024 lds
  buffer_load_dwordx4 v18, s[12:15], s63 offen offset:2048 lds
  s_cbranch_vccz L_kg_skip31
  buffer_load_dwordx4 v19, s[12:15], s63 offen offset:3072 lds
L_kg_skip31:
  s_waitcnt vmcnt(14)
  s_barrier
  s_lshl_b32 s59, s54, 13
  buffer_load_dword v25, v24, s[36:39], s59 offen sc1
  s_add_u32 m0, s69, 36864
  s_movk_i32 s62, 1920
  buffer_load_dwordx4 v2, s[8:11], s62 offen offset:0 lds
  buffer_load_dwordx4 v3, s[8:11], s62 offen offset:1024 lds
  buffer_load_dwordx4 v4, s[8:11], s62 offen offset:2048 lds
  buffer_load_dwordx4 v5, s[8:11], s62 offen offset:3072 lds
  s_add_u32 m0, s70, 112640
  s_add_u32 s63, s65, 215040
  buffer_load_dwordx4 v16, s[12:15], s63 offen offset:0 lds
  buffer_load_dwordx4 v17, s[12:15], s63 offen offset:1024 lds
  buffer_load_dwordx4 v18, s[12:15], s63 offen offset:2048 lds
  s_cbranch_vccz L_kg_skip32
  buffer_load_dwordx4 v19, s[12:15], s63 offen offset:3072 lds
L_kg_skip32:
  s_waitcnt vmcnt(15)
  s_barrier
  s_lshl_b32 s59, s54, 13
  s_movk_i32 s61, 20000
  s_waitcnt vmcnt(7)
  v_cmp_eq_u32 s[90:91], 0, v25
  s_nop 0
  s_cmp_eq_u64 s[90:91], 0
  s_cbranch_scc1 L_kg_pollZ1_fast
L_kg_pollZ1:
  buffer_load_dword v25, v24, s[36:39], s59 offen sc1
  s_waitcnt vmcnt(0)
  v_cmp_eq_u32 s[90:91], 0, v25
  s_nop 0
  s_cmp_eq_u64 s[90:91], 0
  s_cbranch_scc1 L_kg_pollZ1_ok
  s_sub_u32 s61, s61, 1
  s_cmp_lg_u32 s61, 0
  s_cbranch_scc1 L_kg_pollZ1
L_kg_pollZ1_ok:
L_kg_pollZ1_fast:
  s_add_u32 m0, s69, 0
  s_movk_i32 s62, 0
  buffer_load_dwordx4 v8, s[16:19], s62 offen offset:0 lds
  buffer_load_dwordx4 v9, s[16:19], s62 offen offset:1024 lds
  buffer_load_dwordx4 v10, s[16:19], s62 offen offset:2048 lds
  buffer_load_dwordx4 v11, s[16:19], s62 offen offset:3072 lds
  s_add_u32 m0, s70, 81920
  s_add_u32 s63, s66, 0
  buffer_load_dwordx4 v16, s[20:23], s63 offen offset:0 sc1 lds
  buffer_load_dwordx4 v17, s[20:23], s63 offen offset:1024 sc1 lds
  buffer_load_dwordx4 v18, s[20:23], s63 offen offset:2048 sc1 lds
  s_cbranch_vccz L_kg_skip33
  buffer_load_dwordx4 v19, s[20:23], s63 offen offset:3072 sc1 lds
L_kg_skip33:
  s_barrier
  s_add_u32 m0, s69, 12288
  s_movk_i32 s62, 128
  buffer_load_dwordx4 v8, s[16:19], s62 offen offset:0 lds
  buffer_load_dwordx4 v9, s[16:19], s62 offen offset:1024 lds
  buffer_load_dwordx4 v10, s[16:19], s62 offen offset:2048 lds
  buffer_load_dwordx4 v11, s[16:19], s62 offen offset:3072 lds
  s_add_u32 m0, s70, 92160
  s_add_u32 s63, s66, 14336
  buffer_load_dwordx4 v16, s[20:23], s63 offen offset:0 sc1 lds
  buffer_load_dwordx4 v17, s[20:23], s63 offen offset:1024 sc1 lds
  buffer_load_dwordx4 v18, s[20:23], s63 offen offset:2048 sc1 lds
  s_cbranch_vccz L_kg_skip34
  buffer_load_dwordx4 v19, s[20:23], s63 offen offset:3072 sc1 lds
L_kg_skip34:
  s_waitcnt vmcnt(14)
  s_barrier
  s_add_u32 m0, s69, 24576
  s_movk_i32 s62, 256
  buffer_load_dwordx4 v8, s[16:19], s62 offen offset:0 lds
  buffer_load_dwordx4 v9, s[16:19], s62 offen offset:1024 lds
  buffer_load_dwordx4 v10, s[16:19], s62 offen offset:2048 lds
  buffer_load_dwordx4 v11, s[16:19], s62 offen offset:3072 lds
  s_add_u32 m0, s70, 102400
  s_add_u32 s63, s66, 28672
  buffer_load_dwordx4 v16, s[20:23], s63 offen offset:0 sc1 lds
  buffer_load_dwordx4 v17, s[20:23], s63 offen offset:1024 sc1 lds
  buffer_load_dwordx4 v18, s[20:23], s63 offen offset:2048 sc1 lds
  s_cbranch_vccz L_kg_skip35
  buffer_load_dwordx4 v19, s[20:23], s63 offen offset:3072 sc1 lds
L_kg_skip35:
  s_waitcnt vmcnt(14)
  s_barrier
  s_add_u32 m0, s69, 36864
  s_movk_i32 s62, 384
  buffer_load_dwordx4 v8, s[16:19], s62 offen offset:0 lds
  buffer_load_dwordx4 v9, s[16:19], s62 offen offset:1024 lds
  buffer_load_dwordx4 v10, s[16:19], s62 offen offset:2048 lds
  buffer_load_dwordx4 v11, s[16:19], s62 offen offset:3072 lds
  s_add_u32 m0, s70, 112640
  s_add_u32 s63, s66, 43008
  buffer_load_dwordx4 v16, s[20:23], s63 offen offset:0 sc1 lds
  buffer_load_dwordx4 v17, s[20:23], s63 offen offset:1024 sc1 lds
  buffer_load_dwordx4 v18, s[20:23], s63 offen offset:2048 sc1 lds
  s_cbranch_vccz L_kg_skip36
  buffer_load_dwordx4 v19, s[20:23], s63 offen offset:3072 sc1 lds
L_kg_skip36:
  s_waitcnt vmcnt(14)
  s_barrier
  s_add_u32 m0, s69, 0
  s_movk_i32 s62, 512
  buffer_load_dwordx4 v8, s[16:19], s62 offen offset:0 lds
  buffer_load_dwordx4 v9, s[16:19], s62 offen offset:1024 lds
  buffer_load_dwordx4 v10, s[16:19], s62 offen offset:2048 lds
  buffer_load_dwordx4 v11, s[16:19], s62 offen offset:3072 lds
  s_add_u32 m0, s70, 81920
  s_add_u32 s63, s66, 57344
  buffer_load_dwordx4 v16, s[20:23], s63 offen offset:0 sc1 lds
  buffer_load_dwordx4 v17, s[20:23], s63 offen offset:1024 sc1 lds
  buffer_load_dwordx4 v18, s[20:23], s63 offen offset:2048 sc1 lds
  s_cbranch_vccz L_kg_skip37
  buffer_load_dwordx4 v19, s[20:23], s63 offen offset:3072 sc1 lds
L_kg_skip37:
  s_waitcnt vmcnt(14)
  s_barrier
  s_add_u32 m0, s69, 12288
  s_movk_i32 s62, 640
  buffer_load_dwordx4 v8, s[16:19], s62 offen offset:0 lds
  buffer_load_dwordx4 v9, s[16:19], s62 offen offset:1024 lds
  buffer_load_dwordx4 v10, s[16:19], s62 offen offset:2048 lds
  buffer_load_dwordx4 v11, s[16:19], s62 offen offset:3072 lds
  s_add_u32 m0, s70, 92160
  s_add_u32 s63, s66, 71680
  buffer_load_dwordx4 v16, s[20:23], s63 offen offset:0 sc1 lds
  buffer_load_dwordx4 v17, s[20:23], s63 offen offset:1024 sc1 lds
  buffer_load_dwordx4 v18, s[20:23], s63 offen offset:2048 sc1 lds
  s_cbranch_vccz L_kg_skip38
  buffer_load_dwordx4 v19, s[20:23], s63 offen offset:3072 sc1 lds
L_kg_skip38:
  s_waitcnt vmcnt(14)
  s_barrier
  s_add_u32 m0, s69, 24576
  s_movk_i32 s62, 768
  buffer_load_dwordx4 v8, s[16:19], s62 offen offset:0 lds
  buffer_load_dwordx4 v9, s[16:19], s62 offen offset:1024 lds
  buffer_load_dwordx4 v10, s[16:19], s62 offen offset:2048 lds
  buffer_load_dwordx4 v11, s[16:19], s62 offen offset:3072 lds
  s_add_u32 m0, s70, 102400
  s_add_u32 s63, s66, 86016
  buffer_load_dwordx4 v16, s[20:23], s63 offen offset:0 sc1 lds
  buffer_load_dwordx4 v17, s[20:23], s63 offen offset:1024 sc1 lds
  buffer_load_dwordx4 v18, s[20:23], s63 offen offset:2048 sc1 lds
  s_cbranch_vccz L_kg_skip39
  buffer_load_dwordx4 v19, s[20:23], s63 offen offset:3072 sc1 lds
L_kg_skip39:
  s_waitcnt vmcnt(14)
  s_barrier
  s_add_u32 m0, s69, 36864
  s_movk_i32 s62, 896
  buffer_load_dwordx4 v8, s[16:19], s62 offen offset:0 lds
  buffer_load_dwordx4 v9, s[16:19], s62 offen offset:1024 lds
  buffer_load_dwordx4 v10, s[16:19], s62 offen offset:2048 lds
  buffer_load_dwordx4 v11, s[16:19], s62 offen offset:3072 lds
  s_add_u32 m0, s70, 112640
  s_add_u32 s63, s66, 100352
  buffer_load_dwordx4 v16, s[20:23], s63 offen offset:0 sc1 lds
  buffer_load_dwordx4 v17, s[20:23], s63 offen offset:1024 sc1 lds
  buffer_load_dwordx4 v18, s[20:23], s63 offen offset:2048 sc1 lds
  s_cbranch_vccz L_kg_skip40
  buffer_load_dwordx4 v19, s[20:23], s63 offen offset:3072 sc1 lds
L_kg_skip40:
  s_waitcnt vmcnt(14)
  s_barrier
  s_add_u32 m0, s69, 0
  s_movk_i32 s62, 1024
  buffer_load_dwordx4 v8, s[16:19], s62 offen offset:0 lds
  buffer_load_dwordx4 v9, s[16:19], s62 offen offset:1024 lds
  buffer_load_dwordx4 v10, s[16:19], s62 offen offset:2048 lds
  buffer_load_dwordx4 v11, s[16:19], s62 offen offset:3072 lds
  s_add_u32 m0, s70, 81920
  s_add_u32 s63, s66, 114688
  buffer_load_dwordx4 v16, s[20:23], s63 offen offset:0 sc1 lds
  buffer_load_dwordx4 v17, s[20:23], s63 offen offset:1024 sc1 lds
  buffer_load_dwordx4 v18, s[20:23], s63 offen offset:2048 sc1 lds
  s_cbranch_vccz L_kg_skip41
  buffer_load_dwordx4 v19, s[20:23], s63 offen offset:3072 sc1 lds
L_kg_skip41:
  s_waitcnt vmcnt(14)
  s_barrier
  s_add_u32 m0, s69, 12288
  s_movk_i32 s62, 1152
  buffer_load_dwordx4 v8, s[16:19], s62 offen offset:0 lds
  buffer_load_dwordx4 v9, s[16:19], s62 offen offset:1024 lds
  buffer_load_dwordx4 v10, s[16:19], s62 offen offset:2048 lds
  buffer_load_dwordx4 v11, s[16:19], s62 offen offset:3072 lds
  s_add_u32 m0, s70, 92160
  s_add_u32 s63, s66, 129024
  buffer_load_dwordx4 v16, s[20:23], s63 offen offset:0 sc1 lds
  buffer_load_dwordx4 v17, s[20:23], s63 offen offset:1024 sc1 lds
  buffer_load_dwordx4 v18, s[20:23], s63 offen offset:2048 sc1 lds
  s_cbranch_vccz L_kg_skip42
  buffer_load_dwordx4 v19, s[20:23], s63 offen offset:3072 sc1 lds
L_kg_skip42:
  s_waitcnt vmcnt(14)
  s_barrier
  s_add_u32 m0, s69, 24576
  s_movk_i32 s62, 1280
  buffer_load_dwordx4 v8, s[16:19], s62 offen offset:0 lds
  buffer_load_dwordx4 v9, s[16:19], s62 offen offset:1024 lds
  buffer_load_dwordx4 v10, s[16:19], s62 offen offset:2048 lds
  buffer_load_dwordx4 v11, s[16:19], s62 offen offset:3072 lds
  s_add_u32 m0, s70, 102400
  s_add_u32 s63, s66, 143360
  buffer_load_dwordx4 v16, s[20:23], s63 offen offset:0 sc1 lds
  buffer_load_dwordx4 v17, s[20:23], s63 offen offset:1024 sc1 lds
  buffer_load_dwordx4 v18, s[20:23], s63 offen offset:2048 sc1 lds
  s_cbranch_vccz L_kg_skip43
  buffer_load_dwordx4 v19, s[20:23], s63 offen offset:3072 sc1 lds
L_kg_skip43:
  s_waitcnt vmcnt(14)
  s_barrier
  s_add_u32 m0, s69, 36864
  s_movk_i32 s62, 1408
  buffer_load_dwordx4 v8, s[16:19], s62 offen offset:0 lds
  buffer_load_dwordx4 v9, s[16:19], s62 offen offset:1024 lds
  buffer_load_dwordx4 v10, s[16:19], s62 offen offset:2048 lds
  buffer_load_dwordx4 v11, s[16:19], s62 offen offset:3072 lds
  s_add_u32 m0, s70, 112640
  s_add_u32 s63, s66, 157696
  buffer_load_dwordx4 v16, s[20:23], s63 offen offset:0 sc1 lds
  buffer_load_dwordx4 v17, s[20:23], s63 offen offset:1024 sc1 lds
  buffer_load_dwordx4 v18, s[20:23], s63 offen offset:2048 sc1 lds
  s_cbranch_vccz L_kg_skip44
  buffer_load_dwordx4 v19, s[20:23], s63 offen offset:3072 sc1 lds
L_kg_skip44:
  s_waitcnt vmcnt(14)
  s_barrier
  s_add_u32 m0, s69, 0
  s_movk_i32 s62, 1536
  buffer_load_dwordx4 v8, s[16:19], s62 offen offset:0 lds
  buffer_load_dwordx4 v9, s[16:19], s62 offen offset:1024 lds
  buffer_load_dwordx4 v10, s[16:19], s62 offen offset:2048 lds
  buffer_load_dwordx4 v11, s[16:19], s62 offen offset:3072 lds
  s_add_u32 m0, s70, 81920
  s_add_u32 s63, s66, 172032
  buffer_load_dwordx4 v16, s[20:23], s63 offen offset:0 sc1 lds
  buffer_load_dwordx4 v17, s[20:23], s63 offen offset:1024 sc1 lds
  buffer_load_dwordx4 v18, s[20:23], s63 offen offset:2048 sc1 lds
  s_cbranch_vccz L_kg_skip45
  buffer_load_dwordx4 v19, s[20:23], s63 offen offset:3072 sc1 lds
L_kg_skip45:
  s_waitcnt vmcnt(14)
  s_barrier
  s_add_u32 m0, s69, 12288
  s_movk_i32 s62, 1664
  buffer_load_dwordx4 v8, s[16:19], s62 offen offset:0 lds
  buffer_load_dwordx4 v9, s[16:19], s62 offen offset:1024 lds
  buffer_load_dwordx4 v10, s[16:19], s62 offen offset:2048 lds
  buffer_load_dwordx4 v11, s[16:19], s62 offen offset:3072 lds
  s_add_u32 m0, s70, 92160
  s_add_u32 s63, s66, 186368
  buffer_load_dwordx4 v16, s[20:23], s63 offen offset:0 sc1 lds
  buffer_load_dwordx4 v17, s[20:23], s63 offen offset:1024 sc1 lds
  buffer_load_dwordx4 v18, s[20:23], s63 offen offset:2048 sc1 lds
  s_cbranch_vccz L_kg_skip46
  buffer_load_dwordx4 v19, s[20:23], s63 offen offset:3072 sc1 lds
L_kg_skip46:
  s_waitcnt vmcnt(14)
  s_barrier
  s_add_u32 m0, s69, 24576
  s_movk_i32 s62, 1792
  buffer_load_dwordx4 v8, s[16:19], s62 offen offset:0 lds
  buffer_load_dwordx4 v9, s[16:19], s62 offen offset:1024 lds
  buffer_load_dwordx4 v10, s[16:19], s62 offen offset:2048 lds
  buffer_load_dwordx4 v11, s[16:19], s62 offen offset:3072 lds
  s_add_u32 m0, s70, 102400
  s_add_u32 s63, s66, 200704
  buffer_load_dwordx4 v16, s[20:23], s63 offen offset:0 sc1 lds
  buffer_load_dwordx4 v17, s[20:23], s63 offen offset:1024 sc1 lds
  buffer_load_dwordx4 v18, s[20:23], s63 offen offset:2048 sc1 lds
  s_cbranch_vccz L_kg_skip47
  buffer_load_dwordx4 v19, s[20:23], s63 offen offset:3072 sc1 lds
L_kg_skip47:
  s_waitcnt vmcnt(14)
  s_barrier
  s_add_u32 m0, s69, 36864
  s_movk_i32 s62, 1920
  buffer_load_dwordx4 v8, s[16:19], s62 offen offset:0 lds
  buffer_load_dwordx4 v9, s[16:19], s62 offen offset:1024 lds
  buffer_load_dwordx4 v10, s[16:19], s62 offen offset:2048 lds
  buffer_load_dwordx4 v11, s[16:19], s62 offen offset:3072 lds
  s_add_u32 m0, s70, 112640
  s_add_u32 s63, s66, 215040
  buffer_load_dwordx4 v16, s[20:23], s63 offen offset:0 sc1 lds
  buffer_load_dwordx4 v17, s[20:23], s63 offen offset:1024 sc1 lds
  buffer_load_dwordx4 v18, s[20:23], s63 offen offset:2048 sc1 lds
  s_cbranch_vccz L_kg_skip48
  buffer_load_dwordx4 v19, s[20:23], s63 offen offset:3072 sc1 lds
L_kg_skip48:
  s_waitcnt vmcnt(14)
  s_barrier
  s_add_u32 m0, s69, 0
  s_movk_i32 s62, 2048
  buffer_load_dwordx4 v8, s[16:19], s62 offen offset:0 lds
  buffer_load_dwordx4 v9, s[16:19], s62 offen offset:1024 lds
  buffer_load_dwordx4 v10, s[16:19], s62 offen offset:2048 lds
  buffer_load_dwordx4 v11, s[16:19], s62 offen offset:3072 lds
  s_add_u32 m0, s70, 81920
  s_add_u32 s63, s66, 229376
  buffer_load_dwordx4 v16, s[20:23], s63 offen offset:0 sc1 lds
  buffer_load_dwordx4 v17, s[20:23], s63 offen offset:1024 sc1 lds
  buffer_load_dwordx4 v18, s[20:23], s63 offen offset:2048 sc1 lds
  s_cbranch_vccz L_kg_skip49
  buffer_load_dwordx4 v19, s[20:23], s63 offen offset:3072 sc1 lds
L_kg_skip49:
  s_waitcnt vmcnt(14)
  s_barrier
  s_add_u32 m0, s69, 12288
  s_movk_i32 s62, 2176
  buffer_load_dwordx4 v8, s[16:19], s62 offen offset:0 lds
  buffer_load_dwordx4 v9, s[16:19], s62 offen offset:1024 lds
  buffer_load_dwordx4 v10, s[16:19], s62 offen offset:2048 lds
  buffer_load_dwordx4 v11, s[16:19], s62 offen offset:3072 lds
  s_add_u32 m0, s70, 92160
  s_add_u32 s63, s66, 243712
  buffer_load_dwordx4 v16, s[20:23], s63 offen offset:0 sc1 lds
  buffer_load_dwordx4 v17, s[20:23], s63 offen offset:1024 sc1 lds
  buffer_load_dwordx4 v18, s[20:23], s63 offen offset:2048 sc1 lds
  s_cbranch_vccz L_kg_skip50
  buffer_load_dwordx4 v19, s[20:23], s63 offen offset:3072 sc1 lds
L_kg_skip50:
  s_waitcnt vmcnt(14)
  s_barrier
  s_add_u32 m0, s69, 24576
  s_movk_i32 s62, 2304
  buffer_load_dwordx4 v8, s[16:19], s62 offen offset:0 lds
  buffer_load_dwordx4 v9, s[16:19], s62 offen offset:1024 lds
  buffer_load_dwordx4 v10, s[16:19], s62 offen offset:2048 lds
  buffer_load_dwordx4 v11, s[16:19], s62 offen offset:3072 lds
  s_add_u32 m0, s70, 102400
  s_add_u32 s63, s66, 258048
  buffer_load_dwordx4 v16, s[20:23], s63 offen offset:0 sc1 lds
  buffer_load_dwordx4 v17, s[20:23], s63 offen offset:1024 sc1 lds
  buffer_load_dwordx4 v18, s[20:23], s63 offen offset:2048 sc1 lds
  s_cbranch_vccz L_kg_skip51
  buffer_load_dwordx4 v19, s[20:23], s63 offen offset:3072 sc1 lds
L_kg_skip51:
  s_waitcnt vmcnt(14)
  s_barrier
  s_add_u32 m0, s69, 36864
  s_movk_i32 s62, 2432
  buffer_load_dwordx4 v8, s[16:19], s62 offen offset:0 lds
  buffer_load_dwordx4 v9, s[16:19], s62 offen offset:1024 lds
  buffer_load_dwordx4 v10, s[16:19], s62 offen offset:2048 lds
  buffer_load_dwordx4 v11, s[16:19], s62 offen offset:3072 lds
  s_add_u32 m0, s70, 112640
  s_add_u32 s63, s66, 272384
  buffer_load_dwordx4 v16, s[20:23], s63 offen offset:0 sc1 lds
  buffer_load_dwordx4 v17, s[20:23], s63 offen offset:1024 sc1 lds
  buffer_load_dwordx4 v18, s[20:23], s63 offen offset:2048 sc1 lds
  s_cbranch_vccz L_kg_skip52
  buffer_load_dwordx4 v19, s[20:23], s63 offen offset:3072 sc1 lds
L_kg_skip52:
  s_waitcnt vmcnt(14)
  s_barrier
  s_add_u32 m0, s69, 0
  s_movk_i32 s62, 2560
  buffer_load_dwordx4 v8, s[16:19], s62 offen offset:0 lds
  buffer_load_dwordx4 v9, s[16:19], s62 offen offset:1024 lds
  buffer_load_dwordx4 v10, s[16:19], s62 offen offset:2048 lds
  buffer_load_dwordx4 v11, s[16:19], s62 offen offset:3072 lds
  s_add_u32 m0, s70, 81920
  s_add_u32 s63, s66, 286720
  buffer_load_dwordx4 v16, s[20:23], s63 offen offset:0 sc1 lds
  buffer_load_dwordx4 v17, s[20:23], s63 offen offset:1024 sc1 lds
  buffer_load_dwordx4 v18, s[20:23], s63 offen offset:2048 sc1 lds
  s_cbranch_vccz L_kg_skip53
  buffer_load_dwordx4 v19, s[20:23], s63 offen offset:3072 sc1 lds
L_kg_skip53:
  s_waitcnt vmcnt(14)
  s_barrier
  s_add_u32 m0, s69, 12288
  s_movk_i32 s62, 2688
  buffer_load_dwordx4 v8, s[16:19], s62 offen offset:0 lds
  buffer_load_dwordx4 v9, s[16:19], s62 offen offset:1024 lds
  buffer_load_dwordx4 v10, s[16:19], s62 offen offset:2048 lds
  buffer_load_dwordx4 v11, s[16:19], s62 offen offset:3072 lds
  s_add_u32 m0, s70, 92160
  s_add_u32 s63, s66, 301056
  buffer_load_dwordx4 v16, s[20:23], s63 offen offset:0 sc1 lds
  buffer_load_dwordx4 v17, s[20:23], s63 offen offset:1024 sc1 lds
  buffer_load_dwordx4 v18, s[20:23], s63 offen offset:2048 sc1 lds
  s_cbranch_vccz L_kg_skip54
  buffer_load_dwordx4 v19, s[20:23], s63 offen offset:3072 sc1 lds
L_kg_skip54:
  s_waitcnt vmcnt(14)
  s_barrier
  s_add_u32 m0, s69, 24576
  s_movk_i32 s62, 2816
  buffer_load_dwordx4 v8, s[16:19], s62 offen offset:0 lds
  buffer_load_dwordx4 v9, s[16:19], s62 offen offset:1024 lds
  buffer_load_dwordx4 v10, s[16:19], s62 offen offset:2048 lds
  buffer_load_dwordx4 v11, s[16:19], s62 offen offset:3072 lds
  s_add_u32 m0, s70, 102400
  s_add_u32 s63, s66, 315392
  buffer_load_dwordx4 v16, s[20:23], s63 offen offset:0 sc1 lds
  buffer_load_dwordx4 v17, s[20:23], s63 offen offset:1024 sc1 lds
  buffer_load_dwordx4 v18, s[20:23], s63 offen offset:2048 sc1 lds
  s_cbranch_vccz L_kg_skip55
  buffer_load_dwordx4 v19, s[20:23], s63 offen offset:3072 sc1 lds
L_kg_skip55:
  s_waitcnt vmcnt(14)
  s_barrier
  s_add_u32 m0, s69, 36864
  s_movk_i32 s62, 2944
  buffer_load_dwordx4 v8, s[16:19], s62 offen offset:0 lds
  buffer_load_dwordx4 v9, s[16:19], s62 offen offset:1024 lds
  buffer_load_dwordx4 v10, s[16:19], s62 offen offset:2048 lds
  buffer_load_dwordx4 v11, s[16:19], s62 offen offset:3072 lds
  s_add_u32 m0, s70, 112640
  s_add_u32 s63, s66, 329728
  buffer_load_dwordx4 v16, s[20:23], s63 offen offset:0 sc1 lds
  buffer_load_dwordx4 v17, s[20:23], s63 offen offset:1024 sc1 lds
  buffer_load_dwordx4 v18, s[20:23], s63 offen offset:2048 sc1 lds
  s_cbranch_vccz L_kg_skip56
  buffer_load_dwordx4 v19, s[20:23], s63 offen offset:3072 sc1 lds
L_kg_skip56:
  s_waitcnt vmcnt(14)
  s_barrier
  s_add_u32 m0, s69, 0
  s_movk_i32 s62, 3072
  buffer_load_dwordx4 v8, s[16:19], s62 offen offset:0 lds
  buffer_load_dwordx4 v9, s[16:19], s62 offen offset:1024 lds
  buffer_load_dwordx4 v10, s[16:19], s62 offen offset:2048 lds
  buffer_load_dwordx4 v11, s[16:19], s62 offen offset:3072 lds
  s_add_u32 m0, s70, 81920
  s_add_u32 s63, s66, 344064
  buffer_load_dwordx4 v16, s[20:23], s63 offen offset:0 sc1 lds
  buffer_load_dwordx4 v17, s[20:23], s63 offen offset:1024 sc1 lds
  buffer_load_dwordx4 v18, s[20:23], s63 offen offset:2048 sc1 lds
  s_cbranch_vccz L_kg_skip57
  buffer_load_dwordx4 v19, s[20:23], s63 offen offset:3072 sc1 lds
L_kg_skip57:
  s_waitcnt vmcnt(14)
  s_barrier
  s_add_u32 m0, s69, 12288
  s_movk_i32 s62, 3200
  buffer_load_dwordx4 v8, s[16:19], s62 offen offset:0 lds
  buffer_load_dwordx4 v9, s[16:19], s62 offen offset:1024 lds
  buffer_load_dwordx4 v10, s[16:19], s62 offen offset:2048 lds
  buffer_load_dwordx4 v11, s[16:19], s62 offen offset:3072 lds
  s_add_u32 m0, s70, 92160
  s_add_u32 s63, s66, 358400
  buffer_load_dwordx4 v16, s[20:23], s63 offen offset:0 sc1 lds
  buffer_load_dwordx4 v17, s[20:23], s63 offen offset:1024 sc1 lds
  buffer_load_dwordx4 v18, s[20:23], s63 offen offset:2048 sc1 lds
  s_cbranch_vccz L_kg_skip58
  buffer_load_dwordx4 v19, s[20:23], s63 offen offset:3072 sc1 lds
L_kg_skip58:
  s_waitcnt vmcnt(14)
  s_barrier
  s_add_u32 m0, s69, 24576
  s_movk_i32 s62, 3328
  buffer_load_dwordx4 v8, s[16:19], s62 offen offset:0 lds
  buffer_load_dwordx4 v9, s[16:19], s62 offen offset:1024 lds
  buffer_load_dwordx4 v10, s[16:19], s62 offen offset:2048 lds
  buffer_load_dwordx4 v11, s[16:19], s62 offen offset:3072 lds
  s_add_u32 m0, s70, 102400
  s_add_u32 s63, s66, 372736
  buffer_load_dwordx4 v16, s[20:23], s63 offen offset:0 sc1 lds
  buffer_load_dwordx4 v17, s[20:23], s63 offen offset:1024 sc1 lds
  buffer_load_dwordx4 v18, s[20:23], s63 offen offset:2048 sc1 lds
  s_cbranch_vccz L_kg_skip59
  buffer_load_dwordx4 v19, s[20:23], s63 offen offset:3072 sc1 lds
L_kg_skip59:
  s_waitcnt vmcnt(14)
  s_barrier
  s_add_u32 m0, s69, 36864
  s_movk_i32 s62, 3456
  buffer_load_dwordx4 v8, s[16:19], s62 offen offset:0 lds
  buffer_load_dwordx4 v9, s[16:19], s62 offen offset:1024 lds
  buffer_load_dwordx4 v10, s[16:19], s62 offen offset:2048 lds
  buffer_load_dwordx4 v11, s[16:19], s62 offen offset:3072 lds
  s_add_u32 m0, s70, 112640
  s_add_u32 s63, s66, 387072
  buffer_load_dwordx4 v16, s[20:23], s63 offen offset:0 sc1 lds
  buffer_load_dwordx4 v17, s[20:23], s63 offen offset:1024 sc1 lds
  buffer_load_dwordx4 v18, s[20:23], s63 offen offset:2048 sc1 lds
  s_cbranch_vccz L_kg_skip60
  buffer_load_dwordx4 v19, s[20:23], s63 offen offset:3072 sc1 lds
L_kg_skip60:
  s_waitcnt vmcnt(14)
  s_barrier
  s_add_u32 m0, s69, 0
  s_movk_i32 s62, 3584
  buffer_load_dwordx4 v8, s[16:19], s62 offen offset:0 lds
  buffer_load_dwordx4 v9, s[16:19], s62 offen offset:1024 lds
  buffer_load_dwordx4 v10, s[16:19], s62 offen offset:2048 lds
  buffer_load_dwordx4 v11, s[16:19], s62 offen offset:3072 lds
  s_add_u32 m0, s70, 81920
  s_add_u32 s63, s66, 401408
  buffer_load_dwordx4 v16, s[20:23], s63 offen offset:0 sc1 lds
  buffer_load_dwordx4 v17, s[20:23], s63 offen offset:1024 sc1 lds
  buffer_load_dwordx4 v18, s[20:23], s63 offen offset:2048 sc1 lds
  s_cbranch_vccz L_kg_skip61
  buffer_load_dwordx4 v19, s[20:23], s63 offen offset:3072 sc1 lds
L_kg_skip61:
  s_waitcnt vmcnt(14)
  s_barrier
  s_add_u32 m0, s69, 12288
  s_movk_i32 s62, 3712
  buffer_load_dwordx4 v8, s[16:19], s62 offen offset:0 lds
  buffer_load_dwordx4 v9, s[16:19], s62 offen offset:1024 lds
  buffer_load_dwordx4 v10, s[16:19], s62 offen offset:2048 lds
  buffer_load_dwordx4 v11, s[16:19], s62 offen offset:3072 lds
  s_add_u32 m0, s70, 92160
  s_add_u32 s63, s66, 415744
  buffer_load_dwordx4 v16, s[20:23], s63 offen offset:0 sc1 lds
  buffer_load_dwordx4 v17, s[20:23], s63 offen offset:1024 sc1 lds
  buffer_load_dwordx4 v18, s[20:23], s63 offen offset:2048 sc1 lds
  s_cbranch_vccz L_kg_skip62
  buffer_load_dwordx4 v19, s[20:23], s63 offen offset:3072 sc1 lds
L_kg_skip62:
  s_waitcnt vmcnt(14)
  s_barrier
  s_add_u32 m0, s69, 24576
  s_movk_i32 s62, 3840
  buffer_load_dwordx4 v8, s[16:19], s62 offen offset:0 lds
  buffer_load_dwordx4 v9, s[16:19], s62 offen offset:1024 lds
  buffer_load_dwordx4 v10, s[16:19], s62 offen offset:2048 lds
  buffer_load_dwordx4 v11, s[16:19], s62 offen offset:3072 lds
  s_add_u32 m0, s70, 102400
  s_add_u32 s63, s66, 430080
  buffer_load_dwordx4 v16, s[20:23], s63 offen offset:0 sc1 lds
  buffer_load_dwordx4 v17, s[20:23], s63 offen offset:1024 sc1 lds
  buffer_load_dwordx4 v18, s[20:23], s63 offen offset:2048 sc1 lds
  s_cbranch_vccz L_kg_skip63
  buffer_load_dwordx4 v19, s[20:23], s63 offen offset:3072 sc1 lds
L_kg_skip63:
  s_waitcnt vmcnt(14)
  s_barrier
  s_add_u32 m0, s69, 36864
  s_movk_i32 s62, 3968
  buffer_load_dwordx4 v8, s[16:19], s62 offen offset:0 lds
  buffer_load_dwordx4 v9, s[16:19], s62 offen offset:1024 lds
  buffer_load_dwordx4 v10, s[16:19], s62 offen offset:2048 lds
  buffer_load_dwordx4 v11, s[16:19], s62 offen offset:3072 lds
  s_add_u32 m0, s70, 112640
  s_add_u32 s63, s66, 444416
  buffer_load_dwordx4 v16, s[20:23], s63 offen offset:0 sc1 lds
  buffer_load_dwordx4 v17, s[20:23], s63 offen offset:1024 sc1 lds
  buffer_load_dwordx4 v18, s[20:23], s63 offen offset:2048 sc1 lds
  s_cbranch_vccz L_kg_skip64
  buffer_load_dwordx4 v19, s[20:23], s63 offen offset:3072 sc1 lds
L_kg_skip64:
  s_waitcnt vmcnt(14)
  s_barrier
  s_add_u32 m0, s71, 81920
  s_add_u32 s63, s41, 0
  s_add_u32 s60, s42, 0
  s_cmp_eq_u32 s52, 2
  s_cselect_b32 s63, s60, s63
  s_add_u32 s60, s43, 0
  s_cmp_eq_u32 s52, 3
  s_cselect_b32 s63, s60, s63
  buffer_load_dwordx4 v20, s[28:31], s63 offen offset:0 lds
  buffer_load_dwordx4 v21, s[28:31], s63 offen offset:1024 lds
  s_waitcnt vmcnt(9)
  s_barrier
  s_add_u32 m0, s71, 92160
  s_add_u32 s63, s45, 0
  s_add_u32 s60, s40, 229376
  s_cmp_eq_u32 s52, 2
  s_cselect_b32 s63, s60, s63
  s_add_u32 s60, s41, 229376
  s_cmp_eq_u32 s52, 3
  s_cselect_b32 s63, s60, s63
  buffer_load_dwordx4 v20, s[28:31], s63 offen offset:0 lds
  buffer_load_dwordx4 v21, s[28:31], s63 offen offset:1024 lds
  s_waitcnt vmcnt(4)
  s_barrier
  s_add_u32 m0, s71, 102400
  s_add_u32 s63, s43, 229376
  s_add_u32 s60, s44, 229376
  s_cmp_eq_u32 s52, 2
  s_cselect_b32 s63, s60, s63
  s_add_u32 s60, s45, 229376
  s_cmp_eq_u32 s52, 3
  s_cselect_b32 s63, s60, s63
  buffer_load_dwordx4 v20, s[28:31], s63 offen offset:0 lds
  buffer_load_dwordx4 v21, s[28:31], s63 offen offset:1024 lds
  s_waitcnt vmcnt(4)
  s_barrier
  s_add_u32 m0, s71, 112640
  s_add_u32 s63, s46, 229376
  s_add_u32 s60, s40, 458752
  s_cmp_eq_u32 s52, 2
  s_cselect_b32 s63, s60, s63
  s_add_u32 s60, s41, 458752
  s_cmp_eq_u32 s52, 3
  s_cselect_b32 s63, s60, s63
  buffer_load_dwordx4 v20, s[28:31], s63 offen offset:0 lds
  buffer_load_dwordx4 v21, s[28:31], s63 offen offset:1024 lds
  s_barrier
  s_barrier
  s_add_u32 m0, s69, 0
  s_add_u32 s62, s67, 0
  buffer_load_dwordx4 v12, s[24:27], s62 offen offset:0 sc1 lds
  buffer_load_dwordx4 v12, s[24:27], s62 offen offset:1024 sc1 lds
  buffer_load_dwordx4 v13, s[24:27], s62 offen offset:2048 sc1 lds
  buffer_load_dwordx4 v13, s[24:27], s62 offen offset:3072 sc1 lds
  s_add_u32 m0, s69, 12288
  s_add_u32 s62, s67, 2048
  buffer_load_dwordx4 v12, s[24:27], s62 offen offset:0 sc1 lds
  buffer_load_dwordx4 v12, s[24:27], s62 offen offset:1024 sc1 lds
  buffer_load_dwordx4 v13, s[24:27], s62 offen offset:2048 sc1 lds
  buffer_load_dwordx4 v13, s[24:27], s62 offen offset:3072 sc1 lds
  s_add_u32 m0, s69, 24576
  s_add_u32 s62, s67, 4096
  buffer_load_dwordx4 v12, s[24:27], s62 offen offset:0 sc1 lds
  buffer_load_dwordx4 v12, s[24:27], s62 offen offset:1024 sc1 lds
  buffer_load_dwordx4 v13, s[24:27], s62 offen offset:2048 sc1 lds
  buffer_load_dwordx4 v13, s[24:27], s62 offen offset:3072 sc1 lds
  s_add_u32 m0, s69, 36864
  s_add_u32 s62, s67, 6144
  buffer_load_dwordx4 v12, s[24:27], s62 offen offset:0 sc1 lds
  buffer_load_dwordx4 v12, s[24:27], s62 offen offset:1024 sc1 lds
  buffer_load_dwordx4 v13, s[24:27], s62 offen offset:2048 sc1 lds
  buffer_load_dwordx4 v13, s[24:27], s62 offen offset:3072 sc1 lds
  s_waitcnt vmcnt(12)
  s_barrier
  s_waitcnt vmcnt(8)
  s_barrier
  s_add_u32 m0, s69, 0
  s_add_u32 s62, s67, 8192
  buffer_load_dwordx4 v12, s[24:27], s62 offen offset:0 sc1 lds
  buffer_load_dwordx4 v12, s[24:27], s62 offen offset:1024 sc1 lds
  buffer_load_dwordx4 v13, s[24:27], s62 offen offset:2048 sc1 lds
  buffer_load_dwordx4 v13, s[24:27], s62 offen offset:3072 sc1 lds
  s_add_u32 m0, s71, 81920
  s_add_u32 s63, s43, 458752
  s_add_u32 s60, s44, 458752
  s_cmp_eq_u32 s52, 2
  s_cselect_b32 s63, s60, s63
  s_add_u32 s60, s45, 458752
  s_cmp_eq_u32 s52, 3
  s_cselect_b32 s63, s60, s63
  buffer_load_dwordx4 v20, s[28:31], s63 offen offset:0 lds
  buffer_load_dwordx4 v21, s[28:31], s63 offen offset:1024 lds
  s_waitcnt vmcnt(10)
  s_barrier
  s_add_u32 m0, s69, 12288
  s_add_u32 s62, s67, 10240
  buffer_load_dwordx4 v12, s[24:27], s62 offen offset:0 sc1 lds
  buffer_load_dwordx4 v12, s[24:27], s62 offen offset:1024 sc1 lds
  buffer_load_dwordx4 v13, s[24:27], s62 offen offset:2048 sc1 lds
  buffer_load_dwordx4 v13, s[24:27], s62 offen offset:3072 sc1 lds
  s_add_u32 m0, s71, 92160
  s_add_u32 s63, s41, 688128
  s_add_u32 s60, s42, 688128
  s_cmp_eq_u32 s52, 2
  s_cselect_b32 s63, s60, s63
  s_add_u32 s60, s43, 688128
  s_cmp_eq_u32 s52, 3
  s_cselect_b32 s63, s60, s63
  buffer_load_dwordx4 v20, s[28:31], s63 offen offset:0 lds
  buffer_load_dwordx4 v21, s[28:31], s63 offen offset:1024 lds
  s_waitcnt vmcnt(12)
  s_barrier
  s_add_u32 m0, s69, 24576
  s_add_u32 s62, s67, 12288
  buffer_load_dwordx4 v12, s[24:27], s62 offen offset:0 sc1 lds
  buffer_load_dwordx4 v12, s[24:27], s62 offen offset:1024 sc1 lds
  buffer_load_dwordx4 v13, s[24:27], s62 offen offset:2048 sc1 lds
  buffer_load_dwordx4 v13, s[24:27], s62 offen offset:3072 sc1 lds
  s_add_u32 m0, s71, 102400
  s_add_u32 s63, s45, 688128
  s_add_u32 s60, s46, 458752
  s_cmp_eq_u32 s52, 2
  s_cselect_b32 s63, s60, s63
  s_add_u32 s60, s46, 688128
  s_cmp_eq_u32 s52, 3
  s_cselect_b32 s63, s60, s63
  buffer_load_dwordx4 v20, s[28:31], s63 offen offset:0 lds
  buffer_load_dwordx4 v21, s[28:31], s63 offen offset:1024 lds
  s_waitcnt vmcnt(12)
  s_barrier
  s_add_u32 m0, s69, 36864
  s_add_u32 s62, s67, 14336
  buffer_load_dwordx4 v12, s[24:27], s62 offen offset:0 sc1 lds
  buffer_load_dwordx4 v12, s[24:27], s62 offen offset:1024 sc1 lds
  buffer_load_dwordx4 v13, s[24:27], s62 offen offset:2048 sc1 lds
  buffer_load_dwordx4 v13, s[24:27], s62 offen offset:3072 sc1 lds
  s_add_u32 m0, s71, 112640
  s_add_u32 s63, s41, 917504
  s_add_u32 s60, s42, 917504
  s_cmp_eq_u32 s52, 2
  s_cselect_b32 s63, s60, s63
  s_add_u32 s60, s43, 917504
  s_cmp_eq_u32 s52, 3
  s_cselect_b32 s63, s60, s63
  buffer_load_dwordx4 v20, s[28:31], s63 offen offset:0 lds
  buffer_load_dwordx4 v21, s[28:31], s63 offen offset:1024 lds
  s_waitcnt vmcnt(12)
  s_barrier
  s_add_u32 m0, s69, 0
  s_add_u32 s62, s67, 16384
  buffer_load_dwordx4 v12, s[24:27], s62 offen offset:0 sc1 lds
  buffer_load_dwordx4 v12, s[24:27], s62 offen offset:1024 sc1 lds
  buffer_load_dwordx4 v13, s[24:27], s62 offen offset:2048 sc1 lds
  buffer_load_dwordx4 v13, s[24:27], s62 offen offset:3072 sc1 lds
  s_add_u32 m0, s71, 81920
  s_add_u32 s63, s45, 917504
  s_add_u32 s60, s40, 1146880
  s_cmp_eq_u32 s52, 2
  s_cselect_b32 s63, s60, s63
  s_add_u32 s60, s41, 1146880
  s_cmp_eq_u32 s52, 3
  s_cselect_b32 s63, s60, s63
  buffer_load_dwordx4 v20, s[28:31], s63 offen offset:0 lds
  buffer_load_dwordx4 v21, s[28:31], s63 offen offset:1024 lds
  s_waitcnt vmcnt(12)
  s_barrier
  s_add_u32 m0, s69, 12288
  s_add_u32 s62, s67, 18432
  buffer_load_dwordx4 v12, s[24:27], s62 offen offset:0 sc1 lds
  buffer_load_dwordx4 v12, s[24:27], s62 offen offset:1024 sc1 lds
  buffer_load_dwordx4 v13, s[24:27], s62 offen offset:2048 sc1 lds
  buffer_load_dwordx4 v13, s[24:27], s62 offen offset:3072 sc1 lds
  s_add_u32 m0, s71, 92160
  s_add_u32 s63, s43, 1146880
  s_add_u32 s60, s44, 1146880
  s_cmp_eq_u32 s52, 2
  s_cselect_b32 s63, s60, s63
  s_add_u32 s60, s45, 1146880
  s_cmp_eq_u32 s52, 3
  s_cselect_b32 s63, s60, s63
  buffer_load_dwordx4 v20, s[28:31], s63 offen offset:0 lds
  buffer_load_dwordx4 v21, s[28:31], s63 offen offset:1024 lds
  s_waitcnt vmcnt(12)
  s_barrier
  s_add_u32 m0, s69, 24576
  s_add_u32 s62, s67, 20480
  buffer_load_dwordx4 v12, s[24:27], s62 offen offset:0 sc1 lds
  buffer_load_dwordx4 v12, s[24:27], s62 offen offset:1024 sc1 lds
  buffer_load_dwordx4 v13, s[24:27], s62 offen offset:2048 sc1 lds
  buffer_load_dwordx4 v13, s[24:27], s62 offen offset:3072 sc1 lds
  s_add_u32 m0, s71, 102400
  s_add_u32 s63, s46, 1146880
  s_add_u32 s60, s40, 1376256
  s_cmp_eq_u32 s52, 2
  s_cselect_b32 s63, s60, s63
  s_add_u32 s60, s41, 1376256
  s_cmp_eq_u32 s52, 3
  s_cselect_b32 s63, s60, s63
  buffer_load_dwordx4 v20, s[28:31], s63 offen offset:0 lds
  buffer_load_dwordx4 v21, s[28:31], s63 offen offset:1024 lds
  s_waitcnt vmcnt(12)
  s_barrier
  s_add_u32 m0, s69, 36864
  s_add_u32 s62, s67, 22528
  buffer_load_dwordx4 v12, s[24:27], s62 offen offset:0 sc1 lds
  buffer_load_dwordx4 v12, s[24:27], s62 offen offset:1024 sc1 lds
  buffer_load_dwordx4 v13, s[24:27], s62 offen offset:2048 sc1 lds
  buffer_load_dwordx4 v13, s[24:27], s62 offen offset:3072 sc1 lds
  s_add_u32 m0, s71, 112640
  s_add_u32 s63, s43, 1376256
  s_add_u32 s60, s44, 1376256
  s_cmp_eq_u32 s52, 2
  s_cselect_b32 s63, s60, s63
  s_add_u32 s60, s45, 1376256
  s_cmp_eq_u32 s52, 3
  s_cselect_b32 s63, s60, s63
  buffer_load_dwordx4 v20, s[28:31], s63 offen offset:0 lds
  buffer_load_dwordx4 v21, s[28:31], s63 offen offset:1024 lds
  s_waitcnt vmcnt(12)
  s_barrier
  s_add_u32 m0, s69, 0
  s_add_u32 s62, s67, 24576
  buffer_load_dwordx4 v12, s[24:27], s62 offen offset:0 sc1 lds
  buffer_load_dwordx4 v12, s[24:27], s62 offen offset:1024 sc1 lds
  buffer_load_dwordx4 v13, s[24:27], s62 offen offset:2048 sc1 lds
  buffer_load_dwordx4 v13, s[24:27], s62 offen offset:3072 sc1 lds
  s_add_u32 m0, s71, 81920
  s_add_u32 s63, s41, 1605632
  s_add_u32 s60, s42, 1605632
  s_cmp_eq_u32 s52, 2
  s_cselect_b32 s63, s60, s63
  s_add_u32 s60, s43, 1605632
  s_cmp_eq_u32 s52, 3
  s_cselect_b32 s63, s60, s63
  buffer_load_dwordx4 v20, s[28:31], s63 offen offset:0 lds
  buffer_load_dwordx4 v21, s[28:31], s63 offen offset:1024 lds
  s_waitcnt vmcnt(12)
  s_barrier
  s_add_u32 m0, s69, 12288
  s_add_u32 s62, s67, 26624
  buffer_load_dwordx4 v12, s[24:27], s62 offen offset:0 sc1 lds
  buffer_load_dwordx4 v12, s[24:27], s62 offen offset:1024 sc1 lds
  buffer_load_dwordx4 v13, s[24:27], s62 offen offset:2048 sc1 lds
  buffer_load_dwordx4 v13, s[24:27], s62 offen offset:3072 sc1 lds
  s_add_u32 m0, s71, 92160
  s_add_u32 s63, s45, 1605632
  s_add_u32 s60, s46, 1376256
  s_cmp_eq_u32 s52, 2
  s_cselect_b32 s63, s60, s63
  s_add_u32 s60, s46, 1605632
  s_cmp_eq_u32 s52, 3
  s_cselect_b32 s63, s60, s63
  buffer_load_dwordx4 v20, s[28:31], s63 offen offset:0 lds
  buffer_load_dwordx4 v21, s[28:31], s63 offen offset:1024 lds
  s_waitcnt vmcnt(12)
  s_barrier
  s_add_u32 m0, s69, 24576
  s_add_u32 s62, s67, 28672
  buffer_load_dwordx4 v12, s[24:27], s62 offen offset:0 sc1 lds
  buffer_load_dwordx4 v12, s[24:27], s62 offen offset:1024 sc1 lds
  buffer_load_dwordx4 v13, s[24:27], s62 offen offset:2048 sc1 lds
  buffer_load_dwordx4 v13, s[24:27], s62 offen offset:3072 sc1 lds
  s_add_u32 m0, s71, 102400
  s_add_u32 s63, s41, 1835008
  s_add_u32 s60, s42, 1835008
  s_cmp_eq_u32 s52, 2
  s_cselect_b32 s63, s60, s63
  s_add_u32 s60, s43, 1835008
  s_cmp_eq_u32 s52, 3
  s_cselect_b32 s63, s60, s63
  buffer_load_dwordx4 v20, s[28:31], s63 offen offset:0 lds
  buffer_load_dwordx4 v21, s[28:31], s63 offen offset:1024 lds
  s_waitcnt vmcnt(12)
  s_barrier
  s_add_u32 m0, s69, 36864
  s_add_u32 s62, s67, 30720
  buffer_load_dwordx4 v12, s[24:27], s62 offen offset:0 sc1 lds
  buffer_load_dwordx4 v12, s[24:27], s62 offen offset:1024 sc1 lds
  buffer_load_dwordx4 v13, s[24:27], s62 offen offset:2048 sc1 lds
  buffer_load_dwordx4 v13, s[24:27], s62 offen offset:3072 sc1 lds
  s_add_u32 m0, s71, 112640
  s_add_u32 s63, s45, 1835008
  s_add_u32 s60, s40, 2064384
  s_cmp_eq_u32 s52, 2
  s_cselect_b32 s63, s60, s63
  s_add_u32 s60, s41, 2064384
  s_cmp_eq_u32 s52, 3
  s_cselect_b32 s63, s60, s63
  buffer_load_dwordx4 v20, s[28:31], s63 offen offset:0 lds
  buffer_load_dwordx4 v21, s[28:31], s63 offen offset:1024 lds
  s_waitcnt vmcnt(12)
  s_barrier
  s_add_u32 m0, s69, 0
  s_add_u32 s62, s67, 32768
  buffer_load_dwordx4 v12, s[24:27], s62 offen offset:0 sc1 lds
  buffer_load_dwordx4 v12, s[24:27], s62 offen offset:1024 sc1 lds
  buffer_load_dwordx4 v13, s[24:27], s62 offen offset:2048 sc1 lds
  buffer_load_dwordx4 v13, s[24:27], s62 offen offset:3072 sc1 lds
  s_add_u32 m0, s71, 81920
  s_add_u32 s63, s43, 2064384
  s_add_u32 s60, s44, 2064384
  s_cmp_eq_u32 s52, 2
  s_cselect_b32 s63, s60, s63
  s_add_u32 s60, s45, 2064384
  s_cmp_eq_u32 s52, 3
  s_cselect_b32 s63, s60, s63
  buffer_load_dwordx4 v20, s[28:31], s63 offen offset:0 lds
  buffer_load_dwordx4 v21, s[28:31], s63 offen offset:1024 lds
  s_waitcnt vmcnt(12)
  s_barrier
  s_add_u32 m0, s69, 12288
  s_add_u32 s62, s67, 34816
  buffer_load_dwordx4 v12, s[24:27], s62 offen offset:0 sc1 lds
  buffer_load_dwordx4 v12, s[24:27], s62 offen offset:1024 sc1 lds
  buffer_load_dwordx4 v13, s[24:27], s62 offen offset:2048 sc1 lds
  buffer_load_dwordx4 v13, s[24:27], s62 offen offset:3072 sc1 lds
  s_add_u32 m0, s71, 92160
  s_add_u32 s63, s46, 2064384
  s_add_u32 s60, s40, 2293760
  s_cmp_eq_u32 s52, 2
  s_cselect_b32 s63, s60, s63
  s_add_u32 s60, s41, 2293760
  s_cmp_eq_u32 s52, 3
  s_cselect_b32 s63, s60, s63
  buffer_load_dwordx4 v20, s[28:31], s63 offen offset:0 lds
  buffer_load_dwordx4 v21, s[28:31], s63 offen offset:1024 lds
  s_waitcnt vmcnt(12)
  s_barrier
  s_add_u32 m0, s69, 24576
  s_add_u32 s62, s67, 36864
  buffer_load_dwordx4 v12, s[24:27], s62 offen offset:0 sc1 lds
  buffer_load_dwordx4 v12, s[24:27], s62 offen offset:1024 sc1 lds
  buffer_load_dwordx4 v13, s[24:27], s62 offen offset:2048 sc1 lds
  buffer_load_dwordx4 v13, s[24:27], s62 offen offset:3072 sc1 lds
  s_add_u32 m0, s71, 102400
  s_add_u32 s63, s43, 2293760
  s_add_u32 s60, s44, 2293760
  s_cmp_eq_u32 s52, 2
  s_cselect_b32 s63, s60, s63
  s_add_u32 s60, s45, 2293760
  s_cmp_eq_u32 s52, 3
  s_cselect_b32 s63, s60, s63
  buffer_load_dwordx4 v20, s[28:31], s63 offen offset:0 lds
  buffer_load_dwordx4 v21, s[28:31], s63 offen offset:1024 lds
  s_waitcnt vmcnt(12)
  s_barrier
  s_add_u32 m0, s69, 36864
  s_add_u32 s62, s67, 38912
  buffer_load_dwordx4 v12, s[24:27], s62 offen offset:0 sc1 lds
  buffer_load_dwordx4 v12, s[24:27], s62 offen offset:1024 sc1 lds
  buffer_load_dwordx4 v13, s[24:27], s62 offen offset:2048 sc1 lds
  buffer_load_dwordx4 v13, s[24:27], s62 offen offset:3072 sc1 lds
  s_add_u32 m0, s71, 112640
  s_add_u32 s63, s41, 2523136
  s_add_u32 s60, s42, 2523136
  s_cmp_eq_u32 s52, 2
  s_cselect_b32 s63, s60, s63
  s_add_u32 s60, s43, 2523136
  s_cmp_eq_u32 s52, 3
  s_cselect_b32 s63, s60, s63
  buffer_load_dwordx4 v20, s[28:31], s63 offen offset:0 lds
  buffer_load_dwordx4 v21, s[28:31], s63 offen offset:1024 lds
  s_waitcnt vmcnt(12)
  s_barrier
  s_add_u32 m0, s69, 0
  s_add_u32 s62, s67, 40960
  buffer_load_dwordx4 v12, s[24:27], s62 offen offset:0 sc1 lds
  buffer_load_dwordx4 v12, s[24:27], s62 offen offset:1024 sc1 lds
  buffer_load_dwordx4 v13, s[24:27], s62 offen offset:2048 sc1 lds
  buffer_load_dwordx4 v13, s[24:27], s62 offen offset:3072 sc1 lds
  s_add_u32 m0, s71, 81920
  s_add_u32 s63, s45, 2523136
  s_add_u32 s60, s46, 2293760
  s_cmp_eq_u32 s52, 2
  s_cselect_b32 s63, s60, s63
  s_add_u32 s60, s46, 2523136
  s_cmp_eq_u32 s52, 3
  s_cselect_b32 s63, s60, s63
  buffer_load_dwordx4 v20, s[28:31], s63 offen offset:0 lds
  buffer_load_dwordx4 v21, s[28:31], s63 offen offset:1024 lds
  s_waitcnt vmcnt(12)
  s_barrier
  s_add_u32 m0, s69, 12288
  s_add_u32 s62, s67, 43008
  buffer_load_dwordx4 v12, s[24:27], s62 offen offset:0 sc1 lds
  buffer_load_dwordx4 v12, s[24:27], s62 offen offset:1024 sc1 lds
  buffer_load_dwordx4 v13, s[24:27], s62 offen offset:2048 sc1 lds
  buffer_load_dwordx4 v13, s[24:27], s62 offen offset:3072 sc1 lds
  s_add_u32 m0, s71, 92160
  s_add_u32 s63, s41, 2752512
  s_add_u32 s60, s42, 2752512
  s_cmp_eq_u32 s52, 2
  s_cselect_b32 s63, s60, s63
  s_add_u32 s60, s43, 2752512
  s_cmp_eq_u32 s52, 3
  s_cselect_b32 s63, s60, s63
  buffer_load_dwordx4 v20, s[28:31], s63 offen offset:0 lds
  buffer_load_dwordx4 v21, s[28:31], s63 offen offset:1024 lds
  s_waitcnt vmcnt(12)
  s_barrier
  s_add_u32 m0, s69, 24576
  s_add_u32 s62, s67, 45056
  buffer_load_dwordx4 v12, s[24:27], s62 offen offset:0 sc1 lds
  buffer_load_dwordx4 v12, s[24:27], s62 offen offset:1024 sc1 lds
  buffer_load_dwordx4 v13, s[24:27], s62 offen offset:2048 sc1 lds
  buffer_load_dwordx4 v13, s[24:27], s62 offen offset:3072 sc1 lds
  s_add_u32 m0, s71, 102400
  s_add_u32 s63, s45, 2752512
  s_add_u32 s60, s40, 2981888
  s_cmp_eq_u32 s52, 2
  s_cselect_b32 s63, s60, s63
  s_add_u32 s60, s41, 2981888
  s_cmp_eq_u32 s52, 3
  s_cselect_b32 s63, s60, s63
  buffer_load_dwordx4 v20, s[28:31], s63 offen offset:0 lds
  buffer_load_dwordx4 v21, s[28:31], s63 offen offset:1024 lds
  s_waitcnt vmcnt(12)
  s_barrier
  s_add_u32 m0, s69, 36864
  s_add_u32 s62, s67, 47104
  buffer_load_dwordx4 v12, s[24:27], s62 offen offset:0 sc1 lds
  buffer_load_dwordx4 v12, s[24:27], s62 offen offset:1024 sc1 lds
  buffer_load_dwordx4 v13, s[24:27], s62 offen offset:2048 sc1 lds
  buffer_load_dwordx4 v13, s[24:27], s62 offen offset:3072 sc1 lds
  s_add_u32 m0, s71, 112640
  s_add_u32 s63, s43, 2981888
  s_add_u32 s60, s44, 2981888
  s_cmp_eq_u32 s52, 2
  s_cselect_b32 s63, s60, s63
  s_add_u32 s60, s45, 2981888
  s_cmp_eq_u32 s52, 3
  s_cselect_b32 s63, s60, s63
  buffer_load_dwordx4 v20, s[28:31], s63 offen offset:0 lds
  buffer_load_dwordx4 v21, s[28:31], s63 offen offset:1024 lds
  s_waitcnt vmcnt(12)
  s_barrier
  s_add_u32 m0, s69, 0
  s_add_u32 s62, s67, 49152
  buffer_load_dwordx4 v12, s[24:27], s62 offen offset:0 sc1 lds
  buffer_load_dwordx4 v12, s[24:27], s62 offen offset:1024 sc1 lds
  buffer_load_dwordx4 v13, s[24:27], s62 offen offset:2048 sc1 lds
  buffer_load_dwordx4 v13, s[24:27], s62 offen offset:3072 sc1 lds
  s_add_u32 m0, s71, 81920
  s_add_u32 s63, s46, 2981888
  s_add_u32 s60, s40, 3211264
  s_cmp_eq_u32 s52, 2
  s_cselect_b32 s63, s60, s63
  s_add_u32 s60, s41, 3211264
  s_cmp_eq_u32 s52, 3
  s_cselect_b32 s63, s60, s63
  buffer_load_dwordx4 v20, s[28:31], s63 offen offset:0 lds
  buffer_load_dwordx4 v21, s[28:31], s63 offen offset:1024 lds
  s_waitcnt vmcnt(12)
  s_barrier
  s_add_u32 m0, s69, 12288
  s_add_u32 s62, s67, 51200
  buffer_load_dwordx4 v12, s[24:27], s62 offen offset:0 sc1 lds
  buffer_load_dwordx4 v12, s[24:27], s62 offen offset:1024 sc1 lds
  buffer_load_dwordx4 v13, s[24:27], s62 offen offset:2048 sc1 lds
  buffer_load_dwordx4 v13, s[24:27], s62 offen offset:3072 sc1 lds
  s_add_u32 m0, s71, 92160
  s_add_u32 s63, s43, 3211264
  s_add_u32 s60, s44, 3211264
  s_cmp_eq_u32 s52, 2
  s_cselect_b32 s63, s60, s63
  s_add_u32 s60, s45, 3211264
  s_cmp_eq_u32 s52, 3
  s_cselect_b32 s63, s60, s63
  buffer_load_dwordx4 v20, s[28:31], s63 offen offset:0 lds
  buffer_load_dwordx4 v21, s[28:31], s63 offen offset:1024 lds
  s_waitcnt vmcnt(12)
  s_barrier
  s_add_u32 m0, s69, 24576
  s_add_u32 s62, s67, 53248
  buffer_load_dwordx4 v12, s[24:27], s62 offen offset:0 sc1 lds
  buffer_load_dwordx4 v12, s[24:27], s62 offen offset:1024 sc1 lds
  buffer_load_dwordx4 v13, s[24:27], s62 offen offset:2048 sc1 lds
  buffer_load_dwordx4 v13, s[24:27], s62 offen offset:3072 sc1 lds
  s_add_u32 m0, s71, 102400
  s_add_u32 s63, s41, 3440640
  s_add_u32 s60, s42, 3440640
  s_cmp_eq_u32 s52, 2
  s_cselect_b32 s63, s60, s63
  s_add_u32 s60, s43, 3440640
  s_cmp_eq_u32 s52, 3
  s_cselect_b32 s63, s60, s63
  buffer_load_dwordx4 v20, s[28:31], s63 offen offset:0 lds
  buffer_load_dwordx4 v21, s[28:31], s63 offen offset:1024 lds
  s_waitcnt vmcnt(12)
  s_barrier
  s_add_u32 m0, s69, 36864
  s_add_u32 s62, s67, 55296
  buffer_load_dwordx4 v12, s[24:27], s62 offen offset:0 sc1 lds
  buffer_load_dwordx4 v12, s[24:27], s62 offen offset:1024 sc1 lds
  buffer_load_dwordx4 v13, s[24:27], s62 offen offset:2048 sc1 lds
  buffer_load_dwordx4 v13, s[24:27], s62 offen offset:3072 sc1 lds
  s_add_u32 m0, s71, 112640
  s_add_u32 s63, s45, 3440640
  s_add_u32 s60, s46, 3211264
  s_cmp_eq_u32 s52, 2
  s_cselect_b32 s63, s60, s63
  s_add_u32 s60, s46, 3440640
  s_cmp_eq_u32 s52, 3
  s_cselect_b32 s63, s60, s63
  buffer_load_dwordx4 v20, s[28:31], s63 offen offset:0 lds
  buffer_load_dwordx4 v21, s[28:31], s63 offen offset:1024 lds
  s_waitcnt vmcnt(12)
  s_barrier
  s_waitcnt vmcnt(6)
  s_barrier
  s_waitcnt vmcnt(0)
  s_barrier
  s_endpgm
L_kg_compute:
  v_and_b32 v1, 15, v14
  v_lshrrev_b32 v7, 2, v1
  v_lshlrev_b32 v7, 3, v7
  v_and_b32 v15, 3, v1
  v_add_u32 v7, v7, v15
  s_lshl_b32 s58, s55, 5
  s_lshl_b32 s59, s53, 7
  s_add_u32 s58, s58, s59
  v_add_u32 v2, s58, v7
  v_lshlrev_b32 v7, 7, v7
  v_lshrrev_b32 v1, 1, v1
  v_lshrrev_b32 v15, 4, v14
  v_xor_b32 v1, v1, v15
  v_lshlrev_b32 v1, 4, v1
  v_add_u32 v7, v7, v1
  s_sub_u32 s58, s52, 1
  s_lshl_b32 s58, s58, 12
  s_add_u32 s58, s58, 0
  s_cmp_eq_u32 s52, 0
  s_cselect_b32 s58, 49152, s58
  v_add_u32 v232, s58, v7
  v_xor_b32 v233, 64, v232
  s_sub_u32 s58, s52, 1
  s_lshl_b32 s58, s58, 12
  s_add_u32 s58, s58, 12288
  s_cmp_eq_u32 s52, 0
  s_cselect_b32 s58, 53248, s58
  v_add_u32 v234, s58, v7
  v_xor_b32 v235, 64, v234
  s_sub_u32 s58, s52, 1
  s_lshl_b32 s58, s58, 12
  s_add_u32 s58, s58, 24576
  s_cmp_eq_u32 s52, 0
  s_cselect_b32 s58, 57344, s58
  v_add_u32 v236, s58, v7
  v_xor_b32 v237, 64, v236
  s_sub_u32 s58, s52, 1
  s_lshl_b32 s58, s58, 12
  s_add_u32 s58, s58, 36864
  s_cmp_eq_u32 s52, 0
  s_cselect_b32 s58, 61440, s58
  v_add_u32 v238, s58, v7
  v_xor_b32 v239, 64, v238
  s_sub_u32 s58, s52, 1
  s_lshl_b32 s58, s58, 12
  s_add_u32 s58, s58, 0
  s_cmp_eq_u32 s52, 0
  s_cselect_b32 s58, 65536, s58
  v_add_u32 v240, s58, v7
  v_xor_b32 v241, 64, v240
  s_sub_u32 s58, s52, 1
  s_lshl_b32 s58, s58, 12
  s_add_u32 s58, s58, 12288
  s_cmp_eq_u32 s52, 0
  s_cselect_b32 s58, 69632, s58
  v_add_u32 v242, s58, v7
  v_xor_b32 v243, 64, v242
  s_sub_u32 s58, s52, 1
  s_lshl_b32 s58, s58, 12
  s_add_u32 s58, s58, 24576
  s_cmp_eq_u32 s52, 0
  s_cselect_b32 s58, 73728, s58
  v_add_u32 v244, s58, v7
  v_xor_b32 v245, 64, v244
  s_sub_u32 s58, s52, 1
  s_lshl_b32 s58, s58, 12
  s_add_u32 s58, s58, 36864
  s_cmp_eq_u32 s52, 0
  s_cselect_b32 s58, 77824, s58
  v_add_u32 v246, s58, v7
  v_xor_b32 v247, 64, v246
  v_lshlrev_b32 v12, 4, v14
  v_add_u32 v13, 122880, v12
  v_add_u32 v12, 81920, v12
  v_mov_b32 v88, 0
  v_mov_b32 v89, 0
  v_mov_b32 v90, 0
  v_mov_b32 v91, 0
  v_mov_b32 v92, 0
  v_mov_b32 v93, 0
  v_mov_b32 v94, 0
  v_mov_b32 v95, 0
  v_mov_b32 v96, 0
  v_mov_b32 v97, 0
  v_mov_b32 v98, 0
  v_mov_b32 v99, 0
  v_mov_b32 v100, 0
  v_mov_b32 v101, 0
  v_mov_b32 v102, 0
  v_mov_b32 v103, 0
  v_mov_b32 v104, 0
  v_mov_b32 v105, 0
  v_mov_b32 v106, 0
  v_mov_b32 v107, 0
  v_mov_b32 v108, 0
  v_mov_b32 v109, 0
  v_mov_b32 v110, 0
  v_mov_b32 v111, 0
  v_mov_b32 v112, 0
  v_mov_b32 v113, 0
  v_mov_b32 v114, 0
  v_mov_b32 v115, 0
  v_mov_b32 v116, 0
  v_mov_b32 v117, 0
  v_mov_b32 v118, 0
  v_mov_b32 v119, 0
  v_mov_b32 v120, 0
  v_mov_b32 v121, 0
  v_mov_b32 v122, 0
  v_mov_b32 v123, 0
  v_mov_b32 v124, 0
  v_mov_b32 v125, 0
  v_mov_b32 v126, 0
  v_mov_b32 v127, 0
  v_mov_b32 v128, 0
  v_mov_b32 v129, 0
  v_mov_b32 v130, 0
  v_mov_b32 v131, 0
  v_mov_b32 v132, 0
  v_mov_b32 v133, 0
  v_mov_b32 v134, 0
  v_mov_b32 v135, 0
  v_mov_b32 v136, 0
  v_mov_b32 v137, 0
  v_mov_b32 v138, 0
  v_mov_b32 v139, 0
  v_mov_b32 v140, 0
  v_mov_b32 v141, 0
  v_mov_b32 v142, 0
  v_mov_b32 v143, 0
  v_mov_b32 v144, 0
  v_mov_b32 v145, 0
  v_mov_b32 v146, 0
  v_mov_b32 v147, 0
  v_mov_b32 v148, 0
  v_mov_b32 v149, 0
  v_mov_b32 v150, 0
  v_mov_b32 v151, 0
  v_mov_b32 v152, 0
  v_mov_b32 v153, 0
  v_mov_b32 v154, 0
  v_mov_b32 v155, 0
  v_mov_b32 v156, 0
  v_mov_b32 v157, 0
  v_mov_b32 v158, 0
  v_mov_b32 v159, 0
  v_mov_b32 v160, 0
  v_mov_b32 v161, 0
  v_mov_b32 v162, 0
  v_mov_b32 v163, 0
  v_mov_b32 v164, 0
  v_mov_b32 v165, 0
  v_mov_b32 v166, 0
  v_mov_b32 v167, 0
  v_mov_b32 v168, 0
  v_mov_b32 v169, 0
  v_mov_b32 v170, 0
  v_mov_b32 v171, 0
  v_mov_b32 v172, 0
  v_mov_b32 v173, 0
  v_mov_b32 v174, 0
  v_mov_b32 v175, 0
  v_mov_b32 v176, 0
  v_mov_b32 v177, 0
  v_mov_b32 v178, 0
  v_mov_b32 v179, 0
  v_mov_b32 v180, 0
  v_mov_b32 v181, 0
  v_mov_b32 v182, 0
  v_mov_b32 v183, 0
  v_mov_b32 v184, 0
  v_mov_b32 v185, 0
  v_mov_b32 v186, 0
  v_mov_b32 v187, 0
  v_mov_b32 v188, 0
  v_mov_b32 v189, 0
  v_mov_b32 v190, 0
  v_mov_b32 v191, 0
  v_mov_b32 v192, 0
  v_mov_b32 v193, 0
  v_mov_b32 v194, 0
  v_mov_b32 v195, 0
  v_mov_b32 v196, 0
  v_mov_b32 v197, 0
  v_mov_b32 v198, 0
  v_mov_b32 v199, 0
  s_add_u32 s58, s56, 0
  s_sub_u32 s59, s58, 7
  s_cmp_ge_u32 s58, 7
  s_cselect_b32 s58, s59, s58
  s_lshl_b32 s8, s58, 10
  s_add_u32 s58, s56, 1
  s_sub_u32 s59, s58, 7
  s_cmp_ge_u32 s58, 7
  s_cselect_b32 s58, s59, s58
  s_lshl_b32 s9, s58, 10
  s_add_u32 s58, s56, 2
  s_sub_u32 s59, s58, 7
  s_cmp_ge_u32 s58, 7
  s_cselect_b32 s58, s59, s58
  s_lshl_b32 s10, s58, 10
  s_add_u32 s58, s56, 3
  s_sub_u32 s59, s58, 7
  s_cmp_ge_u32 s58, 7
  s_cselect_b32 s58, s59, s58
  s_lshl_b32 s11, s58, 10
  s_add_u32 s58, s56, 4
  s_sub_u32 s59, s58, 7
  s_cmp_ge_u32 s58, 7
  s_cselect_b32 s58, s59, s58
  s_lshl_b32 s12, s58, 10
  s_add_u32 s58, s56, 5
  s_sub_u32 s59, s58, 7
  s_cmp_ge_u32 s58, 7
  s_cselect_b32 s58, s59, s58
  s_lshl_b32 s13, s58, 10
  s_add_u32 s58, s56, 6
  s_sub_u32 s59, s58, 7
  s_cmp_ge_u32 s58, 7
  s_cselect_b32 s58, s59, s58
  s_lshl_b32 s14, s58, 10
  s_waitcnt lgkmcnt(0)
  s_add_u32 s32, s4, 46137344
  s_addc_u32 s33, s5, 0
  s_and_b32 s33, s33, 0xffff
  s_mov_b32 s34, 262144
  s_mov_b32 s35, 0x20000
  s_add_u32 s36, s4, 46661632
  s_addc_u32 s37, s5, 0
  s_and_b32 s37, s37, 0xffff
  s_mov_b32 s38, 262144
  s_mov_b32 s39, 0x20000
  s_add_u32 s20, s4, 29360128
  s_addc_u32 s21, s5, 0
  s_and_b32 s21, s21, 0xffff
  s_mov_b32 s22, 7340032
  s_mov_b32 s23, 0x20000
  s_add_u32 s24, s4, 37748736
  s_addc_u32 s25, s5, 0
  s_and_b32 s25, s25, 0xffff
  s_mov_b32 s26, 7340032
  s_mov_b32 s27, 0x20000
  s_mov_b32 s40, s94
  s_and_b32 s41, s95, 0xffff
  s_mov_b32 s42, 4096
  s_mov_b32 s43, 0x20000
  s_add_u32 s44, s4, 12582912
  s_addc_u32 s45, s5, 0
  s_and_b32 s45, s45, 0xffff
  s_mov_b32 s46, 16384
  s_mov_b32 s47, 0x20000
  s_mov_b32 s48, s98
  s_and_b32 s49, s99, 0xffff
  s_mov_b32 s50, 4194304
  s_mov_b32 s51, 0x20000
  s_add_u32 s28, s4, 16777216
  s_addc_u32 s29, s5, 0
  s_and_b32 s29, s29, 0xffff
  s_mov_b32 s30, 4194304
  s_mov_b32 s31, 0x20000
  s_lshl_b32 s58, s53, 2
  s_add_u32 s58, s58, s55
  s_mul_i32 s58, s58, 114688
  s_lshr_b32 s59, s54, 1
  s_mul_i32 s59, s59, 7168
  s_add_u32 s58, s58, s59
  s_and_b32 s59, s54, 1
  s_lshl_b32 s60, s59, 3
  s_mul_i32 s59, s59, 3072
  s_add_u32 s62, s58, s59
  s_and_b32 s60, s54, 1
  s_mul_i32 s60, s60, 57344
  s_add_u32 s15, s58, s60
  s_add_u32 s15, s15, 6144
  s_add_u32 s63, s62, 57344
  v_lshlrev_b32 v6, 4, v14
  v_lshlrev_b32 v1, 1, v2
  buffer_load_ushort v4, v1, s[40:43], 0 offen
  buffer_load_ushort v5, v1, s[40:43], 0 offen offset:8
  v_lshlrev_b32 v2, 11, v2
  v_lshrrev_b32 v1, 4, v14
  v_lshlrev_b32 v1, 3, v1
  v_add_u32 v2, v2, v1
  s_lshl_b32 s58, s54, 7
  v_add_u32 v2, s58, v2
  v_mov_b32 v248, 0xc0135761
  v_mov_b32 v249, 0xc0135761
  v_mov_b32 v250, 1.0
  v_mov_b32 v251, 1.0
  s_mov_b32 s64, 0xbdd2d3e8
  s_lshl_b32 s59, s55, 8
  s_lshl_b32 s58, s53, 4
  s_add_u32 s58, s58, s54
  s_lshl_b32 s58, s58, 10
  s_add_u32 s66, s58, s59
  s_lshl_b32 s58, s53, 14
  s_add_u32 s67, s58, s59
  s_lshl_b32 s58, s54, 6
  s_lshl_b32 s59, s53, 2
  s_add_u32 s58, s58, s59
  s_add_u32 s58, s58, s55
  s_mul_i32 s68, s58, 7168
  s_lshl_b32 s58, s54, 13
  s_lshl_b32 s59, s53, 9
  s_add_u32 s58, s58, s59
  s_lshl_b32 s59, s52, 7
  s_add_u32 s69, s58, s59
  v_lshrrev_b32 v7, 4, v14
  v_lshlrev_b32 v7, 6, v7
  v_and_b32 v15, 15, v14
  v_cmp_gt_u32 s[70:71], 4, v15
  v_lshlrev_b32 v15, 10, v15
  v_add_u32 v15, v15, v7
  v_lshlrev_b32 v1, 4, v14
  s_barrier
  ds_read_b128 v[16:19], v232 offset:0
  ds_read_b128 v[32:35], v13 offset:0
  ds_read_b128 v[20:23], v232 offset:512
  ds_read_b128 v[36:39], v13 offset:1024
  ds_read_b128 v[40:43], v12 offset:0
  ds_read_b128 v[44:47], v12 offset:1024
  ds_read_b128 v[48:51], v12 offset:2048
  ds_read_b128 v[52:55], v12 offset:3072
  ds_read_b128 v[56:59], v12 offset:4096
  s_mov_b32 s65, 2
L_kg_A:
  s_waitcnt lgkmcnt(0)
  v_mfma_f32_16x16x32_bf16 v[88:91], v[16:19], v[32:35], v[88:91]
  ds_read_b128 v[24:27], v233 offset:0
  v_mfma_f32_16x16x32_bf16 v[116:119], v[20:23], v[32:35], v[116:119]
  ds_read_b128 v[60:63], v13 offset:2048
  v_mfma_f32_16x16x32_bf16 v[92:95], v[16:19], v[36:39], v[92:95]
  ds_read_b128 v[28:31], v233 offset:512
  v_mfma_f32_16x16x32_bf16 v[120:123], v[20:23], v[36:39], v[120:123]
  ds_read_b128 v[64:67], v13 offset:3072
  v_mfma_f32_16x16x32_bf16 v[96:99], v[16:19], v[40:43], v[96:99]
  ds_read_b128 v[68:71], v12 offset:5120
  v_mfma_f32_16x16x32_bf16 v[124:127], v[20:23], v[40:43], v[124:127]
  ds_read_b128 v[72:75], v12 offset:6144
  v_mfma_f32_16x16x32_bf16 v[100:103], v[16:19], v[44:47], v[100:103]
  ds_read_b128 v[76:79], v12 offset:7168
  v_mfma_f32_16x16x32_bf16 v[128:131], v[20:23], v[44:47], v[128:131]
  ds_read_b128 v[80:83], v12 offset:8192
  v_mfma_f32_16x16x32_bf16 v[104:107], v[16:19], v[48:51], v[104:107]
  ds_read_b128 v[84:87], v12 offset:9216
  v_mfma_f32_16x16x32_bf16 v[132:135], v[20:23], v[48:51], v[132:135]
  v_mfma_f32_16x16x32_bf16 v[108:111], v[16:19], v[52:55], v[108:111]
  v_mfma_f32_16x16x32_bf16 v[136:139], v[20:23], v[52:55], v[136:139]
  v_mfma_f32_16x16x32_bf16 v[112:115], v[16:19], v[56:59], v[112:115]
  v_mfma_f32_16x16x32_bf16 v[140:143], v[20:23], v[56:59], v[140:143]
  s_waitcnt lgkmcnt(0)
  s_barrier
  v_mfma_f32_16x16x32_bf16 v[88:91], v[24:27], v[60:63], v[88:91]
  ds_read_b128 v[16:19], v234 offset:0
  v_mfma_f32_16x16x32_bf16 v[116:119], v[28:31], v[60:63], v[116:119]
  ds_read_b128 v[32:35], v13 offset:4096
  v_mfma_f32_16x16x32_bf16 v[92:95], v[24:27], v[64:67], v[92:95]
  ds_read_b128 v[20:23], v234 offset:512
  v_mfma_f32_16x16x32_bf16 v[120:123], v[28:31], v[64:67], v[120:123]
  ds_read_b128 v[36:39], v13 offset:5120
  v_mfma_f32_16x16x32_bf16 v[96:99], v[24:27], v[68:71], v[96:99]
  ds_read_b128 v[40:43], v12 offset:10240
  v_mfma_f32_16x16x32_bf16 v[124:127], v[28:31], v[68:71], v[124:127]
  ds_read_b128 v[44:47], v12 offset:11264
  v_mfma_f32_16x16x32_bf16 v[100:103], v[24:27], v[72:75], v[100:103]
  ds_read_b128 v[48:51], v12 offset:12288
  v_mfma_f32_16x16x32_bf16 v[128:131], v[28:31], v[72:75], v[128:131]
  ds_read_b128 v[52:55], v12 offset:13312
  v_mfma_f32_16x16x32_bf16 v[104:107], v[24:27], v[76:79], v[104:107]
  ds_read_b128 v[56:59], v12 offset:14336
  v_mfma_f32_16x16x32_bf16 v[132:135], v[28:31], v[76:79], v[132:135]
  v_mfma_f32_16x16x32_bf16 v[108:111], v[24:27], v[80:83], v[108:111]
  v_mfma_f32_16x16x32_bf16 v[136:139], v[28:31], v[80:83], v[136:139]
  v_mfma_f32_16x16x32_bf16 v[112:115], v[24:27], v[84:87], v[112:115]
  v_mfma_f32_16x16x32_bf16 v[140:143], v[28:31], v[84:87], v[140:143]
  s_waitcnt lgkmcnt(0)
  v_mfma_f32_16x16x32_bf16 v[88:91], v[16:19], v[32:35], v[88:91]
  ds_read_b128 v[24:27], v235 offset:0
  v_mfma_f32_16x16x32_bf16 v[116:119], v[20:23], v[32:35], v[116:119]
  ds_read_b128 v[60:63], v13 offset:6144
  v_mfma_f32_16x16x32_bf16 v[92:95], v[16:19], v[36:39], v[92:95]
  ds_read_b128 v[28:31], v235 offset:512
  v_mfma_f32_16x16x32_bf16 v[120:123], v[20:23], v[36:39], v[120:123]
  ds_read_b128 v[64:67], v13 offset:7168
  v_mfma_f32_16x16x32_bf16 v[96:99], v[16:19], v[40:43], v[96:99]
  ds_read_b128 v[68:71], v12 offset:15360
  v_mfma_f32_16x16x32_bf16 v[124:127], v[20:23], v[40:43], v[124:127]
  ds_read_b128 v[72:75], v12 offset:16384
  v_mfma_f32_16x16x32_bf16 v[100:103], v[16:19], v[44:47], v[100:103]
  ds_read_b128 v[76:79], v12 offset:17408
  v_mfma_f32_16x16x32_bf16 v[128:131], v[20:23], v[44:47], v[128:131]
  ds_read_b128 v[80:83], v12 offset:18432
  v_mfma_f32_16x16x32_bf16 v[104:107], v[16:19], v[48:51], v[104:107]
  ds_read_b128 v[84:87], v12 offset:19456
  v_mfma_f32_16x16x32_bf16 v[132:135], v[20:23], v[48:51], v[132:135]
  v_mfma_f32_16x16x32_bf16 v[108:111], v[16:19], v[52:55], v[108:111]
  v_mfma_f32_16x16x32_bf16 v[136:139], v[20:23], v[52:55], v[136:139]
  v_mfma_f32_16x16x32_bf16 v[112:115], v[16:19], v[56:59], v[112:115]
  v_mfma_f32_16x16x32_bf16 v[140:143], v[20:23], v[56:59], v[140:143]
  s_waitcnt lgkmcnt(0)
  s_barrier
  v_mfma_f32_16x16x32_bf16 v[88:91], v[24:27], v[60:63], v[88:91]
  ds_read_b128 v[16:19], v236 offset:0
  v_mfma_f32_16x16x32_bf16 v[116:119], v[28:31], v[60:63], v[116:119]
  ds_read_b128 v[32:35], v13 offset:8192
  v_mfma_f32_16x16x32_bf16 v[92:95], v[24:27], v[64:67], v[92:95]
  ds_read_b128 v[20:23], v236 offset:512
  v_mfma_f32_16x16x32_bf16 v[120:123], v[28:31], v[64:67], v[120:123]
  ds_read_b128 v[36:39], v13 offset:9216
  v_mfma_f32_16x16x32_bf16 v[96:99], v[24:27], v[68:71], v[96:99]
  ds_read_b128 v[40:43], v12 offset:20480
  v_mfma_f32_16x16x32_bf16 v[124:127], v[28:31], v[68:71], v[124:127]
  ds_read_b128 v[44:47], v12 offset:21504
  v_mfma_f32_16x16x32_bf16 v[100:103], v[24:27], v[72:75], v[100:103]
  ds_read_b128 v[48:51], v12 offset:22528
  v_mfma_f32_16x16x32_bf16 v[128:131], v[28:31], v[72:75], v[128:131]
  ds_read_b128 v[52:55], v12 offset:23552
  v_mfma_f32_16x16x32_bf16 v[104:107], v[24:27], v[76:79], v[104:107]
  ds_read_b128 v[56:59], v12 offset:24576
  v_mfma_f32_16x16x32_bf16 v[132:135], v[28:31], v[76:79], v[132:135]
  v_mfma_f32_16x16x32_bf16 v[108:111], v[24:27], v[80:83], v[108:111]
  v_mfma_f32_16x16x32_bf16 v[136:139], v[28:31], v[80:83], v[136:139]
  v_mfma_f32_16x16x32_bf16 v[112:115], v[24:27], v[84:87], v[112:115]
  v_mfma_f32_16x16x32_bf16 v[140:143], v[28:31], v[84:87], v[140:143]
  s_waitcnt lgkmcnt(0)
  v_mfma_f32_16x16x32_bf16 v[88:91], v[16:19], v[32:35], v[88:91]
  ds_read_b128 v[24:27], v237 offset:0
  v_mfma_f32_16x16x32_bf16 v[116:119], v[20:23], v[32:35], v[116:119]
  ds_read_b128 v[60:63], v13 offset:10240
  v_mfma_f32_16x16x32_bf16 v[92:95], v[16:19], v[36:39], v[92:95]
  ds_read_b128 v[28:31], v237 offset:512
  v_mfma_f32_16x16x32_bf16 v[120:123], v[20:23], v[36:39], v[120:123]
  ds_read_b128 v[64:67], v13 offset:11264
  v_mfma_f32_16x16x32_bf16 v[96:99], v[16:19], v[40:43], v[96:99]
  ds_read_b128 v[68:71], v12 offset:25600
  v_mfma_f32_16x16x32_bf16 v[124:127], v[20:23], v[40:43], v[124:127]
  ds_read_b128 v[72:75], v12 offset:26624
  v_mfma_f32_16x16x32_bf16 v[100:103], v[16:19], v[44:47], v[100:103]
  ds_read_b128 v[76:79], v12 offset:27648
  v_mfma_f32_16x16x32_bf16 v[128:131], v[20:23], v[44:47], v[128:131]
  ds_read_b128 v[80:83], v12 offset:28672
  v_mfma_f32_16x16x32_bf16 v[104:107], v[16:19], v[48:51], v[104:107]
  ds_read_b128 v[84:87], v12 offset:29696
  v_mfma_f32_16x16x32_bf16 v[132:135], v[20:23], v[48:51], v[132:135]
  v_mfma_f32_16x16x32_bf16 v[108:111], v[16:19], v[52:55], v[108:111]
  v_mfma_f32_16x16x32_bf16 v[136:139], v[20:23], v[52:55], v[136:139]
  v_mfma_f32_16x16x32_bf16 v[112:115], v[16:19], v[56:59], v[112:115]
  v_mfma_f32_16x16x32_bf16 v[140:143], v[20:23], v[56:59], v[140:143]
  s_waitcnt lgkmcnt(0)
  s_barrier
  v_mfma_f32_16x16x32_bf16 v[88:91], v[24:27], v[60:63], v[88:91]
  ds_read_b128 v[16:19], v238 offset:0
  v_mfma_f32_16x16x32_bf16 v[116:119], v[28:31], v[60:63], v[116:119]
  ds_read_b128 v[32:35], v13 offset:12288
  v_mfma_f32_16x16x32_bf16 v[92:95], v[24:27], v[64:67], v[92:95]
  ds_read_b128 v[20:23], v238 offset:512
  v_mfma_f32_16x16x32_bf16 v[120:123], v[28:31], v[64:67], v[120:123]
  ds_read_b128 v[36:39], v13 offset:13312
  v_mfma_f32_16x16x32_bf16 v[96:99], v[24:27], v[68:71], v[96:99]
  ds_read_b128 v[40:43], v12 offset:30720
  v_mfma_f32_16x16x32_bf16 v[124:127], v[28:31], v[68:71], v[124:127]
  ds_read_b128 v[44:47], v12 offset:31744
  v_mfma_f32_16x16x32_bf16 v[100:103], v[24:27], v[72:75], v[100:103]
  ds_read_b128 v[48:51], v12 offset:32768
  v_mfma_f32_16x16x32_bf16 v[128:131], v[28:31], v[72:75], v[128:131]
  ds_read_b128 v[52:55], v12 offset:33792
  v_mfma_f32_16x16x32_bf16 v[104:107], v[24:27], v[76:79], v[104:107]
  ds_read_b128 v[56:59], v12 offset:34816
  v_mfma_f32_16x16x32_bf16 v[132:135], v[28:31], v[76:79], v[132:135]
  v_mfma_f32_16x16x32_bf16 v[108:111], v[24:27], v[80:83], v[108:111]
  v_mfma_f32_16x16x32_bf16 v[136:139], v[28:31], v[80:83], v[136:139]
  v_mfma_f32_16x16x32_bf16 v[112:115], v[24:27], v[84:87], v[112:115]
  v_mfma_f32_16x16x32_bf16 v[140:143], v[28:31], v[84:87], v[140:143]
  s_waitcnt lgkmcnt(0)
  v_mfma_f32_16x16x32_bf16 v[88:91], v[16:19], v[32:35], v[88:91]
  ds_read_b128 v[24:27], v239 offset:0
  v_mfma_f32_16x16x32_bf16 v[116:119], v[20:23], v[32:35], v[116:119]
  ds_read_b128 v[60:63], v13 offset:14336
  v_mfma_f32_16x16x32_bf16 v[92:95], v[16:19], v[36:39], v[92:95]
  ds_read_b128 v[28:31], v239 offset:512
  v_mfma_f32_16x16x32_bf16 v[120:123], v[20:23], v[36:39], v[120:123]
  ds_read_b128 v[64:67], v13 offset:15360
  v_mfma_f32_16x16x32_bf16 v[96:99], v[16:19], v[40:43], v[96:99]
  ds_read_b128 v[68:71], v12 offset:35840
  v_mfma_f32_16x16x32_bf16 v[124:127], v[20:23], v[40:43], v[124:127]
  ds_read_b128 v[72:75], v12 offset:36864
  v_mfma_f32_16x16x32_bf16 v[100:103], v[16:19], v[44:47], v[100:103]
  ds_read_b128 v[76:79], v12 offset:37888
  v_mfma_f32_16x16x32_bf16 v[128:131], v[20:23], v[44:47], v[128:131]
  ds_read_b128 v[80:83], v12 offset:38912
  v_mfma_f32_16x16x32_bf16 v[104:107], v[16:19], v[48:51], v[104:107]
  ds_read_b128 v[84:87], v12 offset:39936
  v_mfma_f32_16x16x32_bf16 v[132:135], v[20:23], v[48:51], v[132:135]
  v_mfma_f32_16x16x32_bf16 v[108:111], v[16:19], v[52:55], v[108:111]
  v_mfma_f32_16x16x32_bf16 v[136:139], v[20:23], v[52:55], v[136:139]
  v_mfma_f32_16x16x32_bf16 v[112:115], v[16:19], v[56:59], v[112:115]
  v_mfma_f32_16x16x32_bf16 v[140:143], v[20:23], v[56:59], v[140:143]
  s_waitcnt lgkmcnt(0)
  s_barrier
  v_mfma_f32_16x16x32_bf16 v[88:91], v[24:27], v[60:63], v[88:91]
  ds_read_b128 v[16:19], v240 offset:0
  v_mfma_f32_16x16x32_bf16 v[116:119], v[28:31], v[60:63], v[116:119]
  ds_read_b128 v[32:35], v13 offset:16384
  v_mfma_f32_16x16x32_bf16 v[92:95], v[24:27], v[64:67], v[92:95]
  ds_read_b128 v[20:23], v240 offset:512
  v_mfma_f32_16x16x32_bf16 v[120:123], v[28:31], v[64:67], v[120:123]
  ds_read_b128 v[36:39], v13 offset:17408
  v_mfma_f32_16x16x32_bf16 v[96:99], v[24:27], v[68:71], v[96:99]
  ds_read_b128 v[40:43], v12 offset:0
  v_mfma_f32_16x16x32_bf16 v[124:127], v[28:31], v[68:71], v[124:127]
  ds_read_b128 v[44:47], v12 offset:1024
  v_mfma_f32_16x16x32_bf16 v[100:103], v[24:27], v[72:75], v[100:103]
  ds_read_b128 v[48:51], v12 offset:2048
  v_mfma_f32_16x16x32_bf16 v[128:131], v[28:31], v[72:75], v[128:131]
  ds_read_b128 v[52:55], v12 offset:3072
  v_mfma_f32_16x16x32_bf16 v[104:107], v[24:27], v[76:79], v[104:107]
  ds_read_b128 v[56:59], v12 offset:4096
  v_mfma_f32_16x16x32_bf16 v[132:135], v[28:31], v[76:79], v[132:135]
  v_mfma_f32_16x16x32_bf16 v[108:111], v[24:27], v[80:83], v[108:111]
  v_mfma_f32_16x16x32_bf16 v[136:139], v[28:31], v[80:83], v[136:139]
  v_mfma_f32_16x16x32_bf16 v[112:115], v[24:27], v[84:87], v[112:115]
  v_mfma_f32_16x16x32_bf16 v[140:143], v[28:31], v[84:87], v[140:143]
  s_waitcnt lgkmcnt(0)
  v_mfma_f32_16x16x32_bf16 v[88:91], v[16:19], v[32:35], v[88:91]
  ds_read_b128 v[24:27], v241 offset:0
  v_mfma_f32_16x16x32_bf16 v[116:119], v[20:23], v[32:35], v[116:119]
  ds_read_b128 v[60:63], v13 offset:18432
  v_mfma_f32_16x16x32_bf16 v[92:95], v[16:19], v[36:39], v[92:95]
  ds_read_b128 v[28:31], v241 offset:512
  v_mfma_f32_16x16x32_bf16 v[120:123], v[20:23], v[36:39], v[120:123]
  ds_read_b128 v[64:67], v13 offset:19456
  v_mfma_f32_16x16x32_bf16 v[96:99], v[16:19], v[40:43], v[96:99]
  ds_read_b128 v[68:71], v12 offset:5120
  v_mfma_f32_16x16x32_bf16 v[124:127], v[20:23], v[40:43], v[124:127]
  ds_read_b128 v[72:75], v12 offset:6144
  v_mfma_f32_16x16x32_bf16 v[100:103], v[16:19], v[44:47], v[100:103]
  ds_read_b128 v[76:79], v12 offset:7168
  v_mfma_f32_16x16x32_bf16 v[128:131], v[20:23], v[44:47], v[128:131]
  ds_read_b128 v[80:83], v12 offset:8192
  v_mfma_f32_16x16x32_bf16 v[104:107], v[16:19], v[48:51], v[104:107]
  ds_read_b128 v[84:87], v12 offset:9216
  v_mfma_f32_16x16x32_bf16 v[132:135], v[20:23], v[48:51], v[132:135]
  v_mfma_f32_16x16x32_bf16 v[108:111], v[16:19], v[52:55], v[108:111]
  v_mfma_f32_16x16x32_bf16 v[136:139], v[20:23], v[52:55], v[136:139]
  v_mfma_f32_16x16x32_bf16 v[112:115], v[16:19], v[56:59], v[112:115]
  v_mfma_f32_16x16x32_bf16 v[140:143], v[20:23], v[56:59], v[140:143]
  s_waitcnt lgkmcnt(0)
  s_barrier
  v_mfma_f32_16x16x32_bf16 v[88:91], v[24:27], v[60:63], v[88:91]
  ds_read_b128 v[16:19], v242 offset:0
  v_mfma_f32_16x16x32_bf16 v[116:119], v[28:31], v[60:63], v[116:119]
  ds_read_b128 v[32:35], v13 offset:20480
  v_mfma_f32_16x16x32_bf16 v[92:95], v[24:27], v[64:67], v[92:95]
  ds_read_b128 v[20:23], v242 offset:512
  v_mfma_f32_16x16x32_bf16 v[120:123], v[28:31], v[64:67], v[120:123]
  ds_read_b128 v[36:39], v13 offset:21504
  v_mfma_f32_16x16x32_bf16 v[96:99], v[24:27], v[68:71], v[96:99]
  ds_read_b128 v[40:43], v12 offset:10240
  v_mfma_f32_16x16x32_bf16 v[124:127], v[28:31], v[68:71], v[124:127]
  ds_read_b128 v[44:47], v12 offset:11264
  v_mfma_f32_16x16x32_bf16 v[100:103], v[24:27], v[72:75], v[100:103]
  ds_read_b128 v[48:51], v12 offset:12288
  v_mfma_f32_16x16x32_bf16 v[128:131], v[28:31], v[72:75], v[128:131]
  ds_read_b128 v[52:55], v12 offset:13312
  v_mfma_f32_16x16x32_bf16 v[104:107], v[24:27], v[76:79], v[104:107]
  ds_read_b128 v[56:59], v12 offset:14336
  v_mfma_f32_16x16x32_bf16 v[132:135], v[28:31], v[76:79], v[132:135]
  v_mfma_f32_16x16x32_bf16 v[108:111], v[24:27], v[80:83], v[108:111]
  v_mfma_f32_16x16x32_bf16 v[136:139], v[28:31], v[80:83], v[136:139]
  v_mfma_f32_16x16x32_bf16 v[112:115], v[24:27], v[84:87], v[112:115]
  v_mfma_f32_16x16x32_bf16 v[140:143], v[28:31], v[84:87], v[140:143]
  s_waitcnt lgkmcnt(0)
  v_mfma_f32_16x16x32_bf16 v[88:91], v[16:19], v[32:35], v[88:91]
  ds_read_b128 v[24:27], v243 offset:0
  v_mfma_f32_16x16x32_bf16 v[116:119], v[20:23], v[32:35], v[116:119]
  ds_read_b128 v[60:63], v13 offset:22528
  v_mfma_f32_16x16x32_bf16 v[92:95], v[16:19], v[36:39], v[92:95]
  ds_read_b128 v[28:31], v243 offset:512
  v_mfma_f32_16x16x32_bf16 v[120:123], v[20:23], v[36:39], v[120:123]
  ds_read_b128 v[64:67], v13 offset:23552
  v_mfma_f32_16x16x32_bf16 v[96:99], v[16:19], v[40:43], v[96:99]
  ds_read_b128 v[68:71], v12 offset:15360
  v_mfma_f32_16x16x32_bf16 v[124:127], v[20:23], v[40:43], v[124:127]
  ds_read_b128 v[72:75], v12 offset:16384
  v_mfma_f32_16x16x32_bf16 v[100:103], v[16:19], v[44:47], v[100:103]
  ds_read_b128 v[76:79], v12 offset:17408
  v_mfma_f32_16x16x32_bf16 v[128:131], v[20:23], v[44:47], v[128:131]
  ds_read_b128 v[80:83], v12 offset:18432
  v_mfma_f32_16x16x32_bf16 v[104:107], v[16:19], v[48:51], v[104:107]
  ds_read_b128 v[84:87], v12 offset:19456
  v_mfma_f32_16x16x32_bf16 v[132:135], v[20:23], v[48:51], v[132:135]
  v_mfma_f32_16x16x32_bf16 v[108:111], v[16:19], v[52:55], v[108:111]
  v_mfma_f32_16x16x32_bf16 v[136:139], v[20:23], v[52:55], v[136:139]
  v_mfma_f32_16x16x32_bf16 v[112:115], v[16:19], v[56:59], v[112:115]
  v_mfma_f32_16x16x32_bf16 v[140:143], v[20:23], v[56:59], v[140:143]
  s_waitcnt lgkmcnt(0)
  s_barrier
  v_mfma_f32_16x16x32_bf16 v[88:91], v[24:27], v[60:63], v[88:91]
  ds_read_b128 v[16:19], v244 offset:0
  v_mfma_f32_16x16x32_bf16 v[116:119], v[28:31], v[60:63], v[116:119]
  ds_read_b128 v[32:35], v13 offset:24576
  v_mfma_f32_16x16x32_bf16 v[92:95], v[24:27], v[64:67], v[92:95]
  ds_read_b128 v[20:23], v244 offset:512
  v_mfma_f32_16x16x32_bf16 v[120:123], v[28:31], v[64:67], v[120:123]
  ds_read_b128 v[36:39], v13 offset:25600
  v_mfma_f32_16x16x32_bf16 v[96:99], v[24:27], v[68:71], v[96:99]
  ds_read_b128 v[40:43], v12 offset:20480
  v_mfma_f32_16x16x32_bf16 v[124:127], v[28:31], v[68:71], v[124:127]
  ds_read_b128 v[44:47], v12 offset:21504
  v_mfma_f32_16x16x32_bf16 v[100:103], v[24:27], v[72:75], v[100:103]
  ds_read_b128 v[48:51], v12 offset:22528
  v_mfma_f32_16x16x32_bf16 v[128:131], v[28:31], v[72:75], v[128:131]
  ds_read_b128 v[52:55], v12 offset:23552
  v_mfma_f32_16x16x32_bf16 v[104:107], v[24:27], v[76:79], v[104:107]
  ds_read_b128 v[56:59], v12 offset:24576
  v_mfma_f32_16x16x32_bf16 v[132:135], v[28:31], v[76:79], v[132:135]
  v_mfma_f32_16x16x32_bf16 v[108:111], v[24:27], v[80:83], v[108:111]
  v_mfma_f32_16x16x32_bf16 v[136:139], v[28:31], v[80:83], v[136:139]
  v_mfma_f32_16x16x32_bf16 v[112:115], v[24:27], v[84:87], v[112:115]
  v_mfma_f32_16x16x32_bf16 v[140:143], v[28:31], v[84:87], v[140:143]
  s_waitcnt lgkmcnt(0)
  v_mfma_f32_16x16x32_bf16 v[88:91], v[16:19], v[32:35], v[88:91]
  ds_read_b128 v[24:27], v245 offset:0
  v_mfma_f32_16x16x32_bf16 v[116:119], v[20:23], v[32:35], v[116:119]
  ds_read_b128 v[60:63], v13 offset:26624
  v_mfma_f32_16x16x32_bf16 v[92:95], v[16:19], v[36:39], v[92:95]
  ds_read_b128 v[28:31], v245 offset:512
  v_mfma_f32_16x16x32_bf16 v[120:123], v[20:23], v[36:39], v[120:123]
  ds_read_b128 v[64:67], v13 offset:27648
  v_mfma_f32_16x16x32_bf16 v[96:99], v[16:19], v[40:43], v[96:99]
  ds_read_b128 v[68:71], v12 offset:25600
  v_mfma_f32_16x16x32_bf16 v[124:127], v[20:23], v[40:43], v[124:127]
  ds_read_b128 v[72:75], v12 offset:26624
  v_mfma_f32_16x16x32_bf16 v[100:103], v[16:19], v[44:47], v[100:103]
  ds_read_b128 v[76:79], v12 offset:27648
  v_mfma_f32_16x16x32_bf16 v[128:131], v[20:23], v[44:47], v[128:131]
  ds_read_b128 v[80:83], v12 offset:28672
  v_mfma_f32_16x16x32_bf16 v[104:107], v[16:19], v[48:51], v[104:107]
  ds_read_b128 v[84:87], v12 offset:29696
  v_mfma_f32_16x16x32_bf16 v[132:135], v[20:23], v[48:51], v[132:135]
  v_mfma_f32_16x16x32_bf16 v[108:111], v[16:19], v[52:55], v[108:111]
  v_mfma_f32_16x16x32_bf16 v[136:139], v[20:23], v[52:55], v[136:139]
  v_mfma_f32_16x16x32_bf16 v[112:115], v[16:19], v[56:59], v[112:115]
  v_mfma_f32_16x16x32_bf16 v[140:143], v[20:23], v[56:59], v[140:143]
  s_waitcnt lgkmcnt(0)
  s_barrier
  v_mfma_f32_16x16x32_bf16 v[88:91], v[24:27], v[60:63], v[88:91]
  ds_read_b128 v[16:19], v246 offset:0
  v_mfma_f32_16x16x32_bf16 v[116:119], v[28:31], v[60:63], v[116:119]
  ds_read_b128 v[32:35], v13 offset:28672
  v_mfma_f32_16x16x32_bf16 v[92:95], v[24:27], v[64:67], v[92:95]
  ds_read_b128 v[20:23], v246 offset:512
  v_mfma_f32_16x16x32_bf16 v[120:123], v[28:31], v[64:67], v[120:123]
  ds_read_b128 v[36:39], v13 offset:29696
  v_mfma_f32_16x16x32_bf16 v[96:99], v[24:27], v[68:71], v[96:99]
  ds_read_b128 v[40:43], v12 offset:30720
  v_mfma_f32_16x16x32_bf16 v[124:127], v[28:31], v[68:71], v[124:127]
  ds_read_b128 v[44:47], v12 offset:31744
  v_mfma_f32_16x16x32_bf16 v[100:103], v[24:27], v[72:75], v[100:103]
  ds_read_b128 v[48:51], v12 offset:32768
  v_mfma_f32_16x16x32_bf16 v[128:131], v[28:31], v[72:75], v[128:131]
  ds_read_b128 v[52:55], v12 offset:33792
  v_mfma_f32_16x16x32_bf16 v[104:107], v[24:27], v[76:79], v[104:107]
  ds_read_b128 v[56:59], v12 offset:34816
  v_mfma_f32_16x16x32_bf16 v[132:135], v[28:31], v[76:79], v[132:135]
  v_mfma_f32_16x16x32_bf16 v[108:111], v[24:27], v[80:83], v[108:111]
  v_mfma_f32_16x16x32_bf16 v[136:139], v[28:31], v[80:83], v[136:139]
  v_mfma_f32_16x16x32_bf16 v[112:115], v[24:27], v[84:87], v[112:115]
  v_mfma_f32_16x16x32_bf16 v[140:143], v[28:31], v[84:87], v[140:143]
  s_waitcnt lgkmcnt(0)
  v_mfma_f32_16x16x32_bf16 v[88:91], v[16:19], v[32:35], v[88:91]
  ds_read_b128 v[24:27], v247 offset:0
  v_mfma_f32_16x16x32_bf16 v[116:119], v[20:23], v[32:35], v[116:119]
  ds_read_b128 v[60:63], v13 offset:30720
  v_mfma_f32_16x16x32_bf16 v[92:95], v[16:19], v[36:39], v[92:95]
  ds_read_b128 v[28:31], v247 offset:512
  v_mfma_f32_16x16x32_bf16 v[120:123], v[20:23], v[36:39], v[120:123]
  ds_read_b128 v[64:67], v13 offset:31744
  v_mfma_f32_16x16x32_bf16 v[96:99], v[16:19], v[40:43], v[96:99]
  ds_read_b128 v[68:71], v12 offset:35840
  v_mfma_f32_16x16x32_bf16 v[124:127], v[20:23], v[40:43], v[124:127]
  ds_read_b128 v[72:75], v12 offset:36864
  v_mfma_f32_16x16x32_bf16 v[100:103], v[16:19], v[44:47], v[100:103]
  ds_read_b128 v[76:79], v12 offset:37888
  v_mfma_f32_16x16x32_bf16 v[128:131], v[20:23], v[44:47], v[128:131]
  ds_read_b128 v[80:83], v12 offset:38912
  v_mfma_f32_16x16x32_bf16 v[104:107], v[16:19], v[48:51], v[104:107]
  ds_read_b128 v[84:87], v12 offset:39936
  v_mfma_f32_16x16x32_bf16 v[132:135], v[20:23], v[48:51], v[132:135]
  v_mfma_f32_16x16x32_bf16 v[108:111], v[16:19], v[52:55], v[108:111]
  v_mfma_f32_16x16x32_bf16 v[136:139], v[20:23], v[52:55], v[136:139]
  v_mfma_f32_16x16x32_bf16 v[112:115], v[16:19], v[56:59], v[112:115]
  v_mfma_f32_16x16x32_bf16 v[140:143], v[20:23], v[56:59], v[140:143]
  s_waitcnt lgkmcnt(0)
  s_barrier
  v_mfma_f32_16x16x32_bf16 v[88:91], v[24:27], v[60:63], v[88:91]
  ds_read_b128 v[16:19], v232 offset:0
  v_mfma_f32_16x16x32_bf16 v[116:119], v[28:31], v[60:63], v[116:119]
  ds_read_b128 v[32:35], v13 offset:0
  v_mfma_f32_16x16x32_bf16 v[92:95], v[24:27], v[64:67], v[92:95]
  ds_read_b128 v[20:23], v232 offset:512
  v_mfma_f32_16x16x32_bf16 v[120:123], v[28:31], v[64:67], v[120:123]
  ds_read_b128 v[36:39], v13 offset:1024
  v_mfma_f32_16x16x32_bf16 v[96:99], v[24:27], v[68:71], v[96:99]
  ds_read_b128 v[40:43], v12 offset:0
  v_mfma_f32_16x16x32_bf16 v[124:127], v[28:31], v[68:71], v[124:127]
  ds_read_b128 v[44:47], v12 offset:1024
  v_mfma_f32_16x16x32_bf16 v[100:103], v[24:27], v[72:75], v[100:103]
  ds_read_b128 v[48:51], v12 offset:2048
  v_mfma_f32_16x16x32_bf16 v[128:131], v[28:31], v[72:75], v[128:131]
  ds_read_b128 v[52:55], v12 offset:3072
  v_mfma_f32_16x16x32_bf16 v[104:107], v[24:27], v[76:79], v[104:107]
  ds_read_b128 v[56:59], v12 offset:4096
  v_mfma_f32_16x16x32_bf16 v[132:135], v[28:31], v[76:79], v[132:135]
  v_mfma_f32_16x16x32_bf16 v[108:111], v[24:27], v[80:83], v[108:111]
  v_mfma_f32_16x16x32_bf16 v[136:139], v[28:31], v[80:83], v[136:139]
  v_mfma_f32_16x16x32_bf16 v[112:115], v[24:27], v[84:87], v[112:115]
  v_mfma_f32_16x16x32_bf16 v[140:143], v[28:31], v[84:87], v[140:143]
  s_sub_u32 s65, s65, 1
  s_cmp_lg_u32 s65, 0
  s_cbranch_scc1 L_kg_A
L_kg_cB:
  s_mov_b32 s90, 0xbdd2d3e8
  s_mov_b32 s91, 0xbdd2d3e8
  s_nop 7
  v_pk_mul_f32 v[200:201], v[88:89], v[88:89]
  v_pk_mul_f32 v[202:203], v[90:91], v[90:91]
  v_pk_mul_f32 v[204:205], v[116:117], v[116:117]
  v_pk_mul_f32 v[206:207], v[118:119], v[118:119]
  v_pk_fma_f32 v[200:201], v[200:201], s[90:91], v[248:249]
  v_pk_fma_f32 v[202:203], v[202:203], s[90:91], v[248:249]
  v_pk_fma_f32 v[204:205], v[204:205], s[90:91], v[248:249]
  v_pk_fma_f32 v[206:207], v[206:207], s[90:91], v[248:249]
  v_pk_mul_f32 v[200:201], v[200:201], v[88:89]
  v_pk_mul_f32 v[202:203], v[202:203], v[90:91]
  v_pk_mul_f32 v[204:205], v[204:205], v[116:117]
  v_pk_mul_f32 v[206:207], v[206:207], v[118:119]
  v_exp_f32 v208, v200
  v_exp_f32 v209, v201
  v_exp_f32 v210, v202
  v_exp_f32 v211, v203
  v_exp_f32 v212, v204
  v_exp_f32 v213, v205
  v_exp_f32 v214, v206
  v_exp_f32 v215, v207
  v_pk_add_f32 v[208:209], v[208:209], v[250:251]
  v_pk_add_f32 v[210:211], v[210:211], v[250:251]
  v_pk_add_f32 v[212:213], v[212:213], v[250:251]
  v_pk_add_f32 v[214:215], v[214:215], v[250:251]
  v_rcp_f32 v208, v208
  v_rcp_f32 v209, v209
  v_rcp_f32 v210, v210
  v_rcp_f32 v211, v211
  v_rcp_f32 v212, v212
  v_rcp_f32 v213, v213
  v_rcp_f32 v214, v214
  v_rcp_f32 v215, v215
  v_pk_mul_f32 v[88:89], v[88:89], v[208:209]
  v_pk_mul_f32 v[90:91], v[90:91], v[210:211]
  v_pk_mul_f32 v[116:117], v[116:117], v[212:213]
  v_pk_mul_f32 v[118:119], v[118:119], v[214:215]
  v_pk_mul_f32 v[224:225], v[88:89], v[88:89]
  v_mov_b32 v216, v88
  v_mov_b32 v217, v89
  v_pk_mul_f32 v[226:227], v[90:91], v[90:91]
  v_mov_b32 v218, v90
  v_mov_b32 v219, v91
  v_pk_mul_f32 v[228:229], v[116:117], v[116:117]
  v_mov_b32 v220, v116
  v_mov_b32 v221, v117
  v_pk_mul_f32 v[230:231], v[118:119], v[118:119]
  v_mov_b32 v222, v118
  v_mov_b32 v223, v119
  v_pk_mul_f32 v[200:201], v[92:93], v[92:93]
  v_pk_mul_f32 v[202:203], v[94:95], v[94:95]
  v_pk_mul_f32 v[204:205], v[120:121], v[120:121]
  v_pk_mul_f32 v[206:207], v[122:123], v[122:123]
  v_pk_fma_f32 v[200:201], v[200:201], s[90:91], v[248:249]
  v_pk_fma_f32 v[202:203], v[202:203], s[90:91], v[248:249]
  v_pk_fma_f32 v[204:205], v[204:205], s[90:91], v[248:249]
  v_pk_fma_f32 v[206:207], v[206:207], s[90:91], v[248:249]
  v_pk_mul_f32 v[200:201], v[200:201], v[92:93]
  v_pk_mul_f32 v[202:203], v[202:203], v[94:95]
  v_pk_mul_f32 v[204:205], v[204:205], v[120:121]
  v_pk_mul_f32 v[206:207], v[206:207], v[122:123]
  v_exp_f32 v208, v200
  v_exp_f32 v209, v201
  v_exp_f32 v210, v202
  v_exp_f32 v211, v203
  v_exp_f32 v212, v204
  v_exp_f32 v213, v205
  v_exp_f32 v214, v206
  v_exp_f32 v215, v207
  v_pk_add_f32 v[208:209], v[208:209], v[250:251]
  v_pk_add_f32 v[210:211], v[210:211], v[250:251]
  v_pk_add_f32 v[212:213], v[212:213], v[250:251]
  v_pk_add_f32 v[214:215], v[214:215], v[250:251]
  v_rcp_f32 v208, v208
  v_rcp_f32 v209, v209
  v_rcp_f32 v210, v210
  v_rcp_f32 v211, v211
  v_rcp_f32 v212, v212
  v_rcp_f32 v213, v213
  v_rcp_f32 v214, v214
  v_rcp_f32 v215, v215
  v_pk_mul_f32 v[92:93], v[92:93], v[208:209]
  v_pk_mul_f32 v[94:95], v[94:95], v[210:211]
  v_pk_mul_f32 v[120:121], v[120:121], v[212:213]
  v_pk_mul_f32 v[122:123], v[122:123], v[214:215]
  v_pk_fma_f32 v[224:225], v[92:93], v[92:93], v[224:225]
  v_pk_add_f32 v[216:217], v[216:217], v[92:93]
  v_pk_fma_f32 v[226:227], v[94:95], v[94:95], v[226:227]
  v_pk_add_f32 v[218:219], v[218:219], v[94:95]
  v_pk_fma_f32 v[228:229], v[120:121], v[120:121], v[228:229]
  v_pk_add_f32 v[220:221], v[220:221], v[120:121]
  v_pk_fma_f32 v[230:231], v[122:123], v[122:123], v[230:231]
  v_pk_add_f32 v[222:223], v[222:223], v[122:123]
  v_pk_mul_f32 v[200:201], v[96:97], v[96:97]
  v_pk_mul_f32 v[202:203], v[98:99], v[98:99]
  v_pk_mul_f32 v[204:205], v[124:125], v[124:125]
  v_pk_mul_f32 v[206:207], v[126:127], v[126:127]
  v_pk_fma_f32 v[200:201], v[200:201], s[90:91], v[248:249]
  v_pk_fma_f32 v[202:203], v[202:203], s[90:91], v[248:249]
  v_pk_fma_f32 v[204:205], v[204:205], s[90:91], v[248:249]
  v_pk_fma_f32 v[206:207], v[206:207], s[90:91], v[248:249]
  v_pk_mul_f32 v[200:201], v[200:201], v[96:97]
  v_pk_mul_f32 v[202:203], v[202:203], v[98:99]
  v_pk_mul_f32 v[204:205], v[204:205], v[124:125]
  v_pk_mul_f32 v[206:207], v[206:207], v[126:127]
  v_exp_f32 v208, v200
  v_exp_f32 v209, v201
  v_exp_f32 v210, v202
  v_exp_f32 v211, v203
  v_exp_f32 v212, v204
  v_exp_f32 v213, v205
  v_exp_f32 v214, v206
  v_exp_f32 v215, v207
  v_pk_add_f32 v[208:209], v[208:209], v[250:251]
  v_pk_add_f32 v[210:211], v[210:211], v[250:251]
  v_pk_add_f32 v[212:213], v[212:213], v[250:251]
  v_pk_add_f32 v[214:215], v[214:215], v[250:251]
  v_rcp_f32 v208, v208
  v_rcp_f32 v209, v209
  v_rcp_f32 v210, v210
  v_rcp_f32 v211, v211
  v_rcp_f32 v212, v212
  v_rcp_f32 v213, v213
  v_rcp_f32 v214, v214
  v_rcp_f32 v215, v215
  v_pk_mul_f32 v[96:97], v[96:97], v[208:209]
  v_pk_mul_f32 v[98:99], v[98:99], v[210:211]
  v_pk_mul_f32 v[124:125], v[124:125], v[212:213]
  v_pk_mul_f32 v[126:127], v[126:127], v[214:215]
  v_pk_fma_f32 v[224:225], v[96:97], v[96:97], v[224:225]
  v_pk_add_f32 v[216:217], v[216:217], v[96:97]
  v_pk_fma_f32 v[226:227], v[98:99], v[98:99], v[226:227]
  v_pk_add_f32 v[218:219], v[218:219], v[98:99]
  v_pk_fma_f32 v[228:229], v[124:125], v[124:125], v[228:229]
  v_pk_add_f32 v[220:221], v[220:221], v[124:125]
  v_pk_fma_f32 v[230:231], v[126:127], v[126:127], v[230:231]
  v_pk_add_f32 v[222:223], v[222:223], v[126:127]
  v_pk_mul_f32 v[200:201], v[100:101], v[100:101]
  v_pk_mul_f32 v[202:203], v[102:103], v[102:103]
  v_pk_mul_f32 v[204:205], v[128:129], v[128:129]
  v_pk_mul_f32 v[206:207], v[130:131], v[130:131]
  v_pk_fma_f32 v[200:201], v[200:201], s[90:91], v[248:249]
  v_pk_fma_f32 v[202:203], v[202:203], s[90:91], v[248:249]
  v_pk_fma_f32 v[204:205], v[204:205], s[90:91], v[248:249]
  v_pk_fma_f32 v[206:207], v[206:207], s[90:91], v[248:249]
  v_pk_mul_f32 v[200:201], v[200:201], v[100:101]
  v_pk_mul_f32 v[202:203], v[202:203], v[102:103]
  v_pk_mul_f32 v[204:205], v[204:205], v[128:129]
  v_pk_mul_f32 v[206:207], v[206:207], v[130:131]
  v_exp_f32 v208, v200
  v_exp_f32 v209, v201
  v_exp_f32 v210, v202
  v_exp_f32 v211, v203
  v_exp_f32 v212, v204
  v_exp_f32 v213, v205
  v_exp_f32 v214, v206
  v_exp_f32 v215, v207
  v_pk_add_f32 v[208:209], v[208:209], v[250:251]
  v_pk_add_f32 v[210:211], v[210:211], v[250:251]
  v_pk_add_f32 v[212:213], v[212:213], v[250:251]
  v_pk_add_f32 v[214:215], v[214:215], v[250:251]
  v_rcp_f32 v208, v208
  v_rcp_f32 v209, v209
  v_rcp_f32 v210, v210
  v_rcp_f32 v211, v211
  v_rcp_f32 v212, v212
  v_rcp_f32 v213, v213
  v_rcp_f32 v214, v214
  v_rcp_f32 v215, v215
  v_pk_mul_f32 v[100:101], v[100:101], v[208:209]
  v_pk_mul_f32 v[102:103], v[102:103], v[210:211]
  v_pk_mul_f32 v[128:129], v[128:129], v[212:213]
  v_pk_mul_f32 v[130:131], v[130:131], v[214:215]
  v_pk_fma_f32 v[224:225], v[100:101], v[100:101], v[224:225]
  v_pk_add_f32 v[216:217], v[216:217], v[100:101]
  v_pk_fma_f32 v[226:227], v[102:103], v[102:103], v[226:227]
  v_pk_add_f32 v[218:219], v[218:219], v[102:103]
  v_pk_fma_f32 v[228:229], v[128:129], v[128:129], v[228:229]
  v_pk_add_f32 v[220:221], v[220:221], v[128:129]
  v_pk_fma_f32 v[230:231], v[130:131], v[130:131], v[230:231]
  v_pk_add_f32 v[222:223], v[222:223], v[130:131]
  v_pk_mul_f32 v[200:201], v[104:105], v[104:105]
  v_pk_mul_f32 v[202:203], v[106:107], v[106:107]
  v_pk_mul_f32 v[204:205], v[132:133], v[132:133]
  v_pk_mul_f32 v[206:207], v[134:135], v[134:135]
  v_pk_fma_f32 v[200:201], v[200:201], s[90:91], v[248:249]
  v_pk_fma_f32 v[202:203], v[202:203], s[90:91], v[248:249]
  v_pk_fma_f32 v[204:205], v[204:205], s[90:91], v[248:249]
  v_pk_fma_f32 v[206:207], v[206:207], s[90:91], v[248:249]
  v_pk_mul_f32 v[200:201], v[200:201], v[104:105]
  v_pk_mul_f32 v[202:203], v[202:203], v[106:107]
  v_pk_mul_f32 v[204:205], v[204:205], v[132:133]
  v_pk_mul_f32 v[206:207], v[206:207], v[134:135]
  v_exp_f32 v208, v200
  v_exp_f32 v209, v201
  v_exp_f32 v210, v202
  v_exp_f32 v211, v203
  v_exp_f32 v212, v204
  v_exp_f32 v213, v205
  v_exp_f32 v214, v206
  v_exp_f32 v215, v207
  v_pk_add_f32 v[208:209], v[208:209], v[250:251]
  v_pk_add_f32 v[210:211], v[210:211], v[250:251]
  v_pk_add_f32 v[212:213], v[212:213], v[250:251]
  v_pk_add_f32 v[214:215], v[214:215], v[250:251]
  v_rcp_f32 v208, v208
  v_rcp_f32 v209, v209
  v_rcp_f32 v210, v210
  v_rcp_f32 v211, v211
  v_rcp_f32 v212, v212
  v_rcp_f32 v213, v213
  v_rcp_f32 v214, v214
  v_rcp_f32 v215, v215
  v_pk_mul_f32 v[104:105], v[104:105], v[208:209]
  v_pk_mul_f32 v[106:107], v[106:107], v[210:211]
  v_pk_mul_f32 v[132:133], v[132:133], v[212:213]
  v_pk_mul_f32 v[134:135], v[134:135], v[214:215]
  v_pk_fma_f32 v[224:225], v[104:105], v[104:105], v[224:225]
  v_pk_add_f32 v[216:217], v[216:217], v[104:105]
  v_pk_fma_f32 v[226:227], v[106:107], v[106:107], v[226:227]
  v_pk_add_f32 v[218:219], v[218:219], v[106:107]
  v_pk_fma_f32 v[228:229], v[132:133], v[132:133], v[228:229]
  v_pk_add_f32 v[220:221], v[220:221], v[132:133]
  v_pk_fma_f32 v[230:231], v[134:135], v[134:135], v[230:231]
  v_pk_add_f32 v[222:223], v[222:223], v[134:135]
  v_pk_mul_f32 v[200:201], v[108:109], v[108:109]
  v_pk_mul_f32 v[202:203], v[110:111], v[110:111]
  v_pk_mul_f32 v[204:205], v[136:137], v[136:137]
  v_pk_mul_f32 v[206:207], v[138:139], v[138:139]
  v_pk_fma_f32 v[200:201], v[200:201], s[90:91], v[248:249]
  v_pk_fma_f32 v[202:203], v[202:203], s[90:91], v[248:249]
  v_pk_fma_f32 v[204:205], v[204:205], s[90:91], v[248:249]
  v_pk_fma_f32 v[206:207], v[206:207], s[90:91], v[248:249]
  v_pk_mul_f32 v[200:201], v[200:201], v[108:109]
  v_pk_mul_f32 v[202:203], v[202:203], v[110:111]
  v_pk_mul_f32 v[204:205], v[204:205], v[136:137]
  v_pk_mul_f32 v[206:207], v[206:207], v[138:139]
  v_exp_f32 v208, v200
  v_exp_f32 v209, v201
  v_exp_f32 v210, v202
  v_exp_f32 v211, v203
  v_exp_f32 v212, v204
  v_exp_f32 v213, v205
  v_exp_f32 v214, v206
  v_exp_f32 v215, v207
  v_pk_add_f32 v[208:209], v[208:209], v[250:251]
  v_pk_add_f32 v[210:211], v[210:211], v[250:251]
  v_pk_add_f32 v[212:213], v[212:213], v[250:251]
  v_pk_add_f32 v[214:215], v[214:215], v[250:251]
  v_rcp_f32 v208, v208
  v_rcp_f32 v209, v209
  v_rcp_f32 v210, v210
  v_rcp_f32 v211, v211
  v_rcp_f32 v212, v212
  v_rcp_f32 v213, v213
  v_rcp_f32 v214, v214
  v_rcp_f32 v215, v215
  v_pk_mul_f32 v[108:109], v[108:109], v[208:209]
  v_pk_mul_f32 v[110:111], v[110:111], v[210:211]
  v_pk_mul_f32 v[136:137], v[136:137], v[212:213]
  v_pk_mul_f32 v[138:139], v[138:139], v[214:215]
  v_pk_fma_f32 v[224:225], v[108:109], v[108:109], v[224:225]
  v_pk_add_f32 v[216:217], v[216:217], v[108:109]
  v_pk_fma_f32 v[226:227], v[110:111], v[110:111], v[226:227]
  v_pk_add_f32 v[218:219], v[218:219], v[110:111]
  v_pk_fma_f32 v[228:229], v[136:137], v[136:137], v[228:229]
  v_pk_add_f32 v[220:221], v[220:221], v[136:137]
  v_pk_fma_f32 v[230:231], v[138:139], v[138:139], v[230:231]
  v_pk_add_f32 v[222:223], v[222:223], v[138:139]
  v_pk_mul_f32 v[200:201], v[112:113], v[112:113]
  v_pk_mul_f32 v[202:203], v[114:115], v[114:115]
  v_pk_mul_f32 v[204:205], v[140:141], v[140:141]
  v_pk_mul_f32 v[206:207], v[142:143], v[142:143]
  v_pk_fma_f32 v[200:201], v[200:201], s[90:91], v[248:249]
  v_pk_fma_f32 v[202:203], v[202:203], s[90:91], v[248:249]
  v_pk_fma_f32 v[204:205], v[204:205], s[90:91], v[248:249]
  v_pk_fma_f32 v[206:207], v[206:207], s[90:91], v[248:249]
  v_pk_mul_f32 v[200:201], v[200:201], v[112:113]
  v_pk_mul_f32 v[202:203], v[202:203], v[114:115]
  v_pk_mul_f32 v[204:205], v[204:205], v[140:141]
  v_pk_mul_f32 v[206:207], v[206:207], v[142:143]
  v_exp_f32 v208, v200
  v_exp_f32 v209, v201
  v_exp_f32 v210, v202
  v_exp_f32 v211, v203
  v_exp_f32 v212, v204
  v_exp_f32 v213, v205
  v_exp_f32 v214, v206
  v_exp_f32 v215, v207
  v_pk_add_f32 v[208:209], v[208:209], v[250:251]
  v_pk_add_f32 v[210:211], v[210:211], v[250:251]
  v_pk_add_f32 v[212:213], v[212:213], v[250:251]
  v_pk_add_f32 v[214:215], v[214:215], v[250:251]
  v_rcp_f32 v208, v208
  v_rcp_f32 v209, v209
  v_rcp_f32 v210, v210
  v_rcp_f32 v211, v211
  v_rcp_f32 v212, v212
  v_rcp_f32 v213, v213
  v_rcp_f32 v214, v214
  v_rcp_f32 v215, v215
  v_pk_mul_f32 v[112:113], v[112:113], v[208:209]
  v_pk_mul_f32 v[114:115], v[114:115], v[210:211]
  v_pk_mul_f32 v[140:141], v[140:141], v[212:213]
  v_pk_mul_f32 v[142:143], v[142:143], v[214:215]
  v_pk_fma_f32 v[224:225], v[112:113], v[112:113], v[224:225]
  v_pk_add_f32 v[216:217], v[216:217], v[112:113]
  v_pk_fma_f32 v[226:227], v[114:115], v[114:115], v[226:227]
  v_pk_add_f32 v[218:219], v[218:219], v[114:115]
  v_pk_fma_f32 v[228:229], v[140:141], v[140:141], v[228:229]
  v_pk_add_f32 v[220:221], v[220:221], v[140:141]
  v_pk_fma_f32 v[230:231], v[142:143], v[142:143], v[230:231]
  v_pk_add_f32 v[222:223], v[222:223], v[142:143]
  s_nop 1
  v_add_f32_dpp v216, v216, v216 row_ror:8 row_mask:0xf bank_mask:0xf
  v_add_f32_dpp v217, v217, v217 row_ror:8 row_mask:0xf bank_mask:0xf
  v_add_f32_dpp v218, v218, v218 row_ror:8 row_mask:0xf bank_mask:0xf
  v_add_f32_dpp v219, v219, v219 row_ror:8 row_mask:0xf bank_mask:0xf
  v_add_f32_dpp v220, v220, v220 row_ror:8 row_mask:0xf bank_mask:0xf
  v_add_f32_dpp v221, v221, v221 row_ror:8 row_mask:0xf bank_mask:0xf
  v_add_f32_dpp v222, v222, v222 row_ror:8 row_mask:0xf bank_mask:0xf
  v_add_f32_dpp v223, v223, v223 row_ror:8 row_mask:0xf bank_mask:0xf
  v_add_f32_dpp v224, v224, v224 row_ror:8 row_mask:0xf bank_mask:0xf
  v_add_f32_dpp v225, v225, v225 row_ror:8 row_mask:0xf bank_mask:0xf
  v_add_f32_dpp v226, v226, v226 row_ror:8 row_mask:0xf bank_mask:0xf
  v_add_f32_dpp v227, v227, v227 row_ror:8 row_mask:0xf bank_mask:0xf
  v_add_f32_dpp v228, v228, v228 row_ror:8 row_mask:0xf bank_mask:0xf
  v_add_f32_dpp v229, v229, v229 row_ror:8 row_mask:0xf bank_mask:0xf
  v_add_f32_dpp v230, v230, v230 row_ror:8 row_mask:0xf bank_mask:0xf
  v_add_f32_dpp v231, v231, v231 row_ror:8 row_mask:0xf bank_mask:0xf
  v_add_f32_dpp v216, v216, v216 row_ror:4 row_mask:0xf bank_mask:0xf
  v_add_f32_dpp v217, v217, v217 row_ror:4 row_mask:0xf bank_mask:0xf
  v_add_f32_dpp v218, v218, v218 row_ror:4 row_mask:0xf bank_mask:0xf
  v_add_f32_dpp v219, v219, v219 row_ror:4 row_mask:0xf bank_mask:0xf
  v_add_f32_dpp v220, v220, v220 row_ror:4 row_mask:0xf bank_mask:0xf
  v_add_f32_dpp v221, v221, v221 row_ror:4 row_mask:0xf bank_mask:0xf
  v_add_f32_dpp v222, v222, v222 row_ror:4 row_mask:0xf bank_mask:0xf
  v_add_f32_dpp v223, v223, v223 row_ror:4 row_mask:0xf bank_mask:0xf
  v_add_f32_dpp v224, v224, v224 row_ror:4 row_mask:0xf bank_mask:0xf
  v_add_f32_dpp v225, v225, v225 row_ror:4 row_mask:0xf bank_mask:0xf
  v_add_f32_dpp v226, v226, v226 row_ror:4 row_mask:0xf bank_mask:0xf
  v_add_f32_dpp v227, v227, v227 row_ror:4 row_mask:0xf bank_mask:0xf
  v_add_f32_dpp v228, v228, v228 row_ror:4 row_mask:0xf bank_mask:0xf
  v_add_f32_dpp v229, v229, v229 row_ror:4 row_mask:0xf bank_mask:0xf
  v_add_f32_dpp v230, v230, v230 row_ror:4 row_mask:0xf bank_mask:0xf
  v_add_f32_dpp v231, v231, v231 row_ror:4 row_mask:0xf bank_mask:0xf
  v_add_f32_dpp v216, v216, v216 row_ror:2 row_mask:0xf bank_mask:0xf
  v_add_f32_dpp v217, v217, v217 row_ror:2 row_mask:0xf bank_mask:0xf
  v_add_f32_dpp v218, v218, v218 row_ror:2 row_mask:0xf bank_mask:0xf
  v_add_f32_dpp v219, v219, v219 row_ror:2 row_mask:0xf bank_mask:0xf
  v_add_f32_dpp v220, v220, v220 row_ror:2 row_mask:0xf bank_mask:0xf
  v_add_f32_dpp v221, v221, v221 row_ror:2 row_mask:0xf bank_mask:0xf
  v_add_f32_dpp v222, v222, v222 row_ror:2 row_mask:0xf bank_mask:0xf
  v_add_f32_dpp v223, v223, v223 row_ror:2 row_mask:0xf bank_mask:0xf
  v_add_f32_dpp v224, v224, v224 row_ror:2 row_mask:0xf bank_mask:0xf
  v_add_f32_dpp v225, v225, v225 row_ror:2 row_mask:0xf bank_mask:0xf
  v_add_f32_dpp v226, v226, v226 row_ror:2 row_mask:0xf bank_mask:0xf
  v_add_f32_dpp v227, v227, v227 row_ror:2 row_mask:0xf bank_mask:0xf
  v_add_f32_dpp v228, v228, v228 row_ror:2 row_mask:0xf bank_mask:0xf
  v_add_f32_dpp v229, v229, v229 row_ror:2 row_mask:0xf bank_mask:0xf
  v_add_f32_dpp v230, v230, v230 row_ror:2 row_mask:0xf bank_mask:0xf
  v_add_f32_dpp v231, v231, v231 row_ror:2 row_mask:0xf bank_mask:0xf
  v_add_f32_dpp v216, v216, v216 row_ror:1 row_mask:0xf bank_mask:0xf
  v_add_f32_dpp v217, v217, v217 row_ror:1 row_mask:0xf bank_mask:0xf
  v_add_f32_dpp v218, v218, v218 row_ror:1 row_mask:0xf bank_mask:0xf
  v_add_f32_dpp v219, v219, v219 row_ror:1 row_mask:0xf bank_mask:0xf
  v_add_f32_dpp v220, v220, v220 row_ror:1 row_mask:0xf bank_mask:0xf
  v_add_f32_dpp v221, v221, v221 row_ror:1 row_mask:0xf bank_mask:0xf
  v_add_f32_dpp v222, v222, v222 row_ror:1 row_mask:0xf bank_mask:0xf
  v_add_f32_dpp v223, v223, v223 row_ror:1 row_mask:0xf bank_mask:0xf
  v_add_f32_dpp v224, v224, v224 row_ror:1 row_mask:0xf bank_mask:0xf
  v_add_f32_dpp v225, v225, v225 row_ror:1 row_mask:0xf bank_mask:0xf
  v_add_f32_dpp v226, v226, v226 row_ror:1 row_mask:0xf bank_mask:0xf
  v_add_f32_dpp v227, v227, v227 row_ror:1 row_mask:0xf bank_mask:0xf
  v_add_f32_dpp v228, v228, v228 row_ror:1 row_mask:0xf bank_mask:0xf
  v_add_f32_dpp v229, v229, v229 row_ror:1 row_mask:0xf bank_mask:0xf
  v_add_f32_dpp v230, v230, v230 row_ror:1 row_mask:0xf bank_mask:0xf
  v_add_f32_dpp v231, v231, v231 row_ror:1 row_mask:0xf bank_mask:0xf
  v_and_b32 v8, 3, v14
  v_mov_b32 v200, v216
  v_mov_b32 v201, v224
  v_mov_b32 v202, v217
  v_mov_b32 v203, v225
  v_cmp_eq_u32 vcc, 1, v8
  s_nop 1
  v_cndmask_b32 v200, v200, v218, vcc
  v_cndmask_b32 v201, v201, v226, vcc
  v_cndmask_b32 v202, v202, v219, vcc
  v_cndmask_b32 v203, v203, v227, vcc
  v_cmp_eq_u32 vcc, 2, v8
  s_nop 1
  v_cndmask_b32 v200, v200, v220, vcc
  v_cndmask_b32 v201, v201, v228, vcc
  v_cndmask_b32 v202, v202, v221, vcc
  v_cndmask_b32 v203, v203, v229, vcc
  v_cmp_eq_u32 vcc, 3, v8
  s_nop 1
  v_cndmask_b32 v200, v200, v222, vcc
  v_cndmask_b32 v201, v201, v230, vcc
  v_cndmask_b32 v202, v202, v223, vcc
  v_cndmask_b32 v203, v203, v231, vcc
  v_lshlrev_b32 v8, 4, v8
  v_add_u32 v8, v8, v7
  s_mov_b64 exec, s[70:71]
  buffer_store_dwordx4 v[200:203], v8, s[32:35], s66 offen sc1
  s_mov_b64 exec, -1
  s_waitcnt lgkmcnt(0)
  v_mfma_f32_16x16x32_bf16 v[144:147], v[32:35], v[16:19], v[144:147]
  ds_read_b128 v[24:27], v233 offset:0
  v_mfma_f32_16x16x32_bf16 v[172:175], v[32:35], v[20:23], v[172:175]
  ds_read_b128 v[60:63], v13 offset:2048
  v_mfma_f32_16x16x32_bf16 v[148:151], v[36:39], v[16:19], v[148:151]
  ds_read_b128 v[28:31], v233 offset:512
  v_mfma_f32_16x16x32_bf16 v[176:179], v[36:39], v[20:23], v[176:179]
  ds_read_b128 v[64:67], v13 offset:3072
  v_mfma_f32_16x16x32_bf16 v[152:155], v[40:43], v[16:19], v[152:155]
  ds_read_b128 v[68:71], v12 offset:5120
  v_mfma_f32_16x16x32_bf16 v[180:183], v[40:43], v[20:23], v[180:183]
  ds_read_b128 v[72:75], v12 offset:6144
  v_mfma_f32_16x16x32_bf16 v[156:159], v[44:47], v[16:19], v[156:159]
  ds_read_b128 v[76:79], v12 offset:7168
  v_mfma_f32_16x16x32_bf16 v[184:187], v[44:47], v[20:23], v[184:187]
  ds_read_b128 v[80:83], v12 offset:8192
  v_mfma_f32_16x16x32_bf16 v[160:163], v[48:51], v[16:19], v[160:163]
  ds_read_b128 v[84:87], v12 offset:9216
  v_mfma_f32_16x16x32_bf16 v[188:191], v[48:51], v[20:23], v[188:191]
  v_mfma_f32_16x16x32_bf16 v[164:167], v[52:55], v[16:19], v[164:167]
  v_mfma_f32_16x16x32_bf16 v[192:195], v[52:55], v[20:23], v[192:195]
  v_mfma_f32_16x16x32_bf16 v[168:171], v[56:59], v[16:19], v[168:171]
  v_mfma_f32_16x16x32_bf16 v[196:199], v[56:59], v[20:23], v[196:199]
  s_waitcnt lgkmcnt(0)
  s_barrier
  v_mfma_f32_16x16x32_bf16 v[144:147], v[60:63], v[24:27], v[144:147]
  ds_read_b128 v[16:19], v234 offset:0
  v_mfma_f32_16x16x32_bf16 v[172:175], v[60:63], v[28:31], v[172:175]
  ds_read_b128 v[32:35], v13 offset:4096
  v_mfma_f32_16x16x32_bf16 v[148:151], v[64:67], v[24:27], v[148:151]
  ds_read_b128 v[20:23], v234 offset:512
  v_mfma_f32_16x16x32_bf16 v[176:179], v[64:67], v[28:31], v[176:179]
  ds_read_b128 v[36:39], v13 offset:5120
  v_mfma_f32_16x16x32_bf16 v[152:155], v[68:71], v[24:27], v[152:155]
  ds_read_b128 v[40:43], v12 offset:10240
  v_mfma_f32_16x16x32_bf16 v[180:183], v[68:71], v[28:31], v[180:183]
  ds_read_b128 v[44:47], v12 offset:11264
  v_mfma_f32_16x16x32_bf16 v[156:159], v[72:75], v[24:27], v[156:159]
  ds_read_b128 v[48:51], v12 offset:12288
  v_mfma_f32_16x16x32_bf16 v[184:187], v[72:75], v[28:31], v[184:187]
  ds_read_b128 v[52:55], v12 offset:13312
  v_mfma_f32_16x16x32_bf16 v[160:163], v[76:79], v[24:27], v[160:163]
  ds_read_b128 v[56:59], v12 offset:14336
  v_mfma_f32_16x16x32_bf16 v[188:191], v[76:79], v[28:31], v[188:191]
  v_mfma_f32_16x16x32_bf16 v[164:167], v[80:83], v[24:27], v[164:167]
  v_mfma_f32_16x16x32_bf16 v[192:195], v[80:83], v[28:31], v[192:195]
  v_mfma_f32_16x16x32_bf16 v[168:171], v[84:87], v[24:27], v[168:171]
  v_mfma_f32_16x16x32_bf16 v[196:199], v[84:87], v[28:31], v[196:199]
  s_waitcnt lgkmcnt(0)
  v_mfma_f32_16x16x32_bf16 v[144:147], v[32:35], v[16:19], v[144:147]
  ds_read_b128 v[24:27], v235 offset:0
  v_mfma_f32_16x16x32_bf16 v[172:175], v[32:35], v[20:23], v[172:175]
  ds_read_b128 v[60:63], v13 offset:6144
  v_mfma_f32_16x16x32_bf16 v[148:151], v[36:39], v[16:19], v[148:151]
  ds_read_b128 v[28:31], v235 offset:512
  v_mfma_f32_16x16x32_bf16 v[176:179], v[36:39], v[20:23], v[176:179]
  ds_read_b128 v[64:67], v13 offset:7168
  v_mfma_f32_16x16x32_bf16 v[152:155], v[40:43], v[16:19], v[152:155]
  ds_read_b128 v[68:71], v12 offset:15360
  v_mfma_f32_16x16x32_bf16 v[180:183], v[40:43], v[20:23], v[180:183]
  ds_read_b128 v[72:75], v12 offset:16384
  v_mfma_f32_16x16x32_bf16 v[156:159], v[44:47], v[16:19], v[156:159]
  ds_read_b128 v[76:79], v12 offset:17408
  v_mfma_f32_16x16x32_bf16 v[184:187], v[44:47], v[20:23], v[184:187]
  ds_read_b128 v[80:83], v12 offset:18432
  v_mfma_f32_16x16x32_bf16 v[160:163], v[48:51], v[16:19], v[160:163]
  ds_read_b128 v[84:87], v12 offset:19456
  v_mfma_f32_16x16x32_bf16 v[188:191], v[48:51], v[20:23], v[188:191]
  v_mfma_f32_16x16x32_bf16 v[164:167], v[52:55], v[16:19], v[164:167]
  v_mfma_f32_16x16x32_bf16 v[192:195], v[52:55], v[20:23], v[192:195]
  v_mfma_f32_16x16x32_bf16 v[168:171], v[56:59], v[16:19], v[168:171]
  v_mfma_f32_16x16x32_bf16 v[196:199], v[56:59], v[20:23], v[196:199]
  s_waitcnt lgkmcnt(0)
  s_barrier
  v_mfma_f32_16x16x32_bf16 v[144:147], v[60:63], v[24:27], v[144:147]
  ds_read_b128 v[16:19], v236 offset:0
  v_mfma_f32_16x16x32_bf16 v[172:175], v[60:63], v[28:31], v[172:175]
  ds_read_b128 v[32:35], v13 offset:8192
  v_mfma_f32_16x16x32_bf16 v[148:151], v[64:67], v[24:27], v[148:151]
  ds_read_b128 v[20:23], v236 offset:512
  v_mfma_f32_16x16x32_bf16 v[176:179], v[64:67], v[28:31], v[176:179]
  ds_read_b128 v[36:39], v13 offset:9216
  v_mfma_f32_16x16x32_bf16 v[152:155], v[68:71], v[24:27], v[152:155]
  ds_read_b128 v[40:43], v12 offset:20480
  v_mfma_f32_16x16x32_bf16 v[180:183], v[68:71], v[28:31], v[180:183]
  ds_read_b128 v[44:47], v12 offset:21504
  v_mfma_f32_16x16x32_bf16 v[156:159], v[72:75], v[24:27], v[156:159]
  ds_read_b128 v[48:51], v12 offset:22528
  v_mfma_f32_16x16x32_bf16 v[184:187], v[72:75], v[28:31], v[184:187]
  ds_read_b128 v[52:55], v12 offset:23552
  v_mfma_f32_16x16x32_bf16 v[160:163], v[76:79], v[24:27], v[160:163]
  ds_read_b128 v[56:59], v12 offset:24576
  v_mfma_f32_16x16x32_bf16 v[188:191], v[76:79], v[28:31], v[188:191]
  v_mfma_f32_16x16x32_bf16 v[164:167], v[80:83], v[24:27], v[164:167]
  v_mfma_f32_16x16x32_bf16 v[192:195], v[80:83], v[28:31], v[192:195]
  v_mfma_f32_16x16x32_bf16 v[168:171], v[84:87], v[24:27], v[168:171]
  v_mfma_f32_16x16x32_bf16 v[196:199], v[84:87], v[28:31], v[196:199]
  s_waitcnt lgkmcnt(0)
  v_mfma_f32_16x16x32_bf16 v[144:147], v[32:35], v[16:19], v[144:147]
  ds_read_b128 v[24:27], v237 offset:0
  buffer_load_dwordx4 v[216:219], v15, s[32:35], s67 offen offset:0 sc1
  buffer_load_dwordx4 v[220:223], v15, s[32:35], s67 offen offset:16 sc1
  buffer_load_dwordx4 v[224:227], v15, s[32:35], s67 offen offset:32 sc1
  buffer_load_dwordx4 v[228:231], v15, s[32:35], s67 offen offset:48 sc1
  v_mfma_f32_16x16x32_bf16 v[172:175], v[32:35], v[20:23], v[172:175]
  ds_read_b128 v[60:63], v13 offset:10240
  v_mfma_f32_16x16x32_bf16 v[148:151], v[36:39], v[16:19], v[148:151]
  ds_read_b128 v[28:31], v237 offset:512
  v_mfma_f32_16x16x32_bf16 v[176:179], v[36:39], v[20:23], v[176:179]
  ds_read_b128 v[64:67], v13 offset:11264
  v_mfma_f32_16x16x32_bf16 v[152:155], v[40:43], v[16:19], v[152:155]
  ds_read_b128 v[68:71], v12 offset:25600
  v_mfma_f32_16x16x32_bf16 v[180:183], v[40:43], v[20:23], v[180:183]
  ds_read_b128 v[72:75], v12 offset:26624
  v_mfma_f32_16x16x32_bf16 v[156:159], v[44:47], v[16:19], v[156:159]
  ds_read_b128 v[76:79], v12 offset:27648
  v_mfma_f32_16x16x32_bf16 v[184:187], v[44:47], v[20:23], v[184:187]
  ds_read_b128 v[80:83], v12 offset:28672
  v_mfma_f32_16x16x32_bf16 v[160:163], v[48:51], v[16:19], v[160:163]
  ds_read_b128 v[84:87], v12 offset:29696
  v_mfma_f32_16x16x32_bf16 v[188:191], v[48:51], v[20:23], v[188:191]
  v_mfma_f32_16x16x32_bf16 v[164:167], v[52:55], v[16:19], v[164:167]
  v_mfma_f32_16x16x32_bf16 v[192:195], v[52:55], v[20:23], v[192:195]
  v_mfma_f32_16x16x32_bf16 v[168:171], v[56:59], v[16:19], v[168:171]
  v_mfma_f32_16x16x32_bf16 v[196:199], v[56:59], v[20:23], v[196:199]
  s_waitcnt lgkmcnt(0)
  s_barrier
  v_mfma_f32_16x16x32_bf16 v[144:147], v[60:63], v[24:27], v[144:147]
  ds_read_b128 v[16:19], v238 offset:0
  v_mfma_f32_16x16x32_bf16 v[172:175], v[60:63], v[28:31], v[172:175]
  ds_read_b128 v[32:35], v13 offset:12288
  v_mfma_f32_16x16x32_bf16 v[148:151], v[64:67], v[24:27], v[148:151]
  ds_read_b128 v[20:23], v238 offset:512
  v_mfma_f32_16x16x32_bf16 v[176:179], v[64:67], v[28:31], v[176:179]
  ds_read_b128 v[36:39], v13 offset:13312
  v_mfma_f32_16x16x32_bf16 v[152:155], v[68:71], v[24:27], v[152:155]
  ds_read_b128 v[40:43], v12 offset:30720
  v_mfma_f32_16x16x32_bf16 v[180:183], v[68:71], v[28:31], v[180:183]
  ds_read_b128 v[44:47], v12 offset:31744
  v_mfma_f32_16x16x32_bf16 v[156:159], v[72:75], v[24:27], v[156:159]
  ds_read_b128 v[48:51], v12 offset:32768
  v_mfma_f32_16x16x32_bf16 v[184:187], v[72:75], v[28:31], v[184:187]
  ds_read_b128 v[52:55], v12 offset:33792
  v_mfma_f32_16x16x32_bf16 v[160:163], v[76:79], v[24:27], v[160:163]
  ds_read_b128 v[56:59], v12 offset:34816
  v_mfma_f32_16x16x32_bf16 v[188:191], v[76:79], v[28:31], v[188:191]
  v_mfma_f32_16x16x32_bf16 v[164:167], v[80:83], v[24:27], v[164:167]
  v_mfma_f32_16x16x32_bf16 v[192:195], v[80:83], v[28:31], v[192:195]
  v_mfma_f32_16x16x32_bf16 v[168:171], v[84:87], v[24:27], v[168:171]
  v_mfma_f32_16x16x32_bf16 v[196:199], v[84:87], v[28:31], v[196:199]
  s_waitcnt lgkmcnt(0)
  v_mfma_f32_16x16x32_bf16 v[144:147], v[32:35], v[16:19], v[144:147]
  ds_read_b128 v[24:27], v239 offset:0
  v_mfma_f32_16x16x32_bf16 v[172:175], v[32:35], v[20:23], v[172:175]
  ds_read_b128 v[60:63], v13 offset:14336
  v_mfma_f32_16x16x32_bf16 v[148:151], v[36:39], v[16:19], v[148:151]
  ds_read_b128 v[28:31], v239 offset:512
  v_mfma_f32_16x16x32_bf16 v[176:179], v[36:39], v[20:23], v[176:179]
  ds_read_b128 v[64:67], v13 offset:15360
  v_mfma_f32_16x16x32_bf16 v[152:155], v[40:43], v[16:19], v[152:155]
  ds_read_b128 v[68:71], v12 offset:35840
  v_mfma_f32_16x16x32_bf16 v[180:183], v[40:43], v[20:23], v[180:183]
  ds_read_b128 v[72:75], v12 offset:36864
  v_mfma_f32_16x16x32_bf16 v[156:159], v[44:47], v[16:19], v[156:159]
  ds_read_b128 v[76:79], v12 offset:37888
  v_mfma_f32_16x16x32_bf16 v[184:187], v[44:47], v[20:23], v[184:187]
  ds_read_b128 v[80:83], v12 offset:38912
  v_mfma_f32_16x16x32_bf16 v[160:163], v[48:51], v[16:19], v[160:163]
  ds_read_b128 v[84:87], v12 offset:39936
  v_mfma_f32_16x16x32_bf16 v[188:191], v[48:51], v[20:23], v[188:191]
  v_mfma_f32_16x16x32_bf16 v[164:167], v[52:55], v[16:19], v[164:167]
  v_mfma_f32_16x16x32_bf16 v[192:195], v[52:55], v[20:23], v[192:195]
  v_mfma_f32_16x16x32_bf16 v[168:171], v[56:59], v[16:19], v[168:171]
  v_mfma_f32_16x16x32_bf16 v[196:199], v[56:59], v[20:23], v[196:199]
  s_waitcnt lgkmcnt(0)
  s_barrier
  v_mfma_f32_16x16x32_bf16 v[144:147], v[60:63], v[24:27], v[144:147]
  ds_read_b128 v[16:19], v240 offset:0
  v_mfma_f32_16x16x32_bf16 v[172:175], v[60:63], v[28:31], v[172:175]
  ds_read_b128 v[32:35], v13 offset:16384
  v_mfma_f32_16x16x32_bf16 v[148:151], v[64:67], v[24:27], v[148:151]
  ds_read_b128 v[20:23], v240 offset:512
  v_mfma_f32_16x16x32_bf16 v[176:179], v[64:67], v[28:31], v[176:179]
  ds_read_b128 v[36:39], v13 offset:17408
  v_mfma_f32_16x16x32_bf16 v[152:155], v[68:71], v[24:27], v[152:155]
  ds_read_b128 v[40:43], v12 offset:0
  v_mfma_f32_16x16x32_bf16 v[180:183], v[68:71], v[28:31], v[180:183]
  ds_read_b128 v[44:47], v12 offset:1024
  v_mfma_f32_16x16x32_bf16 v[156:159], v[72:75], v[24:27], v[156:159]
  ds_read_b128 v[48:51], v12 offset:2048
  v_mfma_f32_16x16x32_bf16 v[184:187], v[72:75], v[28:31], v[184:187]
  ds_read_b128 v[52:55], v12 offset:3072
  v_mfma_f32_16x16x32_bf16 v[160:163], v[76:79], v[24:27], v[160:163]
  ds_read_b128 v[56:59], v12 offset:4096
  v_mfma_f32_16x16x32_bf16 v[188:191], v[76:79], v[28:31], v[188:191]
  v_mfma_f32_16x16x32_bf16 v[164:167], v[80:83], v[24:27], v[164:167]
  v_mfma_f32_16x16x32_bf16 v[192:195], v[80:83], v[28:31], v[192:195]
  v_mfma_f32_16x16x32_bf16 v[168:171], v[84:87], v[24:27], v[168:171]
  v_mfma_f32_16x16x32_bf16 v[196:199], v[84:87], v[28:31], v[196:199]
  v_mov_b32 v200, 0xbf800000
  s_movk_i32 s61, 20000
  s_branch L_kg_pollS_chk
L_kg_pollS:
  buffer_load_dwordx4 v[216:219], v15, s[32:35], s67 offen offset:0 sc1
  buffer_load_dwordx4 v[220:223], v15, s[32:35], s67 offen offset:16 sc1
  buffer_load_dwordx4 v[224:227], v15, s[32:35], s67 offen offset:32 sc1
  buffer_load_dwordx4 v[228:231], v15, s[32:35], s67 offen offset:48 sc1
L_kg_pollS_chk:
  s_waitcnt vmcnt(0)
  v_cmp_eq_u32 vcc, v217, v200
  v_cmp_eq_u32 s[90:91], v219, v200
  s_nop 0
  s_or_b64 vcc, vcc, s[90:91]
  v_cmp_eq_u32 s[90:91], v221, v200
  s_nop 0
  s_or_b64 vcc, vcc, s[90:91]
  v_cmp_eq_u32 s[90:91], v223, v200
  s_nop 0
  s_or_b64 vcc, vcc, s[90:91]
  v_cmp_eq_u32 s[90:91], v225, v200
  s_nop 0
  s_or_b64 vcc, vcc, s[90:91]
  v_cmp_eq_u32 s[90:91], v227, v200
  s_nop 0
  s_or_b64 vcc, vcc, s[90:91]
  v_cmp_eq_u32 s[90:91], v229, v200
  s_nop 0
  s_or_b64 vcc, vcc, s[90:91]
  v_cmp_eq_u32 s[90:91], v231, v200
  s_nop 0
  s_or_b64 vcc, vcc, s[90:91]
  s_cbranch_vccz L_kg_pollS_ok
  s_sub_u32 s61, s61, 1
  s_cmp_lg_u32 s61, 0
  s_cbranch_scc1 L_kg_pollS
L_kg_pollS_ok:
  v_add_f32_dpp v216, v216, v216 row_ror:8 row_mask:0xf bank_mask:0xf
  v_add_f32_dpp v217, v217, v217 row_ror:8 row_mask:0xf bank_mask:0xf
  v_add_f32_dpp v218, v218, v218 row_ror:8 row_mask:0xf bank_mask:0xf
  v_add_f32_dpp v219, v219, v219 row_ror:8 row_mask:0xf bank_mask:0xf
  v_add_f32_dpp v220, v220, v220 row_ror:8 row_mask:0xf bank_mask:0xf
  v_add_f32_dpp v221, v221, v221 row_ror:8 row_mask:0xf bank_mask:0xf
  v_add_f32_dpp v222, v222, v222 row_ror:8 row_mask:0xf bank_mask:0xf
  v_add_f32_dpp v223, v223, v223 row_ror:8 row_mask:0xf bank_mask:0xf
  v_add_f32_dpp v224, v224, v224 row_ror:8 row_mask:0xf bank_mask:0xf
  v_add_f32_dpp v225, v225, v225 row_ror:8 row_mask:0xf bank_mask:0xf
  v_add_f32_dpp v226, v226, v226 row_ror:8 row_mask:0xf bank_mask:0xf
  v_add_f32_dpp v227, v227, v227 row_ror:8 row_mask:0xf bank_mask:0xf
  v_add_f32_dpp v228, v228, v228 row_ror:8 row_mask:0xf bank_mask:0xf
  v_add_f32_dpp v229, v229, v229 row_ror:8 row_mask:0xf bank_mask:0xf
  v_add_f32_dpp v230, v230, v230 row_ror:8 row_mask:0xf bank_mask:0xf
  v_add_f32_dpp v231, v231, v231 row_ror:8 row_mask:0xf bank_mask:0xf
  v_add_f32_dpp v216, v216, v216 row_ror:4 row_mask:0xf bank_mask:0xf
  v_add_f32_dpp v217, v217, v217 row_ror:4 row_mask:0xf bank_mask:0xf
  v_add_f32_dpp v218, v218, v218 row_ror:4 row_mask:0xf bank_mask:0xf
  v_add_f32_dpp v219, v219, v219 row_ror:4 row_mask:0xf bank_mask:0xf
  v_add_f32_dpp v220, v220, v220 row_ror:4 row_mask:0xf bank_mask:0xf
  v_add_f32_dpp v221, v221, v221 row_ror:4 row_mask:0xf bank_mask:0xf
  v_add_f32_dpp v222, v222, v222 row_ror:4 row_mask:0xf bank_mask:0xf
  v_add_f32_dpp v223, v223, v223 row_ror:4 row_mask:0xf bank_mask:0xf
  v_add_f32_dpp v224, v224, v224 row_ror:4 row_mask:0xf bank_mask:0xf
  v_add_f32_dpp v225, v225, v225 row_ror:4 row_mask:0xf bank_mask:0xf
  v_add_f32_dpp v226, v226, v226 row_ror:4 row_mask:0xf bank_mask:0xf
  v_add_f32_dpp v227, v227, v227 row_ror:4 row_mask:0xf bank_mask:0xf
  v_add_f32_dpp v228, v228, v228 row_ror:4 row_mask:0xf bank_mask:0xf
  v_add_f32_dpp v229, v229, v229 row_ror:4 row_mask:0xf bank_mask:0xf
  v_add_f32_dpp v230, v230, v230 row_ror:4 row_mask:0xf bank_mask:0xf
  v_add_f32_dpp v231, v231, v231 row_ror:4 row_mask:0xf bank_mask:0xf
  v_add_f32_dpp v216, v216, v216 row_ror:2 row_mask:0xf bank_mask:0xf
  v_add_f32_dpp v217, v217, v217 row_ror:2 row_mask:0xf bank_mask:0xf
  v_add_f32_dpp v218, v218, v218 row_ror:2 row_mask:0xf bank_mask:0xf
  v_add_f32_dpp v219, v219, v219 row_ror:2 row_mask:0xf bank_mask:0xf
  v_add_f32_dpp v220, v220, v220 row_ror:2 row_mask:0xf bank_mask:0xf
  v_add_f32_dpp v221, v221, v221 row_ror:2 row_mask:0xf bank_mask:0xf
  v_add_f32_dpp v222, v222, v222 row_ror:2 row_mask:0xf bank_mask:0xf
  v_add_f32_dpp v223, v223, v223 row_ror:2 row_mask:0xf bank_mask:0xf
  v_add_f32_dpp v224, v224, v224 row_ror:2 row_mask:0xf bank_mask:0xf
  v_add_f32_dpp v225, v225, v225 row_ror:2 row_mask:0xf bank_mask:0xf
  v_add_f32_dpp v226, v226, v226 row_ror:2 row_mask:0xf bank_mask:0xf
  v_add_f32_dpp v227, v227, v227 row_ror:2 row_mask:0xf bank_mask:0xf
  v_add_f32_dpp v228, v228, v228 row_ror:2 row_mask:0xf bank_mask:0xf
  v_add_f32_dpp v229, v229, v229 row_ror:2 row_mask:0xf bank_mask:0xf
  v_add_f32_dpp v230, v230, v230 row_ror:2 row_mask:0xf bank_mask:0xf
  v_add_f32_dpp v231, v231, v231 row_ror:2 row_mask:0xf bank_mask:0xf
  v_add_f32_dpp v216, v216, v216 row_ror:1 row_mask:0xf bank_mask:0xf
  v_add_f32_dpp v217, v217, v217 row_ror:1 row_mask:0xf bank_mask:0xf
  v_add_f32_dpp v218, v218, v218 row_ror:1 row_mask:0xf bank_mask:0xf
  v_add_f32_dpp v219, v219, v219 row_ror:1 row_mask:0xf bank_mask:0xf
  v_add_f32_dpp v220, v220, v220 row_ror:1 row_mask:0xf bank_mask:0xf
  v_add_f32_dpp v221, v221, v221 row_ror:1 row_mask:0xf bank_mask:0xf
  v_add_f32_dpp v222, v222, v222 row_ror:1 row_mask:0xf bank_mask:0xf
  v_add_f32_dpp v223, v223, v223 row_ror:1 row_mask:0xf bank_mask:0xf
  v_add_f32_dpp v224, v224, v224 row_ror:1 row_mask:0xf bank_mask:0xf
  v_add_f32_dpp v225, v225, v225 row_ror:1 row_mask:0xf bank_mask:0xf
  v_add_f32_dpp v226, v226, v226 row_ror:1 row_mask:0xf bank_mask:0xf
  v_add_f32_dpp v227, v227, v227 row_ror:1 row_mask:0xf bank_mask:0xf
  v_add_f32_dpp v228, v228, v228 row_ror:1 row_mask:0xf bank_mask:0xf
  v_add_f32_dpp v229, v229, v229 row_ror:1 row_mask:0xf bank_mask:0xf
  v_add_f32_dpp v230, v230, v230 row_ror:1 row_mask:0xf bank_mask:0xf
  v_add_f32_dpp v231, v231, v231 row_ror:1 row_mask:0xf bank_mask:0xf
  v_mul_f32 v216, 0x3a124925, v216
  v_mul_f32 v218, 0x3a124925, v218
  v_mul_f32 v220, 0x3a124925, v220
  v_mul_f32 v222, 0x3a124925, v222
  v_mul_f32 v224, 0x3a124925, v224
  v_mul_f32 v226, 0x3a124925, v226
  v_mul_f32 v228, 0x3a124925, v228
  v_mul_f32 v230, 0x3a124925, v230
  v_mul_f32 v217, 0x3a124925, v217
  v_mul_f32 v219, 0x3a124925, v219
  v_mul_f32 v221, 0x3a124925, v221
  v_mul_f32 v223, 0x3a124925, v223
  v_mul_f32 v225, 0x3a124925, v225
  v_mul_f32 v227, 0x3a124925, v227
  v_mul_f32 v229, 0x3a124925, v229
  v_mul_f32 v231, 0x3a124925, v231
  v_fma_f32 v217, -v216, v216, v217
  v_fma_f32 v219, -v218, v218, v219
  v_fma_f32 v221, -v220, v220, v221
  v_fma_f32 v223, -v222, v222, v223
  v_fma_f32 v225, -v224, v224, v225
  v_fma_f32 v227, -v226, v226, v227
  v_fma_f32 v229, -v228, v228, v229
  v_fma_f32 v231, -v230, v230, v231
  v_max_f32 v217, 0, v217
  v_max_f32 v219, 0, v219
  v_max_f32 v221, 0, v221
  v_max_f32 v223, 0, v223
  v_max_f32 v225, 0, v225
  v_max_f32 v227, 0, v227
  v_max_f32 v229, 0, v229
  v_max_f32 v231, 0, v231
  v_add_f32 v217, 0x3727c5ac, v217
  v_add_f32 v219, 0x3727c5ac, v219
  v_add_f32 v221, 0x3727c5ac, v221
  v_add_f32 v223, 0x3727c5ac, v223
  v_add_f32 v225, 0x3727c5ac, v225
  v_add_f32 v227, 0x3727c5ac, v227
  v_add_f32 v229, 0x3727c5ac, v229
  v_add_f32 v231, 0x3727c5ac, v231
  v_rsq_f32 v200, v217
  v_rsq_f32 v201, v219
  v_rsq_f32 v202, v221
  v_rsq_f32 v203, v223
  v_rsq_f32 v204, v225
  v_rsq_f32 v205, v227
  v_rsq_f32 v206, v229
  v_rsq_f32 v207, v231
  v_mul_f32 v208, v216, v200
  v_mul_f32 v209, v218, v201
  v_mul_f32 v210, v220, v202
  v_mul_f32 v211, v222, v203
  v_mul_f32 v212, v224, v204
  v_mul_f32 v213, v226, v205
  v_mul_f32 v214, v228, v206
  v_mul_f32 v215, v230, v207
  v_pk_fma_f32 v[88:89], v[88:89], v[200:201], v[208:209] neg_lo:[0,0,1] neg_hi:[0,0,1]
  v_pk_fma_f32 v[90:91], v[90:91], v[202:203], v[210:211] neg_lo:[0,0,1] neg_hi:[0,0,1]
  v_pk_fma_f32 v[116:117], v[116:117], v[204:205], v[212:213] neg_lo:[0,0,1] neg_hi:[0,0,1]
  v_pk_fma_f32 v[118:119], v[118:119], v[206:207], v[214:215] neg_lo:[0,0,1] neg_hi:[0,0,1]
  v_cvt_pk_bf16_f32 v216, v88, v89
  v_cvt_pk_bf16_f32 v217, v90, v91
  v_cvt_pk_bf16_f32 v218, v116, v117
  v_cvt_pk_bf16_f32 v219, v118, v119
  s_add_u32 s58, s68, s8
  buffer_store_dwordx4 v[216:219], v1, s[20:23], s58 offen sc1
  v_pk_fma_f32 v[92:93], v[92:93], v[200:201], v[208:209] neg_lo:[0,0,1] neg_hi:[0,0,1]
  v_pk_fma_f32 v[94:95], v[94:95], v[202:203], v[210:211] neg_lo:[0,0,1] neg_hi:[0,0,1]
  v_pk_fma_f32 v[120:121], v[120:121], v[204:205], v[212:213] neg_lo:[0,0,1] neg_hi:[0,0,1]
  v_pk_fma_f32 v[122:123], v[122:123], v[206:207], v[214:215] neg_lo:[0,0,1] neg_hi:[0,0,1]
  v_cvt_pk_bf16_f32 v220, v92, v93
  v_cvt_pk_bf16_f32 v221, v94, v95
  v_cvt_pk_bf16_f32 v222, v120, v121
  v_cvt_pk_bf16_f32 v223, v122, v123
  s_add_u32 s58, s68, s9
  buffer_store_dwordx4 v[220:223], v1, s[20:23], s58 offen sc1
  v_pk_fma_f32 v[96:97], v[96:97], v[200:201], v[208:209] neg_lo:[0,0,1] neg_hi:[0,0,1]
  v_pk_fma_f32 v[98:99], v[98:99], v[202:203], v[210:211] neg_lo:[0,0,1] neg_hi:[0,0,1]
  v_pk_fma_f32 v[124:125], v[124:125], v[204:205], v[212:213] neg_lo:[0,0,1] neg_hi:[0,0,1]
  v_pk_fma_f32 v[126:127], v[126:127], v[206:207], v[214:215] neg_lo:[0,0,1] neg_hi:[0,0,1]
  v_cvt_pk_bf16_f32 v224, v96, v97
  v_cvt_pk_bf16_f32 v225, v98, v99
  v_cvt_pk_bf16_f32 v226, v124, v125
  v_cvt_pk_bf16_f32 v227, v126, v127
  s_add_u32 s58, s68, s10
  buffer_store_dwordx4 v[224:227], v1, s[20:23], s58 offen sc1
  v_pk_fma_f32 v[100:101], v[100:101], v[200:201], v[208:209] neg_lo:[0,0,1] neg_hi:[0,0,1]
  v_pk_fma_f32 v[102:103], v[102:103], v[202:203], v[210:211] neg_lo:[0,0,1] neg_hi:[0,0,1]
  v_pk_fma_f32 v[128:129], v[128:129], v[204:205], v[212:213] neg_lo:[0,0,1] neg_hi:[0,0,1]
  v_pk_fma_f32 v[130:131], v[130:131], v[206:207], v[214:215] neg_lo:[0,0,1] neg_hi:[0,0,1]
  v_cvt_pk_bf16_f32 v228, v100, v101
  v_cvt_pk_bf16_f32 v229, v102, v103
  v_cvt_pk_bf16_f32 v230, v128, v129
  v_cvt_pk_bf16_f32 v231, v130, v131
  s_add_u32 s58, s68, s11
  buffer_store_dwordx4 v[228:231], v1, s[20:23], s58 offen sc1
  v_pk_fma_f32 v[104:105], v[104:105], v[200:201], v[208:209] neg_lo:[0,0,1] neg_hi:[0,0,1]
  v_pk_fma_f32 v[106:107], v[106:107], v[202:203], v[210:211] neg_lo:[0,0,1] neg_hi:[0,0,1]
  v_pk_fma_f32 v[132:133], v[132:133], v[204:205], v[212:213] neg_lo:[0,0,1] neg_hi:[0,0,1]
  v_pk_fma_f32 v[134:135], v[134:135], v[206:207], v[214:215] neg_lo:[0,0,1] neg_hi:[0,0,1]
  v_cvt_pk_bf16_f32 v216, v104, v105
  v_cvt_pk_bf16_f32 v217, v106, v107
  v_cvt_pk_bf16_f32 v218, v132, v133
  v_cvt_pk_bf16_f32 v219, v134, v135
  s_add_u32 s58, s68, s12
  buffer_store_dwordx4 v[216:219], v1, s[20:23], s58 offen sc1
  v_pk_fma_f32 v[108:109], v[108:109], v[200:201], v[208:209] neg_lo:[0,0,1] neg_hi:[0,0,1]
  v_pk_fma_f32 v[110:111], v[110:111], v[202:203], v[210:211] neg_lo:[0,0,1] neg_hi:[0,0,1]
  v_pk_fma_f32 v[136:137], v[136:137], v[204:205], v[212:213] neg_lo:[0,0,1] neg_hi:[0,0,1]
  v_pk_fma_f32 v[138:139], v[138:139], v[206:207], v[214:215] neg_lo:[0,0,1] neg_hi:[0,0,1]
  v_cvt_pk_bf16_f32 v220, v108, v109
  v_cvt_pk_bf16_f32 v221, v110, v111
  v_cvt_pk_bf16_f32 v222, v136, v137
  v_cvt_pk_bf16_f32 v223, v138, v139
  s_add_u32 s58, s68, s13
  buffer_store_dwordx4 v[220:223], v1, s[20:23], s58 offen sc1
  v_pk_fma_f32 v[112:113], v[112:113], v[200:201], v[208:209] neg_lo:[0,0,1] neg_hi:[0,0,1]
  v_pk_fma_f32 v[114:115], v[114:115], v[202:203], v[210:211] neg_lo:[0,0,1] neg_hi:[0,0,1]
  v_pk_fma_f32 v[140:141], v[140:141], v[204:205], v[212:213] neg_lo:[0,0,1] neg_hi:[0,0,1]
  v_pk_fma_f32 v[142:143], v[142:143], v[206:207], v[214:215] neg_lo:[0,0,1] neg_hi:[0,0,1]
  v_cvt_pk_bf16_f32 v224, v112, v113
  v_cvt_pk_bf16_f32 v225, v114, v115
  v_cvt_pk_bf16_f32 v226, v140, v141
  v_cvt_pk_bf16_f32 v227, v142, v143
  s_add_u32 s58, s68, s14
  buffer_store_dwordx4 v[224:227], v1, s[20:23], s58 offen sc1
  v_lshlrev_b32 v4, 16, v4
  v_lshlrev_b32 v5, 16, v5
  s_waitcnt lgkmcnt(0)
  v_mfma_f32_16x16x32_bf16 v[144:147], v[32:35], v[16:19], v[144:147]
  ds_read_b128 v[24:27], v241 offset:0
  v_mfma_f32_16x16x32_bf16 v[172:175], v[32:35], v[20:23], v[172:175]
  ds_read_b128 v[60:63], v13 offset:18432
  v_mfma_f32_16x16x32_bf16 v[148:151], v[36:39], v[16:19], v[148:151]
  ds_read_b128 v[28:31], v241 offset:512
  v_mfma_f32_16x16x32_bf16 v[176:179], v[36:39], v[20:23], v[176:179]
  ds_read_b128 v[64:67], v13 offset:19456
  v_mfma_f32_16x16x32_bf16 v[152:155], v[40:43], v[16:19], v[152:155]
  ds_read_b128 v[68:71], v12 offset:5120
  v_mfma_f32_16x16x32_bf16 v[180:183], v[40:43], v[20:23], v[180:183]
  ds_read_b128 v[72:75], v12 offset:6144
  v_mfma_f32_16x16x32_bf16 v[156:159], v[44:47], v[16:19], v[156:159]
  ds_read_b128 v[76:79], v12 offset:7168
  v_mfma_f32_16x16x32_bf16 v[184:187], v[44:47], v[20:23], v[184:187]
  ds_read_b128 v[80:83], v12 offset:8192
  v_mfma_f32_16x16x32_bf16 v[160:163], v[48:51], v[16:19], v[160:163]
  ds_read_b128 v[84:87], v12 offset:9216
  v_mfma_f32_16x16x32_bf16 v[188:191], v[48:51], v[20:23], v[188:191]
  v_mov_b32 v88, v4
  v_mov_b32 v89, v4
  v_mfma_f32_16x16x32_bf16 v[164:167], v[52:55], v[16:19], v[164:167]
  v_mov_b32 v90, v4
  v_mov_b32 v91, v4
  v_mfma_f32_16x16x32_bf16 v[192:195], v[52:55], v[20:23], v[192:195]
  v_mov_b32 v92, v4
  v_mov_b32 v93, v4
  v_mfma_f32_16x16x32_bf16 v[168:171], v[56:59], v[16:19], v[168:171]
  v_mov_b32 v94, v4
  v_mov_b32 v95, v4
  v_mfma_f32_16x16x32_bf16 v[196:199], v[56:59], v[20:23], v[196:199]
  v_mov_b32 v96, v4
  v_mov_b32 v97, v4
  s_waitcnt lgkmcnt(0)
  s_barrier
  v_mfma_f32_16x16x32_bf16 v[144:147], v[60:63], v[24:27], v[144:147]
  ds_read_b128 v[16:19], v242 offset:0
  v_mfma_f32_16x16x32_bf16 v[172:175], v[60:63], v[28:31], v[172:175]
  ds_read_b128 v[32:35], v13 offset:20480
  v_mfma_f32_16x16x32_bf16 v[148:151], v[64:67], v[24:27], v[148:151]
  ds_read_b128 v[20:23], v242 offset:512
  v_mfma_f32_16x16x32_bf16 v[176:179], v[64:67], v[28:31], v[176:179]
  ds_read_b128 v[36:39], v13 offset:21504
  v_mfma_f32_16x16x32_bf16 v[152:155], v[68:71], v[24:27], v[152:155]
  ds_read_b128 v[40:43], v12 offset:10240
  v_mfma_f32_16x16x32_bf16 v[180:183], v[68:71], v[28:31], v[180:183]
  ds_read_b128 v[44:47], v12 offset:11264
  v_mfma_f32_16x16x32_bf16 v[156:159], v[72:75], v[24:27], v[156:159]
  ds_read_b128 v[48:51], v12 offset:12288
  v_mfma_f32_16x16x32_bf16 v[184:187], v[72:75], v[28:31], v[184:187]
  ds_read_b128 v[52:55], v12 offset:13312
  v_mfma_f32_16x16x32_bf16 v[160:163], v[76:79], v[24:27], v[160:163]
  ds_read_b128 v[56:59], v12 offset:14336
  v_mfma_f32_16x16x32_bf16 v[188:191], v[76:79], v[28:31], v[188:191]
  v_mov_b32 v98, v4
  v_mov_b32 v99, v4
  v_mfma_f32_16x16x32_bf16 v[164:167], v[80:83], v[24:27], v[164:167]
  v_mov_b32 v100, v4
  v_mov_b32 v101, v4
  v_mfma_f32_16x16x32_bf16 v[192:195], v[80:83], v[28:31], v[192:195]
  v_mov_b32 v102, v4
  v_mov_b32 v103, v4
  v_mfma_f32_16x16x32_bf16 v[168:171], v[84:87], v[24:27], v[168:171]
  v_mov_b32 v104, v4
  v_mov_b32 v105, v4
  v_mfma_f32_16x16x32_bf16 v[196:199], v[84:87], v[28:31], v[196:199]
  v_mov_b32 v106, v4
  v_mov_b32 v107, v4
  s_waitcnt lgkmcnt(0)
  v_mfma_f32_16x16x32_bf16 v[144:147], v[32:35], v[16:19], v[144:147]
  ds_read_b128 v[24:27], v243 offset:0
  v_mfma_f32_16x16x32_bf16 v[172:175], v[32:35], v[20:23], v[172:175]
  ds_read_b128 v[60:63], v13 offset:22528
  v_mfma_f32_16x16x32_bf16 v[148:151], v[36:39], v[16:19], v[148:151]
  ds_read_b128 v[28:31], v243 offset:512
  v_mfma_f32_16x16x32_bf16 v[176:179], v[36:39], v[20:23], v[176:179]
  ds_read_b128 v[64:67], v13 offset:23552
  v_mfma_f32_16x16x32_bf16 v[152:155], v[40:43], v[16:19], v[152:155]
  ds_read_b128 v[68:71], v12 offset:15360
  v_mfma_f32_16x16x32_bf16 v[180:183], v[40:43], v[20:23], v[180:183]
  ds_read_b128 v[72:75], v12 offset:16384
  v_mfma_f32_16x16x32_bf16 v[156:159], v[44:47], v[16:19], v[156:159]
  ds_read_b128 v[76:79], v12 offset:17408
  v_mfma_f32_16x16x32_bf16 v[184:187], v[44:47], v[20:23], v[184:187]
  ds_read_b128 v[80:83], v12 offset:18432
  v_mfma_f32_16x16x32_bf16 v[160:163], v[48:51], v[16:19], v[160:163]
  ds_read_b128 v[84:87], v12 offset:19456
  v_mfma_f32_16x16x32_bf16 v[188:191], v[48:51], v[20:23], v[188:191]
  v_mov_b32 v108, v4
  v_mov_b32 v109, v4
  v_mfma_f32_16x16x32_bf16 v[164:167], v[52:55], v[16:19], v[164:167]
  v_mov_b32 v110, v4
  v_mov_b32 v111, v4
  v_mfma_f32_16x16x32_bf16 v[192:195], v[52:55], v[20:23], v[192:195]
  v_mov_b32 v112, v4
  v_mov_b32 v113, v4
  v_mfma_f32_16x16x32_bf16 v[168:171], v[56:59], v[16:19], v[168:171]
  v_mov_b32 v114, v4
  v_mov_b32 v115, v4
  v_mfma_f32_16x16x32_bf16 v[196:199], v[56:59], v[20:23], v[196:199]
  v_mov_b32 v116, v5
  v_mov_b32 v117, v5
  s_waitcnt lgkmcnt(0)
  s_barrier
  v_mfma_f32_16x16x32_bf16 v[144:147], v[60:63], v[24:27], v[144:147]
  ds_read_b128 v[16:19], v244 offset:0
  v_mfma_f32_16x16x32_bf16 v[172:175], v[60:63], v[28:31], v[172:175]
  ds_read_b128 v[32:35], v13 offset:24576
  v_mfma_f32_16x16x32_bf16 v[148:151], v[64:67], v[24:27], v[148:151]
  ds_read_b128 v[20:23], v244 offset:512
  v_mfma_f32_16x16x32_bf16 v[176:179], v[64:67], v[28:31], v[176:179]
  ds_read_b128 v[36:39], v13 offset:25600
  v_mfma_f32_16x16x32_bf16 v[152:155], v[68:71], v[24:27], v[152:155]
  ds_read_b128 v[40:43], v12 offset:20480
  v_mfma_f32_16x16x32_bf16 v[180:183], v[68:71], v[28:31], v[180:183]
  ds_read_b128 v[44:47], v12 offset:21504
  v_mfma_f32_16x16x32_bf16 v[156:159], v[72:75], v[24:27], v[156:159]
  ds_read_b128 v[48:51], v12 offset:22528
  v_mfma_f32_16x16x32_bf16 v[184:187], v[72:75], v[28:31], v[184:187]
  ds_read_b128 v[52:55], v12 offset:23552
  v_mfma_f32_16x16x32_bf16 v[160:163], v[76:79], v[24:27], v[160:163]
  ds_read_b128 v[56:59], v12 offset:24576
  v_mfma_f32_16x16x32_bf16 v[188:191], v[76:79], v[28:31], v[188:191]
  v_mov_b32 v118, v5
  v_mov_b32 v119, v5
  v_mfma_f32_16x16x32_bf16 v[164:167], v[80:83], v[24:27], v[164:167]
  v_mov_b32 v120, v5
  v_mov_b32 v121, v5
  v_mfma_f32_16x16x32_bf16 v[192:195], v[80:83], v[28:31], v[192:195]
  v_mov_b32 v122, v5
  v_mov_b32 v123, v5
  v_mfma_f32_16x16x32_bf16 v[168:171], v[84:87], v[24:27], v[168:171]
  v_mov_b32 v124, v5
  v_mov_b32 v125, v5
  v_mfma_f32_16x16x32_bf16 v[196:199], v[84:87], v[28:31], v[196:199]
  v_mov_b32 v126, v5
  v_mov_b32 v127, v5
  s_waitcnt lgkmcnt(0)
  v_mfma_f32_16x16x32_bf16 v[144:147], v[32:35], v[16:19], v[144:147]
  ds_read_b128 v[24:27], v245 offset:0
  v_mfma_f32_16x16x32_bf16 v[172:175], v[32:35], v[20:23], v[172:175]
  ds_read_b128 v[60:63], v13 offset:26624
  v_mfma_f32_16x16x32_bf16 v[148:151], v[36:39], v[16:19], v[148:151]
  ds_read_b128 v[28:31], v245 offset:512
  v_mfma_f32_16x16x32_bf16 v[176:179], v[36:39], v[20:23], v[176:179]
  ds_read_b128 v[64:67], v13 offset:27648
  v_mfma_f32_16x16x32_bf16 v[152:155], v[40:43], v[16:19], v[152:155]
  ds_read_b128 v[68:71], v12 offset:25600
  v_mfma_f32_16x16x32_bf16 v[180:183], v[40:43], v[20:23], v[180:183]
  ds_read_b128 v[72:75], v12 offset:26624
  v_mfma_f32_16x16x32_bf16 v[156:159], v[44:47], v[16:19], v[156:159]
  ds_read_b128 v[76:79], v12 offset:27648
  v_mfma_f32_16x16x32_bf16 v[184:187], v[44:47], v[20:23], v[184:187]
  ds_read_b128 v[80:83], v12 offset:28672
  v_mfma_f32_16x16x32_bf16 v[160:163], v[48:51], v[16:19], v[160:163]
  ds_read_b128 v[84:87], v12 offset:29696
  v_mfma_f32_16x16x32_bf16 v[188:191], v[48:51], v[20:23], v[188:191]
  v_mov_b32 v128, v5
  v_mov_b32 v129, v5
  v_mfma_f32_16x16x32_bf16 v[164:167], v[52:55], v[16:19], v[164:167]
  v_mov_b32 v130, v5
  v_mov_b32 v131, v5
  v_mfma_f32_16x16x32_bf16 v[192:195], v[52:55], v[20:23], v[192:195]
  v_mov_b32 v132, v5
  v_mov_b32 v133, v5
  v_mfma_f32_16x16x32_bf16 v[168:171], v[56:59], v[16:19], v[168:171]
  v_mov_b32 v134, v5
  v_mov_b32 v135, v5
  v_mfma_f32_16x16x32_bf16 v[196:199], v[56:59], v[20:23], v[196:199]
  v_mov_b32 v136, v5
  v_mov_b32 v137, v5
  s_waitcnt lgkmcnt(0)
  s_barrier
  v_mfma_f32_16x16x32_bf16 v[144:147], v[60:63], v[24:27], v[144:147]
  ds_read_b128 v[16:19], v246 offset:0
  v_mfma_f32_16x16x32_bf16 v[172:175], v[60:63], v[28:31], v[172:175]
  ds_read_b128 v[32:35], v13 offset:28672
  v_mfma_f32_16x16x32_bf16 v[148:151], v[64:67], v[24:27], v[148:151]
  ds_read_b128 v[20:23], v246 offset:512
  v_mfma_f32_16x16x32_bf16 v[176:179], v[64:67], v[28:31], v[176:179]
  ds_read_b128 v[36:39], v13 offset:29696
  v_mfma_f32_16x16x32_bf16 v[152:155], v[68:71], v[24:27], v[152:155]
  ds_read_b128 v[40:43], v12 offset:30720
  v_mfma_f32_16x16x32_bf16 v[180:183], v[68:71], v[28:31], v[180:183]
  ds_read_b128 v[44:47], v12 offset:31744
  v_mfma_f32_16x16x32_bf16 v[156:159], v[72:75], v[24:27], v[156:159]
  ds_read_b128 v[48:51], v12 offset:32768
  v_mfma_f32_16x16x32_bf16 v[184:187], v[72:75], v[28:31], v[184:187]
  ds_read_b128 v[52:55], v12 offset:33792
  v_mfma_f32_16x16x32_bf16 v[160:163], v[76:79], v[24:27], v[160:163]
  ds_read_b128 v[56:59], v12 offset:34816
  v_mfma_f32_16x16x32_bf16 v[188:191], v[76:79], v[28:31], v[188:191]
  v_mov_b32 v138, v5
  v_mov_b32 v139, v5
  v_mfma_f32_16x16x32_bf16 v[164:167], v[80:83], v[24:27], v[164:167]
  v_mov_b32 v140, v5
  v_mov_b32 v141, v5
  v_mfma_f32_16x16x32_bf16 v[192:195], v[80:83], v[28:31], v[192:195]
  v_mov_b32 v142, v5
  v_mov_b32 v143, v5
  v_mfma_f32_16x16x32_bf16 v[168:171], v[84:87], v[24:27], v[168:171]
  v_mfma_f32_16x16x32_bf16 v[196:199], v[84:87], v[28:31], v[196:199]
  s_waitcnt lgkmcnt(0)
  v_mfma_f32_16x16x32_bf16 v[144:147], v[32:35], v[16:19], v[144:147]
  ds_read_b128 v[24:27], v247 offset:0
  v_mfma_f32_16x16x32_bf16 v[172:175], v[32:35], v[20:23], v[172:175]
  ds_read_b128 v[60:63], v13 offset:30720
  v_mfma_f32_16x16x32_bf16 v[148:151], v[36:39], v[16:19], v[148:151]
  ds_read_b128 v[28:31], v247 offset:512
  v_mfma_f32_16x16x32_bf16 v[176:179], v[36:39], v[20:23], v[176:179]
  ds_read_b128 v[64:67], v13 offset:31744
  v_mfma_f32_16x16x32_bf16 v[152:155], v[40:43], v[16:19], v[152:155]
  ds_read_b128 v[68:71], v12 offset:35840
  v_mfma_f32_16x16x32_bf16 v[180:183], v[40:43], v[20:23], v[180:183]
  ds_read_b128 v[72:75], v12 offset:36864
  v_mfma_f32_16x16x32_bf16 v[156:159], v[44:47], v[16:19], v[156:159]
  ds_read_b128 v[76:79], v12 offset:37888
  v_mfma_f32_16x16x32_bf16 v[184:187], v[44:47], v[20:23], v[184:187]
  ds_read_b128 v[80:83], v12 offset:38912
  v_mfma_f32_16x16x32_bf16 v[160:163], v[48:51], v[16:19], v[160:163]
  ds_read_b128 v[84:87], v12 offset:39936
  v_mfma_f32_16x16x32_bf16 v[188:191], v[48:51], v[20:23], v[188:191]
  v_mfma_f32_16x16x32_bf16 v[164:167], v[52:55], v[16:19], v[164:167]
  v_mfma_f32_16x16x32_bf16 v[192:195], v[52:55], v[20:23], v[192:195]
  v_mfma_f32_16x16x32_bf16 v[168:171], v[56:59], v[16:19], v[168:171]
  v_mfma_f32_16x16x32_bf16 v[196:199], v[56:59], v[20:23], v[196:199]
  s_waitcnt lgkmcnt(0)
  s_barrier
  v_mfma_f32_16x16x32_bf16 v[144:147], v[60:63], v[24:27], v[144:147]
  ds_read_b128 v[16:19], v232 offset:0
  v_mfma_f32_16x16x32_bf16 v[172:175], v[60:63], v[28:31], v[172:175]
  ds_read_b128 v[32:35], v13 offset:0
  v_mfma_f32_16x16x32_bf16 v[148:151], v[64:67], v[24:27], v[148:151]
  ds_read_b128 v[20:23], v232 offset:512
  v_mfma_f32_16x16x32_bf16 v[176:179], v[64:67], v[28:31], v[176:179]
  ds_read_b128 v[36:39], v13 offset:1024
  v_mfma_f32_16x16x32_bf16 v[152:155], v[68:71], v[24:27], v[152:155]
  ds_read_b128 v[40:43], v12 offset:0
  v_mfma_f32_16x16x32_bf16 v[180:183], v[68:71], v[28:31], v[180:183]
  ds_read_b128 v[44:47], v12 offset:1024
  v_mfma_f32_16x16x32_bf16 v[156:159], v[72:75], v[24:27], v[156:159]
  ds_read_b128 v[48:51], v12 offset:2048
  v_mfma_f32_16x16x32_bf16 v[184:187], v[72:75], v[28:31], v[184:187]
  ds_read_b128 v[52:55], v12 offset:3072
  v_mfma_f32_16x16x32_bf16 v[160:163], v[76:79], v[24:27], v[160:163]
  ds_read_b128 v[56:59], v12 offset:4096
  v_mfma_f32_16x16x32_bf16 v[188:191], v[76:79], v[28:31], v[188:191]
  v_mfma_f32_16x16x32_bf16 v[164:167], v[80:83], v[24:27], v[164:167]
  v_mfma_f32_16x16x32_bf16 v[192:195], v[80:83], v[28:31], v[192:195]
  v_mfma_f32_16x16x32_bf16 v[168:171], v[84:87], v[24:27], v[168:171]
  v_mfma_f32_16x16x32_bf16 v[196:199], v[84:87], v[28:31], v[196:199]
  s_waitcnt lgkmcnt(0)
  v_mfma_f32_16x16x32_bf16 v[144:147], v[32:35], v[16:19], v[144:147]
  ds_read_b128 v[24:27], v233 offset:0
  v_mfma_f32_16x16x32_bf16 v[172:175], v[32:35], v[20:23], v[172:175]
  ds_read_b128 v[60:63], v13 offset:2048
  v_mfma_f32_16x16x32_bf16 v[148:151], v[36:39], v[16:19], v[148:151]
  ds_read_b128 v[28:31], v233 offset:512
  v_mfma_f32_16x16x32_bf16 v[176:179], v[36:39], v[20:23], v[176:179]
  ds_read_b128 v[64:67], v13 offset:3072
  v_mfma_f32_16x16x32_bf16 v[152:155], v[40:43], v[16:19], v[152:155]
  ds_read_b128 v[68:71], v12 offset:5120
  v_mfma_f32_16x16x32_bf16 v[180:183], v[40:43], v[20:23], v[180:183]
  ds_read_b128 v[72:75], v12 offset:6144
  v_mfma_f32_16x16x32_bf16 v[156:159], v[44:47], v[16:19], v[156:159]
  ds_read_b128 v[76:79], v12 offset:7168
  v_mfma_f32_16x16x32_bf16 v[184:187], v[44:47], v[20:23], v[184:187]
  ds_read_b128 v[80:83], v12 offset:8192
  v_mfma_f32_16x16x32_bf16 v[160:163], v[48:51], v[16:19], v[160:163]
  ds_read_b128 v[84:87], v12 offset:9216
  v_mfma_f32_16x16x32_bf16 v[188:191], v[48:51], v[20:23], v[188:191]
  v_mfma_f32_16x16x32_bf16 v[164:167], v[52:55], v[16:19], v[164:167]
  v_mfma_f32_16x16x32_bf16 v[192:195], v[52:55], v[20:23], v[192:195]
  v_mfma_f32_16x16x32_bf16 v[168:171], v[56:59], v[16:19], v[168:171]
  v_mfma_f32_16x16x32_bf16 v[196:199], v[56:59], v[20:23], v[196:199]
  s_waitcnt lgkmcnt(0)
  s_barrier
  v_mfma_f32_16x16x32_bf16 v[144:147], v[60:63], v[24:27], v[144:147]
  ds_read_b128 v[16:19], v234 offset:0
  v_mfma_f32_16x16x32_bf16 v[172:175], v[60:63], v[28:31], v[172:175]
  ds_read_b128 v[32:35], v13 offset:4096
  v_mfma_f32_16x16x32_bf16 v[148:151], v[64:67], v[24:27], v[148:151]
  ds_read_b128 v[20:23], v234 offset:512
  v_mfma_f32_16x16x32_bf16 v[176:179], v[64:67], v[28:31], v[176:179]
  ds_read_b128 v[36:39], v13 offset:5120
  v_mfma_f32_16x16x32_bf16 v[152:155], v[68:71], v[24:27], v[152:155]
  ds_read_b128 v[40:43], v12 offset:10240
  v_mfma_f32_16x16x32_bf16 v[180:183], v[68:71], v[28:31], v[180:183]
  ds_read_b128 v[44:47], v12 offset:11264
  v_mfma_f32_16x16x32_bf16 v[156:159], v[72:75], v[24:27], v[156:159]
  ds_read_b128 v[48:51], v12 offset:12288
  v_mfma_f32_16x16x32_bf16 v[184:187], v[72:75], v[28:31], v[184:187]
  ds_read_b128 v[52:55], v12 offset:13312
  v_mfma_f32_16x16x32_bf16 v[160:163], v[76:79], v[24:27], v[160:163]
  ds_read_b128 v[56:59], v12 offset:14336
  v_mfma_f32_16x16x32_bf16 v[188:191], v[76:79], v[28:31], v[188:191]
  v_mfma_f32_16x16x32_bf16 v[164:167], v[80:83], v[24:27], v[164:167]
  v_mfma_f32_16x16x32_bf16 v[192:195], v[80:83], v[28:31], v[192:195]
  v_mfma_f32_16x16x32_bf16 v[168:171], v[84:87], v[24:27], v[168:171]
  v_mfma_f32_16x16x32_bf16 v[196:199], v[84:87], v[28:31], v[196:199]
  v_mov_b32 v8, 1
  v_mov_b32 v9, 1
  v_mov_b32 v10, 1
  v_mov_b32 v11, 1
  v_lshlrev_b32 v7, 4, v14
  s_waitcnt vmcnt(0)
  s_mov_b64 exec, 0xff
  buffer_store_dwordx4 v[8:11], v7, s[36:39], s69 offen sc1
  s_mov_b64 exec, -1
  s_waitcnt lgkmcnt(0)
  v_mfma_f32_16x16x32_bf16 v[144:147], v[32:35], v[16:19], v[144:147]
  ds_read_b128 v[24:27], v235 offset:0
  v_mfma_f32_16x16x32_bf16 v[172:175], v[32:35], v[20:23], v[172:175]
  ds_read_b128 v[60:63], v13 offset:6144
  v_mfma_f32_16x16x32_bf16 v[148:151], v[36:39], v[16:19], v[148:151]
  ds_read_b128 v[28:31], v235 offset:512
  v_mfma_f32_16x16x32_bf16 v[176:179], v[36:39], v[20:23], v[176:179]
  ds_read_b128 v[64:67], v13 offset:7168
  v_mfma_f32_16x16x32_bf16 v[152:155], v[40:43], v[16:19], v[152:155]
  ds_read_b128 v[68:71], v12 offset:15360
  v_mfma_f32_16x16x32_bf16 v[180:183], v[40:43], v[20:23], v[180:183]
  ds_read_b128 v[72:75], v12 offset:16384
  v_mfma_f32_16x16x32_bf16 v[156:159], v[44:47], v[16:19], v[156:159]
  ds_read_b128 v[76:79], v12 offset:17408
  v_mfma_f32_16x16x32_bf16 v[184:187], v[44:47], v[20:23], v[184:187]
  ds_read_b128 v[80:83], v12 offset:18432
  v_mfma_f32_16x16x32_bf16 v[160:163], v[48:51], v[16:19], v[160:163]
  ds_read_b128 v[84:87], v12 offset:19456
  v_mfma_f32_16x16x32_bf16 v[188:191], v[48:51], v[20:23], v[188:191]
  v_mfma_f32_16x16x32_bf16 v[164:167], v[52:55], v[16:19], v[164:167]
  v_mfma_f32_16x16x32_bf16 v[192:195], v[52:55], v[20:23], v[192:195]
  v_mfma_f32_16x16x32_bf16 v[168:171], v[56:59], v[16:19], v[168:171]
  v_mfma_f32_16x16x32_bf16 v[196:199], v[56:59], v[20:23], v[196:199]
  s_waitcnt lgkmcnt(0)
  s_barrier
  v_mfma_f32_16x16x32_bf16 v[144:147], v[60:63], v[24:27], v[144:147]
  ds_read_b128 v[16:19], v236 offset:0
  v_mfma_f32_16x16x32_bf16 v[172:175], v[60:63], v[28:31], v[172:175]
  ds_read_b128 v[32:35], v13 offset:8192
  v_mfma_f32_16x16x32_bf16 v[148:151], v[64:67], v[24:27], v[148:151]
  ds_read_b128 v[20:23], v236 offset:512
  v_mfma_f32_16x16x32_bf16 v[176:179], v[64:67], v[28:31], v[176:179]
  ds_read_b128 v[36:39], v13 offset:9216
  v_mfma_f32_16x16x32_bf16 v[152:155], v[68:71], v[24:27], v[152:155]
  ds_read_b128 v[40:43], v12 offset:20480
  v_mfma_f32_16x16x32_bf16 v[180:183], v[68:71], v[28:31], v[180:183]
  ds_read_b128 v[44:47], v12 offset:21504
  v_mfma_f32_16x16x32_bf16 v[156:159], v[72:75], v[24:27], v[156:159]
  ds_read_b128 v[48:51], v12 offset:22528
  v_mfma_f32_16x16x32_bf16 v[184:187], v[72:75], v[28:31], v[184:187]
  ds_read_b128 v[52:55], v12 offset:23552
  v_mfma_f32_16x16x32_bf16 v[160:163], v[76:79], v[24:27], v[160:163]
  ds_read_b128 v[56:59], v12 offset:24576
  v_mfma_f32_16x16x32_bf16 v[188:191], v[76:79], v[28:31], v[188:191]
  v_mfma_f32_16x16x32_bf16 v[164:167], v[80:83], v[24:27], v[164:167]
  v_mfma_f32_16x16x32_bf16 v[192:195], v[80:83], v[28:31], v[192:195]
  v_mfma_f32_16x16x32_bf16 v[168:171], v[84:87], v[24:27], v[168:171]
  v_mfma_f32_16x16x32_bf16 v[196:199], v[84:87], v[28:31], v[196:199]
  s_waitcnt lgkmcnt(0)
  v_mfma_f32_16x16x32_bf16 v[144:147], v[32:35], v[16:19], v[144:147]
  ds_read_b128 v[24:27], v237 offset:0
  v_mfma_f32_16x16x32_bf16 v[172:175], v[32:35], v[20:23], v[172:175]
  ds_read_b128 v[60:63], v13 offset:10240
  v_mfma_f32_16x16x32_bf16 v[148:151], v[36:39], v[16:19], v[148:151]
  ds_read_b128 v[28:31], v237 offset:512
  v_mfma_f32_16x16x32_bf16 v[176:179], v[36:39], v[20:23], v[176:179]
  ds_read_b128 v[64:67], v13 offset:11264
  v_mfma_f32_16x16x32_bf16 v[152:155], v[40:43], v[16:19], v[152:155]
  ds_read_b128 v[68:71], v12 offset:25600
  v_mfma_f32_16x16x32_bf16 v[180:183], v[40:43], v[20:23], v[180:183]
  ds_read_b128 v[72:75], v12 offset:26624
  v_mfma_f32_16x16x32_bf16 v[156:159], v[44:47], v[16:19], v[156:159]
  ds_read_b128 v[76:79], v12 offset:27648
  v_mfma_f32_16x16x32_bf16 v[184:187], v[44:47], v[20:23], v[184:187]
  ds_read_b128 v[80:83], v12 offset:28672
  v_mfma_f32_16x16x32_bf16 v[160:163], v[48:51], v[16:19], v[160:163]
  ds_read_b128 v[84:87], v12 offset:29696
  v_mfma_f32_16x16x32_bf16 v[188:191], v[48:51], v[20:23], v[188:191]
  v_mfma_f32_16x16x32_bf16 v[164:167], v[52:55], v[16:19], v[164:167]
  v_mfma_f32_16x16x32_bf16 v[192:195], v[52:55], v[20:23], v[192:195]
  v_mfma_f32_16x16x32_bf16 v[168:171], v[56:59], v[16:19], v[168:171]
  v_mfma_f32_16x16x32_bf16 v[196:199], v[56:59], v[20:23], v[196:199]
  s_waitcnt lgkmcnt(0)
  s_barrier
  v_mfma_f32_16x16x32_bf16 v[144:147], v[60:63], v[24:27], v[144:147]
  ds_read_b128 v[16:19], v238 offset:0
  v_mfma_f32_16x16x32_bf16 v[172:175], v[60:63], v[28:31], v[172:175]
  ds_read_b128 v[32:35], v13 offset:12288
  v_mfma_f32_16x16x32_bf16 v[148:151], v[64:67], v[24:27], v[148:151]
  ds_read_b128 v[20:23], v238 offset:512
  v_mfma_f32_16x16x32_bf16 v[176:179], v[64:67], v[28:31], v[176:179]
  ds_read_b128 v[36:39], v13 offset:13312
  v_mfma_f32_16x16x32_bf16 v[152:155], v[68:71], v[24:27], v[152:155]
  ds_read_b128 v[40:43], v12 offset:30720
  v_mfma_f32_16x16x32_bf16 v[180:183], v[68:71], v[28:31], v[180:183]
  ds_read_b128 v[44:47], v12 offset:31744
  v_mfma_f32_16x16x32_bf16 v[156:159], v[72:75], v[24:27], v[156:159]
  ds_read_b128 v[48:51], v12 offset:32768
  v_mfma_f32_16x16x32_bf16 v[184:187], v[72:75], v[28:31], v[184:187]
  ds_read_b128 v[52:55], v12 offset:33792
  v_mfma_f32_16x16x32_bf16 v[160:163], v[76:79], v[24:27], v[160:163]
  ds_read_b128 v[56:59], v12 offset:34816
  v_mfma_f32_16x16x32_bf16 v[188:191], v[76:79], v[28:31], v[188:191]
  v_mfma_f32_16x16x32_bf16 v[164:167], v[80:83], v[24:27], v[164:167]
  v_mfma_f32_16x16x32_bf16 v[192:195], v[80:83], v[28:31], v[192:195]
  v_mfma_f32_16x16x32_bf16 v[168:171], v[84:87], v[24:27], v[168:171]
  v_mfma_f32_16x16x32_bf16 v[196:199], v[84:87], v[28:31], v[196:199]
  s_waitcnt lgkmcnt(0)
  v_mfma_f32_16x16x32_bf16 v[144:147], v[32:35], v[16:19], v[144:147]
  ds_read_b128 v[24:27], v239 offset:0
  v_mfma_f32_16x16x32_bf16 v[172:175], v[32:35], v[20:23], v[172:175]
  ds_read_b128 v[60:63], v13 offset:14336
  v_mfma_f32_16x16x32_bf16 v[148:151], v[36:39], v[16:19], v[148:151]
  ds_read_b128 v[28:31], v239 offset:512
  v_mfma_f32_16x16x32_bf16 v[176:179], v[36:39], v[20:23], v[176:179]
  ds_read_b128 v[64:67], v13 offset:15360
  v_mfma_f32_16x16x32_bf16 v[152:155], v[40:43], v[16:19], v[152:155]
  ds_read_b128 v[68:71], v12 offset:35840
  v_mfma_f32_16x16x32_bf16 v[180:183], v[40:43], v[20:23], v[180:183]
  ds_read_b128 v[72:75], v12 offset:36864
  v_mfma_f32_16x16x32_bf16 v[156:159], v[44:47], v[16:19], v[156:159]
  ds_read_b128 v[76:79], v12 offset:37888
  v_mfma_f32_16x16x32_bf16 v[184:187], v[44:47], v[20:23], v[184:187]
  ds_read_b128 v[80:83], v12 offset:38912
  v_mfma_f32_16x16x32_bf16 v[160:163], v[48:51], v[16:19], v[160:163]
  ds_read_b128 v[84:87], v12 offset:39936
  v_mfma_f32_16x16x32_bf16 v[188:191], v[48:51], v[20:23], v[188:191]
  v_mfma_f32_16x16x32_bf16 v[164:167], v[52:55], v[16:19], v[164:167]
  v_mfma_f32_16x16x32_bf16 v[192:195], v[52:55], v[20:23], v[192:195]
  v_mfma_f32_16x16x32_bf16 v[168:171], v[56:59], v[16:19], v[168:171]
  v_mfma_f32_16x16x32_bf16 v[196:199], v[56:59], v[20:23], v[196:199]
  s_waitcnt lgkmcnt(0)
  s_barrier
  v_mfma_f32_16x16x32_bf16 v[144:147], v[60:63], v[24:27], v[144:147]
  ds_read_b128 v[16:19], v240 offset:0
  v_mfma_f32_16x16x32_bf16 v[172:175], v[60:63], v[28:31], v[172:175]
  ds_read_b128 v[32:35], v13 offset:16384
  v_mfma_f32_16x16x32_bf16 v[148:151], v[64:67], v[24:27], v[148:151]
  ds_read_b128 v[20:23], v240 offset:512
  v_mfma_f32_16x16x32_bf16 v[176:179], v[64:67], v[28:31], v[176:179]
  ds_read_b128 v[36:39], v13 offset:17408
  v_mfma_f32_16x16x32_bf16 v[152:155], v[68:71], v[24:27], v[152:155]
  ds_read_b128 v[40:43], v12 offset:0
  v_mfma_f32_16x16x32_bf16 v[180:183], v[68:71], v[28:31], v[180:183]
  ds_read_b128 v[44:47], v12 offset:1024
  v_mfma_f32_16x16x32_bf16 v[156:159], v[72:75], v[24:27], v[156:159]
  ds_read_b128 v[48:51], v12 offset:2048
  v_mfma_f32_16x16x32_bf16 v[184:187], v[72:75], v[28:31], v[184:187]
  ds_read_b128 v[52:55], v12 offset:3072
  v_mfma_f32_16x16x32_bf16 v[160:163], v[76:79], v[24:27], v[160:163]
  ds_read_b128 v[56:59], v12 offset:4096
  v_mfma_f32_16x16x32_bf16 v[188:191], v[76:79], v[28:31], v[188:191]
  v_mfma_f32_16x16x32_bf16 v[164:167], v[80:83], v[24:27], v[164:167]
  v_mfma_f32_16x16x32_bf16 v[192:195], v[80:83], v[28:31], v[192:195]
  v_mfma_f32_16x16x32_bf16 v[168:171], v[84:87], v[24:27], v[168:171]
  v_mfma_f32_16x16x32_bf16 v[196:199], v[84:87], v[28:31], v[196:199]
  s_waitcnt lgkmcnt(0)
  v_mfma_f32_16x16x32_bf16 v[144:147], v[32:35], v[16:19], v[144:147]
  ds_read_b128 v[24:27], v241 offset:0
  v_mfma_f32_16x16x32_bf16 v[172:175], v[32:35], v[20:23], v[172:175]
  ds_read_b128 v[60:63], v13 offset:18432
  v_mfma_f32_16x16x32_bf16 v[148:151], v[36:39], v[16:19], v[148:151]
  ds_read_b128 v[28:31], v241 offset:512
  v_mfma_f32_16x16x32_bf16 v[176:179], v[36:39], v[20:23], v[176:179]
  ds_read_b128 v[64:67], v13 offset:19456
  v_mfma_f32_16x16x32_bf16 v[152:155], v[40:43], v[16:19], v[152:155]
  ds_read_b128 v[68:71], v12 offset:5120
  v_mfma_f32_16x16x32_bf16 v[180:183], v[40:43], v[20:23], v[180:183]
  ds_read_b128 v[72:75], v12 offset:6144
  v_mfma_f32_16x16x32_bf16 v[156:159], v[44:47], v[16:19], v[156:159]
  ds_read_b128 v[76:79], v12 offset:7168
  v_mfma_f32_16x16x32_bf16 v[184:187], v[44:47], v[20:23], v[184:187]
  ds_read_b128 v[80:83], v12 offset:8192
  v_mfma_f32_16x16x32_bf16 v[160:163], v[48:51], v[16:19], v[160:163]
  ds_read_b128 v[84:87], v12 offset:9216
  v_mfma_f32_16x16x32_bf16 v[188:191], v[48:51], v[20:23], v[188:191]
  v_mfma_f32_16x16x32_bf16 v[164:167], v[52:55], v[16:19], v[164:167]
  v_mfma_f32_16x16x32_bf16 v[192:195], v[52:55], v[20:23], v[192:195]
  v_mfma_f32_16x16x32_bf16 v[168:171], v[56:59], v[16:19], v[168:171]
  v_mfma_f32_16x16x32_bf16 v[196:199], v[56:59], v[20:23], v[196:199]
  s_waitcnt lgkmcnt(0)
  s_barrier
  v_mfma_f32_16x16x32_bf16 v[144:147], v[60:63], v[24:27], v[144:147]
  ds_read_b128 v[16:19], v242 offset:0
  v_mfma_f32_16x16x32_bf16 v[172:175], v[60:63], v[28:31], v[172:175]
  ds_read_b128 v[32:35], v13 offset:20480
  v_mfma_f32_16x16x32_bf16 v[148:151], v[64:67], v[24:27], v[148:151]
  ds_read_b128 v[20:23], v242 offset:512
  v_mfma_f32_16x16x32_bf16 v[176:179], v[64:67], v[28:31], v[176:179]
  ds_read_b128 v[36:39], v13 offset:21504
  v_mfma_f32_16x16x32_bf16 v[152:155], v[68:71], v[24:27], v[152:155]
  ds_read_b128 v[40:43], v12 offset:10240
  v_mfma_f32_16x16x32_bf16 v[180:183], v[68:71], v[28:31], v[180:183]
  ds_read_b128 v[44:47], v12 offset:11264
  v_mfma_f32_16x16x32_bf16 v[156:159], v[72:75], v[24:27], v[156:159]
  ds_read_b128 v[48:51], v12 offset:12288
  v_mfma_f32_16x16x32_bf16 v[184:187], v[72:75], v[28:31], v[184:187]
  ds_read_b128 v[52:55], v12 offset:13312
  v_mfma_f32_16x16x32_bf16 v[160:163], v[76:79], v[24:27], v[160:163]
  ds_read_b128 v[56:59], v12 offset:14336
  v_mfma_f32_16x16x32_bf16 v[188:191], v[76:79], v[28:31], v[188:191]
  v_mfma_f32_16x16x32_bf16 v[164:167], v[80:83], v[24:27], v[164:167]
  v_mfma_f32_16x16x32_bf16 v[192:195], v[80:83], v[28:31], v[192:195]
  v_mfma_f32_16x16x32_bf16 v[168:171], v[84:87], v[24:27], v[168:171]
  v_mfma_f32_16x16x32_bf16 v[196:199], v[84:87], v[28:31], v[196:199]
  s_waitcnt lgkmcnt(0)
  v_mfma_f32_16x16x32_bf16 v[144:147], v[32:35], v[16:19], v[144:147]
  ds_read_b128 v[24:27], v243 offset:0
  v_mfma_f32_16x16x32_bf16 v[172:175], v[32:35], v[20:23], v[172:175]
  ds_read_b128 v[60:63], v13 offset:22528
  v_mfma_f32_16x16x32_bf16 v[148:151], v[36:39], v[16:19], v[148:151]
  ds_read_b128 v[28:31], v243 offset:512
  v_mfma_f32_16x16x32_bf16 v[176:179], v[36:39], v[20:23], v[176:179]
  ds_read_b128 v[64:67], v13 offset:23552
  v_mfma_f32_16x16x32_bf16 v[152:155], v[40:43], v[16:19], v[152:155]
  ds_read_b128 v[68:71], v12 offset:15360
  v_mfma_f32_16x16x32_bf16 v[180:183], v[40:43], v[20:23], v[180:183]
  ds_read_b128 v[72:75], v12 offset:16384
  v_mfma_f32_16x16x32_bf16 v[156:159], v[44:47], v[16:19], v[156:159]
  ds_read_b128 v[76:79], v12 offset:17408
  v_mfma_f32_16x16x32_bf16 v[184:187], v[44:47], v[20:23], v[184:187]
  ds_read_b128 v[80:83], v12 offset:18432
  v_mfma_f32_16x16x32_bf16 v[160:163], v[48:51], v[16:19], v[160:163]
  ds_read_b128 v[84:87], v12 offset:19456
  v_mfma_f32_16x16x32_bf16 v[188:191], v[48:51], v[20:23], v[188:191]
  v_mfma_f32_16x16x32_bf16 v[164:167], v[52:55], v[16:19], v[164:167]
  v_mfma_f32_16x16x32_bf16 v[192:195], v[52:55], v[20:23], v[192:195]
  v_mfma_f32_16x16x32_bf16 v[168:171], v[56:59], v[16:19], v[168:171]
  v_mfma_f32_16x16x32_bf16 v[196:199], v[56:59], v[20:23], v[196:199]
  s_waitcnt lgkmcnt(0)
  s_barrier
  v_mfma_f32_16x16x32_bf16 v[144:147], v[60:63], v[24:27], v[144:147]
  ds_read_b128 v[16:19], v244 offset:0
  v_mfma_f32_16x16x32_bf16 v[172:175], v[60:63], v[28:31], v[172:175]
  ds_read_b128 v[32:35], v13 offset:24576
  v_mfma_f32_16x16x32_bf16 v[148:151], v[64:67], v[24:27], v[148:151]
  ds_read_b128 v[20:23], v244 offset:512
  v_mfma_f32_16x16x32_bf16 v[176:179], v[64:67], v[28:31], v[176:179]
  ds_read_b128 v[36:39], v13 offset:25600
  v_mfma_f32_16x16x32_bf16 v[152:155], v[68:71], v[24:27], v[152:155]
  ds_read_b128 v[40:43], v12 offset:20480
  v_mfma_f32_16x16x32_bf16 v[180:183], v[68:71], v[28:31], v[180:183]
  ds_read_b128 v[44:47], v12 offset:21504
  v_mfma_f32_16x16x32_bf16 v[156:159], v[72:75], v[24:27], v[156:159]
  ds_read_b128 v[48:51], v12 offset:22528
  v_mfma_f32_16x16x32_bf16 v[184:187], v[72:75], v[28:31], v[184:187]
  ds_read_b128 v[52:55], v12 offset:23552
  v_mfma_f32_16x16x32_bf16 v[160:163], v[76:79], v[24:27], v[160:163]
  ds_read_b128 v[56:59], v12 offset:24576
  v_mfma_f32_16x16x32_bf16 v[188:191], v[76:79], v[28:31], v[188:191]
  v_mfma_f32_16x16x32_bf16 v[164:167], v[80:83], v[24:27], v[164:167]
  v_mfma_f32_16x16x32_bf16 v[192:195], v[80:83], v[28:31], v[192:195]
  v_mfma_f32_16x16x32_bf16 v[168:171], v[84:87], v[24:27], v[168:171]
  v_mfma_f32_16x16x32_bf16 v[196:199], v[84:87], v[28:31], v[196:199]
  s_waitcnt lgkmcnt(0)
  v_mfma_f32_16x16x32_bf16 v[144:147], v[32:35], v[16:19], v[144:147]
  ds_read_b128 v[24:27], v245 offset:0
  v_mfma_f32_16x16x32_bf16 v[172:175], v[32:35], v[20:23], v[172:175]
  ds_read_b128 v[60:63], v13 offset:26624
  v_mfma_f32_16x16x32_bf16 v[148:151], v[36:39], v[16:19], v[148:151]
  ds_read_b128 v[28:31], v245 offset:512
  v_mfma_f32_16x16x32_bf16 v[176:179], v[36:39], v[20:23], v[176:179]
  ds_read_b128 v[64:67], v13 offset:27648
  v_mfma_f32_16x16x32_bf16 v[152:155], v[40:43], v[16:19], v[152:155]
  ds_read_b128 v[68:71], v12 offset:25600
  v_mfma_f32_16x16x32_bf16 v[180:183], v[40:43], v[20:23], v[180:183]
  ds_read_b128 v[72:75], v12 offset:26624
  v_mfma_f32_16x16x32_bf16 v[156:159], v[44:47], v[16:19], v[156:159]
  ds_read_b128 v[76:79], v12 offset:27648
  v_mfma_f32_16x16x32_bf16 v[184:187], v[44:47], v[20:23], v[184:187]
  ds_read_b128 v[80:83], v12 offset:28672
  v_mfma_f32_16x16x32_bf16 v[160:163], v[48:51], v[16:19], v[160:163]
  ds_read_b128 v[84:87], v12 offset:29696
  v_mfma_f32_16x16x32_bf16 v[188:191], v[48:51], v[20:23], v[188:191]
  v_mfma_f32_16x16x32_bf16 v[164:167], v[52:55], v[16:19], v[164:167]
  v_mfma_f32_16x16x32_bf16 v[192:195], v[52:55], v[20:23], v[192:195]
  v_mfma_f32_16x16x32_bf16 v[168:171], v[56:59], v[16:19], v[168:171]
  v_mfma_f32_16x16x32_bf16 v[196:199], v[56:59], v[20:23], v[196:199]
  s_waitcnt lgkmcnt(0)
  s_barrier
  v_mfma_f32_16x16x32_bf16 v[144:147], v[60:63], v[24:27], v[144:147]
  ds_read_b128 v[16:19], v246 offset:0
  v_mfma_f32_16x16x32_bf16 v[172:175], v[60:63], v[28:31], v[172:175]
  ds_read_b128 v[32:35], v13 offset:28672
  v_mfma_f32_16x16x32_bf16 v[148:151], v[64:67], v[24:27], v[148:151]
  ds_read_b128 v[20:23], v246 offset:512
  v_mfma_f32_16x16x32_bf16 v[176:179], v[64:67], v[28:31], v[176:179]
  ds_read_b128 v[36:39], v13 offset:29696
  v_mfma_f32_16x16x32_bf16 v[152:155], v[68:71], v[24:27], v[152:155]
  ds_read_b128 v[40:43], v12 offset:30720
  v_mfma_f32_16x16x32_bf16 v[180:183], v[68:71], v[28:31], v[180:183]
  ds_read_b128 v[44:47], v12 offset:31744
  v_mfma_f32_16x16x32_bf16 v[156:159], v[72:75], v[24:27], v[156:159]
  ds_read_b128 v[48:51], v12 offset:32768
  v_mfma_f32_16x16x32_bf16 v[184:187], v[72:75], v[28:31], v[184:187]
  ds_read_b128 v[52:55], v12 offset:33792
  v_mfma_f32_16x16x32_bf16 v[160:163], v[76:79], v[24:27], v[160:163]
  ds_read_b128 v[56:59], v12 offset:34816
  v_mfma_f32_16x16x32_bf16 v[188:191], v[76:79], v[28:31], v[188:191]
  v_mfma_f32_16x16x32_bf16 v[164:167], v[80:83], v[24:27], v[164:167]
  v_mfma_f32_16x16x32_bf16 v[192:195], v[80:83], v[28:31], v[192:195]
  v_mfma_f32_16x16x32_bf16 v[168:171], v[84:87], v[24:27], v[168:171]
  v_mfma_f32_16x16x32_bf16 v[196:199], v[84:87], v[28:31], v[196:199]
  s_waitcnt lgkmcnt(0)
  v_mfma_f32_16x16x32_bf16 v[144:147], v[32:35], v[16:19], v[144:147]
  ds_read_b128 v[24:27], v247 offset:0
  v_mfma_f32_16x16x32_bf16 v[172:175], v[32:35], v[20:23], v[172:175]
  ds_read_b128 v[60:63], v13 offset:30720
  v_mfma_f32_16x16x32_bf16 v[148:151], v[36:39], v[16:19], v[148:151]
  ds_read_b128 v[28:31], v247 offset:512
  v_mfma_f32_16x16x32_bf16 v[176:179], v[36:39], v[20:23], v[176:179]
  ds_read_b128 v[64:67], v13 offset:31744
  v_mfma_f32_16x16x32_bf16 v[152:155], v[40:43], v[16:19], v[152:155]
  ds_read_b128 v[68:71], v12 offset:35840
  v_mfma_f32_16x16x32_bf16 v[180:183], v[40:43], v[20:23], v[180:183]
  ds_read_b128 v[72:75], v12 offset:36864
  v_mfma_f32_16x16x32_bf16 v[156:159], v[44:47], v[16:19], v[156:159]
  ds_read_b128 v[76:79], v12 offset:37888
  v_mfma_f32_16x16x32_bf16 v[184:187], v[44:47], v[20:23], v[184:187]
  ds_read_b128 v[80:83], v12 offset:38912
  v_mfma_f32_16x16x32_bf16 v[160:163], v[48:51], v[16:19], v[160:163]
  ds_read_b128 v[84:87], v12 offset:39936
  v_mfma_f32_16x16x32_bf16 v[188:191], v[48:51], v[20:23], v[188:191]
  v_mfma_f32_16x16x32_bf16 v[164:167], v[52:55], v[16:19], v[164:167]
  v_mfma_f32_16x16x32_bf16 v[192:195], v[52:55], v[20:23], v[192:195]
  v_mfma_f32_16x16x32_bf16 v[168:171], v[56:59], v[16:19], v[168:171]
  v_mfma_f32_16x16x32_bf16 v[196:199], v[56:59], v[20:23], v[196:199]
  s_waitcnt lgkmcnt(0)
  s_barrier
  v_mfma_f32_16x16x32_bf16 v[144:147], v[60:63], v[24:27], v[144:147]
  ds_read_b128 v[16:19], v232 offset:0
  v_mfma_f32_16x16x32_bf16 v[172:175], v[60:63], v[28:31], v[172:175]
  ds_read_b128 v[32:35], v13 offset:0
  v_mfma_f32_16x16x32_bf16 v[148:151], v[64:67], v[24:27], v[148:151]
  ds_read_b128 v[20:23], v232 offset:512
  v_mfma_f32_16x16x32_bf16 v[176:179], v[64:67], v[28:31], v[176:179]
  ds_read_b128 v[36:39], v13 offset:1024
  v_mfma_f32_16x16x32_bf16 v[152:155], v[68:71], v[24:27], v[152:155]
  ds_read_b128 v[40:43], v12 offset:0
  v_mfma_f32_16x16x32_bf16 v[180:183], v[68:71], v[28:31], v[180:183]
  ds_read_b128 v[44:47], v12 offset:1024
  v_mfma_f32_16x16x32_bf16 v[156:159], v[72:75], v[24:27], v[156:159]
  ds_read_b128 v[48:51], v12 offset:2048
  v_mfma_f32_16x16x32_bf16 v[184:187], v[72:75], v[28:31], v[184:187]
  ds_read_b128 v[52:55], v12 offset:3072
  v_mfma_f32_16x16x32_bf16 v[160:163], v[76:79], v[24:27], v[160:163]
  ds_read_b128 v[56:59], v12 offset:4096
  v_mfma_f32_16x16x32_bf16 v[188:191], v[76:79], v[28:31], v[188:191]
  v_mfma_f32_16x16x32_bf16 v[164:167], v[80:83], v[24:27], v[164:167]
  v_mfma_f32_16x16x32_bf16 v[192:195], v[80:83], v[28:31], v[192:195]
  v_mfma_f32_16x16x32_bf16 v[168:171], v[84:87], v[24:27], v[168:171]
  v_mfma_f32_16x16x32_bf16 v[196:199], v[84:87], v[28:31], v[196:199]
L_kg_cC:
  s_waitcnt lgkmcnt(0)
  v_mfma_f32_16x16x32_bf16 v[88:91], v[32:35], v[16:19], v[88:91]
  ds_read_b128 v[24:27], v233 offset:0
  v_mfma_f32_16x16x32_bf16 v[116:119], v[32:35], v[20:23], v[116:119]
  ds_read_b128 v[60:63], v13 offset:2048
  v_mfma_f32_16x16x32_bf16 v[92:95], v[36:39], v[16:19], v[92:95]
  ds_read_b128 v[28:31], v233 offset:512
  v_mfma_f32_16x16x32_bf16 v[120:123], v[36:39], v[20:23], v[120:123]
  ds_read_b128 v[64:67], v13 offset:3072
  v_mfma_f32_16x16x32_bf16 v[96:99], v[40:43], v[16:19], v[96:99]
  ds_read_b128 v[68:71], v12 offset:5120
  v_mfma_f32_16x16x32_bf16 v[124:127], v[40:43], v[20:23], v[124:127]
  ds_read_b128 v[72:75], v12 offset:6144
  v_mfma_f32_16x16x32_bf16 v[100:103], v[44:47], v[16:19], v[100:103]
  ds_read_b128 v[76:79], v12 offset:7168
  v_mfma_f32_16x16x32_bf16 v[128:131], v[44:47], v[20:23], v[128:131]
  ds_read_b128 v[80:83], v12 offset:8192
  v_mfma_f32_16x16x32_bf16 v[104:107], v[48:51], v[16:19], v[104:107]
  ds_read_b128 v[84:87], v12 offset:9216
  v_mfma_f32_16x16x32_bf16 v[132:135], v[48:51], v[20:23], v[132:135]
  s_nop 7
  v_mul_f32 v200, v144, v144
  v_mfma_f32_16x16x32_bf16 v[108:111], v[52:55], v[16:19], v[108:111]
  v_mul_f32 v201, v145, v145
  v_mul_f32 v202, v146, v146
  v_mfma_f32_16x16x32_bf16 v[136:139], v[52:55], v[20:23], v[136:139]
  v_mul_f32 v203, v147, v147
  v_mul_f32 v204, v172, v172
  v_mfma_f32_16x16x32_bf16 v[112:115], v[56:59], v[16:19], v[112:115]
  v_mul_f32 v205, v173, v173
  v_mul_f32 v206, v174, v174
  v_mfma_f32_16x16x32_bf16 v[140:143], v[56:59], v[20:23], v[140:143]
  v_mul_f32 v207, v175, v175
  v_fma_f32 v200, v200, s64, v248
  s_waitcnt lgkmcnt(0)
  s_barrier
  v_mfma_f32_16x16x32_bf16 v[88:91], v[60:63], v[24:27], v[88:91]
  ds_read_b128 v[16:19], v234 offset:0
  v_mfma_f32_16x16x32_bf16 v[116:119], v[60:63], v[28:31], v[116:119]
  ds_read_b128 v[32:35], v13 offset:4096
  v_mfma_f32_16x16x32_bf16 v[92:95], v[64:67], v[24:27], v[92:95]
  ds_read_b128 v[20:23], v234 offset:512
  v_mfma_f32_16x16x32_bf16 v[120:123], v[64:67], v[28:31], v[120:123]
  ds_read_b128 v[36:39], v13 offset:5120
  v_mfma_f32_16x16x32_bf16 v[96:99], v[68:71], v[24:27], v[96:99]
  ds_read_b128 v[40:43], v12 offset:10240
  v_mfma_f32_16x16x32_bf16 v[124:127], v[68:71], v[28:31], v[124:127]
  ds_read_b128 v[44:47], v12 offset:11264
  v_mfma_f32_16x16x32_bf16 v[100:103], v[72:75], v[24:27], v[100:103]
  ds_read_b128 v[48:51], v12 offset:12288
  v_mfma_f32_16x16x32_bf16 v[128:131], v[72:75], v[28:31], v[128:131]
  ds_read_b128 v[52:55], v12 offset:13312
  v_mfma_f32_16x16x32_bf16 v[104:107], v[76:79], v[24:27], v[104:107]
  ds_read_b128 v[56:59], v12 offset:14336
  v_mfma_f32_16x16x32_bf16 v[132:135], v[76:79], v[28:31], v[132:135]
  v_fma_f32 v201, v201, s64, v248
  v_fma_f32 v202, v202, s64, v248
  v_mfma_f32_16x16x32_bf16 v[108:111], v[80:83], v[24:27], v[108:111]
  v_fma_f32 v203, v203, s64, v248
  v_fma_f32 v204, v204, s64, v248
  v_mfma_f32_16x16x32_bf16 v[136:139], v[80:83], v[28:31], v[136:139]
  v_fma_f32 v205, v205, s64, v248
  v_fma_f32 v206, v206, s64, v248
  v_mfma_f32_16x16x32_bf16 v[112:115], v[84:87], v[24:27], v[112:115]
  v_fma_f32 v207, v207, s64, v248
  v_mul_f32 v200, v200, v144
  v_mfma_f32_16x16x32_bf16 v[140:143], v[84:87], v[28:31], v[140:143]
  v_mul_f32 v201, v201, v145
  v_mul_f32 v202, v202, v146
  s_waitcnt lgkmcnt(0)
  v_mfma_f32_16x16x32_bf16 v[88:91], v[32:35], v[16:19], v[88:91]
  ds_read_b128 v[24:27], v235 offset:0
  v_mfma_f32_16x16x32_bf16 v[116:119], v[32:35], v[20:23], v[116:119]
  ds_read_b128 v[60:63], v13 offset:6144
  v_mfma_f32_16x16x32_bf16 v[92:95], v[36:39], v[16:19], v[92:95]
  ds_read_b128 v[28:31], v235 offset:512
  v_mfma_f32_16x16x32_bf16 v[120:123], v[36:39], v[20:23], v[120:123]
  ds_read_b128 v[64:67], v13 offset:7168
  v_mfma_f32_16x16x32_bf16 v[96:99], v[40:43], v[16:19], v[96:99]
  ds_read_b128 v[68:71], v12 offset:15360
  v_mfma_f32_16x16x32_bf16 v[124:127], v[40:43], v[20:23], v[124:127]
  ds_read_b128 v[72:75], v12 offset:16384
  v_mfma_f32_16x16x32_bf16 v[100:103], v[44:47], v[16:19], v[100:103]
  ds_read_b128 v[76:79], v12 offset:17408
  v_mfma_f32_16x16x32_bf16 v[128:131], v[44:47], v[20:23], v[128:131]
  ds_read_b128 v[80:83], v12 offset:18432
  v_mfma_f32_16x16x32_bf16 v[104:107], v[48:51], v[16:19], v[104:107]
  ds_read_b128 v[84:87], v12 offset:19456
  v_mfma_f32_16x16x32_bf16 v[132:135], v[48:51], v[20:23], v[132:135]
  v_mul_f32 v203, v203, v147
  v_mul_f32 v204, v204, v172
  v_mfma_f32_16x16x32_bf16 v[108:111], v[52:55], v[16:19], v[108:111]
  v_mul_f32 v205, v205, v173
  v_mul_f32 v206, v206, v174
  v_mfma_f32_16x16x32_bf16 v[136:139], v[52:55], v[20:23], v[136:139]
  v_mul_f32 v207, v207, v175
  v_mfma_f32_16x16x32_bf16 v[112:115], v[56:59], v[16:19], v[112:115]
  v_exp_f32 v208, v200
  v_mfma_f32_16x16x32_bf16 v[140:143], v[56:59], v[20:23], v[140:143]
  v_exp_f32 v209, v201
  s_waitcnt lgkmcnt(0)
  s_barrier
  v_mfma_f32_16x16x32_bf16 v[88:91], v[60:63], v[24:27], v[88:91]
  ds_read_b128 v[16:19], v236 offset:0
  v_mfma_f32_16x16x32_bf16 v[116:119], v[60:63], v[28:31], v[116:119]
  ds_read_b128 v[32:35], v13 offset:8192
  v_mfma_f32_16x16x32_bf16 v[92:95], v[64:67], v[24:27], v[92:95]
  ds_read_b128 v[20:23], v236 offset:512
  v_mfma_f32_16x16x32_bf16 v[120:123], v[64:67], v[28:31], v[120:123]
  ds_read_b128 v[36:39], v13 offset:9216
  v_mfma_f32_16x16x32_bf16 v[96:99], v[68:71], v[24:27], v[96:99]
  ds_read_b128 v[40:43], v12 offset:20480
  v_mfma_f32_16x16x32_bf16 v[124:127], v[68:71], v[28:31], v[124:127]
  ds_read_b128 v[44:47], v12 offset:21504
  v_mfma_f32_16x16x32_bf16 v[100:103], v[72:75], v[24:27], v[100:103]
  ds_read_b128 v[48:51], v12 offset:22528
  v_mfma_f32_16x16x32_bf16 v[128:131], v[72:75], v[28:31], v[128:131]
  ds_read_b128 v[52:55], v12 offset:23552
  v_mfma_f32_16x16x32_bf16 v[104:107], v[76:79], v[24:27], v[104:107]
  ds_read_b128 v[56:59], v12 offset:24576
  v_mfma_f32_16x16x32_bf16 v[132:135], v[76:79], v[28:31], v[132:135]
  v_exp_f32 v210, v202
  v_mfma_f32_16x16x32_bf16 v[108:111], v[80:83], v[24:27], v[108:111]
  v_exp_f32 v211, v203
  v_mfma_f32_16x16x32_bf16 v[136:139], v[80:83], v[28:31], v[136:139]
  v_exp_f32 v212, v204
  v_mfma_f32_16x16x32_bf16 v[112:115], v[84:87], v[24:27], v[112:115]
  v_exp_f32 v213, v205
  v_mfma_f32_16x16x32_bf16 v[140:143], v[84:87], v[28:31], v[140:143]
  v_exp_f32 v214, v206
  s_waitcnt lgkmcnt(0)
  v_mfma_f32_16x16x32_bf16 v[88:91], v[32:35], v[16:19], v[88:91]
  ds_read_b128 v[24:27], v237 offset:0
  v_mfma_f32_16x16x32_bf16 v[116:119], v[32:35], v[20:23], v[116:119]
  ds_read_b128 v[60:63], v13 offset:10240
  v_mfma_f32_16x16x32_bf16 v[92:95], v[36:39], v[16:19], v[92:95]
  ds_read_b128 v[28:31], v237 offset:512
  v_mfma_f32_16x16x32_bf16 v[120:123], v[36:39], v[20:23], v[120:123]
  ds_read_b128 v[64:67], v13 offset:11264
  v_mfma_f32_16x16x32_bf16 v[96:99], v[40:43], v[16:19], v[96:99]
  ds_read_b128 v[68:71], v12 offset:25600
  v_mfma_f32_16x16x32_bf16 v[124:127], v[40:43], v[20:23], v[124:127]
  ds_read_b128 v[72:75], v12 offset:26624
  v_mfma_f32_16x16x32_bf16 v[100:103], v[44:47], v[16:19], v[100:103]
  ds_read_b128 v[76:79], v12 offset:27648
  v_mfma_f32_16x16x32_bf16 v[128:131], v[44:47], v[20:23], v[128:131]
  ds_read_b128 v[80:83], v12 offset:28672
  v_mfma_f32_16x16x32_bf16 v[104:107], v[48:51], v[16:19], v[104:107]
  ds_read_b128 v[84:87], v12 offset:29696
  v_mfma_f32_16x16x32_bf16 v[132:135], v[48:51], v[20:23], v[132:135]
  v_exp_f32 v215, v207
  v_mfma_f32_16x16x32_bf16 v[108:111], v[52:55], v[16:19], v[108:111]
  v_add_f32 v208, 1.0, v208
  v_add_f32 v209, 1.0, v209
  v_mfma_f32_16x16x32_bf16 v[136:139], v[52:55], v[20:23], v[136:139]
  v_add_f32 v210, 1.0, v210
  v_add_f32 v211, 1.0, v211
  v_mfma_f32_16x16x32_bf16 v[112:115], v[56:59], v[16:19], v[112:115]
  v_add_f32 v212, 1.0, v212
  v_add_f32 v213, 1.0, v213
  v_mfma_f32_16x16x32_bf16 v[140:143], v[56:59], v[20:23], v[140:143]
  v_add_f32 v214, 1.0, v214
  v_add_f32 v215, 1.0, v215
  s_waitcnt lgkmcnt(0)
  s_barrier
  v_mfma_f32_16x16x32_bf16 v[88:91], v[60:63], v[24:27], v[88:91]
  ds_read_b128 v[16:19], v238 offset:0
  v_mfma_f32_16x16x32_bf16 v[116:119], v[60:63], v[28:31], v[116:119]
  ds_read_b128 v[32:35], v13 offset:12288
  v_mfma_f32_16x16x32_bf16 v[92:95], v[64:67], v[24:27], v[92:95]
  ds_read_b128 v[20:23], v238 offset:512
  v_mfma_f32_16x16x32_bf16 v[120:123], v[64:67], v[28:31], v[120:123]
  ds_read_b128 v[36:39], v13 offset:13312
  v_mfma_f32_16x16x32_bf16 v[96:99], v[68:71], v[24:27], v[96:99]
  ds_read_b128 v[40:43], v12 offset:30720
  v_mfma_f32_16x16x32_bf16 v[124:127], v[68:71], v[28:31], v[124:127]
  ds_read_b128 v[44:47], v12 offset:31744
  v_mfma_f32_16x16x32_bf16 v[100:103], v[72:75], v[24:27], v[100:103]
  ds_read_b128 v[48:51], v12 offset:32768
  v_mfma_f32_16x16x32_bf16 v[128:131], v[72:75], v[28:31], v[128:131]
  ds_read_b128 v[52:55], v12 offset:33792
  v_mfma_f32_16x16x32_bf16 v[104:107], v[76:79], v[24:27], v[104:107]
  ds_read_b128 v[56:59], v12 offset:34816
  v_mfma_f32_16x16x32_bf16 v[132:135], v[76:79], v[28:31], v[132:135]
  v_rcp_f32 v208, v208
  v_mfma_f32_16x16x32_bf16 v[108:111], v[80:83], v[24:27], v[108:111]
  v_rcp_f32 v209, v209
  v_mfma_f32_16x16x32_bf16 v[136:139], v[80:83], v[28:31], v[136:139]
  v_rcp_f32 v210, v210
  v_mfma_f32_16x16x32_bf16 v[112:115], v[84:87], v[24:27], v[112:115]
  v_rcp_f32 v211, v211
  v_mfma_f32_16x16x32_bf16 v[140:143], v[84:87], v[28:31], v[140:143]
  v_rcp_f32 v212, v212
  s_waitcnt lgkmcnt(0)
  v_mfma_f32_16x16x32_bf16 v[88:91], v[32:35], v[16:19], v[88:91]
  ds_read_b128 v[24:27], v239 offset:0
  v_mfma_f32_16x16x32_bf16 v[116:119], v[32:35], v[20:23], v[116:119]
  ds_read_b128 v[60:63], v13 offset:14336
  v_mfma_f32_16x16x32_bf16 v[92:95], v[36:39], v[16:19], v[92:95]
  ds_read_b128 v[28:31], v239 offset:512
  v_mfma_f32_16x16x32_bf16 v[120:123], v[36:39], v[20:23], v[120:123]
  ds_read_b128 v[64:67], v13 offset:15360
  v_mfma_f32_16x16x32_bf16 v[96:99], v[40:43], v[16:19], v[96:99]
  ds_read_b128 v[68:71], v12 offset:35840
  v_mfma_f32_16x16x32_bf16 v[124:127], v[40:43], v[20:23], v[124:127]
  ds_read_b128 v[72:75], v12 offset:36864
  v_mfma_f32_16x16x32_bf16 v[100:103], v[44:47], v[16:19], v[100:103]
  ds_read_b128 v[76:79], v12 offset:37888
  v_mfma_f32_16x16x32_bf16 v[128:131], v[44:47], v[20:23], v[128:131]
  ds_read_b128 v[80:83], v12 offset:38912
  v_mfma_f32_16x16x32_bf16 v[104:107], v[48:51], v[16:19], v[104:107]
  ds_read_b128 v[84:87], v12 offset:39936
  v_mfma_f32_16x16x32_bf16 v[132:135], v[48:51], v[20:23], v[132:135]
  v_rcp_f32 v213, v213
  v_mfma_f32_16x16x32_bf16 v[108:111], v[52:55], v[16:19], v[108:111]
  v_rcp_f32 v214, v214
  v_mfma_f32_16x16x32_bf16 v[136:139], v[52:55], v[20:23], v[136:139]
  v_rcp_f32 v215, v215
  v_mfma_f32_16x16x32_bf16 v[112:115], v[56:59], v[16:19], v[112:115]
  v_mul_f32 v144, v144, v208
  v_mul_f32 v145, v145, v209
  v_mfma_f32_16x16x32_bf16 v[140:143], v[56:59], v[20:23], v[140:143]
  v_mul_f32 v146, v146, v210
  v_mul_f32 v147, v147, v211
  s_waitcnt lgkmcnt(0)
  s_barrier
  v_mfma_f32_16x16x32_bf16 v[88:91], v[60:63], v[24:27], v[88:91]
  ds_read_b128 v[16:19], v240 offset:0
  v_mfma_f32_16x16x32_bf16 v[116:119], v[60:63], v[28:31], v[116:119]
  ds_read_b128 v[32:35], v13 offset:16384
  v_mfma_f32_16x16x32_bf16 v[92:95], v[64:67], v[24:27], v[92:95]
  ds_read_b128 v[20:23], v240 offset:512
  v_mfma_f32_16x16x32_bf16 v[120:123], v[64:67], v[28:31], v[120:123]
  ds_read_b128 v[36:39], v13 offset:17408
  v_mfma_f32_16x16x32_bf16 v[96:99], v[68:71], v[24:27], v[96:99]
  ds_read_b128 v[40:43], v12 offset:0
  v_mfma_f32_16x16x32_bf16 v[124:127], v[68:71], v[28:31], v[124:127]
  ds_read_b128 v[44:47], v12 offset:1024
  v_mfma_f32_16x16x32_bf16 v[100:103], v[72:75], v[24:27], v[100:103]
  ds_read_b128 v[48:51], v12 offset:2048
  v_mfma_f32_16x16x32_bf16 v[128:131], v[72:75], v[28:31], v[128:131]
  ds_read_b128 v[52:55], v12 offset:3072
  v_mfma_f32_16x16x32_bf16 v[104:107], v[76:79], v[24:27], v[104:107]
  ds_read_b128 v[56:59], v12 offset:4096
  v_mfma_f32_16x16x32_bf16 v[132:135], v[76:79], v[28:31], v[132:135]
  v_mul_f32 v172, v172, v212
  v_mul_f32 v173, v173, v213
  v_mfma_f32_16x16x32_bf16 v[108:111], v[80:83], v[24:27], v[108:111]
  v_mul_f32 v174, v174, v214
  v_mul_f32 v175, v175, v215
  v_mfma_f32_16x16x32_bf16 v[136:139], v[80:83], v[28:31], v[136:139]
  v_mul_f32 v200, v148, v148
  v_mul_f32 v201, v149, v149
  v_mfma_f32_16x16x32_bf16 v[112:115], v[84:87], v[24:27], v[112:115]
  v_mul_f32 v202, v150, v150
  v_mul_f32 v203, v151, v151
  v_mfma_f32_16x16x32_bf16 v[140:143], v[84:87], v[28:31], v[140:143]
  v_mul_f32 v204, v176, v176
  v_mul_f32 v205, v177, v177
  s_waitcnt lgkmcnt(0)
  v_mfma_f32_16x16x32_bf16 v[88:91], v[32:35], v[16:19], v[88:91]
  ds_read_b128 v[24:27], v241 offset:0
  v_mfma_f32_16x16x32_bf16 v[116:119], v[32:35], v[20:23], v[116:119]
  ds_read_b128 v[60:63], v13 offset:18432
  v_mfma_f32_16x16x32_bf16 v[92:95], v[36:39], v[16:19], v[92:95]
  ds_read_b128 v[28:31], v241 offset:512
  v_mfma_f32_16x16x32_bf16 v[120:123], v[36:39], v[20:23], v[120:123]
  ds_read_b128 v[64:67], v13 offset:19456
  v_mfma_f32_16x16x32_bf16 v[96:99], v[40:43], v[16:19], v[96:99]
  ds_read_b128 v[68:71], v12 offset:5120
  v_mfma_f32_16x16x32_bf16 v[124:127], v[40:43], v[20:23], v[124:127]
  ds_read_b128 v[72:75], v12 offset:6144
  v_mfma_f32_16x16x32_bf16 v[100:103], v[44:47], v[16:19], v[100:103]
  ds_read_b128 v[76:79], v12 offset:7168
  v_mfma_f32_16x16x32_bf16 v[128:131], v[44:47], v[20:23], v[128:131]
  ds_read_b128 v[80:83], v12 offset:8192
  v_mfma_f32_16x16x32_bf16 v[104:107], v[48:51], v[16:19], v[104:107]
  ds_read_b128 v[84:87], v12 offset:9216
  v_mfma_f32_16x16x32_bf16 v[132:135], v[48:51], v[20:23], v[132:135]
  v_mul_f32 v206, v178, v178
  v_mul_f32 v207, v179, v179
  v_mfma_f32_16x16x32_bf16 v[108:111], v[52:55], v[16:19], v[108:111]
  v_fma_f32 v200, v200, s64, v248
  v_fma_f32 v201, v201, s64, v248
  v_mfma_f32_16x16x32_bf16 v[136:139], v[52:55], v[20:23], v[136:139]
  v_fma_f32 v202, v202, s64, v248
  v_fma_f32 v203, v203, s64, v248
  v_mfma_f32_16x16x32_bf16 v[112:115], v[56:59], v[16:19], v[112:115]
  v_fma_f32 v204, v204, s64, v248
  v_fma_f32 v205, v205, s64, v248
  v_mfma_f32_16x16x32_bf16 v[140:143], v[56:59], v[20:23], v[140:143]
  v_fma_f32 v206, v206, s64, v248
  v_fma_f32 v207, v207, s64, v248
  s_waitcnt lgkmcnt(0)
  s_barrier
  v_mfma_f32_16x16x32_bf16 v[88:91], v[60:63], v[24:27], v[88:91]
  ds_read_b128 v[16:19], v242 offset:0
  v_mfma_f32_16x16x32_bf16 v[116:119], v[60:63], v[28:31], v[116:119]
  ds_read_b128 v[32:35], v13 offset:20480
  v_mfma_f32_16x16x32_bf16 v[92:95], v[64:67], v[24:27], v[92:95]
  ds_read_b128 v[20:23], v242 offset:512
  v_mfma_f32_16x16x32_bf16 v[120:123], v[64:67], v[28:31], v[120:123]
  ds_read_b128 v[36:39], v13 offset:21504
  v_mfma_f32_16x16x32_bf16 v[96:99], v[68:71], v[24:27], v[96:99]
  ds_read_b128 v[40:43], v12 offset:10240
  v_mfma_f32_16x16x32_bf16 v[124:127], v[68:71], v[28:31], v[124:127]
  ds_read_b128 v[44:47], v12 offset:11264
  v_mfma_f32_16x16x32_bf16 v[100:103], v[72:75], v[24:27], v[100:103]
  ds_read_b128 v[48:51], v12 offset:12288
  v_mfma_f32_16x16x32_bf16 v[128:131], v[72:75], v[28:31], v[128:131]
  ds_read_b128 v[52:55], v12 offset:13312
  v_mfma_f32_16x16x32_bf16 v[104:107], v[76:79], v[24:27], v[104:107]
  ds_read_b128 v[56:59], v12 offset:14336
  v_mfma_f32_16x16x32_bf16 v[132:135], v[76:79], v[28:31], v[132:135]
  v_mul_f32 v200, v200, v148
  v_mul_f32 v201, v201, v149
  v_mfma_f32_16x16x32_bf16 v[108:111], v[80:83], v[24:27], v[108:111]
  v_mul_f32 v202, v202, v150
  v_mul_f32 v203, v203, v151
  v_mfma_f32_16x16x32_bf16 v[136:139], v[80:83], v[28:31], v[136:139]
  v_mul_f32 v204, v204, v176
  v_mul_f32 v205, v205, v177
  v_mfma_f32_16x16x32_bf16 v[112:115], v[84:87], v[24:27], v[112:115]
  v_mul_f32 v206, v206, v178
  v_mul_f32 v207, v207, v179
  v_mfma_f32_16x16x32_bf16 v[140:143], v[84:87], v[28:31], v[140:143]
  v_exp_f32 v208, v200
  s_waitcnt lgkmcnt(0)
  v_mfma_f32_16x16x32_bf16 v[88:91], v[32:35], v[16:19], v[88:91]
  ds_read_b128 v[24:27], v243 offset:0
  v_mfma_f32_16x16x32_bf16 v[116:119], v[32:35], v[20:23], v[116:119]
  ds_read_b128 v[60:63], v13 offset:22528
  v_mfma_f32_16x16x32_bf16 v[92:95], v[36:39], v[16:19], v[92:95]
  ds_read_b128 v[28:31], v243 offset:512
  v_mfma_f32_16x16x32_bf16 v[120:123], v[36:39], v[20:23], v[120:123]
  ds_read_b128 v[64:67], v13 offset:23552
  v_mfma_f32_16x16x32_bf16 v[96:99], v[40:43], v[16:19], v[96:99]
  ds_read_b128 v[68:71], v12 offset:15360
  v_mfma_f32_16x16x32_bf16 v[124:127], v[40:43], v[20:23], v[124:127]
  ds_read_b128 v[72:75], v12 offset:16384
  v_mfma_f32_16x16x32_bf16 v[100:103], v[44:47], v[16:19], v[100:103]
  ds_read_b128 v[76:79], v12 offset:17408
  v_mfma_f32_16x16x32_bf16 v[128:131], v[44:47], v[20:23], v[128:131]
  ds_read_b128 v[80:83], v12 offset:18432
  v_mfma_f32_16x16x32_bf16 v[104:107], v[48:51], v[16:19], v[104:107]
  ds_read_b128 v[84:87], v12 offset:19456
  v_mfma_f32_16x16x32_bf16 v[132:135], v[48:51], v[20:23], v[132:135]
  v_exp_f32 v209, v201
  v_mfma_f32_16x16x32_bf16 v[108:111], v[52:55], v[16:19], v[108:111]
  v_exp_f32 v210, v202
  v_mfma_f32_16x16x32_bf16 v[136:139], v[52:55], v[20:23], v[136:139]
  v_exp_f32 v211, v203
  v_mfma_f32_16x16x32_bf16 v[112:115], v[56:59], v[16:19], v[112:115]
  v_exp_f32 v212, v204
  v_mfma_f32_16x16x32_bf16 v[140:143], v[56:59], v[20:23], v[140:143]
  v_exp_f32 v213, v205
  s_waitcnt lgkmcnt(0)
  s_barrier
  v_mfma_f32_16x16x32_bf16 v[88:91], v[60:63], v[24:27], v[88:91]
  ds_read_b128 v[16:19], v244 offset:0
  v_mfma_f32_16x16x32_bf16 v[116:119], v[60:63], v[28:31], v[116:119]
  ds_read_b128 v[32:35], v13 offset:24576
  v_mfma_f32_16x16x32_bf16 v[92:95], v[64:67], v[24:27], v[92:95]
  ds_read_b128 v[20:23], v244 offset:512
  v_mfma_f32_16x16x32_bf16 v[120:123], v[64:67], v[28:31], v[120:123]
  ds_read_b128 v[36:39], v13 offset:25600
  v_mfma_f32_16x16x32_bf16 v[96:99], v[68:71], v[24:27], v[96:99]
  ds_read_b128 v[40:43], v12 offset:20480
  v_mfma_f32_16x16x32_bf16 v[124:127], v[68:71], v[28:31], v[124:127]
  ds_read_b128 v[44:47], v12 offset:21504
  v_mfma_f32_16x16x32_bf16 v[100:103], v[72:75], v[24:27], v[100:103]
  ds_read_b128 v[48:51], v12 offset:22528
  v_mfma_f32_16x16x32_bf16 v[128:131], v[72:75], v[28:31], v[128:131]
  ds_read_b128 v[52:55], v12 offset:23552
  v_mfma_f32_16x16x32_bf16 v[104:107], v[76:79], v[24:27], v[104:107]
  ds_read_b128 v[56:59], v12 offset:24576
  v_mfma_f32_16x16x32_bf16 v[132:135], v[76:79], v[28:31], v[132:135]
  v_exp_f32 v214, v206
  v_mfma_f32_16x16x32_bf16 v[108:111], v[80:83], v[24:27], v[108:111]
  v_exp_f32 v215, v207
  v_mfma_f32_16x16x32_bf16 v[136:139], v[80:83], v[28:31], v[136:139]
  v_add_f32 v208, 1.0, v208
  v_add_f32 v209, 1.0, v209
  v_mfma_f32_16x16x32_bf16 v[112:115], v[84:87], v[24:27], v[112:115]
  v_add_f32 v210, 1.0, v210
  v_add_f32 v211, 1.0, v211
  v_mfma_f32_16x16x32_bf16 v[140:143], v[84:87], v[28:31], v[140:143]
  v_add_f32 v212, 1.0, v212
  v_add_f32 v213, 1.0, v213
  s_waitcnt lgkmcnt(0)
  v_mfma_f32_16x16x32_bf16 v[88:91], v[32:35], v[16:19], v[88:91]
  ds_read_b128 v[24:27], v245 offset:0
  v_mfma_f32_16x16x32_bf16 v[116:119], v[32:35], v[20:23], v[116:119]
  ds_read_b128 v[60:63], v13 offset:26624
  v_mfma_f32_16x16x32_bf16 v[92:95], v[36:39], v[16:19], v[92:95]
  ds_read_b128 v[28:31], v245 offset:512
  v_mfma_f32_16x16x32_bf16 v[120:123], v[36:39], v[20:23], v[120:123]
  ds_read_b128 v[64:67], v13 offset:27648
  v_mfma_f32_16x16x32_bf16 v[96:99], v[40:43], v[16:19], v[96:99]
  ds_read_b128 v[68:71], v12 offset:25600
  v_mfma_f32_16x16x32_bf16 v[124:127], v[40:43], v[20:23], v[124:127]
  ds_read_b128 v[72:75], v12 offset:26624
  v_mfma_f32_16x16x32_bf16 v[100:103], v[44:47], v[16:19], v[100:103]
  ds_read_b128 v[76:79], v12 offset:27648
  v_mfma_f32_16x16x32_bf16 v[128:131], v[44:47], v[20:23], v[128:131]
  ds_read_b128 v[80:83], v12 offset:28672
  v_mfma_f32_16x16x32_bf16 v[104:107], v[48:51], v[16:19], v[104:107]
  ds_read_b128 v[84:87], v12 offset:29696
  v_mfma_f32_16x16x32_bf16 v[132:135], v[48:51], v[20:23], v[132:135]
  v_add_f32 v214, 1.0, v214
  v_add_f32 v215, 1.0, v215
  v_mfma_f32_16x16x32_bf16 v[108:111], v[52:55], v[16:19], v[108:111]
  v_rcp_f32 v208, v208
  v_mfma_f32_16x16x32_bf16 v[136:139], v[52:55], v[20:23], v[136:139]
  v_rcp_f32 v209, v209
  v_mfma_f32_16x16x32_bf16 v[112:115], v[56:59], v[16:19], v[112:115]
  v_rcp_f32 v210, v210
  v_mfma_f32_16x16x32_bf16 v[140:143], v[56:59], v[20:23], v[140:143]
  v_rcp_f32 v211, v211
  s_waitcnt lgkmcnt(0)
  s_barrier
  v_mfma_f32_16x16x32_bf16 v[88:91], v[60:63], v[24:27], v[88:91]
  ds_read_b128 v[16:19], v246 offset:0
  v_mfma_f32_16x16x32_bf16 v[116:119], v[60:63], v[28:31], v[116:119]
  ds_read_b128 v[32:35], v13 offset:28672
  v_mfma_f32_16x16x32_bf16 v[92:95], v[64:67], v[24:27], v[92:95]
  ds_read_b128 v[20:23], v246 offset:512
  v_mfma_f32_16x16x32_bf16 v[120:123], v[64:67], v[28:31], v[120:123]
  ds_read_b128 v[36:39], v13 offset:29696
  v_mfma_f32_16x16x32_bf16 v[96:99], v[68:71], v[24:27], v[96:99]
  ds_read_b128 v[40:43], v12 offset:30720
  v_mfma_f32_16x16x32_bf16 v[124:127], v[68:71], v[28:31], v[124:127]
  ds_read_b128 v[44:47], v12 offset:31744
  v_mfma_f32_16x16x32_bf16 v[100:103], v[72:75], v[24:27], v[100:103]
  ds_read_b128 v[48:51], v12 offset:32768
  v_mfma_f32_16x16x32_bf16 v[128:131], v[72:75], v[28:31], v[128:131]
  ds_read_b128 v[52:55], v12 offset:33792
  v_mfma_f32_16x16x32_bf16 v[104:107], v[76:79], v[24:27], v[104:107]
  ds_read_b128 v[56:59], v12 offset:34816
  v_mfma_f32_16x16x32_bf16 v[132:135], v[76:79], v[28:31], v[132:135]
  v_rcp_f32 v212, v212
  v_mfma_f32_16x16x32_bf16 v[108:111], v[80:83], v[24:27], v[108:111]
  v_rcp_f32 v213, v213
  v_mfma_f32_16x16x32_bf16 v[136:139], v[80:83], v[28:31], v[136:139]
  v_rcp_f32 v214, v214
  v_mfma_f32_16x16x32_bf16 v[112:115], v[84:87], v[24:27], v[112:115]
  v_rcp_f32 v215, v215
  v_mfma_f32_16x16x32_bf16 v[140:143], v[84:87], v[28:31], v[140:143]
  v_mul_f32 v148, v148, v208
  v_mul_f32 v149, v149, v209
  s_waitcnt lgkmcnt(0)
  v_mfma_f32_16x16x32_bf16 v[88:91], v[32:35], v[16:19], v[88:91]
  ds_read_b128 v[24:27], v247 offset:0
  v_mfma_f32_16x16x32_bf16 v[116:119], v[32:35], v[20:23], v[116:119]
  ds_read_b128 v[60:63], v13 offset:30720
  v_mfma_f32_16x16x32_bf16 v[92:95], v[36:39], v[16:19], v[92:95]
  ds_read_b128 v[28:31], v247 offset:512
  v_mfma_f32_16x16x32_bf16 v[120:123], v[36:39], v[20:23], v[120:123]
  ds_read_b128 v[64:67], v13 offset:31744
  v_mfma_f32_16x16x32_bf16 v[96:99], v[40:43], v[16:19], v[96:99]
  ds_read_b128 v[68:71], v12 offset:35840
  v_mfma_f32_16x16x32_bf16 v[124:127], v[40:43], v[20:23], v[124:127]
  ds_read_b128 v[72:75], v12 offset:36864
  v_mfma_f32_16x16x32_bf16 v[100:103], v[44:47], v[16:19], v[100:103]
  ds_read_b128 v[76:79], v12 offset:37888
  v_mfma_f32_16x16x32_bf16 v[128:131], v[44:47], v[20:23], v[128:131]
  ds_read_b128 v[80:83], v12 offset:38912
  v_mfma_f32_16x16x32_bf16 v[104:107], v[48:51], v[16:19], v[104:107]
  ds_read_b128 v[84:87], v12 offset:39936
  v_mfma_f32_16x16x32_bf16 v[132:135], v[48:51], v[20:23], v[132:135]
  v_mul_f32 v150, v150, v210
  v_mul_f32 v151, v151, v211
  v_mfma_f32_16x16x32_bf16 v[108:111], v[52:55], v[16:19], v[108:111]
  v_mul_f32 v176, v176, v212
  v_mul_f32 v177, v177, v213
  v_mfma_f32_16x16x32_bf16 v[136:139], v[52:55], v[20:23], v[136:139]
  v_mul_f32 v178, v178, v214
  v_mul_f32 v179, v179, v215
  v_mfma_f32_16x16x32_bf16 v[112:115], v[56:59], v[16:19], v[112:115]
  v_mul_f32 v200, v152, v152
  v_mul_f32 v201, v153, v153
  v_mfma_f32_16x16x32_bf16 v[140:143], v[56:59], v[20:23], v[140:143]
  v_mul_f32 v202, v154, v154
  v_mul_f32 v203, v155, v155
  s_waitcnt lgkmcnt(0)
  s_barrier
  v_mfma_f32_16x16x32_bf16 v[88:91], v[60:63], v[24:27], v[88:91]
  ds_read_b128 v[16:19], v232 offset:0
  v_mfma_f32_16x16x32_bf16 v[116:119], v[60:63], v[28:31], v[116:119]
  ds_read_b128 v[32:35], v13 offset:0
  v_mfma_f32_16x16x32_bf16 v[92:95], v[64:67], v[24:27], v[92:95]
  ds_read_b128 v[20:23], v232 offset:512
  v_mfma_f32_16x16x32_bf16 v[120:123], v[64:67], v[28:31], v[120:123]
  ds_read_b128 v[36:39], v13 offset:1024
  v_mfma_f32_16x16x32_bf16 v[96:99], v[68:71], v[24:27], v[96:99]
  ds_read_b128 v[40:43], v12 offset:0
  v_mfma_f32_16x16x32_bf16 v[124:127], v[68:71], v[28:31], v[124:127]
  ds_read_b128 v[44:47], v12 offset:1024
  v_mfma_f32_16x16x32_bf16 v[100:103], v[72:75], v[24:27], v[100:103]
  ds_read_b128 v[48:51], v12 offset:2048
  v_mfma_f32_16x16x32_bf16 v[128:131], v[72:75], v[28:31], v[128:131]
  ds_read_b128 v[52:55], v12 offset:3072
  v_mfma_f32_16x16x32_bf16 v[104:107], v[76:79], v[24:27], v[104:107]
  ds_read_b128 v[56:59], v12 offset:4096
  v_mfma_f32_16x16x32_bf16 v[132:135], v[76:79], v[28:31], v[132:135]
  v_mul_f32 v204, v180, v180
  v_mul_f32 v205, v181, v181
  v_mfma_f32_16x16x32_bf16 v[108:111], v[80:83], v[24:27], v[108:111]
  v_mul_f32 v206, v182, v182
  v_mul_f32 v207, v183, v183
  v_mfma_f32_16x16x32_bf16 v[136:139], v[80:83], v[28:31], v[136:139]
  v_fma_f32 v200, v200, s64, v248
  v_fma_f32 v201, v201, s64, v248
  v_mfma_f32_16x16x32_bf16 v[112:115], v[84:87], v[24:27], v[112:115]
  v_fma_f32 v202, v202, s64, v248
  v_fma_f32 v203, v203, s64, v248
  v_mfma_f32_16x16x32_bf16 v[140:143], v[84:87], v[28:31], v[140:143]
  v_fma_f32 v204, v204, s64, v248
  v_fma_f32 v205, v205, s64, v248
  s_waitcnt lgkmcnt(0)
  v_mfma_f32_16x16x32_bf16 v[88:91], v[32:35], v[16:19], v[88:91]
  ds_read_b128 v[24:27], v233 offset:0
  v_mfma_f32_16x16x32_bf16 v[116:119], v[32:35], v[20:23], v[116:119]
  ds_read_b128 v[60:63], v13 offset:2048
  v_mfma_f32_16x16x32_bf16 v[92:95], v[36:39], v[16:19], v[92:95]
  ds_read_b128 v[28:31], v233 offset:512
  v_mfma_f32_16x16x32_bf16 v[120:123], v[36:39], v[20:23], v[120:123]
  ds_read_b128 v[64:67], v13 offset:3072
  v_mfma_f32_16x16x32_bf16 v[96:99], v[40:43], v[16:19], v[96:99]
  ds_read_b128 v[68:71], v12 offset:5120
  v_mfma_f32_16x16x32_bf16 v[124:127], v[40:43], v[20:23], v[124:127]
  ds_read_b128 v[72:75], v12 offset:6144
  v_mfma_f32_16x16x32_bf16 v[100:103], v[44:47], v[16:19], v[100:103]
  ds_read_b128 v[76:79], v12 offset:7168
  v_mfma_f32_16x16x32_bf16 v[128:131], v[44:47], v[20:23], v[128:131]
  ds_read_b128 v[80:83], v12 offset:8192
  v_mfma_f32_16x16x32_bf16 v[104:107], v[48:51], v[16:19], v[104:107]
  ds_read_b128 v[84:87], v12 offset:9216
  v_mfma_f32_16x16x32_bf16 v[132:135], v[48:51], v[20:23], v[132:135]
  v_fma_f32 v206, v206, s64, v248
  v_fma_f32 v207, v207, s64, v248
  v_mfma_f32_16x16x32_bf16 v[108:111], v[52:55], v[16:19], v[108:111]
  v_mul_f32 v200, v200, v152
  v_mul_f32 v201, v201, v153
  v_mfma_f32_16x16x32_bf16 v[136:139], v[52:55], v[20:23], v[136:139]
  v_mul_f32 v202, v202, v154
  v_mul_f32 v203, v203, v155
  v_mfma_f32_16x16x32_bf16 v[112:115], v[56:59], v[16:19], v[112:115]
  v_mul_f32 v204, v204, v180
  v_mul_f32 v205, v205, v181
  v_mfma_f32_16x16x32_bf16 v[140:143], v[56:59], v[20:23], v[140:143]
  v_mul_f32 v206, v206, v182
  v_mul_f32 v207, v207, v183
  s_waitcnt lgkmcnt(0)
  s_barrier
  v_mfma_f32_16x16x32_bf16 v[88:91], v[60:63], v[24:27], v[88:91]
  ds_read_b128 v[16:19], v234 offset:0
  v_mfma_f32_16x16x32_bf16 v[116:119], v[60:63], v[28:31], v[116:119]
  ds_read_b128 v[32:35], v13 offset:4096
  v_mfma_f32_16x16x32_bf16 v[92:95], v[64:67], v[24:27], v[92:95]
  ds_read_b128 v[20:23], v234 offset:512
  v_mfma_f32_16x16x32_bf16 v[120:123], v[64:67], v[28:31], v[120:123]
  ds_read_b128 v[36:39], v13 offset:5120
  v_mfma_f32_16x16x32_bf16 v[96:99], v[68:71], v[24:27], v[96:99]
  ds_read_b128 v[40:43], v12 offset:10240
  v_mfma_f32_16x16x32_bf16 v[124:127], v[68:71], v[28:31], v[124:127]
  ds_read_b128 v[44:47], v12 offset:11264
  v_mfma_f32_16x16x32_bf16 v[100:103], v[72:75], v[24:27], v[100:103]
  ds_read_b128 v[48:51], v12 offset:12288
  v_mfma_f32_16x16x32_bf16 v[128:131], v[72:75], v[28:31], v[128:131]
  ds_read_b128 v[52:55], v12 offset:13312
  v_mfma_f32_16x16x32_bf16 v[104:107], v[76:79], v[24:27], v[104:107]
  ds_read_b128 v[56:59], v12 offset:14336
  v_mfma_f32_16x16x32_bf16 v[132:135], v[76:79], v[28:31], v[132:135]
  v_exp_f32 v208, v200
  v_mfma_f32_16x16x32_bf16 v[108:111], v[80:83], v[24:27], v[108:111]
  v_exp_f32 v209, v201
  v_mfma_f32_16x16x32_bf16 v[136:139], v[80:83], v[28:31], v[136:139]
  v_exp_f32 v210, v202
  v_mfma_f32_16x16x32_bf16 v[112:115], v[84:87], v[24:27], v[112:115]
  v_exp_f32 v211, v203
  v_mfma_f32_16x16x32_bf16 v[140:143], v[84:87], v[28:31], v[140:143]
  v_exp_f32 v212, v204
  s_waitcnt lgkmcnt(0)
  v_mfma_f32_16x16x32_bf16 v[88:91], v[32:35], v[16:19], v[88:91]
  ds_read_b128 v[24:27], v235 offset:0
  v_mfma_f32_16x16x32_bf16 v[116:119], v[32:35], v[20:23], v[116:119]
  ds_read_b128 v[60:63], v13 offset:6144
  v_mfma_f32_16x16x32_bf16 v[92:95], v[36:39], v[16:19], v[92:95]
  ds_read_b128 v[28:31], v235 offset:512
  v_mfma_f32_16x16x32_bf16 v[120:123], v[36:39], v[20:23], v[120:123]
  ds_read_b128 v[64:67], v13 offset:7168
  v_mfma_f32_16x16x32_bf16 v[96:99], v[40:43], v[16:19], v[96:99]
  ds_read_b128 v[68:71], v12 offset:15360
  v_mfma_f32_16x16x32_bf16 v[124:127], v[40:43], v[20:23], v[124:127]
  ds_read_b128 v[72:75], v12 offset:16384
  v_mfma_f32_16x16x32_bf16 v[100:103], v[44:47], v[16:19], v[100:103]
  ds_read_b128 v[76:79], v12 offset:17408
  v_mfma_f32_16x16x32_bf16 v[128:131], v[44:47], v[20:23], v[128:131]
  ds_read_b128 v[80:83], v12 offset:18432
  v_mfma_f32_16x16x32_bf16 v[104:107], v[48:51], v[16:19], v[104:107]
  ds_read_b128 v[84:87], v12 offset:19456
  v_mfma_f32_16x16x32_bf16 v[132:135], v[48:51], v[20:23], v[132:135]
  v_exp_f32 v213, v205
  v_mfma_f32_16x16x32_bf16 v[108:111], v[52:55], v[16:19], v[108:111]
  v_exp_f32 v214, v206
  v_mfma_f32_16x16x32_bf16 v[136:139], v[52:55], v[20:23], v[136:139]
  v_exp_f32 v215, v207
  v_mfma_f32_16x16x32_bf16 v[112:115], v[56:59], v[16:19], v[112:115]
  v_add_f32 v208, 1.0, v208
  v_add_f32 v209, 1.0, v209
  v_mfma_f32_16x16x32_bf16 v[140:143], v[56:59], v[20:23], v[140:143]
  v_add_f32 v210, 1.0, v210
  v_add_f32 v211, 1.0, v211
  s_waitcnt lgkmcnt(0)
  s_barrier
  v_mfma_f32_16x16x32_bf16 v[88:91], v[60:63], v[24:27], v[88:91]
  ds_read_b128 v[16:19], v236 offset:0
  v_mfma_f32_16x16x32_bf16 v[116:119], v[60:63], v[28:31], v[116:119]
  ds_read_b128 v[32:35], v13 offset:8192
  v_mfma_f32_16x16x32_bf16 v[92:95], v[64:67], v[24:27], v[92:95]
  ds_read_b128 v[20:23], v236 offset:512
  v_mfma_f32_16x16x32_bf16 v[120:123], v[64:67], v[28:31], v[120:123]
  ds_read_b128 v[36:39], v13 offset:9216
  v_mfma_f32_16x16x32_bf16 v[96:99], v[68:71], v[24:27], v[96:99]
  ds_read_b128 v[40:43], v12 offset:20480
  v_mfma_f32_16x16x32_bf16 v[124:127], v[68:71], v[28:31], v[124:127]
  ds_read_b128 v[44:47], v12 offset:21504
  v_mfma_f32_16x16x32_bf16 v[100:103], v[72:75], v[24:27], v[100:103]
  ds_read_b128 v[48:51], v12 offset:22528
  v_mfma_f32_16x16x32_bf16 v[128:131], v[72:75], v[28:31], v[128:131]
  ds_read_b128 v[52:55], v12 offset:23552
  v_mfma_f32_16x16x32_bf16 v[104:107], v[76:79], v[24:27], v[104:107]
  ds_read_b128 v[56:59], v12 offset:24576
  v_mfma_f32_16x16x32_bf16 v[132:135], v[76:79], v[28:31], v[132:135]
  v_add_f32 v212, 1.0, v212
  v_add_f32 v213, 1.0, v213
  v_mfma_f32_16x16x32_bf16 v[108:111], v[80:83], v[24:27], v[108:111]
  v_add_f32 v214, 1.0, v214
  v_add_f32 v215, 1.0, v215
  v_mfma_f32_16x16x32_bf16 v[136:139], v[80:83], v[28:31], v[136:139]
  v_rcp_f32 v208, v208
  v_mfma_f32_16x16x32_bf16 v[112:115], v[84:87], v[24:27], v[112:115]
  v_rcp_f32 v209, v209
  v_mfma_f32_16x16x32_bf16 v[140:143], v[84:87], v[28:31], v[140:143]
  v_rcp_f32 v210, v210
  s_waitcnt lgkmcnt(0)
  v_mfma_f32_16x16x32_bf16 v[88:91], v[32:35], v[16:19], v[88:91]
  ds_read_b128 v[24:27], v237 offset:0
  v_mfma_f32_16x16x32_bf16 v[116:119], v[32:35], v[20:23], v[116:119]
  ds_read_b128 v[60:63], v13 offset:10240
  v_mfma_f32_16x16x32_bf16 v[92:95], v[36:39], v[16:19], v[92:95]
  ds_read_b128 v[28:31], v237 offset:512
  v_mfma_f32_16x16x32_bf16 v[120:123], v[36:39], v[20:23], v[120:123]
  ds_read_b128 v[64:67], v13 offset:11264
  v_mfma_f32_16x16x32_bf16 v[96:99], v[40:43], v[16:19], v[96:99]
  ds_read_b128 v[68:71], v12 offset:25600
  v_mfma_f32_16x16x32_bf16 v[124:127], v[40:43], v[20:23], v[124:127]
  ds_read_b128 v[72:75], v12 offset:26624
  v_mfma_f32_16x16x32_bf16 v[100:103], v[44:47], v[16:19], v[100:103]
  ds_read_b128 v[76:79], v12 offset:27648
  v_mfma_f32_16x16x32_bf16 v[128:131], v[44:47], v[20:23], v[128:131]
  ds_read_b128 v[80:83], v12 offset:28672
  v_mfma_f32_16x16x32_bf16 v[104:107], v[48:51], v[16:19], v[104:107]
  ds_read_b128 v[84:87], v12 offset:29696
  v_mfma_f32_16x16x32_bf16 v[132:135], v[48:51], v[20:23], v[132:135]
  v_rcp_f32 v211, v211
  v_mfma_f32_16x16x32_bf16 v[108:111], v[52:55], v[16:19], v[108:111]
  v_rcp_f32 v212, v212
  v_mfma_f32_16x16x32_bf16 v[136:139], v[52:55], v[20:23], v[136:139]
  v_rcp_f32 v213, v213
  v_mfma_f32_16x16x32_bf16 v[112:115], v[56:59], v[16:19], v[112:115]
  v_rcp_f32 v214, v214
  v_mfma_f32_16x16x32_bf16 v[140:143], v[56:59], v[20:23], v[140:143]
  v_rcp_f32 v215, v215
  s_waitcnt lgkmcnt(0)
  s_barrier
  v_mfma_f32_16x16x32_bf16 v[88:91], v[60:63], v[24:27], v[88:91]
  ds_read_b128 v[16:19], v238 offset:0
  v_mfma_f32_16x16x32_bf16 v[116:119], v[60:63], v[28:31], v[116:119]
  ds_read_b128 v[32:35], v13 offset:12288
  v_mfma_f32_16x16x32_bf16 v[92:95], v[64:67], v[24:27], v[92:95]
  ds_read_b128 v[20:23], v238 offset:512
  v_mfma_f32_16x16x32_bf16 v[120:123], v[64:67], v[28:31], v[120:123]
  ds_read_b128 v[36:39], v13 offset:13312
  v_mfma_f32_16x16x32_bf16 v[96:99], v[68:71], v[24:27], v[96:99]
  ds_read_b128 v[40:43], v12 offset:30720
  v_mfma_f32_16x16x32_bf16 v[124:127], v[68:71], v[28:31], v[124:127]
  ds_read_b128 v[44:47], v12 offset:31744
  v_mfma_f32_16x16x32_bf16 v[100:103], v[72:75], v[24:27], v[100:103]
  ds_read_b128 v[48:51], v12 offset:32768
  v_mfma_f32_16x16x32_bf16 v[128:131], v[72:75], v[28:31], v[128:131]
  ds_read_b128 v[52:55], v12 offset:33792
  v_mfma_f32_16x16x32_bf16 v[104:107], v[76:79], v[24:27], v[104:107]
  ds_read_b128 v[56:59], v12 offset:34816
  v_mfma_f32_16x16x32_bf16 v[132:135], v[76:79], v[28:31], v[132:135]
  v_mul_f32 v152, v152, v208
  v_mul_f32 v153, v153, v209
  v_mfma_f32_16x16x32_bf16 v[108:111], v[80:83], v[24:27], v[108:111]
  v_mul_f32 v154, v154, v210
  v_mul_f32 v155, v155, v211
  v_mfma_f32_16x16x32_bf16 v[136:139], v[80:83], v[28:31], v[136:139]
  v_mul_f32 v180, v180, v212
  v_mul_f32 v181, v181, v213
  v_mfma_f32_16x16x32_bf16 v[112:115], v[84:87], v[24:27], v[112:115]
  v_mul_f32 v182, v182, v214
  v_mul_f32 v183, v183, v215
  v_mfma_f32_16x16x32_bf16 v[140:143], v[84:87], v[28:31], v[140:143]
  v_mul_f32 v200, v156, v156
  v_mul_f32 v201, v157, v157
  s_waitcnt lgkmcnt(0)
  v_mfma_f32_16x16x32_bf16 v[88:91], v[32:35], v[16:19], v[88:91]
  ds_read_b128 v[24:27], v239 offset:0
  v_mfma_f32_16x16x32_bf16 v[116:119], v[32:35], v[20:23], v[116:119]
  ds_read_b128 v[60:63], v13 offset:14336
  v_mfma_f32_16x16x32_bf16 v[92:95], v[36:39], v[16:19], v[92:95]
  ds_read_b128 v[28:31], v239 offset:512
  v_mfma_f32_16x16x32_bf16 v[120:123], v[36:39], v[20:23], v[120:123]
  ds_read_b128 v[64:67], v13 offset:15360
  v_mfma_f32_16x16x32_bf16 v[96:99], v[40:43], v[16:19], v[96:99]
  ds_read_b128 v[68:71], v12 offset:35840
  v_mfma_f32_16x16x32_bf16 v[124:127], v[40:43], v[20:23], v[124:127]
  ds_read_b128 v[72:75], v12 offset:36864
  v_mfma_f32_16x16x32_bf16 v[100:103], v[44:47], v[16:19], v[100:103]
  ds_read_b128 v[76:79], v12 offset:37888
  v_mfma_f32_16x16x32_bf16 v[128:131], v[44:47], v[20:23], v[128:131]
  ds_read_b128 v[80:83], v12 offset:38912
  v_mfma_f32_16x16x32_bf16 v[104:107], v[48:51], v[16:19], v[104:107]
  ds_read_b128 v[84:87], v12 offset:39936
  v_mfma_f32_16x16x32_bf16 v[132:135], v[48:51], v[20:23], v[132:135]
  v_mul_f32 v202, v158, v158
  v_mul_f32 v203, v159, v159
  v_mfma_f32_16x16x32_bf16 v[108:111], v[52:55], v[16:19], v[108:111]
  v_mul_f32 v204, v184, v184
  v_mul_f32 v205, v185, v185
  v_mfma_f32_16x16x32_bf16 v[136:139], v[52:55], v[20:23], v[136:139]
  v_mul_f32 v206, v186, v186
  v_mul_f32 v207, v187, v187
  v_mfma_f32_16x16x32_bf16 v[112:115], v[56:59], v[16:19], v[112:115]
  v_fma_f32 v200, v200, s64, v248
  v_fma_f32 v201, v201, s64, v248
  v_mfma_f32_16x16x32_bf16 v[140:143], v[56:59], v[20:23], v[140:143]
  v_fma_f32 v202, v202, s64, v248
  v_fma_f32 v203, v203, s64, v248
  s_waitcnt lgkmcnt(0)
  s_barrier
  v_mfma_f32_16x16x32_bf16 v[88:91], v[60:63], v[24:27], v[88:91]
  ds_read_b128 v[16:19], v240 offset:0
  v_mfma_f32_16x16x32_bf16 v[116:119], v[60:63], v[28:31], v[116:119]
  ds_read_b128 v[32:35], v13 offset:16384
  v_mfma_f32_16x16x32_bf16 v[92:95], v[64:67], v[24:27], v[92:95]
  ds_read_b128 v[20:23], v240 offset:512
  v_mfma_f32_16x16x32_bf16 v[120:123], v[64:67], v[28:31], v[120:123]
  ds_read_b128 v[36:39], v13 offset:17408
  v_mfma_f32_16x16x32_bf16 v[96:99], v[68:71], v[24:27], v[96:99]
  ds_read_b128 v[40:43], v12 offset:0
  v_mfma_f32_16x16x32_bf16 v[124:127], v[68:71], v[28:31], v[124:127]
  ds_read_b128 v[44:47], v12 offset:1024
  v_mfma_f32_16x16x32_bf16 v[100:103], v[72:75], v[24:27], v[100:103]
  ds_read_b128 v[48:51], v12 offset:2048
  v_mfma_f32_16x16x32_bf16 v[128:131], v[72:75], v[28:31], v[128:131]
  ds_read_b128 v[52:55], v12 offset:3072
  v_mfma_f32_16x16x32_bf16 v[104:107], v[76:79], v[24:27], v[104:107]
  ds_read_b128 v[56:59], v12 offset:4096
  v_mfma_f32_16x16x32_bf16 v[132:135], v[76:79], v[28:31], v[132:135]
  v_fma_f32 v204, v204, s64, v248
  v_fma_f32 v205, v205, s64, v248
  v_mfma_f32_16x16x32_bf16 v[108:111], v[80:83], v[24:27], v[108:111]
  v_fma_f32 v206, v206, s64, v248
  v_fma_f32 v207, v207, s64, v248
  v_mfma_f32_16x16x32_bf16 v[136:139], v[80:83], v[28:31], v[136:139]
  v_mul_f32 v200, v200, v156
  v_mul_f32 v201, v201, v157
  v_mfma_f32_16x16x32_bf16 v[112:115], v[84:87], v[24:27], v[112:115]
  v_mul_f32 v202, v202, v158
  v_mul_f32 v203, v203, v159
  v_mfma_f32_16x16x32_bf16 v[140:143], v[84:87], v[28:31], v[140:143]
  v_mul_f32 v204, v204, v184
  v_mul_f32 v205, v205, v185
  s_waitcnt lgkmcnt(0)
  v_mfma_f32_16x16x32_bf16 v[88:91], v[32:35], v[16:19], v[88:91]
  ds_read_b128 v[24:27], v241 offset:0
  v_mfma_f32_16x16x32_bf16 v[116:119], v[32:35], v[20:23], v[116:119]
  ds_read_b128 v[60:63], v13 offset:18432
  v_mfma_f32_16x16x32_bf16 v[92:95], v[36:39], v[16:19], v[92:95]
  ds_read_b128 v[28:31], v241 offset:512
  v_mfma_f32_16x16x32_bf16 v[120:123], v[36:39], v[20:23], v[120:123]
  ds_read_b128 v[64:67], v13 offset:19456
  v_mfma_f32_16x16x32_bf16 v[96:99], v[40:43], v[16:19], v[96:99]
  ds_read_b128 v[68:71], v12 offset:5120
  v_mfma_f32_16x16x32_bf16 v[124:127], v[40:43], v[20:23], v[124:127]
  ds_read_b128 v[72:75], v12 offset:6144
  v_mfma_f32_16x16x32_bf16 v[100:103], v[44:47], v[16:19], v[100:103]
  ds_read_b128 v[76:79], v12 offset:7168
  v_mfma_f32_16x16x32_bf16 v[128:131], v[44:47], v[20:23], v[128:131]
  ds_read_b128 v[80:83], v12 offset:8192
  v_mfma_f32_16x16x32_bf16 v[104:107], v[48:51], v[16:19], v[104:107]
  ds_read_b128 v[84:87], v12 offset:9216
  v_mfma_f32_16x16x32_bf16 v[132:135], v[48:51], v[20:23], v[132:135]
  v_mul_f32 v206, v206, v186
  v_mul_f32 v207, v207, v187
  v_mfma_f32_16x16x32_bf16 v[108:111], v[52:55], v[16:19], v[108:111]
  v_exp_f32 v208, v200
  v_mfma_f32_16x16x32_bf16 v[136:139], v[52:55], v[20:23], v[136:139]
  v_exp_f32 v209, v201
  v_mfma_f32_16x16x32_bf16 v[112:115], v[56:59], v[16:19], v[112:115]
  v_exp_f32 v210, v202
  v_mfma_f32_16x16x32_bf16 v[140:143], v[56:59], v[20:23], v[140:143]
  v_exp_f32 v211, v203
  s_waitcnt lgkmcnt(0)
  s_barrier
  v_mfma_f32_16x16x32_bf16 v[88:91], v[60:63], v[24:27], v[88:91]
  ds_read_b128 v[16:19], v242 offset:0
  v_mfma_f32_16x16x32_bf16 v[116:119], v[60:63], v[28:31], v[116:119]
  ds_read_b128 v[32:35], v13 offset:20480
  v_mfma_f32_16x16x32_bf16 v[92:95], v[64:67], v[24:27], v[92:95]
  ds_read_b128 v[20:23], v242 offset:512
  v_mfma_f32_16x16x32_bf16 v[120:123], v[64:67], v[28:31], v[120:123]
  ds_read_b128 v[36:39], v13 offset:21504
  v_mfma_f32_16x16x32_bf16 v[96:99], v[68:71], v[24:27], v[96:99]
  ds_read_b128 v[40:43], v12 offset:10240
  v_mfma_f32_16x16x32_bf16 v[124:127], v[68:71], v[28:31], v[124:127]
  ds_read_b128 v[44:47], v12 offset:11264
  v_mfma_f32_16x16x32_bf16 v[100:103], v[72:75], v[24:27], v[100:103]
  ds_read_b128 v[48:51], v12 offset:12288
  v_mfma_f32_16x16x32_bf16 v[128:131], v[72:75], v[28:31], v[128:131]
  ds_read_b128 v[52:55], v12 offset:13312
  v_mfma_f32_16x16x32_bf16 v[104:107], v[76:79], v[24:27], v[104:107]
  ds_read_b128 v[56:59], v12 offset:14336
  v_mfma_f32_16x16x32_bf16 v[132:135], v[76:79], v[28:31], v[132:135]
  v_exp_f32 v212, v204
  v_mfma_f32_16x16x32_bf16 v[108:111], v[80:83], v[24:27], v[108:111]
  v_exp_f32 v213, v205
  v_mfma_f32_16x16x32_bf16 v[136:139], v[80:83], v[28:31], v[136:139]
  v_exp_f32 v214, v206
  v_mfma_f32_16x16x32_bf16 v[112:115], v[84:87], v[24:27], v[112:115]
  v_exp_f32 v215, v207
  v_mfma_f32_16x16x32_bf16 v[140:143], v[84:87], v[28:31], v[140:143]
  v_add_f32 v208, 1.0, v208
  v_add_f32 v209, 1.0, v209
  s_waitcnt lgkmcnt(0)
  v_mfma_f32_16x16x32_bf16 v[88:91], v[32:35], v[16:19], v[88:91]
  ds_read_b128 v[24:27], v243 offset:0
  v_mfma_f32_16x16x32_bf16 v[116:119], v[32:35], v[20:23], v[116:119]
  ds_read_b128 v[60:63], v13 offset:22528
  v_mfma_f32_16x16x32_bf16 v[92:95], v[36:39], v[16:19], v[92:95]
  ds_read_b128 v[28:31], v243 offset:512
  v_mfma_f32_16x16x32_bf16 v[120:123], v[36:39], v[20:23], v[120:123]
  ds_read_b128 v[64:67], v13 offset:23552
  v_mfma_f32_16x16x32_bf16 v[96:99], v[40:43], v[16:19], v[96:99]
  ds_read_b128 v[68:71], v12 offset:15360
  v_mfma_f32_16x16x32_bf16 v[124:127], v[40:43], v[20:23], v[124:127]
  ds_read_b128 v[72:75], v12 offset:16384
  v_mfma_f32_16x16x32_bf16 v[100:103], v[44:47], v[16:19], v[100:103]
  ds_read_b128 v[76:79], v12 offset:17408
  v_mfma_f32_16x16x32_bf16 v[128:131], v[44:47], v[20:23], v[128:131]
  ds_read_b128 v[80:83], v12 offset:18432
  v_mfma_f32_16x16x32_bf16 v[104:107], v[48:51], v[16:19], v[104:107]
  ds_read_b128 v[84:87], v12 offset:19456
  v_mfma_f32_16x16x32_bf16 v[132:135], v[48:51], v[20:23], v[132:135]
  v_add_f32 v210, 1.0, v210
  v_add_f32 v211, 1.0, v211
  v_mfma_f32_16x16x32_bf16 v[108:111], v[52:55], v[16:19], v[108:111]
  v_add_f32 v212, 1.0, v212
  v_add_f32 v213, 1.0, v213
  v_mfma_f32_16x16x32_bf16 v[136:139], v[52:55], v[20:23], v[136:139]
  v_add_f32 v214, 1.0, v214
  v_add_f32 v215, 1.0, v215
  v_mfma_f32_16x16x32_bf16 v[112:115], v[56:59], v[16:19], v[112:115]
  v_rcp_f32 v208, v208
  v_mfma_f32_16x16x32_bf16 v[140:143], v[56:59], v[20:23], v[140:143]
  v_rcp_f32 v209, v209
  s_waitcnt lgkmcnt(0)
  s_barrier
  v_mfma_f32_16x16x32_bf16 v[88:91], v[60:63], v[24:27], v[88:91]
  ds_read_b128 v[16:19], v244 offset:0
  v_mfma_f32_16x16x32_bf16 v[116:119], v[60:63], v[28:31], v[116:119]
  ds_read_b128 v[32:35], v13 offset:24576
  v_mfma_f32_16x16x32_bf16 v[92:95], v[64:67], v[24:27], v[92:95]
  ds_read_b128 v[20:23], v244 offset:512
  v_mfma_f32_16x16x32_bf16 v[120:123], v[64:67], v[28:31], v[120:123]
  ds_read_b128 v[36:39], v13 offset:25600
  v_mfma_f32_16x16x32_bf16 v[96:99], v[68:71], v[24:27], v[96:99]
  ds_read_b128 v[40:43], v12 offset:20480
  v_mfma_f32_16x16x32_bf16 v[124:127], v[68:71], v[28:31], v[124:127]
  ds_read_b128 v[44:47], v12 offset:21504
  v_mfma_f32_16x16x32_bf16 v[100:103], v[72:75], v[24:27], v[100:103]
  ds_read_b128 v[48:51], v12 offset:22528
  v_mfma_f32_16x16x32_bf16 v[128:131], v[72:75], v[28:31], v[128:131]
  ds_read_b128 v[52:55], v12 offset:23552
  v_mfma_f32_16x16x32_bf16 v[104:107], v[76:79], v[24:27], v[104:107]
  ds_read_b128 v[56:59], v12 offset:24576
  v_mfma_f32_16x16x32_bf16 v[132:135], v[76:79], v[28:31], v[132:135]
  v_rcp_f32 v210, v210
  v_mfma_f32_16x16x32_bf16 v[108:111], v[80:83], v[24:27], v[108:111]
  v_rcp_f32 v211, v211
  v_mfma_f32_16x16x32_bf16 v[136:139], v[80:83], v[28:31], v[136:139]
  v_rcp_f32 v212, v212
  v_mfma_f32_16x16x32_bf16 v[112:115], v[84:87], v[24:27], v[112:115]
  v_rcp_f32 v213, v213
  v_mfma_f32_16x16x32_bf16 v[140:143], v[84:87], v[28:31], v[140:143]
  v_rcp_f32 v214, v214
  s_waitcnt lgkmcnt(0)
  v_mfma_f32_16x16x32_bf16 v[88:91], v[32:35], v[16:19], v[88:91]
  ds_read_b128 v[24:27], v245 offset:0
  v_mfma_f32_16x16x32_bf16 v[116:119], v[32:35], v[20:23], v[116:119]
  ds_read_b128 v[60:63], v13 offset:26624
  v_mfma_f32_16x16x32_bf16 v[92:95], v[36:39], v[16:19], v[92:95]
  ds_read_b128 v[28:31], v245 offset:512
  v_mfma_f32_16x16x32_bf16 v[120:123], v[36:39], v[20:23], v[120:123]
  ds_read_b128 v[64:67], v13 offset:27648
  v_mfma_f32_16x16x32_bf16 v[96:99], v[40:43], v[16:19], v[96:99]
  ds_read_b128 v[68:71], v12 offset:25600
  v_mfma_f32_16x16x32_bf16 v[124:127], v[40:43], v[20:23], v[124:127]
  ds_read_b128 v[72:75], v12 offset:26624
  v_mfma_f32_16x16x32_bf16 v[100:103], v[44:47], v[16:19], v[100:103]
  ds_read_b128 v[76:79], v12 offset:27648
  v_mfma_f32_16x16x32_bf16 v[128:131], v[44:47], v[20:23], v[128:131]
  ds_read_b128 v[80:83], v12 offset:28672
  v_mfma_f32_16x16x32_bf16 v[104:107], v[48:51], v[16:19], v[104:107]
  ds_read_b128 v[84:87], v12 offset:29696
  v_mfma_f32_16x16x32_bf16 v[132:135], v[48:51], v[20:23], v[132:135]
  v_rcp_f32 v215, v215
  v_mfma_f32_16x16x32_bf16 v[108:111], v[52:55], v[16:19], v[108:111]
  v_mul_f32 v156, v156, v208
  v_mul_f32 v157, v157, v209
  v_mfma_f32_16x16x32_bf16 v[136:139], v[52:55], v[20:23], v[136:139]
  v_mul_f32 v158, v158, v210
  v_mul_f32 v159, v159, v211
  v_mfma_f32_16x16x32_bf16 v[112:115], v[56:59], v[16:19], v[112:115]
  v_mul_f32 v184, v184, v212
  v_mul_f32 v185, v185, v213
  v_mfma_f32_16x16x32_bf16 v[140:143], v[56:59], v[20:23], v[140:143]
  v_mul_f32 v186, v186, v214
  v_mul_f32 v187, v187, v215
  s_waitcnt lgkmcnt(0)
  s_barrier
  v_mfma_f32_16x16x32_bf16 v[88:91], v[60:63], v[24:27], v[88:91]
  ds_read_b128 v[16:19], v246 offset:0
  v_mfma_f32_16x16x32_bf16 v[116:119], v[60:63], v[28:31], v[116:119]
  ds_read_b128 v[32:35], v13 offset:28672
  v_mfma_f32_16x16x32_bf16 v[92:95], v[64:67], v[24:27], v[92:95]
  ds_read_b128 v[20:23], v246 offset:512
  v_mfma_f32_16x16x32_bf16 v[120:123], v[64:67], v[28:31], v[120:123]
  ds_read_b128 v[36:39], v13 offset:29696
  v_mfma_f32_16x16x32_bf16 v[96:99], v[68:71], v[24:27], v[96:99]
  ds_read_b128 v[40:43], v12 offset:30720
  v_mfma_f32_16x16x32_bf16 v[124:127], v[68:71], v[28:31], v[124:127]
  ds_read_b128 v[44:47], v12 offset:31744
  v_mfma_f32_16x16x32_bf16 v[100:103], v[72:75], v[24:27], v[100:103]
  ds_read_b128 v[48:51], v12 offset:32768
  v_mfma_f32_16x16x32_bf16 v[128:131], v[72:75], v[28:31], v[128:131]
  ds_read_b128 v[52:55], v12 offset:33792
  v_mfma_f32_16x16x32_bf16 v[104:107], v[76:79], v[24:27], v[104:107]
  ds_read_b128 v[56:59], v12 offset:34816
  v_mfma_f32_16x16x32_bf16 v[132:135], v[76:79], v[28:31], v[132:135]
  v_mul_f32 v200, v160, v160
  v_mul_f32 v201, v161, v161
  v_mfma_f32_16x16x32_bf16 v[108:111], v[80:83], v[24:27], v[108:111]
  v_mul_f32 v202, v162, v162
  v_mul_f32 v203, v163, v163
  v_mfma_f32_16x16x32_bf16 v[136:139], v[80:83], v[28:31], v[136:139]
  v_mul_f32 v204, v188, v188
  v_mul_f32 v205, v189, v189
  v_mfma_f32_16x16x32_bf16 v[112:115], v[84:87], v[24:27], v[112:115]
  v_mul_f32 v206, v190, v190
  v_mul_f32 v207, v191, v191
  v_mfma_f32_16x16x32_bf16 v[140:143], v[84:87], v[28:31], v[140:143]
  v_fma_f32 v200, v200, s64, v248
  v_fma_f32 v201, v201, s64, v248
  s_waitcnt lgkmcnt(0)
  v_mfma_f32_16x16x32_bf16 v[88:91], v[32:35], v[16:19], v[88:91]
  ds_read_b128 v[24:27], v247 offset:0
  v_mfma_f32_16x16x32_bf16 v[116:119], v[32:35], v[20:23], v[116:119]
  ds_read_b128 v[60:63], v13 offset:30720
  v_mfma_f32_16x16x32_bf16 v[92:95], v[36:39], v[16:19], v[92:95]
  ds_read_b128 v[28:31], v247 offset:512
  v_mfma_f32_16x16x32_bf16 v[120:123], v[36:39], v[20:23], v[120:123]
  ds_read_b128 v[64:67], v13 offset:31744
  v_mfma_f32_16x16x32_bf16 v[96:99], v[40:43], v[16:19], v[96:99]
  ds_read_b128 v[68:71], v12 offset:35840
  v_mfma_f32_16x16x32_bf16 v[124:127], v[40:43], v[20:23], v[124:127]
  ds_read_b128 v[72:75], v12 offset:36864
  v_mfma_f32_16x16x32_bf16 v[100:103], v[44:47], v[16:19], v[100:103]
  ds_read_b128 v[76:79], v12 offset:37888
  v_mfma_f32_16x16x32_bf16 v[128:131], v[44:47], v[20:23], v[128:131]
  ds_read_b128 v[80:83], v12 offset:38912
  v_mfma_f32_16x16x32_bf16 v[104:107], v[48:51], v[16:19], v[104:107]
  ds_read_b128 v[84:87], v12 offset:39936
  v_mfma_f32_16x16x32_bf16 v[132:135], v[48:51], v[20:23], v[132:135]
  v_fma_f32 v202, v202, s64, v248
  v_fma_f32 v203, v203, s64, v248
  v_mfma_f32_16x16x32_bf16 v[108:111], v[52:55], v[16:19], v[108:111]
  v_fma_f32 v204, v204, s64, v248
  v_fma_f32 v205, v205, s64, v248
  v_mfma_f32_16x16x32_bf16 v[136:139], v[52:55], v[20:23], v[136:139]
  v_fma_f32 v206, v206, s64, v248
  v_fma_f32 v207, v207, s64, v248
  v_mfma_f32_16x16x32_bf16 v[112:115], v[56:59], v[16:19], v[112:115]
  v_mul_f32 v200, v200, v160
  v_mul_f32 v201, v201, v161
  v_mfma_f32_16x16x32_bf16 v[140:143], v[56:59], v[20:23], v[140:143]
  v_mul_f32 v202, v202, v162
  v_mul_f32 v203, v203, v163
  s_waitcnt lgkmcnt(0)
  s_barrier
  v_mfma_f32_16x16x32_bf16 v[88:91], v[60:63], v[24:27], v[88:91]
  ds_read_b128 v[16:19], v232 offset:0
  v_mfma_f32_16x16x32_bf16 v[116:119], v[60:63], v[28:31], v[116:119]
  ds_read_b128 v[32:35], v13 offset:0
  v_mfma_f32_16x16x32_bf16 v[92:95], v[64:67], v[24:27], v[92:95]
  ds_read_b128 v[20:23], v232 offset:512
  v_mfma_f32_16x16x32_bf16 v[120:123], v[64:67], v[28:31], v[120:123]
  ds_read_b128 v[36:39], v13 offset:1024
  v_mfma_f32_16x16x32_bf16 v[96:99], v[68:71], v[24:27], v[96:99]
  ds_read_b128 v[40:43], v12 offset:0
  v_mfma_f32_16x16x32_bf16 v[124:127], v[68:71], v[28:31], v[124:127]
  ds_read_b128 v[44:47], v12 offset:1024
  v_mfma_f32_16x16x32_bf16 v[100:103], v[72:75], v[24:27], v[100:103]
  ds_read_b128 v[48:51], v12 offset:2048
  v_mfma_f32_16x16x32_bf16 v[128:131], v[72:75], v[28:31], v[128:131]
  ds_read_b128 v[52:55], v12 offset:3072
  v_mfma_f32_16x16x32_bf16 v[104:107], v[76:79], v[24:27], v[104:107]
  ds_read_b128 v[56:59], v12 offset:4096
  v_mfma_f32_16x16x32_bf16 v[132:135], v[76:79], v[28:31], v[132:135]
  v_mul_f32 v204, v204, v188
  v_mul_f32 v205, v205, v189
  v_mfma_f32_16x16x32_bf16 v[108:111], v[80:83], v[24:27], v[108:111]
  v_mul_f32 v206, v206, v190
  v_mul_f32 v207, v207, v191
  v_mfma_f32_16x16x32_bf16 v[136:139], v[80:83], v[28:31], v[136:139]
  v_exp_f32 v208, v200
  v_mfma_f32_16x16x32_bf16 v[112:115], v[84:87], v[24:27], v[112:115]
  v_exp_f32 v209, v201
  v_mfma_f32_16x16x32_bf16 v[140:143], v[84:87], v[28:31], v[140:143]
  v_exp_f32 v210, v202
  s_waitcnt lgkmcnt(0)
  v_mfma_f32_16x16x32_bf16 v[88:91], v[32:35], v[16:19], v[88:91]
  ds_read_b128 v[24:27], v233 offset:0
  v_mfma_f32_16x16x32_bf16 v[116:119], v[32:35], v[20:23], v[116:119]
  ds_read_b128 v[60:63], v13 offset:2048
  v_mfma_f32_16x16x32_bf16 v[92:95], v[36:39], v[16:19], v[92:95]
  ds_read_b128 v[28:31], v233 offset:512
  v_mfma_f32_16x16x32_bf16 v[120:123], v[36:39], v[20:23], v[120:123]
  ds_read_b128 v[64:67], v13 offset:3072
  v_mfma_f32_16x16x32_bf16 v[96:99], v[40:43], v[16:19], v[96:99]
  ds_read_b128 v[68:71], v12 offset:5120
  v_mfma_f32_16x16x32_bf16 v[124:127], v[40:43], v[20:23], v[124:127]
  ds_read_b128 v[72:75], v12 offset:6144
  v_mfma_f32_16x16x32_bf16 v[100:103], v[44:47], v[16:19], v[100:103]
  ds_read_b128 v[76:79], v12 offset:7168
  v_mfma_f32_16x16x32_bf16 v[128:131], v[44:47], v[20:23], v[128:131]
  ds_read_b128 v[80:83], v12 offset:8192
  v_mfma_f32_16x16x32_bf16 v[104:107], v[48:51], v[16:19], v[104:107]
  ds_read_b128 v[84:87], v12 offset:9216
  v_mfma_f32_16x16x32_bf16 v[132:135], v[48:51], v[20:23], v[132:135]
  v_exp_f32 v211, v203
  v_mfma_f32_16x16x32_bf16 v[108:111], v[52:55], v[16:19], v[108:111]
  v_exp_f32 v212, v204
  v_mfma_f32_16x16x32_bf16 v[136:139], v[52:55], v[20:23], v[136:139]
  v_exp_f32 v213, v205
  v_mfma_f32_16x16x32_bf16 v[112:115], v[56:59], v[16:19], v[112:115]
  v_exp_f32 v214, v206
  v_mfma_f32_16x16x32_bf16 v[140:143], v[56:59], v[20:23], v[140:143]
  v_exp_f32 v215, v207
  s_waitcnt lgkmcnt(0)
  s_barrier
  v_mfma_f32_16x16x32_bf16 v[88:91], v[60:63], v[24:27], v[88:91]
  ds_read_b128 v[16:19], v234 offset:0
  v_mfma_f32_16x16x32_bf16 v[116:119], v[60:63], v[28:31], v[116:119]
  ds_read_b128 v[32:35], v13 offset:4096
  v_mfma_f32_16x16x32_bf16 v[92:95], v[64:67], v[24:27], v[92:95]
  ds_read_b128 v[20:23], v234 offset:512
  v_mfma_f32_16x16x32_bf16 v[120:123], v[64:67], v[28:31], v[120:123]
  ds_read_b128 v[36:39], v13 offset:5120
  v_mfma_f32_16x16x32_bf16 v[96:99], v[68:71], v[24:27], v[96:99]
  ds_read_b128 v[40:43], v12 offset:10240
  v_mfma_f32_16x16x32_bf16 v[124:127], v[68:71], v[28:31], v[124:127]
  ds_read_b128 v[44:47], v12 offset:11264
  v_mfma_f32_16x16x32_bf16 v[100:103], v[72:75], v[24:27], v[100:103]
  ds_read_b128 v[48:51], v12 offset:12288
  v_mfma_f32_16x16x32_bf16 v[128:131], v[72:75], v[28:31], v[128:131]
  ds_read_b128 v[52:55], v12 offset:13312
  v_mfma_f32_16x16x32_bf16 v[104:107], v[76:79], v[24:27], v[104:107]
  ds_read_b128 v[56:59], v12 offset:14336
  v_mfma_f32_16x16x32_bf16 v[132:135], v[76:79], v[28:31], v[132:135]
  v_add_f32 v208, 1.0, v208
  v_add_f32 v209, 1.0, v209
  v_mfma_f32_16x16x32_bf16 v[108:111], v[80:83], v[24:27], v[108:111]
  v_add_f32 v210, 1.0, v210
  v_add_f32 v211, 1.0, v211
  v_mfma_f32_16x16x32_bf16 v[136:139], v[80:83], v[28:31], v[136:139]
  v_add_f32 v212, 1.0, v212
  v_add_f32 v213, 1.0, v213
  v_mfma_f32_16x16x32_bf16 v[112:115], v[84:87], v[24:27], v[112:115]
  v_add_f32 v214, 1.0, v214
  v_add_f32 v215, 1.0, v215
  v_mfma_f32_16x16x32_bf16 v[140:143], v[84:87], v[28:31], v[140:143]
  v_rcp_f32 v208, v208
  s_waitcnt lgkmcnt(0)
  v_mfma_f32_16x16x32_bf16 v[88:91], v[32:35], v[16:19], v[88:91]
  ds_read_b128 v[24:27], v235 offset:0
  v_mfma_f32_16x16x32_bf16 v[116:119], v[32:35], v[20:23], v[116:119]
  ds_read_b128 v[60:63], v13 offset:6144
  v_mfma_f32_16x16x32_bf16 v[92:95], v[36:39], v[16:19], v[92:95]
  ds_read_b128 v[28:31], v235 offset:512
  v_mfma_f32_16x16x32_bf16 v[120:123], v[36:39], v[20:23], v[120:123]
  ds_read_b128 v[64:67], v13 offset:7168
  v_mfma_f32_16x16x32_bf16 v[96:99], v[40:43], v[16:19], v[96:99]
  ds_read_b128 v[68:71], v12 offset:15360
  v_mfma_f32_16x16x32_bf16 v[124:127], v[40:43], v[20:23], v[124:127]
  ds_read_b128 v[72:75], v12 offset:16384
  v_mfma_f32_16x16x32_bf16 v[100:103], v[44:47], v[16:19], v[100:103]
  ds_read_b128 v[76:79], v12 offset:17408
  v_mfma_f32_16x16x32_bf16 v[128:131], v[44:47], v[20:23], v[128:131]
  ds_read_b128 v[80:83], v12 offset:18432
  v_mfma_f32_16x16x32_bf16 v[104:107], v[48:51], v[16:19], v[104:107]
  ds_read_b128 v[84:87], v12 offset:19456
  v_mfma_f32_16x16x32_bf16 v[132:135], v[48:51], v[20:23], v[132:135]
  v_rcp_f32 v209, v209
  v_mfma_f32_16x16x32_bf16 v[108:111], v[52:55], v[16:19], v[108:111]
  v_rcp_f32 v210, v210
  v_mfma_f32_16x16x32_bf16 v[136:139], v[52:55], v[20:23], v[136:139]
  v_rcp_f32 v211, v211
  v_mfma_f32_16x16x32_bf16 v[112:115], v[56:59], v[16:19], v[112:115]
  v_rcp_f32 v212, v212
  v_mfma_f32_16x16x32_bf16 v[140:143], v[56:59], v[20:23], v[140:143]
  v_rcp_f32 v213, v213
  s_waitcnt lgkmcnt(0)
  s_barrier
  v_mfma_f32_16x16x32_bf16 v[88:91], v[60:63], v[24:27], v[88:91]
  ds_read_b128 v[16:19], v236 offset:0
  v_mfma_f32_16x16x32_bf16 v[116:119], v[60:63], v[28:31], v[116:119]
  ds_read_b128 v[32:35], v13 offset:8192
  v_mfma_f32_16x16x32_bf16 v[92:95], v[64:67], v[24:27], v[92:95]
  ds_read_b128 v[20:23], v236 offset:512
  v_mfma_f32_16x16x32_bf16 v[120:123], v[64:67], v[28:31], v[120:123]
  ds_read_b128 v[36:39], v13 offset:9216
  v_mfma_f32_16x16x32_bf16 v[96:99], v[68:71], v[24:27], v[96:99]
  ds_read_b128 v[40:43], v12 offset:20480
  v_mfma_f32_16x16x32_bf16 v[124:127], v[68:71], v[28:31], v[124:127]
  ds_read_b128 v[44:47], v12 offset:21504
  v_mfma_f32_16x16x32_bf16 v[100:103], v[72:75], v[24:27], v[100:103]
  ds_read_b128 v[48:51], v12 offset:22528
  v_mfma_f32_16x16x32_bf16 v[128:131], v[72:75], v[28:31], v[128:131]
  ds_read_b128 v[52:55], v12 offset:23552
  v_mfma_f32_16x16x32_bf16 v[104:107], v[76:79], v[24:27], v[104:107]
  ds_read_b128 v[56:59], v12 offset:24576
  v_mfma_f32_16x16x32_bf16 v[132:135], v[76:79], v[28:31], v[132:135]
  v_rcp_f32 v214, v214
  v_mfma_f32_16x16x32_bf16 v[108:111], v[80:83], v[24:27], v[108:111]
  v_rcp_f32 v215, v215
  v_mfma_f32_16x16x32_bf16 v[136:139], v[80:83], v[28:31], v[136:139]
  v_mul_f32 v160, v160, v208
  v_mul_f32 v161, v161, v209
  v_mfma_f32_16x16x32_bf16 v[112:115], v[84:87], v[24:27], v[112:115]
  v_mul_f32 v162, v162, v210
  v_mul_f32 v163, v163, v211
  v_mfma_f32_16x16x32_bf16 v[140:143], v[84:87], v[28:31], v[140:143]
  v_mul_f32 v188, v188, v212
  v_mul_f32 v189, v189, v213
  s_waitcnt lgkmcnt(0)
  v_mfma_f32_16x16x32_bf16 v[88:91], v[32:35], v[16:19], v[88:91]
  ds_read_b128 v[24:27], v237 offset:0
  v_mfma_f32_16x16x32_bf16 v[116:119], v[32:35], v[20:23], v[116:119]
  ds_read_b128 v[60:63], v13 offset:10240
  v_mfma_f32_16x16x32_bf16 v[92:95], v[36:39], v[16:19], v[92:95]
  ds_read_b128 v[28:31], v237 offset:512
  v_mfma_f32_16x16x32_bf16 v[120:123], v[36:39], v[20:23], v[120:123]
  ds_read_b128 v[64:67], v13 offset:11264
  v_mfma_f32_16x16x32_bf16 v[96:99], v[40:43], v[16:19], v[96:99]
  ds_read_b128 v[68:71], v12 offset:25600
  v_mfma_f32_16x16x32_bf16 v[124:127], v[40:43], v[20:23], v[124:127]
  ds_read_b128 v[72:75], v12 offset:26624
  v_mfma_f32_16x16x32_bf16 v[100:103], v[44:47], v[16:19], v[100:103]
  ds_read_b128 v[76:79], v12 offset:27648
  v_mfma_f32_16x16x32_bf16 v[128:131], v[44:47], v[20:23], v[128:131]
  ds_read_b128 v[80:83], v12 offset:28672
  v_mfma_f32_16x16x32_bf16 v[104:107], v[48:51], v[16:19], v[104:107]
  ds_read_b128 v[84:87], v12 offset:29696
  v_mfma_f32_16x16x32_bf16 v[132:135], v[48:51], v[20:23], v[132:135]
  v_mul_f32 v190, v190, v214
  v_mul_f32 v191, v191, v215
  v_mfma_f32_16x16x32_bf16 v[108:111], v[52:55], v[16:19], v[108:111]
  v_mul_f32 v200, v164, v164
  v_mul_f32 v201, v165, v165
  v_mfma_f32_16x16x32_bf16 v[136:139], v[52:55], v[20:23], v[136:139]
  v_mul_f32 v202, v166, v166
  v_mul_f32 v203, v167, v167
  v_mfma_f32_16x16x32_bf16 v[112:115], v[56:59], v[16:19], v[112:115]
  v_mul_f32 v204, v192, v192
  v_mul_f32 v205, v193, v193
  v_mfma_f32_16x16x32_bf16 v[140:143], v[56:59], v[20:23], v[140:143]
  v_mul_f32 v206, v194, v194
  v_mul_f32 v207, v195, v195
  s_waitcnt lgkmcnt(0)
  s_barrier
  v_mfma_f32_16x16x32_bf16 v[88:91], v[60:63], v[24:27], v[88:91]
  ds_read_b128 v[16:19], v238 offset:0
  v_mfma_f32_16x16x32_bf16 v[116:119], v[60:63], v[28:31], v[116:119]
  ds_read_b128 v[32:35], v13 offset:12288
  v_mfma_f32_16x16x32_bf16 v[92:95], v[64:67], v[24:27], v[92:95]
  ds_read_b128 v[20:23], v238 offset:512
  v_mfma_f32_16x16x32_bf16 v[120:123], v[64:67], v[28:31], v[120:123]
  ds_read_b128 v[36:39], v13 offset:13312
  v_mfma_f32_16x16x32_bf16 v[96:99], v[68:71], v[24:27], v[96:99]
  ds_read_b128 v[40:43], v12 offset:30720
  v_mfma_f32_16x16x32_bf16 v[124:127], v[68:71], v[28:31], v[124:127]
  ds_read_b128 v[44:47], v12 offset:31744
  v_mfma_f32_16x16x32_bf16 v[100:103], v[72:75], v[24:27], v[100:103]
  ds_read_b128 v[48:51], v12 offset:32768
  v_mfma_f32_16x16x32_bf16 v[128:131], v[72:75], v[28:31], v[128:131]
  ds_read_b128 v[52:55], v12 offset:33792
  v_mfma_f32_16x16x32_bf16 v[104:107], v[76:79], v[24:27], v[104:107]
  ds_read_b128 v[56:59], v12 offset:34816
  v_mfma_f32_16x16x32_bf16 v[132:135], v[76:79], v[28:31], v[132:135]
  v_fma_f32 v200, v200, s64, v248
  v_fma_f32 v201, v201, s64, v248
  v_mfma_f32_16x16x32_bf16 v[108:111], v[80:83], v[24:27], v[108:111]
  v_fma_f32 v202, v202, s64, v248
  v_fma_f32 v203, v203, s64, v248
  v_mfma_f32_16x16x32_bf16 v[136:139], v[80:83], v[28:31], v[136:139]
  v_fma_f32 v204, v204, s64, v248
  v_fma_f32 v205, v205, s64, v248
  v_mfma_f32_16x16x32_bf16 v[112:115], v[84:87], v[24:27], v[112:115]
  v_fma_f32 v206, v206, s64, v248
  v_fma_f32 v207, v207, s64, v248
  v_mfma_f32_16x16x32_bf16 v[140:143], v[84:87], v[28:31], v[140:143]
  v_mul_f32 v200, v200, v164
  v_mul_f32 v201, v201, v165
  s_waitcnt lgkmcnt(0)
  v_mfma_f32_16x16x32_bf16 v[88:91], v[32:35], v[16:19], v[88:91]
  ds_read_b128 v[24:27], v239 offset:0
  v_mfma_f32_16x16x32_bf16 v[116:119], v[32:35], v[20:23], v[116:119]
  ds_read_b128 v[60:63], v13 offset:14336
  v_mfma_f32_16x16x32_bf16 v[92:95], v[36:39], v[16:19], v[92:95]
  ds_read_b128 v[28:31], v239 offset:512
  v_mfma_f32_16x16x32_bf16 v[120:123], v[36:39], v[20:23], v[120:123]
  ds_read_b128 v[64:67], v13 offset:15360
  v_mfma_f32_16x16x32_bf16 v[96:99], v[40:43], v[16:19], v[96:99]
  ds_read_b128 v[68:71], v12 offset:35840
  v_mfma_f32_16x16x32_bf16 v[124:127], v[40:43], v[20:23], v[124:127]
  ds_read_b128 v[72:75], v12 offset:36864
  v_mfma_f32_16x16x32_bf16 v[100:103], v[44:47], v[16:19], v[100:103]
  ds_read_b128 v[76:79], v12 offset:37888
  v_mfma_f32_16x16x32_bf16 v[128:131], v[44:47], v[20:23], v[128:131]
  ds_read_b128 v[80:83], v12 offset:38912
  v_mfma_f32_16x16x32_bf16 v[104:107], v[48:51], v[16:19], v[104:107]
  ds_read_b128 v[84:87], v12 offset:39936
  v_mfma_f32_16x16x32_bf16 v[132:135], v[48:51], v[20:23], v[132:135]
  v_mul_f32 v202, v202, v166
  v_mul_f32 v203, v203, v167
  v_mfma_f32_16x16x32_bf16 v[108:111], v[52:55], v[16:19], v[108:111]
  v_mul_f32 v204, v204, v192
  v_mul_f32 v205, v205, v193
  v_mfma_f32_16x16x32_bf16 v[136:139], v[52:55], v[20:23], v[136:139]
  v_mul_f32 v206, v206, v194
  v_mul_f32 v207, v207, v195
  v_mfma_f32_16x16x32_bf16 v[112:115], v[56:59], v[16:19], v[112:115]
  v_exp_f32 v208, v200
  v_mfma_f32_16x16x32_bf16 v[140:143], v[56:59], v[20:23], v[140:143]
  v_exp_f32 v209, v201
  s_waitcnt lgkmcnt(0)
  s_barrier
  v_mfma_f32_16x16x32_bf16 v[88:91], v[60:63], v[24:27], v[88:91]
  ds_read_b128 v[16:19], v240 offset:0
  v_mfma_f32_16x16x32_bf16 v[116:119], v[60:63], v[28:31], v[116:119]
  ds_read_b128 v[32:35], v13 offset:16384
  v_mfma_f32_16x16x32_bf16 v[92:95], v[64:67], v[24:27], v[92:95]
  ds_read_b128 v[20:23], v240 offset:512
  v_mfma_f32_16x16x32_bf16 v[120:123], v[64:67], v[28:31], v[120:123]
  ds_read_b128 v[36:39], v13 offset:17408
  v_mfma_f32_16x16x32_bf16 v[96:99], v[68:71], v[24:27], v[96:99]
  ds_read_b128 v[40:43], v12 offset:0
  v_mfma_f32_16x16x32_bf16 v[124:127], v[68:71], v[28:31], v[124:127]
  ds_read_b128 v[44:47], v12 offset:1024
  v_mfma_f32_16x16x32_bf16 v[100:103], v[72:75], v[24:27], v[100:103]
  ds_read_b128 v[48:51], v12 offset:2048
  v_mfma_f32_16x16x32_bf16 v[128:131], v[72:75], v[28:31], v[128:131]
  ds_read_b128 v[52:55], v12 offset:3072
  v_mfma_f32_16x16x32_bf16 v[104:107], v[76:79], v[24:27], v[104:107]
  ds_read_b128 v[56:59], v12 offset:4096
  v_mfma_f32_16x16x32_bf16 v[132:135], v[76:79], v[28:31], v[132:135]
  v_exp_f32 v210, v202
  v_mfma_f32_16x16x32_bf16 v[108:111], v[80:83], v[24:27], v[108:111]
  v_exp_f32 v211, v203
  v_mfma_f32_16x16x32_bf16 v[136:139], v[80:83], v[28:31], v[136:139]
  v_exp_f32 v212, v204
  v_mfma_f32_16x16x32_bf16 v[112:115], v[84:87], v[24:27], v[112:115]
  v_exp_f32 v213, v205
  v_mfma_f32_16x16x32_bf16 v[140:143], v[84:87], v[28:31], v[140:143]
  v_exp_f32 v214, v206
  s_waitcnt lgkmcnt(0)
  v_mfma_f32_16x16x32_bf16 v[88:91], v[32:35], v[16:19], v[88:91]
  ds_read_b128 v[24:27], v241 offset:0
  v_mfma_f32_16x16x32_bf16 v[116:119], v[32:35], v[20:23], v[116:119]
  ds_read_b128 v[60:63], v13 offset:18432
  v_mfma_f32_16x16x32_bf16 v[92:95], v[36:39], v[16:19], v[92:95]
  ds_read_b128 v[28:31], v241 offset:512
  v_mfma_f32_16x16x32_bf16 v[120:123], v[36:39], v[20:23], v[120:123]
  ds_read_b128 v[64:67], v13 offset:19456
  v_mfma_f32_16x16x32_bf16 v[96:99], v[40:43], v[16:19], v[96:99]
  ds_read_b128 v[68:71], v12 offset:5120
  v_mfma_f32_16x16x32_bf16 v[124:127], v[40:43], v[20:23], v[124:127]
  ds_read_b128 v[72:75], v12 offset:6144
  v_mfma_f32_16x16x32_bf16 v[100:103], v[44:47], v[16:19], v[100:103]
  ds_read_b128 v[76:79], v12 offset:7168
  v_mfma_f32_16x16x32_bf16 v[128:131], v[44:47], v[20:23], v[128:131]
  ds_read_b128 v[80:83], v12 offset:8192
  v_mfma_f32_16x16x32_bf16 v[104:107], v[48:51], v[16:19], v[104:107]
  ds_read_b128 v[84:87], v12 offset:9216
  v_mfma_f32_16x16x32_bf16 v[132:135], v[48:51], v[20:23], v[132:135]
  v_exp_f32 v215, v207
  v_mfma_f32_16x16x32_bf16 v[108:111], v[52:55], v[16:19], v[108:111]
  v_add_f32 v208, 1.0, v208
  v_add_f32 v209, 1.0, v209
  v_mfma_f32_16x16x32_bf16 v[136:139], v[52:55], v[20:23], v[136:139]
  v_add_f32 v210, 1.0, v210
  v_add_f32 v211, 1.0, v211
  v_mfma_f32_16x16x32_bf16 v[112:115], v[56:59], v[16:19], v[112:115]
  v_add_f32 v212, 1.0, v212
  v_add_f32 v213, 1.0, v213
  v_mfma_f32_16x16x32_bf16 v[140:143], v[56:59], v[20:23], v[140:143]
  v_add_f32 v214, 1.0, v214
  v_add_f32 v215, 1.0, v215
  s_waitcnt lgkmcnt(0)
  s_barrier
  v_mfma_f32_16x16x32_bf16 v[88:91], v[60:63], v[24:27], v[88:91]
  ds_read_b128 v[16:19], v242 offset:0
  v_mfma_f32_16x16x32_bf16 v[116:119], v[60:63], v[28:31], v[116:119]
  ds_read_b128 v[32:35], v13 offset:20480
  v_mfma_f32_16x16x32_bf16 v[92:95], v[64:67], v[24:27], v[92:95]
  ds_read_b128 v[20:23], v242 offset:512
  v_mfma_f32_16x16x32_bf16 v[120:123], v[64:67], v[28:31], v[120:123]
  ds_read_b128 v[36:39], v13 offset:21504
  v_mfma_f32_16x16x32_bf16 v[96:99], v[68:71], v[24:27], v[96:99]
  ds_read_b128 v[40:43], v12 offset:10240
  v_mfma_f32_16x16x32_bf16 v[124:127], v[68:71], v[28:31], v[124:127]
  ds_read_b128 v[44:47], v12 offset:11264
  v_mfma_f32_16x16x32_bf16 v[100:103], v[72:75], v[24:27], v[100:103]
  ds_read_b128 v[48:51], v12 offset:12288
  v_mfma_f32_16x16x32_bf16 v[128:131], v[72:75], v[28:31], v[128:131]
  ds_read_b128 v[52:55], v12 offset:13312
  v_mfma_f32_16x16x32_bf16 v[104:107], v[76:79], v[24:27], v[104:107]
  ds_read_b128 v[56:59], v12 offset:14336
  v_mfma_f32_16x16x32_bf16 v[132:135], v[76:79], v[28:31], v[132:135]
  v_rcp_f32 v208, v208
  v_mfma_f32_16x16x32_bf16 v[108:111], v[80:83], v[24:27], v[108:111]
  v_rcp_f32 v209, v209
  v_mfma_f32_16x16x32_bf16 v[136:139], v[80:83], v[28:31], v[136:139]
  v_rcp_f32 v210, v210
  v_mfma_f32_16x16x32_bf16 v[112:115], v[84:87], v[24:27], v[112:115]
  v_rcp_f32 v211, v211
  v_mfma_f32_16x16x32_bf16 v[140:143], v[84:87], v[28:31], v[140:143]
  v_rcp_f32 v212, v212
  s_waitcnt lgkmcnt(0)
  v_mfma_f32_16x16x32_bf16 v[88:91], v[32:35], v[16:19], v[88:91]
  ds_read_b128 v[24:27], v243 offset:0
  v_mfma_f32_16x16x32_bf16 v[116:119], v[32:35], v[20:23], v[116:119]
  ds_read_b128 v[60:63], v13 offset:22528
  v_mfma_f32_16x16x32_bf16 v[92:95], v[36:39], v[16:19], v[92:95]
  ds_read_b128 v[28:31], v243 offset:512
  v_mfma_f32_16x16x32_bf16 v[120:123], v[36:39], v[20:23], v[120:123]
  ds_read_b128 v[64:67], v13 offset:23552
  v_mfma_f32_16x16x32_bf16 v[96:99], v[40:43], v[16:19], v[96:99]
  ds_read_b128 v[68:71], v12 offset:15360
  v_mfma_f32_16x16x32_bf16 v[124:127], v[40:43], v[20:23], v[124:127]
  ds_read_b128 v[72:75], v12 offset:16384
  v_mfma_f32_16x16x32_bf16 v[100:103], v[44:47], v[16:19], v[100:103]
  ds_read_b128 v[76:79], v12 offset:17408
  v_mfma_f32_16x16x32_bf16 v[128:131], v[44:47], v[20:23], v[128:131]
  ds_read_b128 v[80:83], v12 offset:18432
  v_mfma_f32_16x16x32_bf16 v[104:107], v[48:51], v[16:19], v[104:107]
  ds_read_b128 v[84:87], v12 offset:19456
  v_mfma_f32_16x16x32_bf16 v[132:135], v[48:51], v[20:23], v[132:135]
  v_rcp_f32 v213, v213
  v_mfma_f32_16x16x32_bf16 v[108:111], v[52:55], v[16:19], v[108:111]
  v_rcp_f32 v214, v214
  v_mfma_f32_16x16x32_bf16 v[136:139], v[52:55], v[20:23], v[136:139]
  v_rcp_f32 v215, v215
  v_mfma_f32_16x16x32_bf16 v[112:115], v[56:59], v[16:19], v[112:115]
  v_mul_f32 v164, v164, v208
  v_mul_f32 v165, v165, v209
  v_mfma_f32_16x16x32_bf16 v[140:143], v[56:59], v[20:23], v[140:143]
  v_mul_f32 v166, v166, v210
  v_mul_f32 v167, v167, v211
  s_waitcnt lgkmcnt(0)
  s_barrier
  v_mfma_f32_16x16x32_bf16 v[88:91], v[60:63], v[24:27], v[88:91]
  ds_read_b128 v[16:19], v244 offset:0
  v_mfma_f32_16x16x32_bf16 v[116:119], v[60:63], v[28:31], v[116:119]
  ds_read_b128 v[32:35], v13 offset:24576
  v_mfma_f32_16x16x32_bf16 v[92:95], v[64:67], v[24:27], v[92:95]
  ds_read_b128 v[20:23], v244 offset:512
  v_mfma_f32_16x16x32_bf16 v[120:123], v[64:67], v[28:31], v[120:123]
  ds_read_b128 v[36:39], v13 offset:25600
  v_mfma_f32_16x16x32_bf16 v[96:99], v[68:71], v[24:27], v[96:99]
  ds_read_b128 v[40:43], v12 offset:20480
  v_mfma_f32_16x16x32_bf16 v[124:127], v[68:71], v[28:31], v[124:127]
  ds_read_b128 v[44:47], v12 offset:21504
  v_mfma_f32_16x16x32_bf16 v[100:103], v[72:75], v[24:27], v[100:103]
  ds_read_b128 v[48:51], v12 offset:22528
  v_mfma_f32_16x16x32_bf16 v[128:131], v[72:75], v[28:31], v[128:131]
  ds_read_b128 v[52:55], v12 offset:23552
  v_mfma_f32_16x16x32_bf16 v[104:107], v[76:79], v[24:27], v[104:107]
  ds_read_b128 v[56:59], v12 offset:24576
  v_mfma_f32_16x16x32_bf16 v[132:135], v[76:79], v[28:31], v[132:135]
  v_mul_f32 v192, v192, v212
  v_mul_f32 v193, v193, v213
  v_mfma_f32_16x16x32_bf16 v[108:111], v[80:83], v[24:27], v[108:111]
  v_mul_f32 v194, v194, v214
  v_mul_f32 v195, v195, v215
  v_mfma_f32_16x16x32_bf16 v[136:139], v[80:83], v[28:31], v[136:139]
  v_mul_f32 v200, v168, v168
  v_mul_f32 v201, v169, v169
  v_mfma_f32_16x16x32_bf16 v[112:115], v[84:87], v[24:27], v[112:115]
  v_mul_f32 v202, v170, v170
  v_mul_f32 v203, v171, v171
  v_mfma_f32_16x16x32_bf16 v[140:143], v[84:87], v[28:31], v[140:143]
  v_mul_f32 v204, v196, v196
  v_mul_f32 v205, v197, v197
  s_waitcnt lgkmcnt(0)
  v_mfma_f32_16x16x32_bf16 v[88:91], v[32:35], v[16:19], v[88:91]
  ds_read_b128 v[24:27], v245 offset:0
  v_mfma_f32_16x16x32_bf16 v[116:119], v[32:35], v[20:23], v[116:119]
  ds_read_b128 v[60:63], v13 offset:26624
  v_mfma_f32_16x16x32_bf16 v[92:95], v[36:39], v[16:19], v[92:95]
  ds_read_b128 v[28:31], v245 offset:512
  v_mfma_f32_16x16x32_bf16 v[120:123], v[36:39], v[20:23], v[120:123]
  ds_read_b128 v[64:67], v13 offset:27648
  v_mfma_f32_16x16x32_bf16 v[96:99], v[40:43], v[16:19], v[96:99]
  ds_read_b128 v[68:71], v12 offset:25600
  v_mfma_f32_16x16x32_bf16 v[124:127], v[40:43], v[20:23], v[124:127]
  ds_read_b128 v[72:75], v12 offset:26624
  v_mfma_f32_16x16x32_bf16 v[100:103], v[44:47], v[16:19], v[100:103]
  ds_read_b128 v[76:79], v12 offset:27648
  v_mfma_f32_16x16x32_bf16 v[128:131], v[44:47], v[20:23], v[128:131]
  ds_read_b128 v[80:83], v12 offset:28672
  v_mfma_f32_16x16x32_bf16 v[104:107], v[48:51], v[16:19], v[104:107]
  ds_read_b128 v[84:87], v12 offset:29696
  v_mfma_f32_16x16x32_bf16 v[132:135], v[48:51], v[20:23], v[132:135]
  v_mul_f32 v206, v198, v198
  v_mul_f32 v207, v199, v199
  v_mfma_f32_16x16x32_bf16 v[108:111], v[52:55], v[16:19], v[108:111]
  v_fma_f32 v200, v200, s64, v248
  v_fma_f32 v201, v201, s64, v248
  v_mfma_f32_16x16x32_bf16 v[136:139], v[52:55], v[20:23], v[136:139]
  v_fma_f32 v202, v202, s64, v248
  v_fma_f32 v203, v203, s64, v248
  v_mfma_f32_16x16x32_bf16 v[112:115], v[56:59], v[16:19], v[112:115]
  v_fma_f32 v204, v204, s64, v248
  v_fma_f32 v205, v205, s64, v248
  v_mfma_f32_16x16x32_bf16 v[140:143], v[56:59], v[20:23], v[140:143]
  v_fma_f32 v206, v206, s64, v248
  v_fma_f32 v207, v207, s64, v248
  s_waitcnt lgkmcnt(0)
  s_barrier
  v_mfma_f32_16x16x32_bf16 v[88:91], v[60:63], v[24:27], v[88:91]
  ds_read_b128 v[16:19], v246 offset:0
  v_mfma_f32_16x16x32_bf16 v[116:119], v[60:63], v[28:31], v[116:119]
  ds_read_b128 v[32:35], v13 offset:28672
  v_mfma_f32_16x16x32_bf16 v[92:95], v[64:67], v[24:27], v[92:95]
  ds_read_b128 v[20:23], v246 offset:512
  v_mfma_f32_16x16x32_bf16 v[120:123], v[64:67], v[28:31], v[120:123]
  ds_read_b128 v[36:39], v13 offset:29696
  v_mfma_f32_16x16x32_bf16 v[96:99], v[68:71], v[24:27], v[96:99]
  ds_read_b128 v[40:43], v12 offset:30720
  v_mfma_f32_16x16x32_bf16 v[124:127], v[68:71], v[28:31], v[124:127]
  ds_read_b128 v[44:47], v12 offset:31744
  v_mfma_f32_16x16x32_bf16 v[100:103], v[72:75], v[24:27], v[100:103]
  ds_read_b128 v[48:51], v12 offset:32768
  v_mfma_f32_16x16x32_bf16 v[128:131], v[72:75], v[28:31], v[128:131]
  ds_read_b128 v[52:55], v12 offset:33792
  v_mfma_f32_16x16x32_bf16 v[104:107], v[76:79], v[24:27], v[104:107]
  ds_read_b128 v[56:59], v12 offset:34816
  v_mfma_f32_16x16x32_bf16 v[132:135], v[76:79], v[28:31], v[132:135]
  v_mul_f32 v200, v200, v168
  v_mul_f32 v201, v201, v169
  v_mfma_f32_16x16x32_bf16 v[108:111], v[80:83], v[24:27], v[108:111]
  v_mul_f32 v202, v202, v170
  v_mul_f32 v203, v203, v171
  v_mfma_f32_16x16x32_bf16 v[136:139], v[80:83], v[28:31], v[136:139]
  v_mul_f32 v204, v204, v196
  v_mul_f32 v205, v205, v197
  v_mfma_f32_16x16x32_bf16 v[112:115], v[84:87], v[24:27], v[112:115]
  v_mul_f32 v206, v206, v198
  v_mul_f32 v207, v207, v199
  v_mfma_f32_16x16x32_bf16 v[140:143], v[84:87], v[28:31], v[140:143]
  v_exp_f32 v208, v200
  s_waitcnt lgkmcnt(0)
  v_mfma_f32_16x16x32_bf16 v[88:91], v[32:35], v[16:19], v[88:91]
  ds_read_b128 v[24:27], v247 offset:0
  v_mfma_f32_16x16x32_bf16 v[116:119], v[32:35], v[20:23], v[116:119]
  ds_read_b128 v[60:63], v13 offset:30720
  v_mfma_f32_16x16x32_bf16 v[92:95], v[36:39], v[16:19], v[92:95]
  ds_read_b128 v[28:31], v247 offset:512
  v_mfma_f32_16x16x32_bf16 v[120:123], v[36:39], v[20:23], v[120:123]
  ds_read_b128 v[64:67], v13 offset:31744
  v_mfma_f32_16x16x32_bf16 v[96:99], v[40:43], v[16:19], v[96:99]
  ds_read_b128 v[68:71], v12 offset:35840
  v_mfma_f32_16x16x32_bf16 v[124:127], v[40:43], v[20:23], v[124:127]
  ds_read_b128 v[72:75], v12 offset:36864
  v_mfma_f32_16x16x32_bf16 v[100:103], v[44:47], v[16:19], v[100:103]
  ds_read_b128 v[76:79], v12 offset:37888
  v_mfma_f32_16x16x32_bf16 v[128:131], v[44:47], v[20:23], v[128:131]
  ds_read_b128 v[80:83], v12 offset:38912
  v_mfma_f32_16x16x32_bf16 v[104:107], v[48:51], v[16:19], v[104:107]
  ds_read_b128 v[84:87], v12 offset:39936
  v_mfma_f32_16x16x32_bf16 v[132:135], v[48:51], v[20:23], v[132:135]
  v_exp_f32 v209, v201
  v_mfma_f32_16x16x32_bf16 v[108:111], v[52:55], v[16:19], v[108:111]
  v_exp_f32 v210, v202
  v_mfma_f32_16x16x32_bf16 v[136:139], v[52:55], v[20:23], v[136:139]
  v_exp_f32 v211, v203
  v_mfma_f32_16x16x32_bf16 v[112:115], v[56:59], v[16:19], v[112:115]
  v_exp_f32 v212, v204
  v_mfma_f32_16x16x32_bf16 v[140:143], v[56:59], v[20:23], v[140:143]
  v_exp_f32 v213, v205
  s_waitcnt lgkmcnt(0)
  s_barrier
  v_mfma_f32_16x16x32_bf16 v[88:91], v[60:63], v[24:27], v[88:91]
  ds_read_b128 v[16:19], v232 offset:0
  v_mfma_f32_16x16x32_bf16 v[116:119], v[60:63], v[28:31], v[116:119]
  ds_read_b128 v[32:35], v13 offset:0
  v_mfma_f32_16x16x32_bf16 v[92:95], v[64:67], v[24:27], v[92:95]
  ds_read_b128 v[20:23], v232 offset:512
  v_mfma_f32_16x16x32_bf16 v[120:123], v[64:67], v[28:31], v[120:123]
  ds_read_b128 v[36:39], v13 offset:1024
  v_mfma_f32_16x16x32_bf16 v[96:99], v[68:71], v[24:27], v[96:99]
  ds_read_b128 v[40:43], v12 offset:0
  v_mfma_f32_16x16x32_bf16 v[124:127], v[68:71], v[28:31], v[124:127]
  ds_read_b128 v[44:47], v12 offset:1024
  v_mfma_f32_16x16x32_bf16 v[100:103], v[72:75], v[24:27], v[100:103]
  ds_read_b128 v[48:51], v12 offset:2048
  v_mfma_f32_16x16x32_bf16 v[128:131], v[72:75], v[28:31], v[128:131]
  ds_read_b128 v[52:55], v12 offset:3072
  v_mfma_f32_16x16x32_bf16 v[104:107], v[76:79], v[24:27], v[104:107]
  ds_read_b128 v[56:59], v12 offset:4096
  v_mfma_f32_16x16x32_bf16 v[132:135], v[76:79], v[28:31], v[132:135]
  v_exp_f32 v214, v206
  v_mfma_f32_16x16x32_bf16 v[108:111], v[80:83], v[24:27], v[108:111]
  v_exp_f32 v215, v207
  v_mfma_f32_16x16x32_bf16 v[136:139], v[80:83], v[28:31], v[136:139]
  v_add_f32 v208, 1.0, v208
  v_add_f32 v209, 1.0, v209
  v_mfma_f32_16x16x32_bf16 v[112:115], v[84:87], v[24:27], v[112:115]
  v_add_f32 v210, 1.0, v210
  v_add_f32 v211, 1.0, v211
  v_mfma_f32_16x16x32_bf16 v[140:143], v[84:87], v[28:31], v[140:143]
  v_add_f32 v212, 1.0, v212
  v_add_f32 v213, 1.0, v213
  v_add_f32 v214, 1.0, v214
  v_add_f32 v215, 1.0, v215
  v_rcp_f32 v208, v208
  v_rcp_f32 v209, v209
  v_rcp_f32 v210, v210
  v_rcp_f32 v211, v211
  v_rcp_f32 v212, v212
  v_rcp_f32 v213, v213
  v_rcp_f32 v214, v214
  v_rcp_f32 v215, v215
  v_mul_f32 v168, v168, v208
  v_mul_f32 v169, v169, v209
  v_mul_f32 v170, v170, v210
  v_mul_f32 v171, v171, v211
  v_mul_f32 v196, v196, v212
  v_mul_f32 v197, v197, v213
  v_mul_f32 v198, v198, v214
  v_mul_f32 v199, v199, v215
L_kg_cC2:
  s_waitcnt lgkmcnt(0)
  v_mfma_f32_16x16x32_bf16 v[88:91], v[32:35], v[16:19], v[88:91]
  ds_read_b128 v[24:27], v233 offset:0
  v_mfma_f32_16x16x32_bf16 v[116:119], v[32:35], v[20:23], v[116:119]
  ds_read_b128 v[60:63], v13 offset:2048
  v_mfma_f32_16x16x32_bf16 v[92:95], v[36:39], v[16:19], v[92:95]
  ds_read_b128 v[28:31], v233 offset:512
  v_mfma_f32_16x16x32_bf16 v[120:123], v[36:39], v[20:23], v[120:123]
  ds_read_b128 v[64:67], v13 offset:3072
  v_mfma_f32_16x16x32_bf16 v[96:99], v[40:43], v[16:19], v[96:99]
  ds_read_b128 v[68:71], v12 offset:5120
  v_mfma_f32_16x16x32_bf16 v[124:127], v[40:43], v[20:23], v[124:127]
  ds_read_b128 v[72:75], v12 offset:6144
  v_mfma_f32_16x16x32_bf16 v[100:103], v[44:47], v[16:19], v[100:103]
  ds_read_b128 v[76:79], v12 offset:7168
  v_mfma_f32_16x16x32_bf16 v[128:131], v[44:47], v[20:23], v[128:131]
  ds_read_b128 v[80:83], v12 offset:8192
  v_mfma_f32_16x16x32_bf16 v[104:107], v[48:51], v[16:19], v[104:107]
  ds_read_b128 v[84:87], v12 offset:9216
  v_mfma_f32_16x16x32_bf16 v[132:135], v[48:51], v[20:23], v[132:135]
  v_mfma_f32_16x16x32_bf16 v[108:111], v[52:55], v[16:19], v[108:111]
  v_mfma_f32_16x16x32_bf16 v[136:139], v[52:55], v[20:23], v[136:139]
  v_mfma_f32_16x16x32_bf16 v[112:115], v[56:59], v[16:19], v[112:115]
  v_mfma_f32_16x16x32_bf16 v[140:143], v[56:59], v[20:23], v[140:143]
  s_waitcnt lgkmcnt(0)
  s_barrier
  v_mfma_f32_16x16x32_bf16 v[88:91], v[60:63], v[24:27], v[88:91]
  ds_read_b128 v[16:19], v234 offset:0
  v_mfma_f32_16x16x32_bf16 v[116:119], v[60:63], v[28:31], v[116:119]
  ds_read_b128 v[32:35], v13 offset:4096
  v_mfma_f32_16x16x32_bf16 v[92:95], v[64:67], v[24:27], v[92:95]
  ds_read_b128 v[20:23], v234 offset:512
  v_mfma_f32_16x16x32_bf16 v[120:123], v[64:67], v[28:31], v[120:123]
  ds_read_b128 v[36:39], v13 offset:5120
  v_mfma_f32_16x16x32_bf16 v[96:99], v[68:71], v[24:27], v[96:99]
  ds_read_b128 v[40:43], v12 offset:10240
  v_mfma_f32_16x16x32_bf16 v[124:127], v[68:71], v[28:31], v[124:127]
  ds_read_b128 v[44:47], v12 offset:11264
  v_mfma_f32_16x16x32_bf16 v[100:103], v[72:75], v[24:27], v[100:103]
  ds_read_b128 v[48:51], v12 offset:12288
  v_mfma_f32_16x16x32_bf16 v[128:131], v[72:75], v[28:31], v[128:131]
  ds_read_b128 v[52:55], v12 offset:13312
  v_mfma_f32_16x16x32_bf16 v[104:107], v[76:79], v[24:27], v[104:107]
  ds_read_b128 v[56:59], v12 offset:14336
  v_mfma_f32_16x16x32_bf16 v[132:135], v[76:79], v[28:31], v[132:135]
  v_mfma_f32_16x16x32_bf16 v[108:111], v[80:83], v[24:27], v[108:111]
  v_mfma_f32_16x16x32_bf16 v[136:139], v[80:83], v[28:31], v[136:139]
  v_mfma_f32_16x16x32_bf16 v[112:115], v[84:87], v[24:27], v[112:115]
  v_mfma_f32_16x16x32_bf16 v[140:143], v[84:87], v[28:31], v[140:143]
  s_waitcnt lgkmcnt(0)
  v_mfma_f32_16x16x32_bf16 v[88:91], v[32:35], v[16:19], v[88:91]
  ds_read_b128 v[24:27], v235 offset:0
  v_mfma_f32_16x16x32_bf16 v[116:119], v[32:35], v[20:23], v[116:119]
  ds_read_b128 v[60:63], v13 offset:6144
  v_mfma_f32_16x16x32_bf16 v[92:95], v[36:39], v[16:19], v[92:95]
  ds_read_b128 v[28:31], v235 offset:512
  v_mfma_f32_16x16x32_bf16 v[120:123], v[36:39], v[20:23], v[120:123]
  ds_read_b128 v[64:67], v13 offset:7168
  v_mfma_f32_16x16x32_bf16 v[96:99], v[40:43], v[16:19], v[96:99]
  ds_read_b128 v[68:71], v12 offset:15360
  v_mfma_f32_16x16x32_bf16 v[124:127], v[40:43], v[20:23], v[124:127]
  ds_read_b128 v[72:75], v12 offset:16384
  v_mfma_f32_16x16x32_bf16 v[100:103], v[44:47], v[16:19], v[100:103]
  ds_read_b128 v[76:79], v12 offset:17408
  v_mfma_f32_16x16x32_bf16 v[128:131], v[44:47], v[20:23], v[128:131]
  ds_read_b128 v[80:83], v12 offset:18432
  v_mfma_f32_16x16x32_bf16 v[104:107], v[48:51], v[16:19], v[104:107]
  ds_read_b128 v[84:87], v12 offset:19456
  v_mfma_f32_16x16x32_bf16 v[132:135], v[48:51], v[20:23], v[132:135]
  v_mfma_f32_16x16x32_bf16 v[108:111], v[52:55], v[16:19], v[108:111]
  v_mfma_f32_16x16x32_bf16 v[136:139], v[52:55], v[20:23], v[136:139]
  v_mfma_f32_16x16x32_bf16 v[112:115], v[56:59], v[16:19], v[112:115]
  v_mfma_f32_16x16x32_bf16 v[140:143], v[56:59], v[20:23], v[140:143]
  s_waitcnt lgkmcnt(0)
  s_barrier
  v_mfma_f32_16x16x32_bf16 v[88:91], v[60:63], v[24:27], v[88:91]
  ds_read_b128 v[16:19], v236 offset:0
  v_mfma_f32_16x16x32_bf16 v[116:119], v[60:63], v[28:31], v[116:119]
  ds_read_b128 v[32:35], v13 offset:8192
  v_mfma_f32_16x16x32_bf16 v[92:95], v[64:67], v[24:27], v[92:95]
  ds_read_b128 v[20:23], v236 offset:512
  v_mfma_f32_16x16x32_bf16 v[120:123], v[64:67], v[28:31], v[120:123]
  ds_read_b128 v[36:39], v13 offset:9216
  v_mfma_f32_16x16x32_bf16 v[96:99], v[68:71], v[24:27], v[96:99]
  ds_read_b128 v[40:43], v12 offset:20480
  v_mfma_f32_16x16x32_bf16 v[124:127], v[68:71], v[28:31], v[124:127]
  ds_read_b128 v[44:47], v12 offset:21504
  v_mfma_f32_16x16x32_bf16 v[100:103], v[72:75], v[24:27], v[100:103]
  ds_read_b128 v[48:51], v12 offset:22528
  v_mfma_f32_16x16x32_bf16 v[128:131], v[72:75], v[28:31], v[128:131]
  ds_read_b128 v[52:55], v12 offset:23552
  v_mfma_f32_16x16x32_bf16 v[104:107], v[76:79], v[24:27], v[104:107]
  ds_read_b128 v[56:59], v12 offset:24576
  v_mfma_f32_16x16x32_bf16 v[132:135], v[76:79], v[28:31], v[132:135]
  v_mfma_f32_16x16x32_bf16 v[108:111], v[80:83], v[24:27], v[108:111]
  v_mfma_f32_16x16x32_bf16 v[136:139], v[80:83], v[28:31], v[136:139]
  v_mfma_f32_16x16x32_bf16 v[112:115], v[84:87], v[24:27], v[112:115]
  v_mfma_f32_16x16x32_bf16 v[140:143], v[84:87], v[28:31], v[140:143]
  s_waitcnt lgkmcnt(0)
  v_mfma_f32_16x16x32_bf16 v[88:91], v[32:35], v[16:19], v[88:91]
  ds_read_b128 v[24:27], v237 offset:0
  v_mfma_f32_16x16x32_bf16 v[116:119], v[32:35], v[20:23], v[116:119]
  ds_read_b128 v[60:63], v13 offset:10240
  v_mfma_f32_16x16x32_bf16 v[92:95], v[36:39], v[16:19], v[92:95]
  ds_read_b128 v[28:31], v237 offset:512
  v_mfma_f32_16x16x32_bf16 v[120:123], v[36:39], v[20:23], v[120:123]
  ds_read_b128 v[64:67], v13 offset:11264
  v_mfma_f32_16x16x32_bf16 v[96:99], v[40:43], v[16:19], v[96:99]
  ds_read_b128 v[68:71], v12 offset:25600
  v_mfma_f32_16x16x32_bf16 v[124:127], v[40:43], v[20:23], v[124:127]
  ds_read_b128 v[72:75], v12 offset:26624
  v_mfma_f32_16x16x32_bf16 v[100:103], v[44:47], v[16:19], v[100:103]
  ds_read_b128 v[76:79], v12 offset:27648
  v_mfma_f32_16x16x32_bf16 v[128:131], v[44:47], v[20:23], v[128:131]
  ds_read_b128 v[80:83], v12 offset:28672
  v_mfma_f32_16x16x32_bf16 v[104:107], v[48:51], v[16:19], v[104:107]
  ds_read_b128 v[84:87], v12 offset:29696
  v_mfma_f32_16x16x32_bf16 v[132:135], v[48:51], v[20:23], v[132:135]
  v_mfma_f32_16x16x32_bf16 v[108:111], v[52:55], v[16:19], v[108:111]
  v_mfma_f32_16x16x32_bf16 v[136:139], v[52:55], v[20:23], v[136:139]
  v_mfma_f32_16x16x32_bf16 v[112:115], v[56:59], v[16:19], v[112:115]
  v_mfma_f32_16x16x32_bf16 v[140:143], v[56:59], v[20:23], v[140:143]
  s_waitcnt lgkmcnt(0)
  s_barrier
  v_mfma_f32_16x16x32_bf16 v[88:91], v[60:63], v[24:27], v[88:91]
  ds_read_b128 v[16:19], v238 offset:0
  v_mfma_f32_16x16x32_bf16 v[116:119], v[60:63], v[28:31], v[116:119]
  ds_read_b128 v[32:35], v13 offset:12288
  v_mfma_f32_16x16x32_bf16 v[92:95], v[64:67], v[24:27], v[92:95]
  ds_read_b128 v[20:23], v238 offset:512
  v_mfma_f32_16x16x32_bf16 v[120:123], v[64:67], v[28:31], v[120:123]
  ds_read_b128 v[36:39], v13 offset:13312
  v_mfma_f32_16x16x32_bf16 v[96:99], v[68:71], v[24:27], v[96:99]
  ds_read_b128 v[40:43], v12 offset:30720
  v_mfma_f32_16x16x32_bf16 v[124:127], v[68:71], v[28:31], v[124:127]
  ds_read_b128 v[44:47], v12 offset:31744
  v_mfma_f32_16x16x32_bf16 v[100:103], v[72:75], v[24:27], v[100:103]
  ds_read_b128 v[48:51], v12 offset:32768
  v_mfma_f32_16x16x32_bf16 v[128:131], v[72:75], v[28:31], v[128:131]
  ds_read_b128 v[52:55], v12 offset:33792
  v_mfma_f32_16x16x32_bf16 v[104:107], v[76:79], v[24:27], v[104:107]
  ds_read_b128 v[56:59], v12 offset:34816
  v_mfma_f32_16x16x32_bf16 v[132:135], v[76:79], v[28:31], v[132:135]
  v_mfma_f32_16x16x32_bf16 v[108:111], v[80:83], v[24:27], v[108:111]
  v_mfma_f32_16x16x32_bf16 v[136:139], v[80:83], v[28:31], v[136:139]
  v_mfma_f32_16x16x32_bf16 v[112:115], v[84:87], v[24:27], v[112:115]
  v_mfma_f32_16x16x32_bf16 v[140:143], v[84:87], v[28:31], v[140:143]
  s_waitcnt lgkmcnt(0)
  v_mfma_f32_16x16x32_bf16 v[88:91], v[32:35], v[16:19], v[88:91]
  ds_read_b128 v[24:27], v239 offset:0
  v_mfma_f32_16x16x32_bf16 v[116:119], v[32:35], v[20:23], v[116:119]
  ds_read_b128 v[60:63], v13 offset:14336
  v_mfma_f32_16x16x32_bf16 v[92:95], v[36:39], v[16:19], v[92:95]
  ds_read_b128 v[28:31], v239 offset:512
  v_mfma_f32_16x16x32_bf16 v[120:123], v[36:39], v[20:23], v[120:123]
  ds_read_b128 v[64:67], v13 offset:15360
  v_mfma_f32_16x16x32_bf16 v[96:99], v[40:43], v[16:19], v[96:99]
  ds_read_b128 v[68:71], v12 offset:35840
  v_mfma_f32_16x16x32_bf16 v[124:127], v[40:43], v[20:23], v[124:127]
  ds_read_b128 v[72:75], v12 offset:36864
  v_mfma_f32_16x16x32_bf16 v[100:103], v[44:47], v[16:19], v[100:103]
  ds_read_b128 v[76:79], v12 offset:37888
  v_mfma_f32_16x16x32_bf16 v[128:131], v[44:47], v[20:23], v[128:131]
  ds_read_b128 v[80:83], v12 offset:38912
  v_mfma_f32_16x16x32_bf16 v[104:107], v[48:51], v[16:19], v[104:107]
  ds_read_b128 v[84:87], v12 offset:39936
  v_mfma_f32_16x16x32_bf16 v[132:135], v[48:51], v[20:23], v[132:135]
  v_mfma_f32_16x16x32_bf16 v[108:111], v[52:55], v[16:19], v[108:111]
  v_mfma_f32_16x16x32_bf16 v[136:139], v[52:55], v[20:23], v[136:139]
  v_mfma_f32_16x16x32_bf16 v[112:115], v[56:59], v[16:19], v[112:115]
  v_mfma_f32_16x16x32_bf16 v[140:143], v[56:59], v[20:23], v[140:143]
  s_waitcnt lgkmcnt(0)
  s_barrier
  v_mfma_f32_16x16x32_bf16 v[88:91], v[60:63], v[24:27], v[88:91]
  ds_read_b128 v[16:19], v240 offset:0
  v_mfma_f32_16x16x32_bf16 v[116:119], v[60:63], v[28:31], v[116:119]
  ds_read_b128 v[32:35], v13 offset:16384
  v_mfma_f32_16x16x32_bf16 v[92:95], v[64:67], v[24:27], v[92:95]
  ds_read_b128 v[20:23], v240 offset:512
  v_mfma_f32_16x16x32_bf16 v[120:123], v[64:67], v[28:31], v[120:123]
  ds_read_b128 v[36:39], v13 offset:17408
  v_mfma_f32_16x16x32_bf16 v[96:99], v[68:71], v[24:27], v[96:99]
  ds_read_b128 v[40:43], v12 offset:0
  v_mfma_f32_16x16x32_bf16 v[124:127], v[68:71], v[28:31], v[124:127]
  ds_read_b128 v[44:47], v12 offset:1024
  v_mfma_f32_16x16x32_bf16 v[100:103], v[72:75], v[24:27], v[100:103]
  ds_read_b128 v[48:51], v12 offset:2048
  v_mfma_f32_16x16x32_bf16 v[128:131], v[72:75], v[28:31], v[128:131]
  ds_read_b128 v[52:55], v12 offset:3072
  v_mfma_f32_16x16x32_bf16 v[104:107], v[76:79], v[24:27], v[104:107]
  ds_read_b128 v[56:59], v12 offset:4096
  v_mfma_f32_16x16x32_bf16 v[132:135], v[76:79], v[28:31], v[132:135]
  v_mfma_f32_16x16x32_bf16 v[108:111], v[80:83], v[24:27], v[108:111]
  v_mfma_f32_16x16x32_bf16 v[136:139], v[80:83], v[28:31], v[136:139]
  v_mfma_f32_16x16x32_bf16 v[112:115], v[84:87], v[24:27], v[112:115]
  v_mfma_f32_16x16x32_bf16 v[140:143], v[84:87], v[28:31], v[140:143]
  s_waitcnt lgkmcnt(0)
  v_mfma_f32_16x16x32_bf16 v[88:91], v[32:35], v[16:19], v[88:91]
  ds_read_b128 v[24:27], v241 offset:0
  v_mfma_f32_16x16x32_bf16 v[116:119], v[32:35], v[20:23], v[116:119]
  ds_read_b128 v[60:63], v13 offset:18432
  v_mfma_f32_16x16x32_bf16 v[92:95], v[36:39], v[16:19], v[92:95]
  ds_read_b128 v[28:31], v241 offset:512
  v_mfma_f32_16x16x32_bf16 v[120:123], v[36:39], v[20:23], v[120:123]
  ds_read_b128 v[64:67], v13 offset:19456
  v_mfma_f32_16x16x32_bf16 v[96:99], v[40:43], v[16:19], v[96:99]
  ds_read_b128 v[68:71], v12 offset:5120
  v_mfma_f32_16x16x32_bf16 v[124:127], v[40:43], v[20:23], v[124:127]
  ds_read_b128 v[72:75], v12 offset:6144
  v_mfma_f32_16x16x32_bf16 v[100:103], v[44:47], v[16:19], v[100:103]
  ds_read_b128 v[76:79], v12 offset:7168
  v_mfma_f32_16x16x32_bf16 v[128:131], v[44:47], v[20:23], v[128:131]
  ds_read_b128 v[80:83], v12 offset:8192
  v_mfma_f32_16x16x32_bf16 v[104:107], v[48:51], v[16:19], v[104:107]
  ds_read_b128 v[84:87], v12 offset:9216
  v_mfma_f32_16x16x32_bf16 v[132:135], v[48:51], v[20:23], v[132:135]
  v_mfma_f32_16x16x32_bf16 v[108:111], v[52:55], v[16:19], v[108:111]
  v_mfma_f32_16x16x32_bf16 v[136:139], v[52:55], v[20:23], v[136:139]
  v_mfma_f32_16x16x32_bf16 v[112:115], v[56:59], v[16:19], v[112:115]
  v_mfma_f32_16x16x32_bf16 v[140:143], v[56:59], v[20:23], v[140:143]
  s_waitcnt lgkmcnt(0)
  s_barrier
  v_mfma_f32_16x16x32_bf16 v[88:91], v[60:63], v[24:27], v[88:91]
  ds_read_b128 v[16:19], v242 offset:0
  v_mfma_f32_16x16x32_bf16 v[116:119], v[60:63], v[28:31], v[116:119]
  ds_read_b128 v[32:35], v13 offset:20480
  v_mfma_f32_16x16x32_bf16 v[92:95], v[64:67], v[24:27], v[92:95]
  ds_read_b128 v[20:23], v242 offset:512
  v_mfma_f32_16x16x32_bf16 v[120:123], v[64:67], v[28:31], v[120:123]
  ds_read_b128 v[36:39], v13 offset:21504
  v_mfma_f32_16x16x32_bf16 v[96:99], v[68:71], v[24:27], v[96:99]
  ds_read_b128 v[40:43], v12 offset:10240
  v_mfma_f32_16x16x32_bf16 v[124:127], v[68:71], v[28:31], v[124:127]
  ds_read_b128 v[44:47], v12 offset:11264
  v_mfma_f32_16x16x32_bf16 v[100:103], v[72:75], v[24:27], v[100:103]
  ds_read_b128 v[48:51], v12 offset:12288
  v_mfma_f32_16x16x32_bf16 v[128:131], v[72:75], v[28:31], v[128:131]
  ds_read_b128 v[52:55], v12 offset:13312
  v_mfma_f32_16x16x32_bf16 v[104:107], v[76:79], v[24:27], v[104:107]
  ds_read_b128 v[56:59], v12 offset:14336
  v_mfma_f32_16x16x32_bf16 v[132:135], v[76:79], v[28:31], v[132:135]
  v_mfma_f32_16x16x32_bf16 v[108:111], v[80:83], v[24:27], v[108:111]
  v_mfma_f32_16x16x32_bf16 v[136:139], v[80:83], v[28:31], v[136:139]
  v_mfma_f32_16x16x32_bf16 v[112:115], v[84:87], v[24:27], v[112:115]
  v_mfma_f32_16x16x32_bf16 v[140:143], v[84:87], v[28:31], v[140:143]
  s_waitcnt lgkmcnt(0)
  v_mfma_f32_16x16x32_bf16 v[88:91], v[32:35], v[16:19], v[88:91]
  ds_read_b128 v[24:27], v243 offset:0
  v_mfma_f32_16x16x32_bf16 v[116:119], v[32:35], v[20:23], v[116:119]
  ds_read_b128 v[60:63], v13 offset:22528
  v_mfma_f32_16x16x32_bf16 v[92:95], v[36:39], v[16:19], v[92:95]
  ds_read_b128 v[28:31], v243 offset:512
  v_mfma_f32_16x16x32_bf16 v[120:123], v[36:39], v[20:23], v[120:123]
  ds_read_b128 v[64:67], v13 offset:23552
  v_mfma_f32_16x16x32_bf16 v[96:99], v[40:43], v[16:19], v[96:99]
  ds_read_b128 v[68:71], v12 offset:15360
  v_mfma_f32_16x16x32_bf16 v[124:127], v[40:43], v[20:23], v[124:127]
  ds_read_b128 v[72:75], v12 offset:16384
  v_mfma_f32_16x16x32_bf16 v[100:103], v[44:47], v[16:19], v[100:103]
  ds_read_b128 v[76:79], v12 offset:17408
  v_mfma_f32_16x16x32_bf16 v[128:131], v[44:47], v[20:23], v[128:131]
  ds_read_b128 v[80:83], v12 offset:18432
  v_mfma_f32_16x16x32_bf16 v[104:107], v[48:51], v[16:19], v[104:107]
  ds_read_b128 v[84:87], v12 offset:19456
  v_mfma_f32_16x16x32_bf16 v[132:135], v[48:51], v[20:23], v[132:135]
  v_mfma_f32_16x16x32_bf16 v[108:111], v[52:55], v[16:19], v[108:111]
  v_mfma_f32_16x16x32_bf16 v[136:139], v[52:55], v[20:23], v[136:139]
  v_mfma_f32_16x16x32_bf16 v[112:115], v[56:59], v[16:19], v[112:115]
  v_mfma_f32_16x16x32_bf16 v[140:143], v[56:59], v[20:23], v[140:143]
  s_waitcnt lgkmcnt(0)
  s_barrier
  v_mfma_f32_16x16x32_bf16 v[88:91], v[60:63], v[24:27], v[88:91]
  ds_read_b128 v[16:19], v244 offset:0
  v_mfma_f32_16x16x32_bf16 v[116:119], v[60:63], v[28:31], v[116:119]
  ds_read_b128 v[32:35], v13 offset:24576
  v_mfma_f32_16x16x32_bf16 v[92:95], v[64:67], v[24:27], v[92:95]
  ds_read_b128 v[20:23], v244 offset:512
  v_mfma_f32_16x16x32_bf16 v[120:123], v[64:67], v[28:31], v[120:123]
  ds_read_b128 v[36:39], v13 offset:25600
  v_mfma_f32_16x16x32_bf16 v[96:99], v[68:71], v[24:27], v[96:99]
  ds_read_b128 v[40:43], v12 offset:20480
  v_mfma_f32_16x16x32_bf16 v[124:127], v[68:71], v[28:31], v[124:127]
  ds_read_b128 v[44:47], v12 offset:21504
  v_mfma_f32_16x16x32_bf16 v[100:103], v[72:75], v[24:27], v[100:103]
  ds_read_b128 v[48:51], v12 offset:22528
  v_mfma_f32_16x16x32_bf16 v[128:131], v[72:75], v[28:31], v[128:131]
  ds_read_b128 v[52:55], v12 offset:23552
  v_mfma_f32_16x16x32_bf16 v[104:107], v[76:79], v[24:27], v[104:107]
  ds_read_b128 v[56:59], v12 offset:24576
  v_mfma_f32_16x16x32_bf16 v[132:135], v[76:79], v[28:31], v[132:135]
  v_mfma_f32_16x16x32_bf16 v[108:111], v[80:83], v[24:27], v[108:111]
  v_mfma_f32_16x16x32_bf16 v[136:139], v[80:83], v[28:31], v[136:139]
  v_mfma_f32_16x16x32_bf16 v[112:115], v[84:87], v[24:27], v[112:115]
  v_mfma_f32_16x16x32_bf16 v[140:143], v[84:87], v[28:31], v[140:143]
  s_waitcnt lgkmcnt(0)
  v_mfma_f32_16x16x32_bf16 v[88:91], v[32:35], v[16:19], v[88:91]
  ds_read_b128 v[24:27], v245 offset:0
  v_mfma_f32_16x16x32_bf16 v[116:119], v[32:35], v[20:23], v[116:119]
  ds_read_b128 v[60:63], v13 offset:26624
  v_mfma_f32_16x16x32_bf16 v[92:95], v[36:39], v[16:19], v[92:95]
  ds_read_b128 v[28:31], v245 offset:512
  v_mfma_f32_16x16x32_bf16 v[120:123], v[36:39], v[20:23], v[120:123]
  ds_read_b128 v[64:67], v13 offset:27648
  v_mfma_f32_16x16x32_bf16 v[96:99], v[40:43], v[16:19], v[96:99]
  ds_read_b128 v[68:71], v12 offset:25600
  v_mfma_f32_16x16x32_bf16 v[124:127], v[40:43], v[20:23], v[124:127]
  ds_read_b128 v[72:75], v12 offset:26624
  v_mfma_f32_16x16x32_bf16 v[100:103], v[44:47], v[16:19], v[100:103]
  ds_read_b128 v[76:79], v12 offset:27648
  v_mfma_f32_16x16x32_bf16 v[128:131], v[44:47], v[20:23], v[128:131]
  ds_read_b128 v[80:83], v12 offset:28672
  v_mfma_f32_16x16x32_bf16 v[104:107], v[48:51], v[16:19], v[104:107]
  ds_read_b128 v[84:87], v12 offset:29696
  v_mfma_f32_16x16x32_bf16 v[132:135], v[48:51], v[20:23], v[132:135]
  v_mfma_f32_16x16x32_bf16 v[108:111], v[52:55], v[16:19], v[108:111]
  v_mfma_f32_16x16x32_bf16 v[136:139], v[52:55], v[20:23], v[136:139]
  v_mfma_f32_16x16x32_bf16 v[112:115], v[56:59], v[16:19], v[112:115]
  v_mfma_f32_16x16x32_bf16 v[140:143], v[56:59], v[20:23], v[140:143]
  s_waitcnt lgkmcnt(0)
  s_barrier
  v_mfma_f32_16x16x32_bf16 v[88:91], v[60:63], v[24:27], v[88:91]
  ds_read_b128 v[16:19], v246 offset:0
  v_mfma_f32_16x16x32_bf16 v[116:119], v[60:63], v[28:31], v[116:119]
  ds_read_b128 v[32:35], v13 offset:28672
  v_mfma_f32_16x16x32_bf16 v[92:95], v[64:67], v[24:27], v[92:95]
  ds_read_b128 v[20:23], v246 offset:512
  v_mfma_f32_16x16x32_bf16 v[120:123], v[64:67], v[28:31], v[120:123]
  ds_read_b128 v[36:39], v13 offset:29696
  v_mfma_f32_16x16x32_bf16 v[96:99], v[68:71], v[24:27], v[96:99]
  ds_read_b128 v[40:43], v12 offset:30720
  v_mfma_f32_16x16x32_bf16 v[124:127], v[68:71], v[28:31], v[124:127]
  ds_read_b128 v[44:47], v12 offset:31744
  v_mfma_f32_16x16x32_bf16 v[100:103], v[72:75], v[24:27], v[100:103]
  ds_read_b128 v[48:51], v12 offset:32768
  v_mfma_f32_16x16x32_bf16 v[128:131], v[72:75], v[28:31], v[128:131]
  ds_read_b128 v[52:55], v12 offset:33792
  v_mfma_f32_16x16x32_bf16 v[104:107], v[76:79], v[24:27], v[104:107]
  ds_read_b128 v[56:59], v12 offset:34816
  v_mfma_f32_16x16x32_bf16 v[132:135], v[76:79], v[28:31], v[132:135]
  v_mfma_f32_16x16x32_bf16 v[108:111], v[80:83], v[24:27], v[108:111]
  v_mfma_f32_16x16x32_bf16 v[136:139], v[80:83], v[28:31], v[136:139]
  v_mfma_f32_16x16x32_bf16 v[112:115], v[84:87], v[24:27], v[112:115]
  v_mfma_f32_16x16x32_bf16 v[140:143], v[84:87], v[28:31], v[140:143]
  s_waitcnt lgkmcnt(0)
  v_mfma_f32_16x16x32_bf16 v[88:91], v[32:35], v[16:19], v[88:91]
  ds_read_b128 v[24:27], v247 offset:0
  v_mfma_f32_16x16x32_bf16 v[116:119], v[32:35], v[20:23], v[116:119]
  ds_read_b128 v[60:63], v13 offset:30720
  v_mfma_f32_16x16x32_bf16 v[92:95], v[36:39], v[16:19], v[92:95]
  ds_read_b128 v[28:31], v247 offset:512
  v_mfma_f32_16x16x32_bf16 v[120:123], v[36:39], v[20:23], v[120:123]
  ds_read_b128 v[64:67], v13 offset:31744
  v_mfma_f32_16x16x32_bf16 v[96:99], v[40:43], v[16:19], v[96:99]
  ds_read_b128 v[68:71], v12 offset:35840
  v_mfma_f32_16x16x32_bf16 v[124:127], v[40:43], v[20:23], v[124:127]
  ds_read_b128 v[72:75], v12 offset:36864
  v_mfma_f32_16x16x32_bf16 v[100:103], v[44:47], v[16:19], v[100:103]
  ds_read_b128 v[76:79], v12 offset:37888
  v_mfma_f32_16x16x32_bf16 v[128:131], v[44:47], v[20:23], v[128:131]
  ds_read_b128 v[80:83], v12 offset:38912
  v_mfma_f32_16x16x32_bf16 v[104:107], v[48:51], v[16:19], v[104:107]
  ds_read_b128 v[84:87], v12 offset:39936
  v_mfma_f32_16x16x32_bf16 v[132:135], v[48:51], v[20:23], v[132:135]
  v_mfma_f32_16x16x32_bf16 v[108:111], v[52:55], v[16:19], v[108:111]
  v_mfma_f32_16x16x32_bf16 v[136:139], v[52:55], v[20:23], v[136:139]
  v_mfma_f32_16x16x32_bf16 v[112:115], v[56:59], v[16:19], v[112:115]
  v_mfma_f32_16x16x32_bf16 v[140:143], v[56:59], v[20:23], v[140:143]
  s_waitcnt lgkmcnt(0)
  s_barrier
  v_mfma_f32_16x16x32_bf16 v[88:91], v[60:63], v[24:27], v[88:91]
  v_mfma_f32_16x16x32_bf16 v[116:119], v[60:63], v[28:31], v[116:119]
  v_mfma_f32_16x16x32_bf16 v[92:95], v[64:67], v[24:27], v[92:95]
  v_mfma_f32_16x16x32_bf16 v[120:123], v[64:67], v[28:31], v[120:123]
  v_mfma_f32_16x16x32_bf16 v[96:99], v[68:71], v[24:27], v[96:99]
  v_mfma_f32_16x16x32_bf16 v[124:127], v[68:71], v[28:31], v[124:127]
  v_mfma_f32_16x16x32_bf16 v[100:103], v[72:75], v[24:27], v[100:103]
  v_mfma_f32_16x16x32_bf16 v[128:131], v[72:75], v[28:31], v[128:131]
  v_mfma_f32_16x16x32_bf16 v[104:107], v[76:79], v[24:27], v[104:107]
  v_mfma_f32_16x16x32_bf16 v[132:135], v[76:79], v[28:31], v[132:135]
  v_mfma_f32_16x16x32_bf16 v[108:111], v[80:83], v[24:27], v[108:111]
  v_mfma_f32_16x16x32_bf16 v[136:139], v[80:83], v[28:31], v[136:139]
  v_mfma_f32_16x16x32_bf16 v[112:115], v[84:87], v[24:27], v[112:115]
  v_mfma_f32_16x16x32_bf16 v[140:143], v[84:87], v[28:31], v[140:143]
  s_nop 7
  v_pk_mul_f32 v[88:89], v[88:89], v[144:145]
  v_pk_mul_f32 v[90:91], v[90:91], v[146:147]
  v_cvt_pk_bf16_f32 v204, v88, v89
  v_cvt_pk_bf16_f32 v205, v90, v91
  v_pk_mul_f32 v[92:93], v[92:93], v[148:149]
  v_pk_mul_f32 v[94:95], v[94:95], v[150:151]
  v_cvt_pk_bf16_f32 v206, v92, v93
  v_cvt_pk_bf16_f32 v207, v94, v95
  s_add_u32 s58, s62, 0
  buffer_store_dwordx4 v[204:207], v6, s[24:27], s58 offen sc1
  v_pk_mul_f32 v[96:97], v[96:97], v[152:153]
  v_pk_mul_f32 v[98:99], v[98:99], v[154:155]
  v_cvt_pk_bf16_f32 v208, v96, v97
  v_cvt_pk_bf16_f32 v209, v98, v99
  v_pk_mul_f32 v[100:101], v[100:101], v[156:157]
  v_pk_mul_f32 v[102:103], v[102:103], v[158:159]
  v_cvt_pk_bf16_f32 v210, v100, v101
  v_cvt_pk_bf16_f32 v211, v102, v103
  s_add_u32 s58, s62, 1024
  buffer_store_dwordx4 v[208:211], v6, s[24:27], s58 offen sc1
  v_pk_mul_f32 v[104:105], v[104:105], v[160:161]
  v_pk_mul_f32 v[106:107], v[106:107], v[162:163]
  v_cvt_pk_bf16_f32 v212, v104, v105
  v_cvt_pk_bf16_f32 v213, v106, v107
  v_pk_mul_f32 v[108:109], v[108:109], v[164:165]
  v_pk_mul_f32 v[110:111], v[110:111], v[166:167]
  v_cvt_pk_bf16_f32 v214, v108, v109
  v_cvt_pk_bf16_f32 v215, v110, v111
  s_add_u32 s58, s62, 2048
  buffer_store_dwordx4 v[212:215], v6, s[24:27], s58 offen sc1
  v_pk_mul_f32 v[116:117], v[116:117], v[172:173]
  v_pk_mul_f32 v[118:119], v[118:119], v[174:175]
  v_cvt_pk_bf16_f32 v216, v116, v117
  v_cvt_pk_bf16_f32 v217, v118, v119
  v_pk_mul_f32 v[120:121], v[120:121], v[176:177]
  v_pk_mul_f32 v[122:123], v[122:123], v[178:179]
  v_cvt_pk_bf16_f32 v218, v120, v121
  v_cvt_pk_bf16_f32 v219, v122, v123
  s_add_u32 s58, s63, 0
  buffer_store_dwordx4 v[216:219], v6, s[24:27], s58 offen sc1
  v_pk_mul_f32 v[124:125], v[124:125], v[180:181]
  v_pk_mul_f32 v[126:127], v[126:127], v[182:183]
  v_cvt_pk_bf16_f32 v204, v124, v125
  v_cvt_pk_bf16_f32 v205, v126, v127
  v_pk_mul_f32 v[128:129], v[128:129], v[184:185]
  v_pk_mul_f32 v[130:131], v[130:131], v[186:187]
  v_cvt_pk_bf16_f32 v206, v128, v129
  v_cvt_pk_bf16_f32 v207, v130, v131
  s_add_u32 s58, s63, 1024
  buffer_store_dwordx4 v[204:207], v6, s[24:27], s58 offen sc1
  v_pk_mul_f32 v[132:133], v[132:133], v[188:189]
  v_pk_mul_f32 v[134:135], v[134:135], v[190:191]
  v_cvt_pk_bf16_f32 v208, v132, v133
  v_cvt_pk_bf16_f32 v209, v134, v135
  v_pk_mul_f32 v[136:137], v[136:137], v[192:193]
  v_pk_mul_f32 v[138:139], v[138:139], v[194:195]
  v_cvt_pk_bf16_f32 v210, v136, v137
  v_cvt_pk_bf16_f32 v211, v138, v139
  s_add_u32 s58, s63, 2048
  buffer_store_dwordx4 v[208:211], v6, s[24:27], s58 offen sc1
  v_pk_mul_f32 v[112:113], v[112:113], v[168:169]
  v_pk_mul_f32 v[114:115], v[114:115], v[170:171]
  v_cvt_pk_bf16_f32 v212, v112, v113
  v_cvt_pk_bf16_f32 v213, v114, v115
  v_pk_mul_f32 v[140:141], v[140:141], v[196:197]
  v_pk_mul_f32 v[142:143], v[142:143], v[198:199]
  v_cvt_pk_bf16_f32 v214, v140, v141
  v_cvt_pk_bf16_f32 v215, v142, v143
  buffer_store_dwordx4 v[212:215], v6, s[24:27], s15 offen sc1
  s_lshl_b32 s58, s53, 13
  s_lshl_b32 s59, s54, 9
  s_add_u32 s58, s58, s59
  s_lshl_b32 s59, s52, 7
  s_add_u32 s58, s58, s59
  s_add_u32 s61, s58, 131072
  v_mov_b32 v8, 1
  v_mov_b32 v9, 1
  v_mov_b32 v10, 1
  v_mov_b32 v11, 1
  v_lshlrev_b32 v7, 4, v14
  s_waitcnt vmcnt(0)
  s_mov_b64 exec, 0xff
  buffer_store_dwordx4 v[8:11], v7, s[36:39], s61 offen sc1
  s_mov_b64 exec, -1
  s_barrier
  s_movk_i32 s16, 8192
  buffer_load_dwordx2 v[176:177], v2, s[28:31], 0 offen offset:0
  buffer_load_dwordx2 v[178:179], v2, s[28:31], 0 offen offset:32
  buffer_load_dwordx2 v[180:181], v2, s[28:31], 0 offen offset:64
  buffer_load_dwordx2 v[182:183], v2, s[28:31], 0 offen offset:96
  buffer_load_dwordx2 v[184:185], v2, s[28:31], s16 offen offset:0
  buffer_load_dwordx2 v[186:187], v2, s[28:31], s16 offen offset:32
  buffer_load_dwordx2 v[188:189], v2, s[28:31], s16 offen offset:64
  buffer_load_dwordx2 v[190:191], v2, s[28:31], s16 offen offset:96
  v_lshrrev_b32 v1, 8, v2
  v_and_b32 v1, 0xfffffff8, v1
  buffer_load_dwordx2 v[192:193], v1, s[44:47], 0 offen
  buffer_load_dwordx2 v[194:195], v1, s[44:47], 0 offen offset:32
  v_lshlrev_b32 v7, 4, v14
  s_sub_u32 s58, s52, 1
  s_lshl_b32 s58, s58, 12
  s_add_u32 s58, s58, 0
  s_cmp_eq_u32 s52, 0
  s_cselect_b32 s58, 49152, s58
  v_add_u32 v232, s58, v7
  s_sub_u32 s58, s52, 1
  s_lshl_b32 s58, s58, 12
  s_add_u32 s58, s58, 12288
  s_cmp_eq_u32 s52, 0
  s_cselect_b32 s58, 53248, s58
  v_add_u32 v234, s58, v7
  s_sub_u32 s58, s52, 1
  s_lshl_b32 s58, s58, 12
  s_add_u32 s58, s58, 24576
  s_cmp_eq_u32 s52, 0
  s_cselect_b32 s58, 57344, s58
  v_add_u32 v236, s58, v7
  s_sub_u32 s58, s52, 1
  s_lshl_b32 s58, s58, 12
  s_add_u32 s58, s58, 36864
  s_cmp_eq_u32 s52, 0
  s_cselect_b32 s58, 61440, s58
  v_add_u32 v238, s58, v7
  s_sub_u32 s58, s52, 1
  s_lshl_b32 s58, s58, 12
  s_add_u32 s58, s58, 0
  s_cmp_eq_u32 s52, 0
  s_cselect_b32 s58, 65536, s58
  v_add_u32 v240, s58, v7
  s_sub_u32 s58, s52, 1
  s_lshl_b32 s58, s58, 12
  s_add_u32 s58, s58, 12288
  s_cmp_eq_u32 s52, 0
  s_cselect_b32 s58, 69632, s58
  v_add_u32 v242, s58, v7
  s_sub_u32 s58, s52, 1
  s_lshl_b32 s58, s58, 12
  s_add_u32 s58, s58, 24576
  s_cmp_eq_u32 s52, 0
  s_cselect_b32 s58, 73728, s58
  v_add_u32 v244, s58, v7
  s_sub_u32 s58, s52, 1
  s_lshl_b32 s58, s58, 12
  s_add_u32 s58, s58, 36864
  s_cmp_eq_u32 s52, 0
  s_cselect_b32 s58, 77824, s58
  v_add_u32 v246, s58, v7
  v_lshrrev_b32 v1, 2, v14
  v_lshlrev_b32 v7, 7, v1
  v_bfe_u32 v1, v1, 1, 2
  v_lshlrev_b32 v1, 5, v1
  v_add_u32 v7, v7, v1
  v_and_b32 v1, 3, v14
  v_lshlrev_b32 v1, 3, v1
  v_add_u32 v7, v7, v1
  v_add_u32 v7, 81920, v7
  v_xor_b32 v8, 0, v7
  v_add_u32 v200, 40960, v8
  v_xor_b32 v9, 32, v7
  v_add_u32 v201, 40960, v9
  v_xor_b32 v10, 64, v7
  v_add_u32 v202, 40960, v10
  v_xor_b32 v11, 96, v7
  v_add_u32 v203, 40960, v11
  s_waitcnt vmcnt(0)
  v_lshlrev_b32 v144, 16, v176
  v_and_b32 v145, 0xffff0000, v176
  v_lshlrev_b32 v146, 16, v177
  v_and_b32 v147, 0xffff0000, v177
  v_fma_f32 v144, v144, v193, v192
  v_fma_f32 v145, v145, v193, v192
  v_fma_f32 v146, v146, v193, v192
  v_fma_f32 v147, v147, v193, v192
  v_lshlrev_b32 v148, 16, v178
  v_and_b32 v149, 0xffff0000, v178
  v_lshlrev_b32 v150, 16, v179
  v_and_b32 v151, 0xffff0000, v179
  v_fma_f32 v148, v148, v193, v192
  v_fma_f32 v149, v149, v193, v192
  v_fma_f32 v150, v150, v193, v192
  v_fma_f32 v151, v151, v193, v192
  v_lshlrev_b32 v152, 16, v180
  v_and_b32 v153, 0xffff0000, v180
  v_lshlrev_b32 v154, 16, v181
  v_and_b32 v155, 0xffff0000, v181
  v_fma_f32 v152, v152, v193, v192
  v_fma_f32 v153, v153, v193, v192
  v_fma_f32 v154, v154, v193, v192
  v_fma_f32 v155, v155, v193, v192
  v_lshlrev_b32 v156, 16, v182
  v_and_b32 v157, 0xffff0000, v182
  v_lshlrev_b32 v158, 16, v183
  v_and_b32 v159, 0xffff0000, v183
  v_fma_f32 v156, v156, v193, v192
  v_fma_f32 v157, v157, v193, v192
  v_fma_f32 v158, v158, v193, v192
  v_fma_f32 v159, v159, v193, v192
  v_lshlrev_b32 v160, 16, v184
  v_and_b32 v161, 0xffff0000, v184
  v_lshlrev_b32 v162, 16, v185
  v_and_b32 v163, 0xffff0000, v185
  v_fma_f32 v160, v160, v195, v194
  v_fma_f32 v161, v161, v195, v194
  v_fma_f32 v162, v162, v195, v194
  v_fma_f32 v163, v163, v195, v194
  v_lshlrev_b32 v164, 16, v186
  v_and_b32 v165, 0xffff0000, v186
  v_lshlrev_b32 v166, 16, v187
  v_and_b32 v167, 0xffff0000, v187
  v_fma_f32 v164, v164, v195, v194
  v_fma_f32 v165, v165, v195, v194
  v_fma_f32 v166, v166, v195, v194
  v_fma_f32 v167, v167, v195, v194
  v_lshlrev_b32 v168, 16, v188
  v_and_b32 v169, 0xffff0000, v188
  v_lshlrev_b32 v170, 16, v189
  v_and_b32 v171, 0xffff0000, v189
  v_fma_f32 v168, v168, v195, v194
  v_fma_f32 v169, v169, v195, v194
  v_fma_f32 v170, v170, v195, v194
  v_fma_f32 v171, v171, v195, v194
  v_lshlrev_b32 v172, 16, v190
  v_and_b32 v173, 0xffff0000, v190
  v_lshlrev_b32 v174, 16, v191
  v_and_b32 v175, 0xffff0000, v191
  v_fma_f32 v172, v172, v195, v194
  v_fma_f32 v173, v173, v195, v194
  v_fma_f32 v174, v174, v195, v194
  v_fma_f32 v175, v175, v195, v194
  s_barrier
  s_barrier
L_kg_cD:
  ds_read_b128 v[16:19], v232 offset:0
  ds_read_b64_tr_b16 v[32:33], v200 offset:0
  ds_read_b64_tr_b16 v[34:35], v8 offset:0
  ds_read_b128 v[20:23], v232 offset:2048
  ds_read_b64_tr_b16 v[36:37], v201 offset:0
  ds_read_b64_tr_b16 v[38:39], v9 offset:0
  ds_read_b64_tr_b16 v[40:41], v202 offset:0
  ds_read_b64_tr_b16 v[42:43], v10 offset:0
  ds_read_b64_tr_b16 v[44:45], v203 offset:0
  ds_read_b64_tr_b16 v[46:47], v11 offset:0
  s_waitcnt lgkmcnt(0)
  v_mfma_f32_16x16x32_bf16 v[144:147], v[32:35], v[16:19], v[144:147]
  ds_read_b128 v[24:27], v232 offset:1024
  ds_read_b64_tr_b16 v[60:61], v8 offset:2048
  v_mfma_f32_16x16x32_bf16 v[160:163], v[32:35], v[20:23], v[160:163]
  ds_read_b64_tr_b16 v[62:63], v8 offset:4096
  ds_read_b128 v[28:31], v232 offset:3072
  v_mfma_f32_16x16x32_bf16 v[148:151], v[36:39], v[16:19], v[148:151]
  ds_read_b64_tr_b16 v[64:65], v9 offset:2048
  ds_read_b64_tr_b16 v[66:67], v9 offset:4096
  v_mfma_f32_16x16x32_bf16 v[164:167], v[36:39], v[20:23], v[164:167]
  ds_read_b64_tr_b16 v[68:69], v10 offset:2048
  ds_read_b64_tr_b16 v[70:71], v10 offset:4096
  v_mfma_f32_16x16x32_bf16 v[152:155], v[40:43], v[16:19], v[152:155]
  ds_read_b64_tr_b16 v[72:73], v11 offset:2048
  ds_read_b64_tr_b16 v[74:75], v11 offset:4096
  v_mfma_f32_16x16x32_bf16 v[168:171], v[40:43], v[20:23], v[168:171]
  v_mfma_f32_16x16x32_bf16 v[156:159], v[44:47], v[16:19], v[156:159]
  v_mfma_f32_16x16x32_bf16 v[172:175], v[44:47], v[20:23], v[172:175]
  s_waitcnt lgkmcnt(0)
  s_barrier
  v_mfma_f32_16x16x32_bf16 v[144:147], v[60:63], v[24:27], v[144:147]
  ds_read_b128 v[16:19], v234 offset:0
  ds_read_b64_tr_b16 v[32:33], v200 offset:4096
  v_mfma_f32_16x16x32_bf16 v[160:163], v[60:63], v[28:31], v[160:163]
  ds_read_b64_tr_b16 v[34:35], v8 offset:10240
  ds_read_b128 v[20:23], v234 offset:2048
  v_mfma_f32_16x16x32_bf16 v[148:151], v[64:67], v[24:27], v[148:151]
  ds_read_b64_tr_b16 v[36:37], v201 offset:4096
  ds_read_b64_tr_b16 v[38:39], v9 offset:10240
  v_mfma_f32_16x16x32_bf16 v[164:167], v[64:67], v[28:31], v[164:167]
  ds_read_b64_tr_b16 v[40:41], v202 offset:4096
  ds_read_b64_tr_b16 v[42:43], v10 offset:10240
  v_mfma_f32_16x16x32_bf16 v[152:155], v[68:71], v[24:27], v[152:155]
  ds_read_b64_tr_b16 v[44:45], v203 offset:4096
  ds_read_b64_tr_b16 v[46:47], v11 offset:10240
  v_mfma_f32_16x16x32_bf16 v[168:171], v[68:71], v[28:31], v[168:171]
  v_mfma_f32_16x16x32_bf16 v[156:159], v[72:75], v[24:27], v[156:159]
  v_mfma_f32_16x16x32_bf16 v[172:175], v[72:75], v[28:31], v[172:175]
  s_waitcnt lgkmcnt(0)
  v_mfma_f32_16x16x32_bf16 v[144:147], v[32:35], v[16:19], v[144:147]
  ds_read_b128 v[24:27], v234 offset:1024
  ds_read_b64_tr_b16 v[60:61], v8 offset:12288
  v_mfma_f32_16x16x32_bf16 v[160:163], v[32:35], v[20:23], v[160:163]
  ds_read_b64_tr_b16 v[62:63], v8 offset:14336
  ds_read_b128 v[28:31], v234 offset:3072
  v_mfma_f32_16x16x32_bf16 v[148:151], v[36:39], v[16:19], v[148:151]
  ds_read_b64_tr_b16 v[64:65], v9 offset:12288
  ds_read_b64_tr_b16 v[66:67], v9 offset:14336
  v_mfma_f32_16x16x32_bf16 v[164:167], v[36:39], v[20:23], v[164:167]
  ds_read_b64_tr_b16 v[68:69], v10 offset:12288
  ds_read_b64_tr_b16 v[70:71], v10 offset:14336
  v_mfma_f32_16x16x32_bf16 v[152:155], v[40:43], v[16:19], v[152:155]
  ds_read_b64_tr_b16 v[72:73], v11 offset:12288
  ds_read_b64_tr_b16 v[74:75], v11 offset:14336
  v_mfma_f32_16x16x32_bf16 v[168:171], v[40:43], v[20:23], v[168:171]
  v_mfma_f32_16x16x32_bf16 v[156:159], v[44:47], v[16:19], v[156:159]
  v_mfma_f32_16x16x32_bf16 v[172:175], v[44:47], v[20:23], v[172:175]
  s_waitcnt lgkmcnt(0)
  s_barrier
  v_mfma_f32_16x16x32_bf16 v[144:147], v[60:63], v[24:27], v[144:147]
  ds_read_b128 v[16:19], v236 offset:0
  ds_read_b64_tr_b16 v[32:33], v200 offset:8192
  v_mfma_f32_16x16x32_bf16 v[160:163], v[60:63], v[28:31], v[160:163]
  ds_read_b64_tr_b16 v[34:35], v8 offset:20480
  ds_read_b128 v[20:23], v236 offset:2048
  v_mfma_f32_16x16x32_bf16 v[148:151], v[64:67], v[24:27], v[148:151]
  ds_read_b64_tr_b16 v[36:37], v201 offset:8192
  ds_read_b64_tr_b16 v[38:39], v9 offset:20480
  v_mfma_f32_16x16x32_bf16 v[164:167], v[64:67], v[28:31], v[164:167]
  ds_read_b64_tr_b16 v[40:41], v202 offset:8192
  ds_read_b64_tr_b16 v[42:43], v10 offset:20480
  v_mfma_f32_16x16x32_bf16 v[152:155], v[68:71], v[24:27], v[152:155]
  ds_read_b64_tr_b16 v[44:45], v203 offset:8192
  ds_read_b64_tr_b16 v[46:47], v11 offset:20480
  v_mfma_f32_16x16x32_bf16 v[168:171], v[68:71], v[28:31], v[168:171]
  v_mfma_f32_16x16x32_bf16 v[156:159], v[72:75], v[24:27], v[156:159]
  v_mfma_f32_16x16x32_bf16 v[172:175], v[72:75], v[28:31], v[172:175]
  s_waitcnt lgkmcnt(0)
  v_mfma_f32_16x16x32_bf16 v[144:147], v[32:35], v[16:19], v[144:147]
  ds_read_b128 v[24:27], v236 offset:1024
  ds_read_b64_tr_b16 v[60:61], v8 offset:22528
  v_mfma_f32_16x16x32_bf16 v[160:163], v[32:35], v[20:23], v[160:163]
  ds_read_b64_tr_b16 v[62:63], v8 offset:24576
  ds_read_b128 v[28:31], v236 offset:3072
  v_mfma_f32_16x16x32_bf16 v[148:151], v[36:39], v[16:19], v[148:151]
  ds_read_b64_tr_b16 v[64:65], v9 offset:22528
  ds_read_b64_tr_b16 v[66:67], v9 offset:24576
  v_mfma_f32_16x16x32_bf16 v[164:167], v[36:39], v[20:23], v[164:167]
  ds_read_b64_tr_b16 v[68:69], v10 offset:22528
  ds_read_b64_tr_b16 v[70:71], v10 offset:24576
  v_mfma_f32_16x16x32_bf16 v[152:155], v[40:43], v[16:19], v[152:155]
  ds_read_b64_tr_b16 v[72:73], v11 offset:22528
  ds_read_b64_tr_b16 v[74:75], v11 offset:24576
  v_mfma_f32_16x16x32_bf16 v[168:171], v[40:43], v[20:23], v[168:171]
  v_mfma_f32_16x16x32_bf16 v[156:159], v[44:47], v[16:19], v[156:159]
  v_mfma_f32_16x16x32_bf16 v[172:175], v[44:47], v[20:23], v[172:175]
  s_waitcnt lgkmcnt(0)
  s_barrier
  v_mfma_f32_16x16x32_bf16 v[144:147], v[60:63], v[24:27], v[144:147]
  ds_read_b64 v[16:17], v238 offset:0
  ds_read_b64 v[18:19], v238 offset:2048
  v_mfma_f32_16x16x32_bf16 v[160:163], v[60:63], v[28:31], v[160:163]
  ds_read_b64_tr_b16 v[32:33], v200 offset:12288
  ds_read_b64_tr_b16 v[34:35], v8 offset:30720
  v_mfma_f32_16x16x32_bf16 v[148:151], v[64:67], v[24:27], v[148:151]
  ds_read_b64 v[20:21], v238 offset:8
  ds_read_b64 v[22:23], v238 offset:2056
  v_mfma_f32_16x16x32_bf16 v[164:167], v[64:67], v[28:31], v[164:167]
  ds_read_b64_tr_b16 v[36:37], v201 offset:12288
  ds_read_b64_tr_b16 v[38:39], v9 offset:30720
  v_mfma_f32_16x16x32_bf16 v[152:155], v[68:71], v[24:27], v[152:155]
  ds_read_b64_tr_b16 v[40:41], v202 offset:12288
  ds_read_b64_tr_b16 v[42:43], v10 offset:30720
  v_mfma_f32_16x16x32_bf16 v[168:171], v[68:71], v[28:31], v[168:171]
  ds_read_b64_tr_b16 v[44:45], v203 offset:12288
  ds_read_b64_tr_b16 v[46:47], v11 offset:30720
  v_mfma_f32_16x16x32_bf16 v[156:159], v[72:75], v[24:27], v[156:159]
  v_mfma_f32_16x16x32_bf16 v[172:175], v[72:75], v[28:31], v[172:175]
  s_waitcnt lgkmcnt(0)
  v_mfma_f32_16x16x32_bf16 v[144:147], v[32:35], v[16:19], v[144:147]
  ds_read_b128 v[24:27], v238 offset:1024
  ds_read_b64_tr_b16 v[60:61], v8 offset:32768
  v_mfma_f32_16x16x32_bf16 v[160:163], v[32:35], v[20:23], v[160:163]
  ds_read_b64_tr_b16 v[62:63], v8 offset:34816
  ds_read_b128 v[28:31], v238 offset:3072
  v_mfma_f32_16x16x32_bf16 v[148:151], v[36:39], v[16:19], v[148:151]
  ds_read_b64_tr_b16 v[64:65], v9 offset:32768
  ds_read_b64_tr_b16 v[66:67], v9 offset:34816
  v_mfma_f32_16x16x32_bf16 v[164:167], v[36:39], v[20:23], v[164:167]
  ds_read_b64_tr_b16 v[68:69], v10 offset:32768
  ds_read_b64_tr_b16 v[70:71], v10 offset:34816
  v_mfma_f32_16x16x32_bf16 v[152:155], v[40:43], v[16:19], v[152:155]
  ds_read_b64_tr_b16 v[72:73], v11 offset:32768
  ds_read_b64_tr_b16 v[74:75], v11 offset:34816
  v_mfma_f32_16x16x32_bf16 v[168:171], v[40:43], v[20:23], v[168:171]
  v_mfma_f32_16x16x32_bf16 v[156:159], v[44:47], v[16:19], v[156:159]
  v_mfma_f32_16x16x32_bf16 v[172:175], v[44:47], v[20:23], v[172:175]
  s_waitcnt lgkmcnt(0)
  s_barrier
  v_mfma_f32_16x16x32_bf16 v[144:147], v[60:63], v[24:27], v[144:147]
  ds_read_b128 v[16:19], v240 offset:0
  ds_read_b64_tr_b16 v[32:33], v200 offset:16384
  v_mfma_f32_16x16x32_bf16 v[160:163], v[60:63], v[28:31], v[160:163]
  ds_read_b64_tr_b16 v[34:35], v8 offset:0
  ds_read_b128 v[20:23], v240 offset:2048
  v_mfma_f32_16x16x32_bf16 v[148:151], v[64:67], v[24:27], v[148:151]
  ds_read_b64_tr_b16 v[36:37], v201 offset:16384
  ds_read_b64_tr_b16 v[38:39], v9 offset:0
  v_mfma_f32_16x16x32_bf16 v[164:167], v[64:67], v[28:31], v[164:167]
  ds_read_b64_tr_b16 v[40:41], v202 offset:16384
  ds_read_b64_tr_b16 v[42:43], v10 offset:0
  v_mfma_f32_16x16x32_bf16 v[152:155], v[68:71], v[24:27], v[152:155]
  ds_read_b64_tr_b16 v[44:45], v203 offset:16384
  ds_read_b64_tr_b16 v[46:47], v11 offset:0
  v_mfma_f32_16x16x32_bf16 v[168:171], v[68:71], v[28:31], v[168:171]
  v_mfma_f32_16x16x32_bf16 v[156:159], v[72:75], v[24:27], v[156:159]
  v_mfma_f32_16x16x32_bf16 v[172:175], v[72:75], v[28:31], v[172:175]
  s_waitcnt lgkmcnt(0)
  v_mfma_f32_16x16x32_bf16 v[144:147], v[32:35], v[16:19], v[144:147]
  ds_read_b128 v[24:27], v240 offset:1024
  ds_read_b64_tr_b16 v[60:61], v8 offset:2048
  v_mfma_f32_16x16x32_bf16 v[160:163], v[32:35], v[20:23], v[160:163]
  ds_read_b64_tr_b16 v[62:63], v8 offset:4096
  ds_read_b128 v[28:31], v240 offset:3072
  v_mfma_f32_16x16x32_bf16 v[148:151], v[36:39], v[16:19], v[148:151]
  ds_read_b64_tr_b16 v[64:65], v9 offset:2048
  ds_read_b64_tr_b16 v[66:67], v9 offset:4096
  v_mfma_f32_16x16x32_bf16 v[164:167], v[36:39], v[20:23], v[164:167]
  ds_read_b64_tr_b16 v[68:69], v10 offset:2048
  ds_read_b64_tr_b16 v[70:71], v10 offset:4096
  v_mfma_f32_16x16x32_bf16 v[152:155], v[40:43], v[16:19], v[152:155]
  ds_read_b64_tr_b16 v[72:73], v11 offset:2048
  ds_read_b64_tr_b16 v[74:75], v11 offset:4096
  v_mfma_f32_16x16x32_bf16 v[168:171], v[40:43], v[20:23], v[168:171]
  v_mfma_f32_16x16x32_bf16 v[156:159], v[44:47], v[16:19], v[156:159]
  v_mfma_f32_16x16x32_bf16 v[172:175], v[44:47], v[20:23], v[172:175]
  s_waitcnt lgkmcnt(0)
  s_barrier
  v_mfma_f32_16x16x32_bf16 v[144:147], v[60:63], v[24:27], v[144:147]
  ds_read_b128 v[16:19], v242 offset:0
  ds_read_b64_tr_b16 v[32:33], v200 offset:20480
  v_mfma_f32_16x16x32_bf16 v[160:163], v[60:63], v[28:31], v[160:163]
  ds_read_b64_tr_b16 v[34:35], v8 offset:10240
  ds_read_b128 v[20:23], v242 offset:2048
  v_mfma_f32_16x16x32_bf16 v[148:151], v[64:67], v[24:27], v[148:151]
  ds_read_b64_tr_b16 v[36:37], v201 offset:20480
  ds_read_b64_tr_b16 v[38:39], v9 offset:10240
  v_mfma_f32_16x16x32_bf16 v[164:167], v[64:67], v[28:31], v[164:167]
  ds_read_b64_tr_b16 v[40:41], v202 offset:20480
  ds_read_b64_tr_b16 v[42:43], v10 offset:10240
  v_mfma_f32_16x16x32_bf16 v[152:155], v[68:71], v[24:27], v[152:155]
  ds_read_b64_tr_b16 v[44:45], v203 offset:20480
  ds_read_b64_tr_b16 v[46:47], v11 offset:10240
  v_mfma_f32_16x16x32_bf16 v[168:171], v[68:71], v[28:31], v[168:171]
  v_mfma_f32_16x16x32_bf16 v[156:159], v[72:75], v[24:27], v[156:159]
  v_mfma_f32_16x16x32_bf16 v[172:175], v[72:75], v[28:31], v[172:175]
  s_waitcnt lgkmcnt(0)
  v_mfma_f32_16x16x32_bf16 v[144:147], v[32:35], v[16:19], v[144:147]
  ds_read_b128 v[24:27], v242 offset:1024
  ds_read_b64_tr_b16 v[60:61], v8 offset:12288
  v_mfma_f32_16x16x32_bf16 v[160:163], v[32:35], v[20:23], v[160:163]
  ds_read_b64_tr_b16 v[62:63], v8 offset:14336
  ds_read_b128 v[28:31], v242 offset:3072
  v_mfma_f32_16x16x32_bf16 v[148:151], v[36:39], v[16:19], v[148:151]
  ds_read_b64_tr_b16 v[64:65], v9 offset:12288
  ds_read_b64_tr_b16 v[66:67], v9 offset:14336
  v_mfma_f32_16x16x32_bf16 v[164:167], v[36:39], v[20:23], v[164:167]
  ds_read_b64_tr_b16 v[68:69], v10 offset:12288
  ds_read_b64_tr_b16 v[70:71], v10 offset:14336
  v_mfma_f32_16x16x32_bf16 v[152:155], v[40:43], v[16:19], v[152:155]
  ds_read_b64_tr_b16 v[72:73], v11 offset:12288
  ds_read_b64_tr_b16 v[74:75], v11 offset:14336
  v_mfma_f32_16x16x32_bf16 v[168:171], v[40:43], v[20:23], v[168:171]
  v_mfma_f32_16x16x32_bf16 v[156:159], v[44:47], v[16:19], v[156:159]
  v_mfma_f32_16x16x32_bf16 v[172:175], v[44:47], v[20:23], v[172:175]
  s_waitcnt lgkmcnt(0)
  s_barrier
  v_mfma_f32_16x16x32_bf16 v[144:147], v[60:63], v[24:27], v[144:147]
  ds_read_b128 v[16:19], v244 offset:0
  ds_read_b64_tr_b16 v[32:33], v200 offset:24576
  v_mfma_f32_16x16x32_bf16 v[160:163], v[60:63], v[28:31], v[160:163]
  ds_read_b64_tr_b16 v[34:35], v8 offset:20480
  ds_read_b128 v[20:23], v244 offset:2048
  v_mfma_f32_16x16x32_bf16 v[148:151], v[64:67], v[24:27], v[148:151]
  ds_read_b64_tr_b16 v[36:37], v201 offset:24576
  ds_read_b64_tr_b16 v[38:39], v9 offset:20480
  v_mfma_f32_16x16x32_bf16 v[164:167], v[64:67], v[28:31], v[164:167]
  ds_read_b64_tr_b16 v[40:41], v202 offset:24576
  ds_read_b64_tr_b16 v[42:43], v10 offset:20480
  v_mfma_f32_16x16x32_bf16 v[152:155], v[68:71], v[24:27], v[152:155]
  ds_read_b64_tr_b16 v[44:45], v203 offset:24576
  ds_read_b64_tr_b16 v[46:47], v11 offset:20480
  v_mfma_f32_16x16x32_bf16 v[168:171], v[68:71], v[28:31], v[168:171]
  v_mfma_f32_16x16x32_bf16 v[156:159], v[72:75], v[24:27], v[156:159]
  v_mfma_f32_16x16x32_bf16 v[172:175], v[72:75], v[28:31], v[172:175]
  s_waitcnt lgkmcnt(0)
  v_mfma_f32_16x16x32_bf16 v[144:147], v[32:35], v[16:19], v[144:147]
  ds_read_b64 v[24:25], v244 offset:1024
  ds_read_b64 v[26:27], v244 offset:3072
  v_mfma_f32_16x16x32_bf16 v[160:163], v[32:35], v[20:23], v[160:163]
  ds_read_b64_tr_b16 v[60:61], v8 offset:22528
  ds_read_b64_tr_b16 v[62:63], v8 offset:24576
  v_mfma_f32_16x16x32_bf16 v[148:151], v[36:39], v[16:19], v[148:151]
  ds_read_b64 v[28:29], v244 offset:1032
  ds_read_b64 v[30:31], v244 offset:3080
  v_mfma_f32_16x16x32_bf16 v[164:167], v[36:39], v[20:23], v[164:167]
  ds_read_b64_tr_b16 v[64:65], v9 offset:22528
  ds_read_b64_tr_b16 v[66:67], v9 offset:24576
  v_mfma_f32_16x16x32_bf16 v[152:155], v[40:43], v[16:19], v[152:155]
  ds_read_b64_tr_b16 v[68:69], v10 offset:22528
  ds_read_b64_tr_b16 v[70:71], v10 offset:24576
  v_mfma_f32_16x16x32_bf16 v[168:171], v[40:43], v[20:23], v[168:171]
  ds_read_b64_tr_b16 v[72:73], v11 offset:22528
  ds_read_b64_tr_b16 v[74:75], v11 offset:24576
  v_mfma_f32_16x16x32_bf16 v[156:159], v[44:47], v[16:19], v[156:159]
  v_mfma_f32_16x16x32_bf16 v[172:175], v[44:47], v[20:23], v[172:175]
  s_waitcnt lgkmcnt(0)
  s_barrier
  v_mfma_f32_16x16x32_bf16 v[144:147], v[60:63], v[24:27], v[144:147]
  ds_read_b128 v[16:19], v246 offset:0
  ds_read_b64_tr_b16 v[32:33], v200 offset:28672
  v_mfma_f32_16x16x32_bf16 v[160:163], v[60:63], v[28:31], v[160:163]
  ds_read_b64_tr_b16 v[34:35], v8 offset:30720
  ds_read_b128 v[20:23], v246 offset:2048
  v_mfma_f32_16x16x32_bf16 v[148:151], v[64:67], v[24:27], v[148:151]
  ds_read_b64_tr_b16 v[36:37], v201 offset:28672
  ds_read_b64_tr_b16 v[38:39], v9 offset:30720
  v_mfma_f32_16x16x32_bf16 v[164:167], v[64:67], v[28:31], v[164:167]
  ds_read_b64_tr_b16 v[40:41], v202 offset:28672
  ds_read_b64_tr_b16 v[42:43], v10 offset:30720
  v_mfma_f32_16x16x32_bf16 v[152:155], v[68:71], v[24:27], v[152:155]
  ds_read_b64_tr_b16 v[44:45], v203 offset:28672
  ds_read_b64_tr_b16 v[46:47], v11 offset:30720
  v_mfma_f32_16x16x32_bf16 v[168:171], v[68:71], v[28:31], v[168:171]
  v_mfma_f32_16x16x32_bf16 v[156:159], v[72:75], v[24:27], v[156:159]
  v_mfma_f32_16x16x32_bf16 v[172:175], v[72:75], v[28:31], v[172:175]
  s_waitcnt lgkmcnt(0)
  v_mfma_f32_16x16x32_bf16 v[144:147], v[32:35], v[16:19], v[144:147]
  ds_read_b128 v[24:27], v246 offset:1024
  ds_read_b64_tr_b16 v[60:61], v8 offset:32768
  v_mfma_f32_16x16x32_bf16 v[160:163], v[32:35], v[20:23], v[160:163]
  ds_read_b64_tr_b16 v[62:63], v8 offset:34816
  ds_read_b128 v[28:31], v246 offset:3072
  v_mfma_f32_16x16x32_bf16 v[148:151], v[36:39], v[16:19], v[148:151]
  ds_read_b64_tr_b16 v[64:65], v9 offset:32768
  ds_read_b64_tr_b16 v[66:67], v9 offset:34816
  v_mfma_f32_16x16x32_bf16 v[164:167], v[36:39], v[20:23], v[164:167]
  ds_read_b64_tr_b16 v[68:69], v10 offset:32768
  ds_read_b64_tr_b16 v[70:71], v10 offset:34816
  v_mfma_f32_16x16x32_bf16 v[152:155], v[40:43], v[16:19], v[152:155]
  ds_read_b64_tr_b16 v[72:73], v11 offset:32768
  ds_read_b64_tr_b16 v[74:75], v11 offset:34816
  v_mfma_f32_16x16x32_bf16 v[168:171], v[40:43], v[20:23], v[168:171]
  v_mfma_f32_16x16x32_bf16 v[156:159], v[44:47], v[16:19], v[156:159]
  v_mfma_f32_16x16x32_bf16 v[172:175], v[44:47], v[20:23], v[172:175]
  s_waitcnt lgkmcnt(0)
  s_barrier
  v_mfma_f32_16x16x32_bf16 v[144:147], v[60:63], v[24:27], v[144:147]
  ds_read_b128 v[16:19], v232 offset:0
  ds_read_b64_tr_b16 v[32:33], v200 offset:0
  v_mfma_f32_16x16x32_bf16 v[160:163], v[60:63], v[28:31], v[160:163]
  ds_read_b64_tr_b16 v[34:35], v8 offset:0
  ds_read_b128 v[20:23], v232 offset:2048
  v_mfma_f32_16x16x32_bf16 v[148:151], v[64:67], v[24:27], v[148:151]
  ds_read_b64_tr_b16 v[36:37], v201 offset:0
  ds_read_b64_tr_b16 v[38:39], v9 offset:0
  v_mfma_f32_16x16x32_bf16 v[164:167], v[64:67], v[28:31], v[164:167]
  ds_read_b64_tr_b16 v[40:41], v202 offset:0
  ds_read_b64_tr_b16 v[42:43], v10 offset:0
  v_mfma_f32_16x16x32_bf16 v[152:155], v[68:71], v[24:27], v[152:155]
  ds_read_b64_tr_b16 v[44:45], v203 offset:0
  ds_read_b64_tr_b16 v[46:47], v11 offset:0
  v_mfma_f32_16x16x32_bf16 v[168:171], v[68:71], v[28:31], v[168:171]
  v_mfma_f32_16x16x32_bf16 v[156:159], v[72:75], v[24:27], v[156:159]
  v_mfma_f32_16x16x32_bf16 v[172:175], v[72:75], v[28:31], v[172:175]
  s_waitcnt lgkmcnt(0)
  v_mfma_f32_16x16x32_bf16 v[144:147], v[32:35], v[16:19], v[144:147]
  ds_read_b128 v[24:27], v232 offset:1024
  ds_read_b64_tr_b16 v[60:61], v8 offset:2048
  v_mfma_f32_16x16x32_bf16 v[160:163], v[32:35], v[20:23], v[160:163]
  ds_read_b64_tr_b16 v[62:63], v8 offset:4096
  ds_read_b128 v[28:31], v232 offset:3072
  v_mfma_f32_16x16x32_bf16 v[148:151], v[36:39], v[16:19], v[148:151]
  ds_read_b64_tr_b16 v[64:65], v9 offset:2048
  ds_read_b64_tr_b16 v[66:67], v9 offset:4096
  v_mfma_f32_16x16x32_bf16 v[164:167], v[36:39], v[20:23], v[164:167]
  ds_read_b64_tr_b16 v[68:69], v10 offset:2048
  ds_read_b64_tr_b16 v[70:71], v10 offset:4096
  v_mfma_f32_16x16x32_bf16 v[152:155], v[40:43], v[16:19], v[152:155]
  ds_read_b64_tr_b16 v[72:73], v11 offset:2048
  ds_read_b64_tr_b16 v[74:75], v11 offset:4096
  v_mfma_f32_16x16x32_bf16 v[168:171], v[40:43], v[20:23], v[168:171]
  v_mfma_f32_16x16x32_bf16 v[156:159], v[44:47], v[16:19], v[156:159]
  v_mfma_f32_16x16x32_bf16 v[172:175], v[44:47], v[20:23], v[172:175]
  s_waitcnt lgkmcnt(0)
  s_barrier
  v_mfma_f32_16x16x32_bf16 v[144:147], v[60:63], v[24:27], v[144:147]
  ds_read_b128 v[16:19], v234 offset:0
  ds_read_b64_tr_b16 v[32:33], v200 offset:4096
  v_mfma_f32_16x16x32_bf16 v[160:163], v[60:63], v[28:31], v[160:163]
  ds_read_b64_tr_b16 v[34:35], v8 offset:10240
  ds_read_b128 v[20:23], v234 offset:2048
  v_mfma_f32_16x16x32_bf16 v[148:151], v[64:67], v[24:27], v[148:151]
  ds_read_b64_tr_b16 v[36:37], v201 offset:4096
  ds_read_b64_tr_b16 v[38:39], v9 offset:10240
  v_mfma_f32_16x16x32_bf16 v[164:167], v[64:67], v[28:31], v[164:167]
  ds_read_b64_tr_b16 v[40:41], v202 offset:4096
  ds_read_b64_tr_b16 v[42:43], v10 offset:10240
  v_mfma_f32_16x16x32_bf16 v[152:155], v[68:71], v[24:27], v[152:155]
  ds_read_b64_tr_b16 v[44:45], v203 offset:4096
  ds_read_b64_tr_b16 v[46:47], v11 offset:10240
  v_mfma_f32_16x16x32_bf16 v[168:171], v[68:71], v[28:31], v[168:171]
  v_mfma_f32_16x16x32_bf16 v[156:159], v[72:75], v[24:27], v[156:159]
  v_mfma_f32_16x16x32_bf16 v[172:175], v[72:75], v[28:31], v[172:175]
  s_waitcnt lgkmcnt(0)
  v_mfma_f32_16x16x32_bf16 v[144:147], v[32:35], v[16:19], v[144:147]
  ds_read_b128 v[24:27], v234 offset:1024
  ds_read_b64_tr_b16 v[60:61], v8 offset:12288
  v_mfma_f32_16x16x32_bf16 v[160:163], v[32:35], v[20:23], v[160:163]
  ds_read_b64_tr_b16 v[62:63], v8 offset:14336
  ds_read_b128 v[28:31], v234 offset:3072
  v_mfma_f32_16x16x32_bf16 v[148:151], v[36:39], v[16:19], v[148:151]
  ds_read_b64_tr_b16 v[64:65], v9 offset:12288
  ds_read_b64_tr_b16 v[66:67], v9 offset:14336
  v_mfma_f32_16x16x32_bf16 v[164:167], v[36:39], v[20:23], v[164:167]
  ds_read_b64_tr_b16 v[68:69], v10 offset:12288
  ds_read_b64_tr_b16 v[70:71], v10 offset:14336
  v_mfma_f32_16x16x32_bf16 v[152:155], v[40:43], v[16:19], v[152:155]
  ds_read_b64_tr_b16 v[72:73], v11 offset:12288
  ds_read_b64_tr_b16 v[74:75], v11 offset:14336
  v_mfma_f32_16x16x32_bf16 v[168:171], v[40:43], v[20:23], v[168:171]
  v_mfma_f32_16x16x32_bf16 v[156:159], v[44:47], v[16:19], v[156:159]
  v_mfma_f32_16x16x32_bf16 v[172:175], v[44:47], v[20:23], v[172:175]
  s_waitcnt lgkmcnt(0)
  s_barrier
  v_mfma_f32_16x16x32_bf16 v[144:147], v[60:63], v[24:27], v[144:147]
  ds_read_b64 v[16:17], v236 offset:0
  ds_read_b64 v[18:19], v236 offset:2048
  v_mfma_f32_16x16x32_bf16 v[160:163], v[60:63], v[28:31], v[160:163]
  ds_read_b64_tr_b16 v[32:33], v200 offset:8192
  ds_read_b64_tr_b16 v[34:35], v8 offset:20480
  v_mfma_f32_16x16x32_bf16 v[148:151], v[64:67], v[24:27], v[148:151]
  ds_read_b64 v[20:21], v236 offset:8
  ds_read_b64 v[22:23], v236 offset:2056
  v_mfma_f32_16x16x32_bf16 v[164:167], v[64:67], v[28:31], v[164:167]
  ds_read_b64_tr_b16 v[36:37], v201 offset:8192
  ds_read_b64_tr_b16 v[38:39], v9 offset:20480
  v_mfma_f32_16x16x32_bf16 v[152:155], v[68:71], v[24:27], v[152:155]
  ds_read_b64_tr_b16 v[40:41], v202 offset:8192
  ds_read_b64_tr_b16 v[42:43], v10 offset:20480
  v_mfma_f32_16x16x32_bf16 v[168:171], v[68:71], v[28:31], v[168:171]
  ds_read_b64_tr_b16 v[44:45], v203 offset:8192
  ds_read_b64_tr_b16 v[46:47], v11 offset:20480
  v_mfma_f32_16x16x32_bf16 v[156:159], v[72:75], v[24:27], v[156:159]
  v_mfma_f32_16x16x32_bf16 v[172:175], v[72:75], v[28:31], v[172:175]
  s_waitcnt lgkmcnt(0)
  v_mfma_f32_16x16x32_bf16 v[144:147], v[32:35], v[16:19], v[144:147]
  ds_read_b128 v[24:27], v236 offset:1024
  ds_read_b64_tr_b16 v[60:61], v8 offset:22528
  v_mfma_f32_16x16x32_bf16 v[160:163], v[32:35], v[20:23], v[160:163]
  ds_read_b64_tr_b16 v[62:63], v8 offset:24576
  ds_read_b128 v[28:31], v236 offset:3072
  v_mfma_f32_16x16x32_bf16 v[148:151], v[36:39], v[16:19], v[148:151]
  ds_read_b64_tr_b16 v[64:65], v9 offset:22528
  ds_read_b64_tr_b16 v[66:67], v9 offset:24576
  v_mfma_f32_16x16x32_bf16 v[164:167], v[36:39], v[20:23], v[164:167]
  ds_read_b64_tr_b16 v[68:69], v10 offset:22528
  ds_read_b64_tr_b16 v[70:71], v10 offset:24576
  v_mfma_f32_16x16x32_bf16 v[152:155], v[40:43], v[16:19], v[152:155]
  ds_read_b64_tr_b16 v[72:73], v11 offset:22528
  ds_read_b64_tr_b16 v[74:75], v11 offset:24576
  v_mfma_f32_16x16x32_bf16 v[168:171], v[40:43], v[20:23], v[168:171]
  v_mfma_f32_16x16x32_bf16 v[156:159], v[44:47], v[16:19], v[156:159]
  v_mfma_f32_16x16x32_bf16 v[172:175], v[44:47], v[20:23], v[172:175]
  s_waitcnt lgkmcnt(0)
  s_barrier
  v_mfma_f32_16x16x32_bf16 v[144:147], v[60:63], v[24:27], v[144:147]
  ds_read_b128 v[16:19], v238 offset:0
  ds_read_b64_tr_b16 v[32:33], v200 offset:12288
  v_mfma_f32_16x16x32_bf16 v[160:163], v[60:63], v[28:31], v[160:163]
  ds_read_b64_tr_b16 v[34:35], v8 offset:30720
  ds_read_b128 v[20:23], v238 offset:2048
  v_mfma_f32_16x16x32_bf16 v[148:151], v[64:67], v[24:27], v[148:151]
  ds_read_b64_tr_b16 v[36:37], v201 offset:12288
  ds_read_b64_tr_b16 v[38:39], v9 offset:30720
  v_mfma_f32_16x16x32_bf16 v[164:167], v[64:67], v[28:31], v[164:167]
  ds_read_b64_tr_b16 v[40:41], v202 offset:12288
  ds_read_b64_tr_b16 v[42:43], v10 offset:30720
  v_mfma_f32_16x16x32_bf16 v[152:155], v[68:71], v[24:27], v[152:155]
  ds_read_b64_tr_b16 v[44:45], v203 offset:12288
  ds_read_b64_tr_b16 v[46:47], v11 offset:30720
  v_mfma_f32_16x16x32_bf16 v[168:171], v[68:71], v[28:31], v[168:171]
  v_mfma_f32_16x16x32_bf16 v[156:159], v[72:75], v[24:27], v[156:159]
  v_mfma_f32_16x16x32_bf16 v[172:175], v[72:75], v[28:31], v[172:175]
  s_waitcnt lgkmcnt(0)
  v_mfma_f32_16x16x32_bf16 v[144:147], v[32:35], v[16:19], v[144:147]
  ds_read_b128 v[24:27], v238 offset:1024
  ds_read_b64_tr_b16 v[60:61], v8 offset:32768
  v_mfma_f32_16x16x32_bf16 v[160:163], v[32:35], v[20:23], v[160:163]
  ds_read_b64_tr_b16 v[62:63], v8 offset:34816
  ds_read_b128 v[28:31], v238 offset:3072
  v_mfma_f32_16x16x32_bf16 v[148:151], v[36:39], v[16:19], v[148:151]
  ds_read_b64_tr_b16 v[64:65], v9 offset:32768
  ds_read_b64_tr_b16 v[66:67], v9 offset:34816
  v_mfma_f32_16x16x32_bf16 v[164:167], v[36:39], v[20:23], v[164:167]
  ds_read_b64_tr_b16 v[68:69], v10 offset:32768
  ds_read_b64_tr_b16 v[70:71], v10 offset:34816
  v_mfma_f32_16x16x32_bf16 v[152:155], v[40:43], v[16:19], v[152:155]
  ds_read_b64_tr_b16 v[72:73], v11 offset:32768
  ds_read_b64_tr_b16 v[74:75], v11 offset:34816
  v_mfma_f32_16x16x32_bf16 v[168:171], v[40:43], v[20:23], v[168:171]
  v_mfma_f32_16x16x32_bf16 v[156:159], v[44:47], v[16:19], v[156:159]
  v_mfma_f32_16x16x32_bf16 v[172:175], v[44:47], v[20:23], v[172:175]
  s_waitcnt lgkmcnt(0)
  s_barrier
  v_mfma_f32_16x16x32_bf16 v[144:147], v[60:63], v[24:27], v[144:147]
  ds_read_b128 v[16:19], v240 offset:0
  ds_read_b64_tr_b16 v[32:33], v200 offset:16384
  v_mfma_f32_16x16x32_bf16 v[160:163], v[60:63], v[28:31], v[160:163]
  ds_read_b64_tr_b16 v[34:35], v8 offset:0
  ds_read_b128 v[20:23], v240 offset:2048
  v_mfma_f32_16x16x32_bf16 v[148:151], v[64:67], v[24:27], v[148:151]
  ds_read_b64_tr_b16 v[36:37], v201 offset:16384
  ds_read_b64_tr_b16 v[38:39], v9 offset:0
  v_mfma_f32_16x16x32_bf16 v[164:167], v[64:67], v[28:31], v[164:167]
  ds_read_b64_tr_b16 v[40:41], v202 offset:16384
  ds_read_b64_tr_b16 v[42:43], v10 offset:0
  v_mfma_f32_16x16x32_bf16 v[152:155], v[68:71], v[24:27], v[152:155]
  ds_read_b64_tr_b16 v[44:45], v203 offset:16384
  ds_read_b64_tr_b16 v[46:47], v11 offset:0
  v_mfma_f32_16x16x32_bf16 v[168:171], v[68:71], v[28:31], v[168:171]
  v_mfma_f32_16x16x32_bf16 v[156:159], v[72:75], v[24:27], v[156:159]
  v_mfma_f32_16x16x32_bf16 v[172:175], v[72:75], v[28:31], v[172:175]
  s_waitcnt lgkmcnt(0)
  v_mfma_f32_16x16x32_bf16 v[144:147], v[32:35], v[16:19], v[144:147]
  ds_read_b128 v[24:27], v240 offset:1024
  ds_read_b64_tr_b16 v[60:61], v8 offset:2048
  v_mfma_f32_16x16x32_bf16 v[160:163], v[32:35], v[20:23], v[160:163]
  ds_read_b64_tr_b16 v[62:63], v8 offset:4096
  ds_read_b128 v[28:31], v240 offset:3072
  v_mfma_f32_16x16x32_bf16 v[148:151], v[36:39], v[16:19], v[148:151]
  ds_read_b64_tr_b16 v[64:65], v9 offset:2048
  ds_read_b64_tr_b16 v[66:67], v9 offset:4096
  v_mfma_f32_16x16x32_bf16 v[164:167], v[36:39], v[20:23], v[164:167]
  ds_read_b64_tr_b16 v[68:69], v10 offset:2048
  ds_read_b64_tr_b16 v[70:71], v10 offset:4096
  v_mfma_f32_16x16x32_bf16 v[152:155], v[40:43], v[16:19], v[152:155]
  ds_read_b64_tr_b16 v[72:73], v11 offset:2048
  ds_read_b64_tr_b16 v[74:75], v11 offset:4096
  v_mfma_f32_16x16x32_bf16 v[168:171], v[40:43], v[20:23], v[168:171]
  v_mfma_f32_16x16x32_bf16 v[156:159], v[44:47], v[16:19], v[156:159]
  v_mfma_f32_16x16x32_bf16 v[172:175], v[44:47], v[20:23], v[172:175]
  s_waitcnt lgkmcnt(0)
  s_barrier
  v_mfma_f32_16x16x32_bf16 v[144:147], v[60:63], v[24:27], v[144:147]
  ds_read_b128 v[16:19], v242 offset:0
  ds_read_b64_tr_b16 v[32:33], v200 offset:20480
  v_mfma_f32_16x16x32_bf16 v[160:163], v[60:63], v[28:31], v[160:163]
  ds_read_b64_tr_b16 v[34:35], v8 offset:10240
  ds_read_b128 v[20:23], v242 offset:2048
  v_mfma_f32_16x16x32_bf16 v[148:151], v[64:67], v[24:27], v[148:151]
  ds_read_b64_tr_b16 v[36:37], v201 offset:20480
  ds_read_b64_tr_b16 v[38:39], v9 offset:10240
  v_mfma_f32_16x16x32_bf16 v[164:167], v[64:67], v[28:31], v[164:167]
  ds_read_b64_tr_b16 v[40:41], v202 offset:20480
  ds_read_b64_tr_b16 v[42:43], v10 offset:10240
  v_mfma_f32_16x16x32_bf16 v[152:155], v[68:71], v[24:27], v[152:155]
  ds_read_b64_tr_b16 v[44:45], v203 offset:20480
  ds_read_b64_tr_b16 v[46:47], v11 offset:10240
  v_mfma_f32_16x16x32_bf16 v[168:171], v[68:71], v[28:31], v[168:171]
  v_mfma_f32_16x16x32_bf16 v[156:159], v[72:75], v[24:27], v[156:159]
  v_mfma_f32_16x16x32_bf16 v[172:175], v[72:75], v[28:31], v[172:175]
  s_waitcnt lgkmcnt(0)
  v_mfma_f32_16x16x32_bf16 v[144:147], v[32:35], v[16:19], v[144:147]
  ds_read_b64 v[24:25], v242 offset:1024
  ds_read_b64 v[26:27], v242 offset:3072
  v_mfma_f32_16x16x32_bf16 v[160:163], v[32:35], v[20:23], v[160:163]
  ds_read_b64_tr_b16 v[60:61], v8 offset:12288
  ds_read_b64_tr_b16 v[62:63], v8 offset:14336
  v_mfma_f32_16x16x32_bf16 v[148:151], v[36:39], v[16:19], v[148:151]
  ds_read_b64 v[28:29], v242 offset:1032
  ds_read_b64 v[30:31], v242 offset:3080
  v_mfma_f32_16x16x32_bf16 v[164:167], v[36:39], v[20:23], v[164:167]
  ds_read_b64_tr_b16 v[64:65], v9 offset:12288
  ds_read_b64_tr_b16 v[66:67], v9 offset:14336
  v_mfma_f32_16x16x32_bf16 v[152:155], v[40:43], v[16:19], v[152:155]
  ds_read_b64_tr_b16 v[68:69], v10 offset:12288
  ds_read_b64_tr_b16 v[70:71], v10 offset:14336
  v_mfma_f32_16x16x32_bf16 v[168:171], v[40:43], v[20:23], v[168:171]
  ds_read_b64_tr_b16 v[72:73], v11 offset:12288
  ds_read_b64_tr_b16 v[74:75], v11 offset:14336
  v_mfma_f32_16x16x32_bf16 v[156:159], v[44:47], v[16:19], v[156:159]
  v_mfma_f32_16x16x32_bf16 v[172:175], v[44:47], v[20:23], v[172:175]
  s_waitcnt lgkmcnt(0)
  s_barrier
  v_mfma_f32_16x16x32_bf16 v[144:147], v[60:63], v[24:27], v[144:147]
  ds_read_b128 v[16:19], v244 offset:0
  ds_read_b64_tr_b16 v[32:33], v200 offset:24576
  v_mfma_f32_16x16x32_bf16 v[160:163], v[60:63], v[28:31], v[160:163]
  ds_read_b64_tr_b16 v[34:35], v8 offset:20480
  ds_read_b128 v[20:23], v244 offset:2048
  v_mfma_f32_16x16x32_bf16 v[148:151], v[64:67], v[24:27], v[148:151]
  ds_read_b64_tr_b16 v[36:37], v201 offset:24576
  ds_read_b64_tr_b16 v[38:39], v9 offset:20480
  v_mfma_f32_16x16x32_bf16 v[164:167], v[64:67], v[28:31], v[164:167]
  ds_read_b64_tr_b16 v[40:41], v202 offset:24576
  ds_read_b64_tr_b16 v[42:43], v10 offset:20480
  v_mfma_f32_16x16x32_bf16 v[152:155], v[68:71], v[24:27], v[152:155]
  ds_read_b64_tr_b16 v[44:45], v203 offset:24576
  ds_read_b64_tr_b16 v[46:47], v11 offset:20480
  v_mfma_f32_16x16x32_bf16 v[168:171], v[68:71], v[28:31], v[168:171]
  v_mfma_f32_16x16x32_bf16 v[156:159], v[72:75], v[24:27], v[156:159]
  v_mfma_f32_16x16x32_bf16 v[172:175], v[72:75], v[28:31], v[172:175]
  s_waitcnt lgkmcnt(0)
  v_mfma_f32_16x16x32_bf16 v[144:147], v[32:35], v[16:19], v[144:147]
  ds_read_b128 v[24:27], v244 offset:1024
  ds_read_b64_tr_b16 v[60:61], v8 offset:22528
  v_mfma_f32_16x16x32_bf16 v[160:163], v[32:35], v[20:23], v[160:163]
  ds_read_b64_tr_b16 v[62:63], v8 offset:24576
  ds_read_b128 v[28:31], v244 offset:3072
  v_mfma_f32_16x16x32_bf16 v[148:151], v[36:39], v[16:19], v[148:151]
  ds_read_b64_tr_b16 v[64:65], v9 offset:22528
  ds_read_b64_tr_b16 v[66:67], v9 offset:24576
  v_mfma_f32_16x16x32_bf16 v[164:167], v[36:39], v[20:23], v[164:167]
  ds_read_b64_tr_b16 v[68:69], v10 offset:22528
  ds_read_b64_tr_b16 v[70:71], v10 offset:24576
  v_mfma_f32_16x16x32_bf16 v[152:155], v[40:43], v[16:19], v[152:155]
  ds_read_b64_tr_b16 v[72:73], v11 offset:22528
  ds_read_b64_tr_b16 v[74:75], v11 offset:24576
  v_mfma_f32_16x16x32_bf16 v[168:171], v[40:43], v[20:23], v[168:171]
  v_mfma_f32_16x16x32_bf16 v[156:159], v[44:47], v[16:19], v[156:159]
  v_mfma_f32_16x16x32_bf16 v[172:175], v[44:47], v[20:23], v[172:175]
  s_waitcnt lgkmcnt(0)
  s_barrier
  v_mfma_f32_16x16x32_bf16 v[144:147], v[60:63], v[24:27], v[144:147]
  ds_read_b128 v[16:19], v246 offset:0
  ds_read_b64_tr_b16 v[32:33], v200 offset:28672
  v_mfma_f32_16x16x32_bf16 v[160:163], v[60:63], v[28:31], v[160:163]
  ds_read_b64_tr_b16 v[34:35], v8 offset:30720
  ds_read_b128 v[20:23], v246 offset:2048
  v_mfma_f32_16x16x32_bf16 v[148:151], v[64:67], v[24:27], v[148:151]
  ds_read_b64_tr_b16 v[36:37], v201 offset:28672
  ds_read_b64_tr_b16 v[38:39], v9 offset:30720
  v_mfma_f32_16x16x32_bf16 v[164:167], v[64:67], v[28:31], v[164:167]
  ds_read_b64_tr_b16 v[40:41], v202 offset:28672
  ds_read_b64_tr_b16 v[42:43], v10 offset:30720
  v_mfma_f32_16x16x32_bf16 v[152:155], v[68:71], v[24:27], v[152:155]
  ds_read_b64_tr_b16 v[44:45], v203 offset:28672
  ds_read_b64_tr_b16 v[46:47], v11 offset:30720
  v_mfma_f32_16x16x32_bf16 v[168:171], v[68:71], v[28:31], v[168:171]
  v_mfma_f32_16x16x32_bf16 v[156:159], v[72:75], v[24:27], v[156:159]
  v_mfma_f32_16x16x32_bf16 v[172:175], v[72:75], v[28:31], v[172:175]
  s_waitcnt lgkmcnt(0)
  v_mfma_f32_16x16x32_bf16 v[144:147], v[32:35], v[16:19], v[144:147]
  ds_read_b128 v[24:27], v246 offset:1024
  ds_read_b64_tr_b16 v[60:61], v8 offset:32768
  v_mfma_f32_16x16x32_bf16 v[160:163], v[32:35], v[20:23], v[160:163]
  ds_read_b64_tr_b16 v[62:63], v8 offset:34816
  ds_read_b128 v[28:31], v246 offset:3072
  v_mfma_f32_16x16x32_bf16 v[148:151], v[36:39], v[16:19], v[148:151]
  ds_read_b64_tr_b16 v[64:65], v9 offset:32768
  ds_read_b64_tr_b16 v[66:67], v9 offset:34816
  v_mfma_f32_16x16x32_bf16 v[164:167], v[36:39], v[20:23], v[164:167]
  ds_read_b64_tr_b16 v[68:69], v10 offset:32768
  ds_read_b64_tr_b16 v[70:71], v10 offset:34816
  v_mfma_f32_16x16x32_bf16 v[152:155], v[40:43], v[16:19], v[152:155]
  ds_read_b64_tr_b16 v[72:73], v11 offset:32768
  ds_read_b64_tr_b16 v[74:75], v11 offset:34816
  v_mfma_f32_16x16x32_bf16 v[168:171], v[40:43], v[20:23], v[168:171]
  v_mfma_f32_16x16x32_bf16 v[156:159], v[44:47], v[16:19], v[156:159]
  v_mfma_f32_16x16x32_bf16 v[172:175], v[44:47], v[20:23], v[172:175]
  s_waitcnt lgkmcnt(0)
  s_barrier
  v_mfma_f32_16x16x32_bf16 v[144:147], v[60:63], v[24:27], v[144:147]
  ds_read_b128 v[16:19], v232 offset:0
  ds_read_b64_tr_b16 v[32:33], v200 offset:0
  v_mfma_f32_16x16x32_bf16 v[160:163], v[60:63], v[28:31], v[160:163]
  ds_read_b64_tr_b16 v[34:35], v8 offset:0
  ds_read_b128 v[20:23], v232 offset:2048
  v_mfma_f32_16x16x32_bf16 v[148:151], v[64:67], v[24:27], v[148:151]
  ds_read_b64_tr_b16 v[36:37], v201 offset:0
  ds_read_b64_tr_b16 v[38:39], v9 offset:0
  v_mfma_f32_16x16x32_bf16 v[164:167], v[64:67], v[28:31], v[164:167]
  ds_read_b64_tr_b16 v[40:41], v202 offset:0
  ds_read_b64_tr_b16 v[42:43], v10 offset:0
  v_mfma_f32_16x16x32_bf16 v[152:155], v[68:71], v[24:27], v[152:155]
  ds_read_b64_tr_b16 v[44:45], v203 offset:0
  ds_read_b64_tr_b16 v[46:47], v11 offset:0
  v_mfma_f32_16x16x32_bf16 v[168:171], v[68:71], v[28:31], v[168:171]
  v_mfma_f32_16x16x32_bf16 v[156:159], v[72:75], v[24:27], v[156:159]
  v_mfma_f32_16x16x32_bf16 v[172:175], v[72:75], v[28:31], v[172:175]
  s_waitcnt lgkmcnt(0)
  v_mfma_f32_16x16x32_bf16 v[144:147], v[32:35], v[16:19], v[144:147]
  ds_read_b128 v[24:27], v232 offset:1024
  ds_read_b64_tr_b16 v[60:61], v8 offset:2048
  v_mfma_f32_16x16x32_bf16 v[160:163], v[32:35], v[20:23], v[160:163]
  ds_read_b64_tr_b16 v[62:63], v8 offset:4096
  ds_read_b128 v[28:31], v232 offset:3072
  v_mfma_f32_16x16x32_bf16 v[148:151], v[36:39], v[16:19], v[148:151]
  ds_read_b64_tr_b16 v[64:65], v9 offset:2048
  ds_read_b64_tr_b16 v[66:67], v9 offset:4096
  v_mfma_f32_16x16x32_bf16 v[164:167], v[36:39], v[20:23], v[164:167]
  ds_read_b64_tr_b16 v[68:69], v10 offset:2048
  ds_read_b64_tr_b16 v[70:71], v10 offset:4096
  v_mfma_f32_16x16x32_bf16 v[152:155], v[40:43], v[16:19], v[152:155]
  ds_read_b64_tr_b16 v[72:73], v11 offset:2048
  ds_read_b64_tr_b16 v[74:75], v11 offset:4096
  v_mfma_f32_16x16x32_bf16 v[168:171], v[40:43], v[20:23], v[168:171]
  v_mfma_f32_16x16x32_bf16 v[156:159], v[44:47], v[16:19], v[156:159]
  v_mfma_f32_16x16x32_bf16 v[172:175], v[44:47], v[20:23], v[172:175]
  s_waitcnt lgkmcnt(0)
  s_barrier
  v_mfma_f32_16x16x32_bf16 v[144:147], v[60:63], v[24:27], v[144:147]
  ds_read_b64 v[16:17], v234 offset:0
  ds_read_b64 v[18:19], v234 offset:2048
  v_mfma_f32_16x16x32_bf16 v[160:163], v[60:63], v[28:31], v[160:163]
  ds_read_b64_tr_b16 v[32:33], v200 offset:4096
  ds_read_b64_tr_b16 v[34:35], v8 offset:10240
  v_mfma_f32_16x16x32_bf16 v[148:151], v[64:67], v[24:27], v[148:151]
  ds_read_b64 v[20:21], v234 offset:8
  ds_read_b64 v[22:23], v234 offset:2056
  v_mfma_f32_16x16x32_bf16 v[164:167], v[64:67], v[28:31], v[164:167]
  ds_read_b64_tr_b16 v[36:37], v201 offset:4096
  ds_read_b64_tr_b16 v[38:39], v9 offset:10240
  v_mfma_f32_16x16x32_bf16 v[152:155], v[68:71], v[24:27], v[152:155]
  ds_read_b64_tr_b16 v[40:41], v202 offset:4096
  ds_read_b64_tr_b16 v[42:43], v10 offset:10240
  v_mfma_f32_16x16x32_bf16 v[168:171], v[68:71], v[28:31], v[168:171]
  ds_read_b64_tr_b16 v[44:45], v203 offset:4096
  ds_read_b64_tr_b16 v[46:47], v11 offset:10240
  v_mfma_f32_16x16x32_bf16 v[156:159], v[72:75], v[24:27], v[156:159]
  v_mfma_f32_16x16x32_bf16 v[172:175], v[72:75], v[28:31], v[172:175]
  s_waitcnt lgkmcnt(0)
  v_mfma_f32_16x16x32_bf16 v[144:147], v[32:35], v[16:19], v[144:147]
  ds_read_b128 v[24:27], v234 offset:1024
  ds_read_b64_tr_b16 v[60:61], v8 offset:12288
  v_mfma_f32_16x16x32_bf16 v[160:163], v[32:35], v[20:23], v[160:163]
  ds_read_b64_tr_b16 v[62:63], v8 offset:14336
  ds_read_b128 v[28:31], v234 offset:3072
  v_mfma_f32_16x16x32_bf16 v[148:151], v[36:39], v[16:19], v[148:151]
  ds_read_b64_tr_b16 v[64:65], v9 offset:12288
  ds_read_b64_tr_b16 v[66:67], v9 offset:14336
  v_mfma_f32_16x16x32_bf16 v[164:167], v[36:39], v[20:23], v[164:167]
  ds_read_b64_tr_b16 v[68:69], v10 offset:12288
  ds_read_b64_tr_b16 v[70:71], v10 offset:14336
  v_mfma_f32_16x16x32_bf16 v[152:155], v[40:43], v[16:19], v[152:155]
  ds_read_b64_tr_b16 v[72:73], v11 offset:12288
  ds_read_b64_tr_b16 v[74:75], v11 offset:14336
  v_mfma_f32_16x16x32_bf16 v[168:171], v[40:43], v[20:23], v[168:171]
  v_mfma_f32_16x16x32_bf16 v[156:159], v[44:47], v[16:19], v[156:159]
  v_mfma_f32_16x16x32_bf16 v[172:175], v[44:47], v[20:23], v[172:175]
  s_waitcnt lgkmcnt(0)
  s_barrier
  v_mfma_f32_16x16x32_bf16 v[144:147], v[60:63], v[24:27], v[144:147]
  ds_read_b128 v[16:19], v236 offset:0
  ds_read_b64_tr_b16 v[32:33], v200 offset:8192
  v_mfma_f32_16x16x32_bf16 v[160:163], v[60:63], v[28:31], v[160:163]
  ds_read_b64_tr_b16 v[34:35], v8 offset:20480
  ds_read_b128 v[20:23], v236 offset:2048
  v_mfma_f32_16x16x32_bf16 v[148:151], v[64:67], v[24:27], v[148:151]
  ds_read_b64_tr_b16 v[36:37], v201 offset:8192
  ds_read_b64_tr_b16 v[38:39], v9 offset:20480
  v_mfma_f32_16x16x32_bf16 v[164:167], v[64:67], v[28:31], v[164:167]
  ds_read_b64_tr_b16 v[40:41], v202 offset:8192
  ds_read_b64_tr_b16 v[42:43], v10 offset:20480
  v_mfma_f32_16x16x32_bf16 v[152:155], v[68:71], v[24:27], v[152:155]
  ds_read_b64_tr_b16 v[44:45], v203 offset:8192
  ds_read_b64_tr_b16 v[46:47], v11 offset:20480
  v_mfma_f32_16x16x32_bf16 v[168:171], v[68:71], v[28:31], v[168:171]
  v_mfma_f32_16x16x32_bf16 v[156:159], v[72:75], v[24:27], v[156:159]
  v_mfma_f32_16x16x32_bf16 v[172:175], v[72:75], v[28:31], v[172:175]
  s_waitcnt lgkmcnt(0)
  v_mfma_f32_16x16x32_bf16 v[144:147], v[32:35], v[16:19], v[144:147]
  ds_read_b128 v[24:27], v236 offset:1024
  ds_read_b64_tr_b16 v[60:61], v8 offset:22528
  v_mfma_f32_16x16x32_bf16 v[160:163], v[32:35], v[20:23], v[160:163]
  ds_read_b64_tr_b16 v[62:63], v8 offset:24576
  ds_read_b128 v[28:31], v236 offset:3072
  v_mfma_f32_16x16x32_bf16 v[148:151], v[36:39], v[16:19], v[148:151]
  ds_read_b64_tr_b16 v[64:65], v9 offset:22528
  ds_read_b64_tr_b16 v[66:67], v9 offset:24576
  v_mfma_f32_16x16x32_bf16 v[164:167], v[36:39], v[20:23], v[164:167]
  ds_read_b64_tr_b16 v[68:69], v10 offset:22528
  ds_read_b64_tr_b16 v[70:71], v10 offset:24576
  v_mfma_f32_16x16x32_bf16 v[152:155], v[40:43], v[16:19], v[152:155]
  ds_read_b64_tr_b16 v[72:73], v11 offset:22528
  ds_read_b64_tr_b16 v[74:75], v11 offset:24576
  v_mfma_f32_16x16x32_bf16 v[168:171], v[40:43], v[20:23], v[168:171]
  v_mfma_f32_16x16x32_bf16 v[156:159], v[44:47], v[16:19], v[156:159]
  v_mfma_f32_16x16x32_bf16 v[172:175], v[44:47], v[20:23], v[172:175]
  s_waitcnt lgkmcnt(0)
  s_barrier
  v_mfma_f32_16x16x32_bf16 v[144:147], v[60:63], v[24:27], v[144:147]
  ds_read_b128 v[16:19], v238 offset:0
  ds_read_b64_tr_b16 v[32:33], v200 offset:12288
  v_mfma_f32_16x16x32_bf16 v[160:163], v[60:63], v[28:31], v[160:163]
  ds_read_b64_tr_b16 v[34:35], v8 offset:30720
  ds_read_b128 v[20:23], v238 offset:2048
  v_mfma_f32_16x16x32_bf16 v[148:151], v[64:67], v[24:27], v[148:151]
  ds_read_b64_tr_b16 v[36:37], v201 offset:12288
  ds_read_b64_tr_b16 v[38:39], v9 offset:30720
  v_mfma_f32_16x16x32_bf16 v[164:167], v[64:67], v[28:31], v[164:167]
  ds_read_b64_tr_b16 v[40:41], v202 offset:12288
  ds_read_b64_tr_b16 v[42:43], v10 offset:30720
  v_mfma_f32_16x16x32_bf16 v[152:155], v[68:71], v[24:27], v[152:155]
  ds_read_b64_tr_b16 v[44:45], v203 offset:12288
  ds_read_b64_tr_b16 v[46:47], v11 offset:30720
  v_mfma_f32_16x16x32_bf16 v[168:171], v[68:71], v[28:31], v[168:171]
  v_mfma_f32_16x16x32_bf16 v[156:159], v[72:75], v[24:27], v[156:159]
  v_mfma_f32_16x16x32_bf16 v[172:175], v[72:75], v[28:31], v[172:175]
  s_waitcnt lgkmcnt(0)
  v_mfma_f32_16x16x32_bf16 v[144:147], v[32:35], v[16:19], v[144:147]
  ds_read_b128 v[24:27], v238 offset:1024
  ds_read_b64_tr_b16 v[60:61], v8 offset:32768
  v_mfma_f32_16x16x32_bf16 v[160:163], v[32:35], v[20:23], v[160:163]
  ds_read_b64_tr_b16 v[62:63], v8 offset:34816
  ds_read_b128 v[28:31], v238 offset:3072
  v_mfma_f32_16x16x32_bf16 v[148:151], v[36:39], v[16:19], v[148:151]
  ds_read_b64_tr_b16 v[64:65], v9 offset:32768
  ds_read_b64_tr_b16 v[66:67], v9 offset:34816
  v_mfma_f32_16x16x32_bf16 v[164:167], v[36:39], v[20:23], v[164:167]
  ds_read_b64_tr_b16 v[68:69], v10 offset:32768
  ds_read_b64_tr_b16 v[70:71], v10 offset:34816
  v_mfma_f32_16x16x32_bf16 v[152:155], v[40:43], v[16:19], v[152:155]
  ds_read_b64_tr_b16 v[72:73], v11 offset:32768
  ds_read_b64_tr_b16 v[74:75], v11 offset:34816
  v_mfma_f32_16x16x32_bf16 v[168:171], v[40:43], v[20:23], v[168:171]
  v_mfma_f32_16x16x32_bf16 v[156:159], v[44:47], v[16:19], v[156:159]
  v_mfma_f32_16x16x32_bf16 v[172:175], v[44:47], v[20:23], v[172:175]
  s_waitcnt lgkmcnt(0)
  s_barrier
  v_mfma_f32_16x16x32_bf16 v[144:147], v[60:63], v[24:27], v[144:147]
  ds_read_b128 v[16:19], v240 offset:0
  ds_read_b64_tr_b16 v[32:33], v200 offset:16384
  v_mfma_f32_16x16x32_bf16 v[160:163], v[60:63], v[28:31], v[160:163]
  ds_read_b64_tr_b16 v[34:35], v8 offset:0
  ds_read_b128 v[20:23], v240 offset:2048
  v_mfma_f32_16x16x32_bf16 v[148:151], v[64:67], v[24:27], v[148:151]
  ds_read_b64_tr_b16 v[36:37], v201 offset:16384
  ds_read_b64_tr_b16 v[38:39], v9 offset:0
  v_mfma_f32_16x16x32_bf16 v[164:167], v[64:67], v[28:31], v[164:167]
  ds_read_b64_tr_b16 v[40:41], v202 offset:16384
  ds_read_b64_tr_b16 v[42:43], v10 offset:0
  v_mfma_f32_16x16x32_bf16 v[152:155], v[68:71], v[24:27], v[152:155]
  ds_read_b64_tr_b16 v[44:45], v203 offset:16384
  ds_read_b64_tr_b16 v[46:47], v11 offset:0
  v_mfma_f32_16x16x32_bf16 v[168:171], v[68:71], v[28:31], v[168:171]
  v_mfma_f32_16x16x32_bf16 v[156:159], v[72:75], v[24:27], v[156:159]
  v_mfma_f32_16x16x32_bf16 v[172:175], v[72:75], v[28:31], v[172:175]
  s_waitcnt lgkmcnt(0)
  v_mfma_f32_16x16x32_bf16 v[144:147], v[32:35], v[16:19], v[144:147]
  ds_read_b64 v[24:25], v240 offset:1024
  ds_read_b64 v[26:27], v240 offset:3072
  v_mfma_f32_16x16x32_bf16 v[160:163], v[32:35], v[20:23], v[160:163]
  ds_read_b64_tr_b16 v[60:61], v8 offset:2048
  ds_read_b64_tr_b16 v[62:63], v8 offset:4096
  v_mfma_f32_16x16x32_bf16 v[148:151], v[36:39], v[16:19], v[148:151]
  ds_read_b64 v[28:29], v240 offset:1032
  ds_read_b64 v[30:31], v240 offset:3080
  v_mfma_f32_16x16x32_bf16 v[164:167], v[36:39], v[20:23], v[164:167]
  ds_read_b64_tr_b16 v[64:65], v9 offset:2048
  ds_read_b64_tr_b16 v[66:67], v9 offset:4096
  v_mfma_f32_16x16x32_bf16 v[152:155], v[40:43], v[16:19], v[152:155]
  ds_read_b64_tr_b16 v[68:69], v10 offset:2048
  ds_read_b64_tr_b16 v[70:71], v10 offset:4096
  v_mfma_f32_16x16x32_bf16 v[168:171], v[40:43], v[20:23], v[168:171]
  ds_read_b64_tr_b16 v[72:73], v11 offset:2048
  ds_read_b64_tr_b16 v[74:75], v11 offset:4096
  v_mfma_f32_16x16x32_bf16 v[156:159], v[44:47], v[16:19], v[156:159]
  v_mfma_f32_16x16x32_bf16 v[172:175], v[44:47], v[20:23], v[172:175]
  s_waitcnt lgkmcnt(0)
  s_barrier
  v_mfma_f32_16x16x32_bf16 v[144:147], v[60:63], v[24:27], v[144:147]
  ds_read_b128 v[16:19], v242 offset:0
  ds_read_b64_tr_b16 v[32:33], v200 offset:20480
  v_mfma_f32_16x16x32_bf16 v[160:163], v[60:63], v[28:31], v[160:163]
  ds_read_b64_tr_b16 v[34:35], v8 offset:10240
  ds_read_b128 v[20:23], v242 offset:2048
  v_mfma_f32_16x16x32_bf16 v[148:151], v[64:67], v[24:27], v[148:151]
  ds_read_b64_tr_b16 v[36:37], v201 offset:20480
  ds_read_b64_tr_b16 v[38:39], v9 offset:10240
  v_mfma_f32_16x16x32_bf16 v[164:167], v[64:67], v[28:31], v[164:167]
  ds_read_b64_tr_b16 v[40:41], v202 offset:20480
  ds_read_b64_tr_b16 v[42:43], v10 offset:10240
  v_mfma_f32_16x16x32_bf16 v[152:155], v[68:71], v[24:27], v[152:155]
  ds_read_b64_tr_b16 v[44:45], v203 offset:20480
  ds_read_b64_tr_b16 v[46:47], v11 offset:10240
  v_mfma_f32_16x16x32_bf16 v[168:171], v[68:71], v[28:31], v[168:171]
  v_mfma_f32_16x16x32_bf16 v[156:159], v[72:75], v[24:27], v[156:159]
  v_mfma_f32_16x16x32_bf16 v[172:175], v[72:75], v[28:31], v[172:175]
  s_waitcnt lgkmcnt(0)
  v_mfma_f32_16x16x32_bf16 v[144:147], v[32:35], v[16:19], v[144:147]
  ds_read_b128 v[24:27], v242 offset:1024
  ds_read_b64_tr_b16 v[60:61], v8 offset:12288
  v_mfma_f32_16x16x32_bf16 v[160:163], v[32:35], v[20:23], v[160:163]
  ds_read_b64_tr_b16 v[62:63], v8 offset:14336
  ds_read_b128 v[28:31], v242 offset:3072
  v_mfma_f32_16x16x32_bf16 v[148:151], v[36:39], v[16:19], v[148:151]
  ds_read_b64_tr_b16 v[64:65], v9 offset:12288
  ds_read_b64_tr_b16 v[66:67], v9 offset:14336
  v_mfma_f32_16x16x32_bf16 v[164:167], v[36:39], v[20:23], v[164:167]
  ds_read_b64_tr_b16 v[68:69], v10 offset:12288
  ds_read_b64_tr_b16 v[70:71], v10 offset:14336
  v_mfma_f32_16x16x32_bf16 v[152:155], v[40:43], v[16:19], v[152:155]
  ds_read_b64_tr_b16 v[72:73], v11 offset:12288
  ds_read_b64_tr_b16 v[74:75], v11 offset:14336
  v_mfma_f32_16x16x32_bf16 v[168:171], v[40:43], v[20:23], v[168:171]
  v_mfma_f32_16x16x32_bf16 v[156:159], v[44:47], v[16:19], v[156:159]
  v_mfma_f32_16x16x32_bf16 v[172:175], v[44:47], v[20:23], v[172:175]
  s_waitcnt lgkmcnt(0)
  s_barrier
  v_mfma_f32_16x16x32_bf16 v[144:147], v[60:63], v[24:27], v[144:147]
  ds_read_b128 v[16:19], v244 offset:0
  ds_read_b64_tr_b16 v[32:33], v200 offset:24576
  v_mfma_f32_16x16x32_bf16 v[160:163], v[60:63], v[28:31], v[160:163]
  ds_read_b64_tr_b16 v[34:35], v8 offset:20480
  ds_read_b128 v[20:23], v244 offset:2048
  v_mfma_f32_16x16x32_bf16 v[148:151], v[64:67], v[24:27], v[148:151]
  ds_read_b64_tr_b16 v[36:37], v201 offset:24576
  ds_read_b64_tr_b16 v[38:39], v9 offset:20480
  v_mfma_f32_16x16x32_bf16 v[164:167], v[64:67], v[28:31], v[164:167]
  ds_read_b64_tr_b16 v[40:41], v202 offset:24576
  ds_read_b64_tr_b16 v[42:43], v10 offset:20480
  v_mfma_f32_16x16x32_bf16 v[152:155], v[68:71], v[24:27], v[152:155]
  ds_read_b64_tr_b16 v[44:45], v203 offset:24576
  ds_read_b64_tr_b16 v[46:47], v11 offset:20480
  v_mfma_f32_16x16x32_bf16 v[168:171], v[68:71], v[28:31], v[168:171]
  v_mfma_f32_16x16x32_bf16 v[156:159], v[72:75], v[24:27], v[156:159]
  v_mfma_f32_16x16x32_bf16 v[172:175], v[72:75], v[28:31], v[172:175]
  s_waitcnt lgkmcnt(0)
  v_mfma_f32_16x16x32_bf16 v[144:147], v[32:35], v[16:19], v[144:147]
  ds_read_b128 v[24:27], v244 offset:1024
  ds_read_b64_tr_b16 v[60:61], v8 offset:22528
  v_mfma_f32_16x16x32_bf16 v[160:163], v[32:35], v[20:23], v[160:163]
  ds_read_b64_tr_b16 v[62:63], v8 offset:24576
  ds_read_b128 v[28:31], v244 offset:3072
  v_mfma_f32_16x16x32_bf16 v[148:151], v[36:39], v[16:19], v[148:151]
  ds_read_b64_tr_b16 v[64:65], v9 offset:22528
  ds_read_b64_tr_b16 v[66:67], v9 offset:24576
  v_mfma_f32_16x16x32_bf16 v[164:167], v[36:39], v[20:23], v[164:167]
  ds_read_b64_tr_b16 v[68:69], v10 offset:22528
  ds_read_b64_tr_b16 v[70:71], v10 offset:24576
  v_mfma_f32_16x16x32_bf16 v[152:155], v[40:43], v[16:19], v[152:155]
  ds_read_b64_tr_b16 v[72:73], v11 offset:22528
  ds_read_b64_tr_b16 v[74:75], v11 offset:24576
  v_mfma_f32_16x16x32_bf16 v[168:171], v[40:43], v[20:23], v[168:171]
  v_mfma_f32_16x16x32_bf16 v[156:159], v[44:47], v[16:19], v[156:159]
  v_mfma_f32_16x16x32_bf16 v[172:175], v[44:47], v[20:23], v[172:175]
  s_waitcnt lgkmcnt(0)
  s_barrier
  v_mfma_f32_16x16x32_bf16 v[144:147], v[60:63], v[24:27], v[144:147]
  ds_read_b128 v[16:19], v246 offset:0
  ds_read_b64_tr_b16 v[32:33], v200 offset:28672
  v_mfma_f32_16x16x32_bf16 v[160:163], v[60:63], v[28:31], v[160:163]
  ds_read_b64_tr_b16 v[34:35], v8 offset:30720
  ds_read_b128 v[20:23], v246 offset:2048
  v_mfma_f32_16x16x32_bf16 v[148:151], v[64:67], v[24:27], v[148:151]
  ds_read_b64_tr_b16 v[36:37], v201 offset:28672
  ds_read_b64_tr_b16 v[38:39], v9 offset:30720
  v_mfma_f32_16x16x32_bf16 v[164:167], v[64:67], v[28:31], v[164:167]
  ds_read_b64_tr_b16 v[40:41], v202 offset:28672
  ds_read_b64_tr_b16 v[42:43], v10 offset:30720
  v_mfma_f32_16x16x32_bf16 v[152:155], v[68:71], v[24:27], v[152:155]
  ds_read_b64_tr_b16 v[44:45], v203 offset:28672
  ds_read_b64_tr_b16 v[46:47], v11 offset:30720
  v_mfma_f32_16x16x32_bf16 v[168:171], v[68:71], v[28:31], v[168:171]
  v_mfma_f32_16x16x32_bf16 v[156:159], v[72:75], v[24:27], v[156:159]
  v_mfma_f32_16x16x32_bf16 v[172:175], v[72:75], v[28:31], v[172:175]
  s_waitcnt lgkmcnt(0)
  v_mfma_f32_16x16x32_bf16 v[144:147], v[32:35], v[16:19], v[144:147]
  ds_read_b128 v[24:27], v246 offset:1024
  ds_read_b64_tr_b16 v[60:61], v8 offset:32768
  v_mfma_f32_16x16x32_bf16 v[160:163], v[32:35], v[20:23], v[160:163]
  ds_read_b64_tr_b16 v[62:63], v8 offset:34816
  ds_read_b128 v[28:31], v246 offset:3072
  v_mfma_f32_16x16x32_bf16 v[148:151], v[36:39], v[16:19], v[148:151]
  ds_read_b64_tr_b16 v[64:65], v9 offset:32768
  ds_read_b64_tr_b16 v[66:67], v9 offset:34816
  v_mfma_f32_16x16x32_bf16 v[164:167], v[36:39], v[20:23], v[164:167]
  ds_read_b64_tr_b16 v[68:69], v10 offset:32768
  ds_read_b64_tr_b16 v[70:71], v10 offset:34816
  v_mfma_f32_16x16x32_bf16 v[152:155], v[40:43], v[16:19], v[152:155]
  ds_read_b64_tr_b16 v[72:73], v11 offset:32768
  ds_read_b64_tr_b16 v[74:75], v11 offset:34816
  v_mfma_f32_16x16x32_bf16 v[168:171], v[40:43], v[20:23], v[168:171]
  v_mfma_f32_16x16x32_bf16 v[156:159], v[44:47], v[16:19], v[156:159]
  v_mfma_f32_16x16x32_bf16 v[172:175], v[44:47], v[20:23], v[172:175]
  s_waitcnt lgkmcnt(0)
  s_barrier
  v_mfma_f32_16x16x32_bf16 v[144:147], v[60:63], v[24:27], v[144:147]
  ds_read_b64 v[16:17], v232 offset:0
  ds_read_b64 v[18:19], v232 offset:2048
  v_mfma_f32_16x16x32_bf16 v[160:163], v[60:63], v[28:31], v[160:163]
  ds_read_b64_tr_b16 v[32:33], v200 offset:0
  ds_read_b64_tr_b16 v[34:35], v8 offset:0
  v_mfma_f32_16x16x32_bf16 v[148:151], v[64:67], v[24:27], v[148:151]
  ds_read_b64 v[20:21], v232 offset:8
  ds_read_b64 v[22:23], v232 offset:2056
  v_mfma_f32_16x16x32_bf16 v[164:167], v[64:67], v[28:31], v[164:167]
  ds_read_b64_tr_b16 v[36:37], v201 offset:0
  ds_read_b64_tr_b16 v[38:39], v9 offset:0
  v_mfma_f32_16x16x32_bf16 v[152:155], v[68:71], v[24:27], v[152:155]
  ds_read_b64_tr_b16 v[40:41], v202 offset:0
  ds_read_b64_tr_b16 v[42:43], v10 offset:0
  v_mfma_f32_16x16x32_bf16 v[168:171], v[68:71], v[28:31], v[168:171]
  ds_read_b64_tr_b16 v[44:45], v203 offset:0
  ds_read_b64_tr_b16 v[46:47], v11 offset:0
  v_mfma_f32_16x16x32_bf16 v[156:159], v[72:75], v[24:27], v[156:159]
  v_mfma_f32_16x16x32_bf16 v[172:175], v[72:75], v[28:31], v[172:175]
  s_waitcnt lgkmcnt(0)
  v_mfma_f32_16x16x32_bf16 v[144:147], v[32:35], v[16:19], v[144:147]
  ds_read_b128 v[24:27], v232 offset:1024
  ds_read_b64_tr_b16 v[60:61], v8 offset:2048
  v_and_b32 v210, 15, v14
  v_mfma_f32_16x16x32_bf16 v[160:163], v[32:35], v[20:23], v[160:163]
  ds_read_b64_tr_b16 v[62:63], v8 offset:4096
  ds_read_b128 v[28:31], v232 offset:3072
  v_lshrrev_b32 v211, 2, v210
  v_lshlrev_b32 v211, 3, v211
  v_mfma_f32_16x16x32_bf16 v[148:151], v[36:39], v[16:19], v[148:151]
  ds_read_b64_tr_b16 v[64:65], v9 offset:2048
  ds_read_b64_tr_b16 v[66:67], v9 offset:4096
  v_and_b32 v210, 3, v210
  v_add_u32 v211, v211, v210
  v_mfma_f32_16x16x32_bf16 v[164:167], v[36:39], v[20:23], v[164:167]
  ds_read_b64_tr_b16 v[68:69], v10 offset:2048
  ds_read_b64_tr_b16 v[70:71], v10 offset:4096
  v_lshlrev_b32 v211, 7, v211
  v_bfe_u32 v212, v14, 4, 1
  v_mfma_f32_16x16x32_bf16 v[152:155], v[40:43], v[16:19], v[152:155]
  ds_read_b64_tr_b16 v[72:73], v11 offset:2048
  ds_read_b64_tr_b16 v[74:75], v11 offset:4096
  v_lshlrev_b32 v212, 3, v212
  v_add_u32 v211, v211, v212
  v_mfma_f32_16x16x32_bf16 v[168:171], v[40:43], v[20:23], v[168:171]
  s_lshl_b32 s58, s52, 12
  v_add_u32 v211, s58, v211
  v_mfma_f32_16x16x32_bf16 v[156:159], v[44:47], v[16:19], v[156:159]
  v_lshrrev_b32 v212, 5, v14
  v_xor_b32 v212, v212, v210
  v_mfma_f32_16x16x32_bf16 v[172:175], v[44:47], v[20:23], v[172:175]
  v_xor_b32 v213, 0, v212
  v_lshlrev_b32 v213, 4, v213
  s_waitcnt lgkmcnt(0)
  s_barrier
  v_mfma_f32_16x16x32_bf16 v[144:147], v[60:63], v[24:27], v[144:147]
  ds_read_b128 v[16:19], v234 offset:0
  ds_read_b64_tr_b16 v[32:33], v200 offset:4096
  v_add_u32 v204, v211, v213
  v_mfma_f32_16x16x32_bf16 v[160:163], v[60:63], v[28:31], v[160:163]
  ds_read_b64_tr_b16 v[34:35], v8 offset:10240
  ds_read_b128 v[20:23], v234 offset:2048
  v_xor_b32 v213, 2, v212
  v_lshlrev_b32 v213, 4, v213
  v_mfma_f32_16x16x32_bf16 v[148:151], v[64:67], v[24:27], v[148:151]
  ds_read_b64_tr_b16 v[36:37], v201 offset:4096
  ds_read_b64_tr_b16 v[38:39], v9 offset:10240
  v_add_u32 v205, v211, v213
  v_xor_b32 v213, 4, v212
  v_mfma_f32_16x16x32_bf16 v[164:167], v[64:67], v[28:31], v[164:167]
  ds_read_b64_tr_b16 v[40:41], v202 offset:4096
  ds_read_b64_tr_b16 v[42:43], v10 offset:10240
  v_lshlrev_b32 v213, 4, v213
  v_add_u32 v206, v211, v213
  v_mfma_f32_16x16x32_bf16 v[152:155], v[68:71], v[24:27], v[152:155]
  ds_read_b64_tr_b16 v[44:45], v203 offset:4096
  ds_read_b64_tr_b16 v[46:47], v11 offset:10240
  v_xor_b32 v213, 6, v212
  v_lshlrev_b32 v213, 4, v213
  v_mfma_f32_16x16x32_bf16 v[168:171], v[68:71], v[28:31], v[168:171]
  v_add_u32 v207, v211, v213
  v_lshrrev_b32 v210, 3, v14
  v_mfma_f32_16x16x32_bf16 v[156:159], v[72:75], v[24:27], v[156:159]
  v_and_b32 v212, 7, v14
  v_xor_b32 v213, v212, v210
  v_mfma_f32_16x16x32_bf16 v[172:175], v[72:75], v[28:31], v[172:175]
  v_lshlrev_b32 v213, 4, v213
  v_lshlrev_b32 v211, 7, v210
  s_waitcnt lgkmcnt(0)
  v_mfma_f32_16x16x32_bf16 v[144:147], v[32:35], v[16:19], v[144:147]
  ds_read_b128 v[24:27], v234 offset:1024
  ds_read_b64_tr_b16 v[60:61], v8 offset:12288
  v_add_u32 v213, v213, v211
  v_mfma_f32_16x16x32_bf16 v[160:163], v[32:35], v[20:23], v[160:163]
  ds_read_b64_tr_b16 v[62:63], v8 offset:14336
  ds_read_b128 v[28:31], v234 offset:3072
  v_add_u32 v208, s58, v213
  s_lshl_b32 s58, s55, 5
  v_mfma_f32_16x16x32_bf16 v[148:151], v[36:39], v[16:19], v[148:151]
  ds_read_b64_tr_b16 v[64:65], v9 offset:12288
  ds_read_b64_tr_b16 v[66:67], v9 offset:14336
  s_lshl_b32 s59, s53, 7
  s_add_u32 s58, s58, s59
  v_mfma_f32_16x16x32_bf16 v[164:167], v[36:39], v[20:23], v[164:167]
  ds_read_b64_tr_b16 v[68:69], v10 offset:12288
  ds_read_b64_tr_b16 v[70:71], v10 offset:14336
  v_add_u32 v210, s58, v210
  v_lshlrev_b32 v210, 11, v210
  v_mfma_f32_16x16x32_bf16 v[152:155], v[40:43], v[16:19], v[152:155]
  ds_read_b64_tr_b16 v[72:73], v11 offset:12288
  ds_read_b64_tr_b16 v[74:75], v11 offset:14336
  v_lshlrev_b32 v212, 4, v212
  v_add_u32 v210, v210, v212
  v_mfma_f32_16x16x32_bf16 v[168:171], v[40:43], v[20:23], v[168:171]
  s_lshl_b32 s58, s54, 7
  v_add_u32 v209, s58, v210
  v_mfma_f32_16x16x32_bf16 v[156:159], v[44:47], v[16:19], v[156:159]
  v_mfma_f32_16x16x32_bf16 v[172:175], v[44:47], v[20:23], v[172:175]
  s_waitcnt lgkmcnt(0)
  s_barrier
  v_mfma_f32_16x16x32_bf16 v[144:147], v[60:63], v[24:27], v[144:147]
  ds_read_b128 v[16:19], v236 offset:0
  ds_read_b64_tr_b16 v[32:33], v200 offset:8192
  v_mfma_f32_16x16x32_bf16 v[160:163], v[60:63], v[28:31], v[160:163]
  ds_read_b64_tr_b16 v[34:35], v8 offset:20480
  ds_read_b128 v[20:23], v236 offset:2048
  v_mfma_f32_16x16x32_bf16 v[148:151], v[64:67], v[24:27], v[148:151]
  ds_read_b64_tr_b16 v[36:37], v201 offset:8192
  ds_read_b64_tr_b16 v[38:39], v9 offset:20480
  v_mfma_f32_16x16x32_bf16 v[164:167], v[64:67], v[28:31], v[164:167]
  ds_read_b64_tr_b16 v[40:41], v202 offset:8192
  ds_read_b64_tr_b16 v[42:43], v10 offset:20480
  v_mfma_f32_16x16x32_bf16 v[152:155], v[68:71], v[24:27], v[152:155]
  ds_read_b64_tr_b16 v[44:45], v203 offset:8192
  ds_read_b64_tr_b16 v[46:47], v11 offset:20480
  v_mfma_f32_16x16x32_bf16 v[168:171], v[68:71], v[28:31], v[168:171]
  v_mfma_f32_16x16x32_bf16 v[156:159], v[72:75], v[24:27], v[156:159]
  v_mfma_f32_16x16x32_bf16 v[172:175], v[72:75], v[28:31], v[172:175]
  s_waitcnt lgkmcnt(0)
  v_mfma_f32_16x16x32_bf16 v[144:147], v[32:35], v[16:19], v[144:147]
  ds_read_b128 v[24:27], v236 offset:1024
  ds_read_b64_tr_b16 v[60:61], v8 offset:22528
  v_mfma_f32_16x16x32_bf16 v[160:163], v[32:35], v[20:23], v[160:163]
  ds_read_b64_tr_b16 v[62:63], v8 offset:24576
  ds_read_b128 v[28:31], v236 offset:3072
  v_mfma_f32_16x16x32_bf16 v[148:151], v[36:39], v[16:19], v[148:151]
  ds_read_b64_tr_b16 v[64:65], v9 offset:22528
  ds_read_b64_tr_b16 v[66:67], v9 offset:24576
  v_mfma_f32_16x16x32_bf16 v[164:167], v[36:39], v[20:23], v[164:167]
  ds_read_b64_tr_b16 v[68:69], v10 offset:22528
  ds_read_b64_tr_b16 v[70:71], v10 offset:24576
  v_mfma_f32_16x16x32_bf16 v[152:155], v[40:43], v[16:19], v[152:155]
  ds_read_b64_tr_b16 v[72:73], v11 offset:22528
  ds_read_b64_tr_b16 v[74:75], v11 offset:24576
  v_mfma_f32_16x16x32_bf16 v[168:171], v[40:43], v[20:23], v[168:171]
  v_mfma_f32_16x16x32_bf16 v[156:159], v[44:47], v[16:19], v[156:159]
  v_mfma_f32_16x16x32_bf16 v[172:175], v[44:47], v[20:23], v[172:175]
  s_waitcnt lgkmcnt(0)
  s_barrier
  v_mfma_f32_16x16x32_bf16 v[144:147], v[60:63], v[24:27], v[144:147]
  ds_read_b128 v[16:19], v238 offset:0
  ds_read_b64_tr_b16 v[32:33], v200 offset:12288
  v_mfma_f32_16x16x32_bf16 v[160:163], v[60:63], v[28:31], v[160:163]
  ds_read_b64_tr_b16 v[34:35], v8 offset:30720
  ds_read_b128 v[20:23], v238 offset:2048
  v_mfma_f32_16x16x32_bf16 v[148:151], v[64:67], v[24:27], v[148:151]
  ds_read_b64_tr_b16 v[36:37], v201 offset:12288
  ds_read_b64_tr_b16 v[38:39], v9 offset:30720
  v_mfma_f32_16x16x32_bf16 v[164:167], v[64:67], v[28:31], v[164:167]
  ds_read_b64_tr_b16 v[40:41], v202 offset:12288
  ds_read_b64_tr_b16 v[42:43], v10 offset:30720
  v_mfma_f32_16x16x32_bf16 v[152:155], v[68:71], v[24:27], v[152:155]
  ds_read_b64_tr_b16 v[44:45], v203 offset:12288
  ds_read_b64_tr_b16 v[46:47], v11 offset:30720
  v_mfma_f32_16x16x32_bf16 v[168:171], v[68:71], v[28:31], v[168:171]
  v_mfma_f32_16x16x32_bf16 v[156:159], v[72:75], v[24:27], v[156:159]
  v_mfma_f32_16x16x32_bf16 v[172:175], v[72:75], v[28:31], v[172:175]
  s_waitcnt lgkmcnt(0)
  v_mfma_f32_16x16x32_bf16 v[144:147], v[32:35], v[16:19], v[144:147]
  ds_read_b64 v[24:25], v238 offset:1024
  ds_read_b64 v[26:27], v238 offset:3072
  v_mfma_f32_16x16x32_bf16 v[160:163], v[32:35], v[20:23], v[160:163]
  ds_read_b64_tr_b16 v[60:61], v8 offset:32768
  ds_read_b64_tr_b16 v[62:63], v8 offset:34816
  v_mfma_f32_16x16x32_bf16 v[148:151], v[36:39], v[16:19], v[148:151]
  ds_read_b64 v[28:29], v238 offset:1032
  ds_read_b64 v[30:31], v238 offset:3080
  v_mfma_f32_16x16x32_bf16 v[164:167], v[36:39], v[20:23], v[164:167]
  ds_read_b64_tr_b16 v[64:65], v9 offset:32768
  ds_read_b64_tr_b16 v[66:67], v9 offset:34816
  v_mfma_f32_16x16x32_bf16 v[152:155], v[40:43], v[16:19], v[152:155]
  ds_read_b64_tr_b16 v[68:69], v10 offset:32768
  ds_read_b64_tr_b16 v[70:71], v10 offset:34816
  v_mfma_f32_16x16x32_bf16 v[168:171], v[40:43], v[20:23], v[168:171]
  ds_read_b64_tr_b16 v[72:73], v11 offset:32768
  ds_read_b64_tr_b16 v[74:75], v11 offset:34816
  v_mfma_f32_16x16x32_bf16 v[156:159], v[44:47], v[16:19], v[156:159]
  v_mfma_f32_16x16x32_bf16 v[172:175], v[44:47], v[20:23], v[172:175]
  s_waitcnt lgkmcnt(0)
  v_mfma_f32_16x16x32_bf16 v[144:147], v[60:63], v[24:27], v[144:147]
  v_mfma_f32_16x16x32_bf16 v[160:163], v[60:63], v[28:31], v[160:163]
  v_mfma_f32_16x16x32_bf16 v[148:151], v[64:67], v[24:27], v[148:151]
  v_mfma_f32_16x16x32_bf16 v[164:167], v[64:67], v[28:31], v[164:167]
  v_mfma_f32_16x16x32_bf16 v[152:155], v[68:71], v[24:27], v[152:155]
  v_mfma_f32_16x16x32_bf16 v[168:171], v[68:71], v[28:31], v[168:171]
  v_mfma_f32_16x16x32_bf16 v[156:159], v[72:75], v[24:27], v[156:159]
  v_mfma_f32_16x16x32_bf16 v[172:175], v[72:75], v[28:31], v[172:175]
  s_nop 7
  v_cvt_pk_bf16_f32 v176, v144, v145
  v_cvt_pk_bf16_f32 v177, v146, v147
  ds_write_b64 v204, v[176:177] offset:0
  v_cvt_pk_bf16_f32 v178, v148, v149
  v_cvt_pk_bf16_f32 v179, v150, v151
  ds_write_b64 v205, v[178:179] offset:0
  v_cvt_pk_bf16_f32 v180, v152, v153
  v_cvt_pk_bf16_f32 v181, v154, v155
  ds_write_b64 v206, v[180:181] offset:0
  v_cvt_pk_bf16_f32 v182, v156, v157
  v_cvt_pk_bf16_f32 v183, v158, v159
  ds_write_b64 v207, v[182:183] offset:0
  v_cvt_pk_bf16_f32 v184, v160, v161
  v_cvt_pk_bf16_f32 v185, v162, v163
  ds_write_b64 v206, v[184:185] offset:512
  v_cvt_pk_bf16_f32 v186, v164, v165
  v_cvt_pk_bf16_f32 v187, v166, v167
  ds_write_b64 v207, v[186:187] offset:512
  v_cvt_pk_bf16_f32 v188, v168, v169
  v_cvt_pk_bf16_f32 v189, v170, v171
  ds_write_b64 v204, v[188:189] offset:512
  v_cvt_pk_bf16_f32 v190, v172, v173
  v_cvt_pk_bf16_f32 v191, v174, v175
  ds_write_b64 v205, v[190:191] offset:512
  s_waitcnt lgkmcnt(0)
  ds_read_b128 v[144:147], v208 offset:0
  ds_read_b128 v[148:151], v208 offset:1024
  ds_read_b128 v[152:155], v208 offset:2048
  ds_read_b128 v[156:159], v208 offset:3072
  s_waitcnt lgkmcnt(3)
  s_mov_b32 s58, 0
  buffer_store_dwordx4 v[144:147], v209, s[48:51], s58 offen sc1
  s_waitcnt lgkmcnt(2)
  s_mov_b32 s58, 16384
  buffer_store_dwordx4 v[148:151], v209, s[48:51], s58 offen sc1
  s_waitcnt lgkmcnt(1)
  s_mov_b32 s58, 32768
  buffer_store_dwordx4 v[152:155], v209, s[48:51], s58 offen sc1
  s_waitcnt lgkmcnt(0)
  s_mov_b32 s58, 49152
  buffer_store_dwordx4 v[156:159], v209, s[48:51], s58 offen sc1
L_kg_end:
  s_endpgm
.section .rodata,"a"
.p2align 6
.amdhsa_kernel k1_kernel
  .amdhsa_next_free_vgpr 256
  .amdhsa_next_free_sgpr 102
  .amdhsa_accum_offset 256
  .amdhsa_group_segment_fixed_size 0
  .amdhsa_kernarg_size 88
  .amdhsa_user_sgpr_count 2
  .amdhsa_user_sgpr_kernarg_segment_ptr 1
  .amdhsa_system_sgpr_workgroup_id_x 1
  .amdhsa_float_denorm_mode_32 3
.end_amdhsa_kernel
.p2align 6
.amdhsa_kernel k2_kernel
  .amdhsa_next_free_vgpr 256
  .amdhsa_next_free_sgpr 102
  .amdhsa_accum_offset 256
  .amdhsa_group_segment_fixed_size 0
  .amdhsa_kernarg_size 88
  .amdhsa_user_sgpr_count 2
  .amdhsa_user_sgpr_kernarg_segment_ptr 1
  .amdhsa_system_sgpr_workgroup_id_x 1
  .amdhsa_float_denorm_mode_32 3
.end_amdhsa_kernel
.p2align 6
.amdhsa_kernel k3_kernel
  .amdhsa_next_free_vgpr 256
  .amdhsa_next_free_sgpr 102
  .amdhsa_accum_offset 256
  .amdhsa_group_segment_fixed_size 0
  .amdhsa_kernarg_size 88
  .amdhsa_user_sgpr_count 2
  .amdhsa_user_sgpr_kernarg_segment_ptr 1
  .amdhsa_system_sgpr_workgroup_id_x 1
  .amdhsa_float_denorm_mode_32 3
.end_amdhsa_kernel
.p2align 6
.amdhsa_kernel kg_kernel
  .amdhsa_next_free_vgpr 256
  .amdhsa_next_free_sgpr 102
  .amdhsa_accum_offset 256
  .amdhsa_group_segment_fixed_size 0
  .amdhsa_kernarg_size 88
  .amdhsa_user_sgpr_count 2
  .amdhsa_user_sgpr_kernarg_segment_ptr 1
  .amdhsa_system_sgpr_workgroup_id_x 1
  .amdhsa_float_denorm_mode_32 3
.end_amdhsa_kernel
```
